```python
import torch

def _softmax(x, axis=-1):
    return torch.softmax(x, dim=axis)
def _gelu(x):
    return torch.nn.functional.gelu(x, approximate="tanh")
def _silu(x):
    return torch.nn.functional.silu(x)
def _sigmoid(x):
    return torch.sigmoid(x)
def _layernorm(x, axis=-1, eps=1e-5):
    m = x.mean(dim=axis, keepdim=True)
    v = x.var(dim=axis, keepdim=True, unbiased=False)
    return (x - m) / torch.sqrt(v + eps)
def _scatter_add(tgt, idx, src, axis=0):
    return tgt.clone().index_add_(axis, idx, src)
def _segment_sum(src, seg, n):
    out = torch.zeros((n,) + src.shape[1:], dtype=src.dtype)
    return out.index_add_(0, seg, src)
def _pad(x, pw):
    flat = tuple(v for pair in reversed(pw) for v in pair)
    return torch.nn.functional.pad(x, flat)

kernel_name = 'recurrent_scan__spectral_gfnet__dense_activation_silu__prompt'

def setup_inputs():

    _w = (lambda a: (lambda t: t.to(torch.bfloat16) if t.is_floating_point() else t)(torch.as_tensor(a)))
    def _A_setup():
        B, S, D = 1, 2048, 1024
        Df = D // 2 + 1
        return {
            "x": _w((lambda *s: torch.randn(*s, dtype=torch.bfloat16) * 0.05)(B, S, D)),
            "w_r": _w((lambda *s: torch.randn(*s, dtype=torch.bfloat16) * 3.2)(S, Df) * 0.02),
            "w_i": _w((lambda *s: torch.randn(*s, dtype=torch.bfloat16) * 3.2)(S, Df) * 0.02),
        }
    _A_in = _A_setup()

    def _B_setup():
        B, S, D, F = 1, 2048, 1024, 3584
        return {
            "x": _w((lambda *s: torch.randn(*s, dtype=torch.bfloat16) * 0.05)(B, S, D)),
            "w1": _w((lambda *s: torch.randn(*s, dtype=torch.bfloat16) * 3.2)(D, F) * (D ** -0.5)),
            "w2": _w((lambda *s: torch.randn(*s, dtype=torch.bfloat16) * 0.4)(F, D) * (F ** -0.5)),
        }
    _B_in = _B_setup()

    return {
        "A_x": _A_in["x"],
        "A_w_r": _A_in["w_r"],
        "A_w_i": _A_in["w_i"],
        "B_x": _B_in["x"],
        "B_w1": _B_in["w1"],
        "B_w2": _B_in["w2"],
    }

def reference(A_x, A_w_r, A_w_i, B_x, B_w1, B_w2):
    def _A_ref(x, w_r, w_i):
        B, S, D = x.shape
        X = (lambda x, axes=(-2,-1): torch.fft.rfft2(x.float(), dim=axes))(x, axes=(-2, -1))
        W = w_r + 1j * w_i
        X = X * W
        y = (lambda x, s, axes=(-2,-1): torch.fft.irfft2(x, s=s, dim=axes).to(torch.bfloat16))(X, (S, D), axes=(-2, -1))
        return y

    def _B_ref(x, w1, w2):
        h = torch.einsum("bsd,df->bsf", x, w1)
        h = _silu(h)
        out = torch.einsum("bsf,fd->bsd", h, w2)
        return out

    x = A_x
    xn = _layernorm(x, axis=-1)
    s = _A_ref(xn, A_w_r, A_w_i)
    g = _silu(_B_ref(xn, B_w1, B_w2))
    return x + s * g
```

```asm
; @launch kernel=ka_kernel grid=(256,1,1) block=(512,1,1) lds=163840
; @launch kernel=k3_kernel grid=(256,1,1) block=(512,1,1) lds=163840

.amdgcn_target "amdgcn-amd-amdhsa--gfx950"
.text
.globl ka_kernel
.p2align 8
.type ka_kernel,@function
ka_kernel:
    s_cmp_ge_u32 s2, 256
    s_cbranch_scc1 ka_done
    s_load_dwordx2 s[4:5], s[0:1], 0
    s_load_dwordx4 s[8:11], s[0:1], 8
    s_load_dwordx2 s[6:7], s[0:1], 64
    s_load_dwordx4 s[60:63], s[0:1], 32
    s_load_dwordx2 s[64:65], s[0:1], 56
    v_readfirstlane_b32 s25, v0
    v_and_b32 v1, 63, v0
    s_nop 2
    s_lshr_b32 s25, s25, 6
    s_and_b32 s20, s2, 7
    s_lshr_b32 s72, s2, 3
    s_and_b32 s22, s20, 1
    s_lshl_b32 s22, s22, 2
    s_and_b32 s23, s72, 3
    s_add_u32 s70, s22, s23
    s_lshr_b32 s23, s20, 1
    s_mul_i32 s23, s23, 7
    s_lshr_b32 s24, s72, 2
    s_add_u32 s71, s23, s24
    s_lshl_b32 s20, s20, 5
    s_add_u32 s20, s20, s72
    s_mov_b32 s73, s20
    s_cmp_ge_u32 s25, 4
    s_cbranch_scc1 ka_hi
    s_lshr_b32 s21, s20, 7
    s_lshl_b32 s21, s21, 4
    s_lshr_b32 s22, s20, 5
    s_and_b32 s22, s22, 1
    s_lshl_b32 s22, s22, 2
    s_add_u32 s21, s21, s22
    s_lshr_b32 s22, s25, 1
    s_lshl_b32 s22, s22, 3
    s_add_u32 s21, s21, s22
    s_and_b32 s22, s25, 1
    s_lshl_b32 s22, s22, 1
    s_add_u32 s21, s21, s22
    s_lshl_b32 s21, s21, 6
    s_lshr_b32 s22, s20, 6
    s_and_b32 s22, s22, 1
    s_lshl_b32 s22, s22, 5
    s_add_u32 s21, s21, s22
    s_and_b32 s22, s20, 31
    s_add_u32 s21, s21, s22
    s_lshl_b32 s21, s21, 11
    s_add_u32 s22, s21, 131072
    v_lshlrev_b32 v2, 4, v1
    s_waitcnt lgkmcnt(0)
    s_mov_b32 s12, s4
    s_mov_b32 s13, s5
    s_mov_b32 s14, 4194304
    s_mov_b32 s15, 0x20000
    buffer_load_dwordx4 v[8:11], v2, s[12:15], s21 offen
    buffer_load_dwordx4 v[12:15], v2, s[12:15], s21 offen offset:1024
    buffer_load_dwordx4 v[16:19], v2, s[12:15], s22 offen
    buffer_load_dwordx4 v[20:23], v2, s[12:15], s22 offen offset:1024
    s_getpc_b64 s[16:17]
    s_add_u32 s16, s16, tab_f1@rel32@lo+4
    s_addc_u32 s17, s17, tab_f1@rel32@hi+12
    s_mov_b32 s18, 16384
    s_mov_b32 s19, 0x20000
    s_mov_b32 s26, 4096
    s_mov_b32 s27, 8192
    s_mov_b32 s28, 12288
    buffer_load_dwordx4 v[64:67], v2, s[16:19], 0 offen offset:0
    buffer_load_dwordx4 v[68:71], v2, s[16:19], 0 offen offset:1024
    buffer_load_dwordx4 v[72:75], v2, s[16:19], 0 offen offset:2048
    buffer_load_dwordx4 v[76:79], v2, s[16:19], 0 offen offset:3072
    buffer_load_dwordx4 v[80:83], v2, s[16:19], s26 offen offset:0
    buffer_load_dwordx4 v[84:87], v2, s[16:19], s26 offen offset:1024
    buffer_load_dwordx4 v[88:91], v2, s[16:19], s26 offen offset:2048
    buffer_load_dwordx4 v[92:95], v2, s[16:19], s26 offen offset:3072
    buffer_load_dwordx4 v[96:99], v2, s[16:19], s27 offen offset:0
    buffer_load_dwordx4 v[100:103], v2, s[16:19], s27 offen offset:1024
    buffer_load_dwordx4 v[104:107], v2, s[16:19], s27 offen offset:2048
    buffer_load_dwordx4 v[108:111], v2, s[16:19], s27 offen offset:3072
    buffer_load_dwordx4 v[112:115], v2, s[16:19], s28 offen offset:0
    buffer_load_dwordx4 v[116:119], v2, s[16:19], s28 offen offset:1024
    buffer_load_dwordx4 v[120:123], v2, s[16:19], s28 offen offset:2048
    buffer_load_dwordx4 v[124:127], v2, s[16:19], s28 offen offset:3072
    s_lshl_b32 s33, s25, 12
    s_add_u32 s33, s33, 98304
    v_add_u32 v4, s33, v2
    v_lshrrev_b32 v5, 5, v1
    v_lshlrev_b32 v5, 3, v5
    v_bfe_u32 v6, v1, 2, 2
    v_add_u32 v5, v5, v6
    v_lshlrev_b32 v5, 6, v5
    v_bfe_u32 v6, v1, 4, 1
    v_lshlrev_b32 v6, 5, v6
    v_add_u32 v5, v5, v6
    v_and_b32 v6, 3, v1
    v_lshlrev_b32 v6, 3, v6
    v_add_u32 v5, v5, v6
    v_add_u32 v5, s33, v5
    v_and_b32 v6, 31, v1
    v_lshlrev_b32 v6, 4, v6
    v_lshrrev_b32 v7, 5, v1
    v_lshlrev_b32 v7, 11, v7
    v_add_u32 v6, v6, v7
    s_lshl_b32 s33, s25, 2
    s_add_u32 s33, s33, 114688
    v_add_u32 v6, s33, v6
    s_lshl_b32 s33, s25, 4
    s_add_u32 s33, s33, 131136
    v_mov_b32 v3, s33
    s_mov_b32 s34, 0xffff0000
    s_waitcnt vmcnt(16)
    v_lshlrev_b32 v24, 16, v8
    v_and_b32 v25, s34, v8
    v_lshlrev_b32 v26, 16, v9
    v_and_b32 v27, s34, v9
    v_lshlrev_b32 v28, 16, v10
    v_and_b32 v29, s34, v10
    v_lshlrev_b32 v30, 16, v11
    v_and_b32 v31, s34, v11
    v_lshlrev_b32 v32, 16, v12
    v_and_b32 v33, s34, v12
    v_lshlrev_b32 v34, 16, v13
    v_and_b32 v35, s34, v13
    v_lshlrev_b32 v36, 16, v14
    v_and_b32 v37, s34, v14
    v_lshlrev_b32 v38, 16, v15
    v_and_b32 v39, s34, v15
    v_lshlrev_b32 v40, 16, v16
    v_and_b32 v41, s34, v16
    v_lshlrev_b32 v42, 16, v17
    v_and_b32 v43, s34, v17
    v_lshlrev_b32 v44, 16, v18
    v_and_b32 v45, s34, v18
    v_lshlrev_b32 v46, 16, v19
    v_and_b32 v47, s34, v19
    v_lshlrev_b32 v48, 16, v20
    v_and_b32 v49, s34, v20
    v_lshlrev_b32 v50, 16, v21
    v_and_b32 v51, s34, v21
    v_lshlrev_b32 v52, 16, v22
    v_and_b32 v53, s34, v22
    v_lshlrev_b32 v54, 16, v23
    v_and_b32 v55, s34, v23
    v_add_f32 v56, v24, v25
    v_add_f32 v57, v40, v41
    v_add_f32 v56, v56, v26
    v_add_f32 v57, v57, v42
    v_add_f32 v56, v56, v27
    v_add_f32 v57, v57, v43
    v_add_f32 v56, v56, v28
    v_add_f32 v57, v57, v44
    v_add_f32 v56, v56, v29
    v_add_f32 v57, v57, v45
    v_add_f32 v56, v56, v30
    v_add_f32 v57, v57, v46
    v_add_f32 v56, v56, v31
    v_add_f32 v57, v57, v47
    v_add_f32 v56, v56, v32
    v_add_f32 v57, v57, v48
    v_add_f32 v56, v56, v33
    v_add_f32 v57, v57, v49
    v_add_f32 v56, v56, v34
    v_add_f32 v57, v57, v50
    v_add_f32 v56, v56, v35
    v_add_f32 v57, v57, v51
    v_add_f32 v56, v56, v36
    v_add_f32 v57, v57, v52
    v_add_f32 v56, v56, v37
    v_add_f32 v57, v57, v53
    v_add_f32 v56, v56, v38
    v_add_f32 v57, v57, v54
    v_add_f32 v56, v56, v39
    v_add_f32 v57, v57, v55
    s_nop 0
    v_add_f32_dpp v56, v56, v56 row_shr:1 row_mask:0xf bank_mask:0xf bound_ctrl:0
    v_add_f32_dpp v57, v57, v57 row_shr:1 row_mask:0xf bank_mask:0xf bound_ctrl:0
    s_nop 0
    v_add_f32_dpp v56, v56, v56 row_shr:2 row_mask:0xf bank_mask:0xf bound_ctrl:0
    v_add_f32_dpp v57, v57, v57 row_shr:2 row_mask:0xf bank_mask:0xf bound_ctrl:0
    s_nop 0
    v_add_f32_dpp v56, v56, v56 row_shr:4 row_mask:0xf bank_mask:0xf bound_ctrl:0
    v_add_f32_dpp v57, v57, v57 row_shr:4 row_mask:0xf bank_mask:0xf bound_ctrl:0
    s_nop 0
    v_add_f32_dpp v56, v56, v56 row_shr:8 row_mask:0xf bank_mask:0xf bound_ctrl:0
    v_add_f32_dpp v57, v57, v57 row_shr:8 row_mask:0xf bank_mask:0xf bound_ctrl:0
    s_nop 0
    v_add_f32_dpp v56, v56, v56 row_bcast:15 row_mask:0xa bank_mask:0xf
    v_add_f32_dpp v57, v57, v57 row_bcast:15 row_mask:0xa bank_mask:0xf
    s_nop 0
    v_add_f32_dpp v56, v56, v56 row_bcast:31 row_mask:0xc bank_mask:0xf
    v_add_f32_dpp v57, v57, v57 row_bcast:31 row_mask:0xc bank_mask:0xf
    v_readlane_b32 s44, v56, 63
    v_readlane_b32 s45, v57, 63
    v_mov_b32 v58, 0x3a800000
    v_mul_f32 v58, s44, v58
    v_mov_b32 v59, 0x3a800000
    v_mul_f32 v59, s45, v59
    v_sub_f32 v60, v24, v58
    v_mul_f32 v56, v60, v60
    v_sub_f32 v61, v40, v59
    v_mul_f32 v57, v61, v61
    v_sub_f32 v60, v25, v58
    v_fmac_f32 v56, v60, v60
    v_sub_f32 v61, v41, v59
    v_fmac_f32 v57, v61, v61
    v_sub_f32 v60, v26, v58
    v_fmac_f32 v56, v60, v60
    v_sub_f32 v61, v42, v59
    v_fmac_f32 v57, v61, v61
    v_sub_f32 v60, v27, v58
    v_fmac_f32 v56, v60, v60
    v_sub_f32 v61, v43, v59
    v_fmac_f32 v57, v61, v61
    v_sub_f32 v60, v28, v58
    v_fmac_f32 v56, v60, v60
    v_sub_f32 v61, v44, v59
    v_fmac_f32 v57, v61, v61
    v_sub_f32 v60, v29, v58
    v_fmac_f32 v56, v60, v60
    v_sub_f32 v61, v45, v59
    v_fmac_f32 v57, v61, v61
    v_sub_f32 v60, v30, v58
    v_fmac_f32 v56, v60, v60
    v_sub_f32 v61, v46, v59
    v_fmac_f32 v57, v61, v61
    v_sub_f32 v60, v31, v58
    v_fmac_f32 v56, v60, v60
    v_sub_f32 v61, v47, v59
    v_fmac_f32 v57, v61, v61
    v_sub_f32 v60, v32, v58
    v_fmac_f32 v56, v60, v60
    v_sub_f32 v61, v48, v59
    v_fmac_f32 v57, v61, v61
    v_sub_f32 v60, v33, v58
    v_fmac_f32 v56, v60, v60
    v_sub_f32 v61, v49, v59
    v_fmac_f32 v57, v61, v61
    v_sub_f32 v60, v34, v58
    v_fmac_f32 v56, v60, v60
    v_sub_f32 v61, v50, v59
    v_fmac_f32 v57, v61, v61
    v_sub_f32 v60, v35, v58
    v_fmac_f32 v56, v60, v60
    v_sub_f32 v61, v51, v59
    v_fmac_f32 v57, v61, v61
    v_sub_f32 v60, v36, v58
    v_fmac_f32 v56, v60, v60
    v_sub_f32 v61, v52, v59
    v_fmac_f32 v57, v61, v61
    v_sub_f32 v60, v37, v58
    v_fmac_f32 v56, v60, v60
    v_sub_f32 v61, v53, v59
    v_fmac_f32 v57, v61, v61
    v_sub_f32 v60, v38, v58
    v_fmac_f32 v56, v60, v60
    v_sub_f32 v61, v54, v59
    v_fmac_f32 v57, v61, v61
    v_sub_f32 v60, v39, v58
    v_fmac_f32 v56, v60, v60
    v_sub_f32 v61, v55, v59
    v_fmac_f32 v57, v61, v61
    v_add_f32_dpp v56, v56, v56 row_shr:1 row_mask:0xf bank_mask:0xf bound_ctrl:0
    s_nop 0
    v_add_f32_dpp v57, v57, v57 row_shr:1 row_mask:0xf bank_mask:0xf bound_ctrl:0
    v_add_f32_dpp v56, v56, v56 row_shr:2 row_mask:0xf bank_mask:0xf bound_ctrl:0
    s_nop 0
    v_add_f32_dpp v57, v57, v57 row_shr:2 row_mask:0xf bank_mask:0xf bound_ctrl:0
    v_add_f32_dpp v56, v56, v56 row_shr:4 row_mask:0xf bank_mask:0xf bound_ctrl:0
    s_nop 0
    v_add_f32_dpp v57, v57, v57 row_shr:4 row_mask:0xf bank_mask:0xf bound_ctrl:0
    v_add_f32_dpp v56, v56, v56 row_shr:8 row_mask:0xf bank_mask:0xf bound_ctrl:0
    s_nop 0
    v_add_f32_dpp v57, v57, v57 row_shr:8 row_mask:0xf bank_mask:0xf bound_ctrl:0
    v_add_f32_dpp v56, v56, v56 row_bcast:15 row_mask:0xa bank_mask:0xf
    s_nop 0
    v_add_f32_dpp v57, v57, v57 row_bcast:15 row_mask:0xa bank_mask:0xf
    v_add_f32_dpp v56, v56, v56 row_bcast:31 row_mask:0xc bank_mask:0xf
    s_nop 0
    v_add_f32_dpp v57, v57, v57 row_bcast:31 row_mask:0xc bank_mask:0xf
    v_readlane_b32 s46, v56, 63
    v_readlane_b32 s47, v57, 63
    v_cvt_pk_bf16_f32 v58, v58, v58
    v_and_b32 v58, s34, v58
    v_mov_b32 v60, 0x3a800000
    v_mul_f32 v60, s46, v60
    v_cvt_pk_bf16_f32 v60, v60, v60
    v_and_b32 v60, s34, v60
    v_add_f32 v60, 0x3727c5ac, v60
    v_cvt_pk_bf16_f32 v60, v60, v60
    v_and_b32 v60, s34, v60
    v_sqrt_f32 v60, v60
    s_nop 0
    v_cvt_pk_bf16_f32 v60, v60, v60
    v_and_b32 v60, s34, v60
    v_rcp_f32 v60, v60
    v_cvt_pk_bf16_f32 v59, v59, v59
    v_and_b32 v59, s34, v59
    v_mov_b32 v61, 0x3a800000
    v_mul_f32 v61, s47, v61
    v_cvt_pk_bf16_f32 v61, v61, v61
    v_and_b32 v61, s34, v61
    v_add_f32 v61, 0x3727c5ac, v61
    v_cvt_pk_bf16_f32 v61, v61, v61
    v_and_b32 v61, s34, v61
    v_sqrt_f32 v61, v61
    s_nop 0
    v_cvt_pk_bf16_f32 v61, v61, v61
    v_and_b32 v61, s34, v61
    v_rcp_f32 v61, v61
    s_mov_b64 exec, 1
    ds_write_b128 v3, v[58:61]
    s_mov_b64 exec, -1
    v_sub_f32 v24, v24, v58
    v_sub_f32 v25, v25, v58
    v_cvt_pk_bf16_f32 v62, v24, v25
    v_lshlrev_b32 v24, 16, v62
    v_and_b32 v25, s34, v62
    v_mul_f32 v24, v24, v60
    v_mul_f32 v25, v25, v60
    v_cvt_pk_bf16_f32 v8, v24, v25
    v_sub_f32 v40, v40, v59
    v_sub_f32 v41, v41, v59
    v_cvt_pk_bf16_f32 v63, v40, v41
    v_lshlrev_b32 v40, 16, v63
    v_and_b32 v41, s34, v63
    v_mul_f32 v40, v40, v61
    v_mul_f32 v41, v41, v61
    v_cvt_pk_bf16_f32 v16, v40, v41
    v_sub_f32 v26, v26, v58
    v_sub_f32 v27, v27, v58
    v_cvt_pk_bf16_f32 v62, v26, v27
    v_lshlrev_b32 v26, 16, v62
    v_and_b32 v27, s34, v62
    v_mul_f32 v26, v26, v60
    v_mul_f32 v27, v27, v60
    v_cvt_pk_bf16_f32 v9, v26, v27
    v_sub_f32 v42, v42, v59
    v_sub_f32 v43, v43, v59
    v_cvt_pk_bf16_f32 v63, v42, v43
    v_lshlrev_b32 v42, 16, v63
    v_and_b32 v43, s34, v63
    v_mul_f32 v42, v42, v61
    v_mul_f32 v43, v43, v61
    v_cvt_pk_bf16_f32 v17, v42, v43
    v_sub_f32 v28, v28, v58
    v_sub_f32 v29, v29, v58
    v_cvt_pk_bf16_f32 v62, v28, v29
    v_lshlrev_b32 v28, 16, v62
    v_and_b32 v29, s34, v62
    v_mul_f32 v28, v28, v60
    v_mul_f32 v29, v29, v60
    v_cvt_pk_bf16_f32 v10, v28, v29
    v_sub_f32 v44, v44, v59
    v_sub_f32 v45, v45, v59
    v_cvt_pk_bf16_f32 v63, v44, v45
    v_lshlrev_b32 v44, 16, v63
    v_and_b32 v45, s34, v63
    v_mul_f32 v44, v44, v61
    v_mul_f32 v45, v45, v61
    v_cvt_pk_bf16_f32 v18, v44, v45
    v_sub_f32 v30, v30, v58
    v_sub_f32 v31, v31, v58
    v_cvt_pk_bf16_f32 v62, v30, v31
    v_lshlrev_b32 v30, 16, v62
    v_and_b32 v31, s34, v62
    v_mul_f32 v30, v30, v60
    v_mul_f32 v31, v31, v60
    v_cvt_pk_bf16_f32 v11, v30, v31
    v_sub_f32 v46, v46, v59
    v_sub_f32 v47, v47, v59
    v_cvt_pk_bf16_f32 v63, v46, v47
    v_lshlrev_b32 v46, 16, v63
    v_and_b32 v47, s34, v63
    v_mul_f32 v46, v46, v61
    v_mul_f32 v47, v47, v61
    v_cvt_pk_bf16_f32 v19, v46, v47
    v_sub_f32 v32, v32, v58
    v_sub_f32 v33, v33, v58
    v_cvt_pk_bf16_f32 v62, v32, v33
    v_lshlrev_b32 v32, 16, v62
    v_and_b32 v33, s34, v62
    v_mul_f32 v32, v32, v60
    v_mul_f32 v33, v33, v60
    v_cvt_pk_bf16_f32 v12, v32, v33
    v_sub_f32 v48, v48, v59
    v_sub_f32 v49, v49, v59
    v_cvt_pk_bf16_f32 v63, v48, v49
    v_lshlrev_b32 v48, 16, v63
    v_and_b32 v49, s34, v63
    v_mul_f32 v48, v48, v61
    v_mul_f32 v49, v49, v61
    v_cvt_pk_bf16_f32 v20, v48, v49
    v_sub_f32 v34, v34, v58
    v_sub_f32 v35, v35, v58
    v_cvt_pk_bf16_f32 v62, v34, v35
    v_lshlrev_b32 v34, 16, v62
    v_and_b32 v35, s34, v62
    v_mul_f32 v34, v34, v60
    v_mul_f32 v35, v35, v60
    v_cvt_pk_bf16_f32 v13, v34, v35
    v_sub_f32 v50, v50, v59
    v_sub_f32 v51, v51, v59
    v_cvt_pk_bf16_f32 v63, v50, v51
    v_lshlrev_b32 v50, 16, v63
    v_and_b32 v51, s34, v63
    v_mul_f32 v50, v50, v61
    v_mul_f32 v51, v51, v61
    v_cvt_pk_bf16_f32 v21, v50, v51
    v_sub_f32 v36, v36, v58
    v_sub_f32 v37, v37, v58
    v_cvt_pk_bf16_f32 v62, v36, v37
    v_lshlrev_b32 v36, 16, v62
    v_and_b32 v37, s34, v62
    v_mul_f32 v36, v36, v60
    v_mul_f32 v37, v37, v60
    v_cvt_pk_bf16_f32 v14, v36, v37
    v_sub_f32 v52, v52, v59
    v_sub_f32 v53, v53, v59
    v_cvt_pk_bf16_f32 v63, v52, v53
    v_lshlrev_b32 v52, 16, v63
    v_and_b32 v53, s34, v63
    v_mul_f32 v52, v52, v61
    v_mul_f32 v53, v53, v61
    v_cvt_pk_bf16_f32 v22, v52, v53
    v_sub_f32 v38, v38, v58
    v_sub_f32 v39, v39, v58
    v_cvt_pk_bf16_f32 v62, v38, v39
    v_lshlrev_b32 v38, 16, v62
    v_and_b32 v39, s34, v62
    v_mul_f32 v38, v38, v60
    v_mul_f32 v39, v39, v60
    v_cvt_pk_bf16_f32 v15, v38, v39
    v_sub_f32 v54, v54, v59
    v_sub_f32 v55, v55, v59
    v_cvt_pk_bf16_f32 v63, v54, v55
    v_lshlrev_b32 v54, 16, v63
    v_and_b32 v55, s34, v63
    v_mul_f32 v54, v54, v61
    v_mul_f32 v55, v55, v61
    v_cvt_pk_bf16_f32 v23, v54, v55
    ds_write_b128 v4, v[8:11] offset:0
    ds_write_b128 v4, v[12:15] offset:1024
    ds_write_b128 v4, v[16:19] offset:2048
    ds_write_b128 v4, v[20:23] offset:3072
    s_waitcnt lgkmcnt(0)
    ds_read_b64_tr_b16 v[24:25], v5 offset:0
    ds_read_b64_tr_b16 v[26:27], v5 offset:256
    ds_read_b64_tr_b16 v[28:29], v5 offset:1024
    ds_read_b64_tr_b16 v[30:31], v5 offset:1280
    ds_read_b64_tr_b16 v[40:41], v5 offset:2048
    ds_read_b64_tr_b16 v[42:43], v5 offset:2304
    ds_read_b64_tr_b16 v[44:45], v5 offset:3072
    ds_read_b64_tr_b16 v[46:47], v5 offset:3328
    s_waitcnt vmcnt(0) lgkmcnt(0)
    v_mfma_f32_32x32x16_bf16 v[128:143], v[24:27], v[64:67], 0
    v_mfma_f32_32x32x16_bf16 v[128:143], v[28:31], v[68:71], v[128:143]
    v_mfma_f32_32x32x16_bf16 v[144:159], v[24:27], v[72:75], 0
    v_mfma_f32_32x32x16_bf16 v[144:159], v[28:31], v[76:79], v[144:159]
    v_mfma_f32_32x32x16_bf16 v[160:175], v[40:43], v[64:67], 0
    v_mfma_f32_32x32x16_bf16 v[160:175], v[44:47], v[68:71], v[160:175]
    v_mfma_f32_32x32x16_bf16 v[176:191], v[40:43], v[72:75], 0
    v_mfma_f32_32x32x16_bf16 v[176:191], v[44:47], v[76:79], v[176:191]
    s_nop 5
    v_sub_f32 v56, v128, v129
    v_add_f32 v56, v56, v130
    v_sub_f32 v56, v56, v131
    v_add_f32 v56, v56, v132
    v_sub_f32 v56, v56, v133
    v_add_f32 v56, v56, v134
    v_sub_f32 v56, v56, v135
    v_add_f32 v56, v56, v136
    v_sub_f32 v56, v56, v137
    v_add_f32 v56, v56, v138
    v_sub_f32 v56, v56, v139
    v_add_f32 v56, v56, v140
    v_sub_f32 v56, v56, v141
    v_add_f32 v56, v56, v142
    v_sub_f32 v56, v56, v143
    v_sub_f32 v57, v160, v161
    v_add_f32 v57, v57, v162
    v_sub_f32 v57, v57, v163
    v_add_f32 v57, v57, v164
    v_sub_f32 v57, v57, v165
    v_add_f32 v57, v57, v166
    v_sub_f32 v57, v57, v167
    v_add_f32 v57, v57, v168
    v_sub_f32 v57, v57, v169
    v_add_f32 v57, v57, v170
    v_sub_f32 v57, v57, v171
    v_add_f32 v57, v57, v172
    v_sub_f32 v57, v57, v173
    v_add_f32 v57, v57, v174
    v_sub_f32 v57, v57, v175
    v_mul_f32 v58, v144, v112
    v_mul_f32 v59, v144, v96
    v_fma_f32 v144, v128, v112, v59
    v_fma_f32 v128, v128, v96, -v58
    v_mul_f32 v60, v145, v113
    v_mul_f32 v61, v145, v97
    v_fma_f32 v145, v129, v113, v61
    v_fma_f32 v129, v129, v97, -v60
    v_cvt_pk_bf16_f32 v192, v128, v129
    v_cvt_pk_bf16_f32 v200, v144, v145
    v_mul_f32 v58, v146, v114
    v_mul_f32 v59, v146, v98
    v_fma_f32 v146, v130, v114, v59
    v_fma_f32 v130, v130, v98, -v58
    v_mul_f32 v60, v147, v115
    v_mul_f32 v61, v147, v99
    v_fma_f32 v147, v131, v115, v61
    v_fma_f32 v131, v131, v99, -v60
    v_cvt_pk_bf16_f32 v193, v130, v131
    v_cvt_pk_bf16_f32 v201, v146, v147
    v_mul_f32 v58, v148, v116
    v_mul_f32 v59, v148, v100
    v_fma_f32 v148, v132, v116, v59
    v_fma_f32 v132, v132, v100, -v58
    v_mul_f32 v60, v149, v117
    v_mul_f32 v61, v149, v101
    v_fma_f32 v149, v133, v117, v61
    v_fma_f32 v133, v133, v101, -v60
    v_cvt_pk_bf16_f32 v194, v132, v133
    v_cvt_pk_bf16_f32 v202, v148, v149
    v_mul_f32 v58, v150, v118
    v_mul_f32 v59, v150, v102
    v_fma_f32 v150, v134, v118, v59
    v_fma_f32 v134, v134, v102, -v58
    v_mul_f32 v60, v151, v119
    v_mul_f32 v61, v151, v103
    v_fma_f32 v151, v135, v119, v61
    v_fma_f32 v135, v135, v103, -v60
    v_cvt_pk_bf16_f32 v195, v134, v135
    v_cvt_pk_bf16_f32 v203, v150, v151
    v_mul_f32 v58, v152, v120
    v_mul_f32 v59, v152, v104
    v_fma_f32 v152, v136, v120, v59
    v_fma_f32 v136, v136, v104, -v58
    v_mul_f32 v60, v153, v121
    v_mul_f32 v61, v153, v105
    v_fma_f32 v153, v137, v121, v61
    v_fma_f32 v137, v137, v105, -v60
    v_cvt_pk_bf16_f32 v196, v136, v137
    v_cvt_pk_bf16_f32 v204, v152, v153
    v_mul_f32 v58, v154, v122
    v_mul_f32 v59, v154, v106
    v_fma_f32 v154, v138, v122, v59
    v_fma_f32 v138, v138, v106, -v58
    v_mul_f32 v60, v155, v123
    v_mul_f32 v61, v155, v107
    v_fma_f32 v155, v139, v123, v61
    v_fma_f32 v139, v139, v107, -v60
    v_cvt_pk_bf16_f32 v197, v138, v139
    v_cvt_pk_bf16_f32 v205, v154, v155
    v_mul_f32 v58, v156, v124
    v_mul_f32 v59, v156, v108
    v_fma_f32 v156, v140, v124, v59
    v_fma_f32 v140, v140, v108, -v58
    v_mul_f32 v60, v157, v125
    v_mul_f32 v61, v157, v109
    v_fma_f32 v157, v141, v125, v61
    v_fma_f32 v141, v141, v109, -v60
    v_cvt_pk_bf16_f32 v198, v140, v141
    v_cvt_pk_bf16_f32 v206, v156, v157
    v_mul_f32 v58, v158, v126
    v_mul_f32 v59, v158, v110
    v_fma_f32 v158, v142, v126, v59
    v_fma_f32 v142, v142, v110, -v58
    v_mul_f32 v60, v159, v127
    v_mul_f32 v61, v159, v111
    v_fma_f32 v159, v143, v127, v61
    v_fma_f32 v143, v143, v111, -v60
    v_cvt_pk_bf16_f32 v199, v142, v143
    v_cvt_pk_bf16_f32 v207, v158, v159
    v_mul_f32 v58, v176, v112
    v_mul_f32 v59, v176, v96
    v_fma_f32 v176, v160, v112, v59
    v_fma_f32 v160, v160, v96, -v58
    v_mul_f32 v60, v177, v113
    v_mul_f32 v61, v177, v97
    v_fma_f32 v177, v161, v113, v61
    v_fma_f32 v161, v161, v97, -v60
    v_cvt_pk_bf16_f32 v208, v160, v161
    v_cvt_pk_bf16_f32 v216, v176, v177
    v_mul_f32 v58, v178, v114
    v_mul_f32 v59, v178, v98
    v_fma_f32 v178, v162, v114, v59
    v_fma_f32 v162, v162, v98, -v58
    v_mul_f32 v60, v179, v115
    v_mul_f32 v61, v179, v99
    v_fma_f32 v179, v163, v115, v61
    v_fma_f32 v163, v163, v99, -v60
    v_cvt_pk_bf16_f32 v209, v162, v163
    v_cvt_pk_bf16_f32 v217, v178, v179
    v_mul_f32 v58, v180, v116
    v_mul_f32 v59, v180, v100
    v_fma_f32 v180, v164, v116, v59
    v_fma_f32 v164, v164, v100, -v58
    v_mul_f32 v60, v181, v117
    v_mul_f32 v61, v181, v101
    v_fma_f32 v181, v165, v117, v61
    v_fma_f32 v165, v165, v101, -v60
    v_cvt_pk_bf16_f32 v210, v164, v165
    v_cvt_pk_bf16_f32 v218, v180, v181
    v_mul_f32 v58, v182, v118
    v_mul_f32 v59, v182, v102
    v_fma_f32 v182, v166, v118, v59
    v_fma_f32 v166, v166, v102, -v58
    v_mul_f32 v60, v183, v119
    v_mul_f32 v61, v183, v103
    v_fma_f32 v183, v167, v119, v61
    v_fma_f32 v167, v167, v103, -v60
    v_cvt_pk_bf16_f32 v211, v166, v167
    v_cvt_pk_bf16_f32 v219, v182, v183
    v_mul_f32 v58, v184, v120
    v_mul_f32 v59, v184, v104
    v_fma_f32 v184, v168, v120, v59
    v_fma_f32 v168, v168, v104, -v58
    v_mul_f32 v60, v185, v121
    v_mul_f32 v61, v185, v105
    v_fma_f32 v185, v169, v121, v61
    v_fma_f32 v169, v169, v105, -v60
    v_cvt_pk_bf16_f32 v212, v168, v169
    v_cvt_pk_bf16_f32 v220, v184, v185
    v_mul_f32 v58, v186, v122
    v_mul_f32 v59, v186, v106
    v_fma_f32 v186, v170, v122, v59
    v_fma_f32 v170, v170, v106, -v58
    v_mul_f32 v60, v187, v123
    v_mul_f32 v61, v187, v107
    v_fma_f32 v187, v171, v123, v61
    v_fma_f32 v171, v171, v107, -v60
    v_cvt_pk_bf16_f32 v213, v170, v171
    v_cvt_pk_bf16_f32 v221, v186, v187
    v_mul_f32 v58, v188, v124
    v_mul_f32 v59, v188, v108
    v_fma_f32 v188, v172, v124, v59
    v_fma_f32 v172, v172, v108, -v58
    v_mul_f32 v60, v189, v125
    v_mul_f32 v61, v189, v109
    v_fma_f32 v189, v173, v125, v61
    v_fma_f32 v173, v173, v109, -v60
    v_cvt_pk_bf16_f32 v214, v172, v173
    v_cvt_pk_bf16_f32 v222, v188, v189
    v_mul_f32 v58, v190, v126
    v_mul_f32 v59, v190, v110
    v_fma_f32 v190, v174, v126, v59
    v_fma_f32 v174, v174, v110, -v58
    v_mul_f32 v60, v191, v127
    v_mul_f32 v61, v191, v111
    v_fma_f32 v191, v175, v127, v61
    v_fma_f32 v175, v175, v111, -v60
    v_cvt_pk_bf16_f32 v215, v174, v175
    v_cvt_pk_bf16_f32 v223, v190, v191
    v_mfma_f32_32x32x16_bf16 v[128:143], v[80:83], v[192:195], 0
    v_mfma_f32_32x32x16_bf16 v[128:143], v[84:87], v[196:199], v[128:143]
    v_mfma_f32_32x32x16_bf16 v[128:143], v[88:91], v[200:203], v[128:143]
    v_mfma_f32_32x32x16_bf16 v[128:143], v[92:95], v[204:207], v[128:143]
    v_mfma_f32_32x32x16_bf16 v[160:175], v[80:83], v[208:211], 0
    v_mfma_f32_32x32x16_bf16 v[160:175], v[84:87], v[212:215], v[160:175]
    v_mfma_f32_32x32x16_bf16 v[160:175], v[88:91], v[216:219], v[160:175]
    v_mfma_f32_32x32x16_bf16 v[160:175], v[92:95], v[220:223], v[160:175]
    v_readlane_b32 s44, v56, 32
    v_readlane_b32 s45, v57, 32
    s_nop 0
    v_add_f32 v56, s44, v56
    v_add_f32 v57, s45, v57
    v_cvt_pk_bf16_f32 v56, v56, v57
    s_lshl_b32 s33, s25, 2
    s_add_u32 s33, s33, 122880
    v_mov_b32 v58, s33
    v_cmp_eq_u32 vcc, 0, v1
    v_mov_b32 v59, 1.0
    v_mov_b32 v60, 0.5
    v_cndmask_b32 v59, v59, v60, vcc
    v_mul_f32 v128, v128, v59
    v_mul_f32 v160, v160, v59
    v_cvt_pk_bf16_f32 v60, v128, v160
    v_cvt_pk_bf16_f32 v61, v136, v168
    ds_write2st64_b32 v6, v60, v61 offset0:0 offset1:32
    v_cvt_pk_bf16_f32 v62, v129, v161
    v_cvt_pk_bf16_f32 v63, v137, v169
    ds_write2st64_b32 v6, v62, v63 offset0:2 offset1:34
    v_cvt_pk_bf16_f32 v60, v130, v162
    v_cvt_pk_bf16_f32 v61, v138, v170
    ds_write2st64_b32 v6, v60, v61 offset0:4 offset1:36
    v_cvt_pk_bf16_f32 v62, v131, v163
    v_cvt_pk_bf16_f32 v63, v139, v171
    ds_write2st64_b32 v6, v62, v63 offset0:6 offset1:38
    v_cvt_pk_bf16_f32 v60, v132, v164
    v_cvt_pk_bf16_f32 v61, v140, v172
    ds_write2st64_b32 v6, v60, v61 offset0:16 offset1:48
    v_cvt_pk_bf16_f32 v62, v133, v165
    v_cvt_pk_bf16_f32 v63, v141, v173
    ds_write2st64_b32 v6, v62, v63 offset0:18 offset1:50
    v_cvt_pk_bf16_f32 v60, v134, v166
    v_cvt_pk_bf16_f32 v61, v142, v174
    ds_write2st64_b32 v6, v60, v61 offset0:20 offset1:52
    v_cvt_pk_bf16_f32 v62, v135, v167
    v_cvt_pk_bf16_f32 v63, v143, v175
    ds_write2st64_b32 v6, v62, v63 offset0:22 offset1:54
    s_mov_b64 exec, 1
    ds_write_b32 v58, v56
    s_mov_b64 exec, -1
    s_waitcnt lgkmcnt(0)
    s_barrier
    s_cmp_ge_u32 s72, 28
    s_cbranch_scc1 ka_f2lo
    v_mov_b32 v230, v1
    s_and_b32 s26, s25, 1
    s_lshr_b32 s27, s25, 1
    v_and_b32 v231, 15, v230
    v_lshrrev_b32 v232, 4, v230
    v_lshrrev_b32 v233, 1, v231
    v_xor_b32 v233, v233, v232
    v_lshlrev_b32 v233, 4, v233
    v_lshlrev_b32 v234, 7, v231
    v_add_u32 v233, v233, v234
    s_lshl_b32 s28, s26, 14
    v_add_u32 v224, s28, v233
    v_xor_b32 v225, 64, v224
    v_lshrrev_b32 v233, 2, v231
    v_and_b32 v234, 1, v232
    v_lshlrev_b32 v234, 2, v234
    v_or_b32 v234, v234, v233
    v_lshlrev_b32 v232, 3, v232
    v_add_u32 v232, v232, v233
    v_lshlrev_b32 v232, 8, v232
    v_and_b32 v231, 3, v231
    v_lshlrev_b32 v231, 3, v231
    v_add_u32 v232, v232, v231
    v_add_u32 v232, 32768, v232
    s_lshl_b32 s28, s27, 2
    s_lshl_b32 s29, s26, 1
    s_add_u32 s28, s28, s29
    s_xor_b32 s29, s28, 0
    v_xor_b32 v231, s29, v234
    v_lshlrev_b32 v231, 5, v231
    v_add_u32 v226, v231, v232
    s_xor_b32 s29, s28, 1
    v_xor_b32 v231, s29, v234
    v_lshlrev_b32 v231, 5, v231
    v_add_u32 v227, v231, v232
    s_xor_b32 s29, s28, 2
    v_xor_b32 v231, s29, v234
    v_lshlrev_b32 v231, 5, v231
    v_add_u32 v228, v231, v232
    s_xor_b32 s29, s28, 3
    v_xor_b32 v231, s29, v234
    v_lshlrev_b32 v231, 5, v231
    v_add_u32 v229, v231, v232
    v_mov_b32 v0, 0
    v_mov_b32 v1, 0
    v_mov_b32 v2, 0
    v_mov_b32 v3, 0
    v_mov_b32 v4, 0
    v_mov_b32 v5, 0
    v_mov_b32 v6, 0
    v_mov_b32 v7, 0
    v_mov_b32 v8, 0
    v_mov_b32 v9, 0
    v_mov_b32 v10, 0
    v_mov_b32 v11, 0
    v_mov_b32 v12, 0
    v_mov_b32 v13, 0
    v_mov_b32 v14, 0
    v_mov_b32 v15, 0
    v_mov_b32 v16, 0
    v_mov_b32 v17, 0
    v_mov_b32 v18, 0
    v_mov_b32 v19, 0
    v_mov_b32 v20, 0
    v_mov_b32 v21, 0
    v_mov_b32 v22, 0
    v_mov_b32 v23, 0
    v_mov_b32 v24, 0
    v_mov_b32 v25, 0
    v_mov_b32 v26, 0
    v_mov_b32 v27, 0
    v_mov_b32 v28, 0
    v_mov_b32 v29, 0
    v_mov_b32 v30, 0
    v_mov_b32 v31, 0
    v_mov_b32 v32, 0
    v_mov_b32 v33, 0
    v_mov_b32 v34, 0
    v_mov_b32 v35, 0
    v_mov_b32 v36, 0
    v_mov_b32 v37, 0
    v_mov_b32 v38, 0
    v_mov_b32 v39, 0
    v_mov_b32 v40, 0
    v_mov_b32 v41, 0
    v_mov_b32 v42, 0
    v_mov_b32 v43, 0
    v_mov_b32 v44, 0
    v_mov_b32 v45, 0
    v_mov_b32 v46, 0
    v_mov_b32 v47, 0
    v_mov_b32 v48, 0
    v_mov_b32 v49, 0
    v_mov_b32 v50, 0
    v_mov_b32 v51, 0
    v_mov_b32 v52, 0
    v_mov_b32 v53, 0
    v_mov_b32 v54, 0
    v_mov_b32 v55, 0
    v_mov_b32 v56, 0
    v_mov_b32 v57, 0
    v_mov_b32 v58, 0
    v_mov_b32 v59, 0
    v_mov_b32 v60, 0
    v_mov_b32 v61, 0
    v_mov_b32 v62, 0
    v_mov_b32 v63, 0
    v_mov_b32 v64, 0
    v_mov_b32 v65, 0
    v_mov_b32 v66, 0
    v_mov_b32 v67, 0
    v_mov_b32 v68, 0
    v_mov_b32 v69, 0
    v_mov_b32 v70, 0
    v_mov_b32 v71, 0
    v_mov_b32 v72, 0
    v_mov_b32 v73, 0
    v_mov_b32 v74, 0
    v_mov_b32 v75, 0
    v_mov_b32 v76, 0
    v_mov_b32 v77, 0
    v_mov_b32 v78, 0
    v_mov_b32 v79, 0
    v_mov_b32 v80, 0
    v_mov_b32 v81, 0
    v_mov_b32 v82, 0
    v_mov_b32 v83, 0
    v_mov_b32 v84, 0
    v_mov_b32 v85, 0
    v_mov_b32 v86, 0
    v_mov_b32 v87, 0
    v_mov_b32 v88, 0
    v_mov_b32 v89, 0
    v_mov_b32 v90, 0
    v_mov_b32 v91, 0
    v_mov_b32 v92, 0
    v_mov_b32 v93, 0
    v_mov_b32 v94, 0
    v_mov_b32 v95, 0
    v_mov_b32 v96, 0
    v_mov_b32 v97, 0
    v_mov_b32 v98, 0
    v_mov_b32 v99, 0
    v_mov_b32 v100, 0
    v_mov_b32 v101, 0
    v_mov_b32 v102, 0
    v_mov_b32 v103, 0
    v_mov_b32 v104, 0
    v_mov_b32 v105, 0
    v_mov_b32 v106, 0
    v_mov_b32 v107, 0
    v_mov_b32 v108, 0
    v_mov_b32 v109, 0
    v_mov_b32 v110, 0
    v_mov_b32 v111, 0
    v_mov_b32 v112, 0
    v_mov_b32 v113, 0
    v_mov_b32 v114, 0
    v_mov_b32 v115, 0
    v_mov_b32 v116, 0
    v_mov_b32 v117, 0
    v_mov_b32 v118, 0
    v_mov_b32 v119, 0
    v_mov_b32 v120, 0
    v_mov_b32 v121, 0
    v_mov_b32 v122, 0
    v_mov_b32 v123, 0
    v_mov_b32 v124, 0
    v_mov_b32 v125, 0
    v_mov_b32 v126, 0
    v_mov_b32 v127, 0
    v_mov_b32 v236, 0x3f803f80
    v_mov_b32 v237, 0x3f803f80
    v_mov_b32 v238, 0x3f803f80
    v_mov_b32 v239, 0x3f803f80
    v_mov_b32 v240, 0
    v_mov_b32 v241, 0
    v_mov_b32 v242, 0
    v_mov_b32 v243, 0
    v_mov_b32 v244, 0
    v_mov_b32 v245, 0
    v_mov_b32 v246, 0
    v_mov_b32 v247, 0
    s_and_b32 s28, s73, 0xfc
    v_mov_b32 v248, s28
    v_mov_b32 v249, 1
    s_cmp_eq_u32 s25, 0
    s_cselect_b32 s37, 1, -1
    s_barrier
    ds_read_b64_tr_b16 v[160:161], v226 offset:0
    ds_read_b128 v[128:131], v224 offset:0
    ds_read_b64_tr_b16 v[162:163], v226 offset:1024
    ds_read_b128 v[132:135], v224 offset:2048
    ds_read_b64_tr_b16 v[164:165], v227 offset:0
    ds_read_b128 v[136:139], v224 offset:4096
    ds_read_b64_tr_b16 v[166:167], v227 offset:1024
    ds_read_b128 v[140:143], v224 offset:6144
    ds_read_b64_tr_b16 v[168:169], v228 offset:0
    ds_read_b128 v[144:147], v224 offset:8192
    ds_read_b64_tr_b16 v[170:171], v228 offset:1024
    ds_read_b128 v[148:151], v224 offset:10240
    ds_read_b64_tr_b16 v[172:173], v229 offset:0
    ds_read_b128 v[152:155], v224 offset:12288
    ds_read_b64_tr_b16 v[174:175], v229 offset:1024
    ds_read_b128 v[156:159], v224 offset:14336
    s_mov_b32 s30, 0
    s_mov_b32 s31, 0
    s_waitcnt lgkmcnt(0)
ka_cloop:
    s_add_u32 s32, s31, 49152
    s_cmp_eq_u32 s32, 147456
    s_cselect_b32 s32, 0, s32
    s_sub_u32 s33, s32, s31
    s_mov_b32 s31, s32
    v_mfma_f32_16x16x32_bf16 v[0:3], v[160:163], v[128:131], v[0:3]
    ds_read_b64_tr_b16 v[208:209], v226 offset:8192
    v_mfma_f32_16x16x32_bf16 v[32:35], v[164:167], v[128:131], v[32:35]
    ds_read_b128 v[176:179], v225 offset:0
    v_mfma_f32_16x16x32_bf16 v[64:67], v[168:171], v[128:131], v[64:67]
    ds_read_b64_tr_b16 v[210:211], v226 offset:9216
    v_mfma_f32_16x16x32_bf16 v[96:99], v[172:175], v[128:131], v[96:99]
    ds_read_b128 v[180:183], v225 offset:2048
    v_mfma_f32_16x16x32_bf16 v[100:103], v[172:175], v[132:135], v[100:103]
    ds_read_b64_tr_b16 v[212:213], v227 offset:8192
    v_mfma_f32_16x16x32_bf16 v[68:71], v[168:171], v[132:135], v[68:71]
    ds_read_b128 v[184:187], v225 offset:4096
    v_mfma_f32_16x16x32_bf16 v[36:39], v[164:167], v[132:135], v[36:39]
    ds_read_b64_tr_b16 v[214:215], v227 offset:9216
    v_mfma_f32_16x16x32_bf16 v[4:7], v[160:163], v[132:135], v[4:7]
    ds_read_b128 v[188:191], v225 offset:6144
    v_mfma_f32_16x16x32_bf16 v[8:11], v[160:163], v[136:139], v[8:11]
    ds_read_b64_tr_b16 v[216:217], v228 offset:8192
    v_mfma_f32_16x16x32_bf16 v[40:43], v[164:167], v[136:139], v[40:43]
    ds_read_b128 v[192:195], v225 offset:8192
    v_mfma_f32_16x16x32_bf16 v[72:75], v[168:171], v[136:139], v[72:75]
    ds_read_b64_tr_b16 v[218:219], v228 offset:9216
    v_mfma_f32_16x16x32_bf16 v[104:107], v[172:175], v[136:139], v[104:107]
    ds_read_b128 v[196:199], v225 offset:10240
    v_mfma_f32_16x16x32_bf16 v[108:111], v[172:175], v[140:143], v[108:111]
    ds_read_b64_tr_b16 v[220:221], v229 offset:8192
    v_mfma_f32_16x16x32_bf16 v[76:79], v[168:171], v[140:143], v[76:79]
    ds_read_b128 v[200:203], v225 offset:12288
    v_mfma_f32_16x16x32_bf16 v[44:47], v[164:167], v[140:143], v[44:47]
    ds_read_b64_tr_b16 v[222:223], v229 offset:9216
    v_mfma_f32_16x16x32_bf16 v[12:15], v[160:163], v[140:143], v[12:15]
    ds_read_b128 v[204:207], v225 offset:14336
    v_mfma_f32_16x16x32_bf16 v[240:243], v[160:163], v[236:239], v[240:243]
    v_mfma_f32_16x16x32_bf16 v[16:19], v[160:163], v[144:147], v[16:19]
    v_mfma_f32_16x16x32_bf16 v[48:51], v[164:167], v[144:147], v[48:51]
    v_mfma_f32_16x16x32_bf16 v[80:83], v[168:171], v[144:147], v[80:83]
    v_mfma_f32_16x16x32_bf16 v[112:115], v[172:175], v[144:147], v[112:115]
    v_mfma_f32_16x16x32_bf16 v[116:119], v[172:175], v[148:151], v[116:119]
    v_mfma_f32_16x16x32_bf16 v[84:87], v[168:171], v[148:151], v[84:87]
    v_mfma_f32_16x16x32_bf16 v[52:55], v[164:167], v[148:151], v[52:55]
    v_mfma_f32_16x16x32_bf16 v[20:23], v[160:163], v[148:151], v[20:23]
    v_mfma_f32_16x16x32_bf16 v[24:27], v[160:163], v[152:155], v[24:27]
    v_mfma_f32_16x16x32_bf16 v[56:59], v[164:167], v[152:155], v[56:59]
    v_mfma_f32_16x16x32_bf16 v[88:91], v[168:171], v[152:155], v[88:91]
    v_mfma_f32_16x16x32_bf16 v[120:123], v[172:175], v[152:155], v[120:123]
    v_mfma_f32_16x16x32_bf16 v[244:247], v[164:167], v[236:239], v[244:247]
    v_mfma_f32_16x16x32_bf16 v[124:127], v[172:175], v[156:159], v[124:127]
    v_mfma_f32_16x16x32_bf16 v[92:95], v[168:171], v[156:159], v[92:95]
    v_mfma_f32_16x16x32_bf16 v[60:63], v[164:167], v[156:159], v[60:63]
    v_mfma_f32_16x16x32_bf16 v[28:31], v[160:163], v[156:159], v[28:31]
    v_add_u32 v224, s33, v224
    v_add_u32 v226, s33, v226
    v_add_u32 v227, s33, v227
    v_add_u32 v228, s33, v228
    v_add_u32 v229, s33, v229
    s_waitcnt lgkmcnt(0)
    s_barrier
    s_cmp_lg_u32 s30, s37
    s_cbranch_scc1 ka_nosig
    s_mov_b64 exec, 1
    global_atomic_add v248, v249, s[64:65] sc1
    s_mov_b64 exec, -1
ka_nosig:
    v_mfma_f32_16x16x32_bf16 v[0:3], v[208:211], v[176:179], v[0:3]
    ds_read_b64_tr_b16 v[160:161], v226 offset:0
    v_mfma_f32_16x16x32_bf16 v[32:35], v[212:215], v[176:179], v[32:35]
    ds_read_b128 v[128:131], v224 offset:0
    v_mfma_f32_16x16x32_bf16 v[64:67], v[216:219], v[176:179], v[64:67]
    ds_read_b64_tr_b16 v[162:163], v226 offset:1024
    v_mfma_f32_16x16x32_bf16 v[96:99], v[220:223], v[176:179], v[96:99]
    ds_read_b128 v[132:135], v224 offset:2048
    v_mfma_f32_16x16x32_bf16 v[100:103], v[220:223], v[180:183], v[100:103]
    ds_read_b64_tr_b16 v[164:165], v227 offset:0
    v_mfma_f32_16x16x32_bf16 v[68:71], v[216:219], v[180:183], v[68:71]
    ds_read_b128 v[136:139], v224 offset:4096
    v_mfma_f32_16x16x32_bf16 v[36:39], v[212:215], v[180:183], v[36:39]
    ds_read_b64_tr_b16 v[166:167], v227 offset:1024
    v_mfma_f32_16x16x32_bf16 v[4:7], v[208:211], v[180:183], v[4:7]
    ds_read_b128 v[140:143], v224 offset:6144
    v_mfma_f32_16x16x32_bf16 v[8:11], v[208:211], v[184:187], v[8:11]
    ds_read_b64_tr_b16 v[168:169], v228 offset:0
    v_mfma_f32_16x16x32_bf16 v[40:43], v[212:215], v[184:187], v[40:43]
    ds_read_b128 v[144:147], v224 offset:8192
    v_mfma_f32_16x16x32_bf16 v[72:75], v[216:219], v[184:187], v[72:75]
    ds_read_b64_tr_b16 v[170:171], v228 offset:1024
    v_mfma_f32_16x16x32_bf16 v[104:107], v[220:223], v[184:187], v[104:107]
    ds_read_b128 v[148:151], v224 offset:10240
    v_mfma_f32_16x16x32_bf16 v[108:111], v[220:223], v[188:191], v[108:111]
    ds_read_b64_tr_b16 v[172:173], v229 offset:0
    v_mfma_f32_16x16x32_bf16 v[76:79], v[216:219], v[188:191], v[76:79]
    ds_read_b128 v[152:155], v224 offset:12288
    v_mfma_f32_16x16x32_bf16 v[44:47], v[212:215], v[188:191], v[44:47]
    ds_read_b64_tr_b16 v[174:175], v229 offset:1024
    v_mfma_f32_16x16x32_bf16 v[12:15], v[208:211], v[188:191], v[12:15]
    ds_read_b128 v[156:159], v224 offset:14336
    v_mfma_f32_16x16x32_bf16 v[240:243], v[208:211], v[236:239], v[240:243]
    v_xor_b32 v225, 64, v224
    v_mfma_f32_16x16x32_bf16 v[16:19], v[208:211], v[192:195], v[16:19]
    v_mfma_f32_16x16x32_bf16 v[48:51], v[212:215], v[192:195], v[48:51]
    v_mfma_f32_16x16x32_bf16 v[80:83], v[216:219], v[192:195], v[80:83]
    v_mfma_f32_16x16x32_bf16 v[112:115], v[220:223], v[192:195], v[112:115]
    v_mfma_f32_16x16x32_bf16 v[116:119], v[220:223], v[196:199], v[116:119]
    v_mfma_f32_16x16x32_bf16 v[84:87], v[216:219], v[196:199], v[84:87]
    v_mfma_f32_16x16x32_bf16 v[52:55], v[212:215], v[196:199], v[52:55]
    v_mfma_f32_16x16x32_bf16 v[20:23], v[208:211], v[196:199], v[20:23]
    v_mfma_f32_16x16x32_bf16 v[24:27], v[208:211], v[200:203], v[24:27]
    v_mfma_f32_16x16x32_bf16 v[56:59], v[212:215], v[200:203], v[56:59]
    v_mfma_f32_16x16x32_bf16 v[88:91], v[216:219], v[200:203], v[88:91]
    v_mfma_f32_16x16x32_bf16 v[120:123], v[220:223], v[200:203], v[120:123]
    v_mfma_f32_16x16x32_bf16 v[244:247], v[212:215], v[236:239], v[244:247]
    v_mfma_f32_16x16x32_bf16 v[124:127], v[220:223], v[204:207], v[124:127]
    v_mfma_f32_16x16x32_bf16 v[92:95], v[216:219], v[204:207], v[92:95]
    v_mfma_f32_16x16x32_bf16 v[60:63], v[212:215], v[204:207], v[60:63]
    v_mfma_f32_16x16x32_bf16 v[28:31], v[208:211], v[204:207], v[28:31]
    s_add_u32 s30, s30, 1
    s_cmp_lt_u32 s30, 16
    s_waitcnt lgkmcnt(0)
    s_cbranch_scc1 ka_cloop
    s_lshl_b32 s28, s25, 11
    s_add_u32 s28, s28, 151552
    v_lshlrev_b32 v231, 5, v230
    v_add_u32 v232, s28, v231
    v_xor_b32 v233, 2048, v232
    ds_write_b128 v232, v[240:243]
    ds_write_b128 v232, v[244:247] offset:16
    v_and_b32 v231, 15, v230
    v_lshrrev_b32 v234, 1, v231
    v_lshlrev_b32 v234, 4, v234
    v_and_b32 v231, 1, v231
    v_lshlrev_b32 v231, 2, v231
    v_add_u32 v234, v234, v231
    s_lshl_b32 s28, s26, 10
    s_add_u32 s28, s28, 147456
    v_add_u32 v234, s28, v234
    s_add_u32 s12, s6, 20971520
    s_addc_u32 s13, s7, 0
    s_mov_b32 s14, 14680064
    s_mov_b32 s15, 0x20000
    s_lshl_b32 s28, s70, 4
    s_lshl_b32 s29, s26, 3
    s_add_u32 s28, s28, s29
    s_mul_i32 s28, s28, 112
    s_lshl_b32 s29, s71, 2
    s_add_u32 s28, s28, s29
    s_lshl_b32 s29, s27, 1
    s_add_u32 s28, s28, s29
    s_lshl_b32 s34, s28, 10
    v_and_b32 v231, 15, v230
    v_lshrrev_b32 v225, 4, v230
    v_and_b32 v224, 1, v225
    v_lshlrev_b32 v224, 1, v224
    v_lshrrev_b32 v225, 1, v225
    v_or_b32 v225, v225, v224
    v_lshlrev_b32 v225, 8, v225
    v_lshlrev_b32 v231, 4, v231
    v_add_u32 v224, v231, v225
    s_lshl_b32 s28, s26, 10
    v_add_u32 v224, s28, v224
    v_xor_b32 v225, 1024, v224
    s_mov_b32 s35, 0xbfb8aa3b
    v_mov_b32 v194, s35
    v_mov_b32 v195, s35
    s_waitcnt lgkmcnt(0)
    s_barrier
    v_mov_b32 v160, v240
    v_mov_b32 v161, v241
    v_mov_b32 v162, v242
    v_mov_b32 v163, v243
    v_mov_b32 v164, v244
    v_mov_b32 v165, v245
    v_mov_b32 v166, v246
    v_mov_b32 v167, v247
    ds_read_b128 v[168:171], v233
    ds_read_b128 v[172:175], v233 offset:16
    ds_read2_b32 v[176:177], v234 offset0:0 offset1:2
    ds_read2_b32 v[178:179], v234 offset0:32 offset1:34
    ds_read2_b32 v[180:181], v234 offset0:64 offset1:66
    ds_read2_b32 v[182:183], v234 offset0:96 offset1:98
    ds_read2_b32 v[184:185], v234 offset0:128 offset1:130
    ds_read2_b32 v[186:187], v234 offset0:160 offset1:162
    ds_read2_b32 v[188:189], v234 offset0:192 offset1:194
    ds_read2_b32 v[190:191], v234 offset0:224 offset1:226
    s_waitcnt lgkmcnt(0)
    v_mul_f32 v192, s35, v177
    v_pk_fma_f32 v[136:137], v[160:161], v[176:177], v[0:1] op_sel_hi:[1,0,1] neg_lo:[0,1,0] neg_hi:[0,1,0]
    v_pk_fma_f32 v[138:139], v[162:163], v[176:177], v[2:3] op_sel_hi:[1,0,1] neg_lo:[0,1,0] neg_hi:[0,1,0]
    v_pk_fma_f32 v[140:141], v[164:165], v[176:177], v[32:33] op_sel_hi:[1,0,1] neg_lo:[0,1,0] neg_hi:[0,1,0]
    v_pk_fma_f32 v[142:143], v[166:167], v[176:177], v[34:35] op_sel_hi:[1,0,1] neg_lo:[0,1,0] neg_hi:[0,1,0]
    v_pk_mul_f32 v[136:137], v[136:137], v[192:193] op_sel_hi:[1,0]
    v_pk_mul_f32 v[138:139], v[138:139], v[192:193] op_sel_hi:[1,0]
    v_pk_mul_f32 v[140:141], v[140:141], v[192:193] op_sel_hi:[1,0]
    v_pk_mul_f32 v[142:143], v[142:143], v[192:193] op_sel_hi:[1,0]
    v_exp_f32 v144, v136
    v_exp_f32 v145, v137
    v_exp_f32 v146, v138
    v_exp_f32 v147, v139
    v_exp_f32 v148, v140
    v_exp_f32 v149, v141
    v_exp_f32 v150, v142
    v_exp_f32 v151, v143
    v_pk_fma_f32 v[144:145], v[144:145], v[194:195], v[194:195]
    v_pk_fma_f32 v[146:147], v[146:147], v[194:195], v[194:195]
    v_pk_fma_f32 v[148:149], v[148:149], v[194:195], v[194:195]
    v_pk_fma_f32 v[150:151], v[150:151], v[194:195], v[194:195]
    v_rcp_f32 v144, v144
    v_rcp_f32 v145, v145
    v_rcp_f32 v146, v146
    v_rcp_f32 v147, v147
    v_rcp_f32 v148, v148
    v_rcp_f32 v149, v149
    v_rcp_f32 v150, v150
    v_rcp_f32 v151, v151
    v_pk_mul_f32 v[144:145], v[136:137], v[144:145]
    v_pk_mul_f32 v[146:147], v[138:139], v[146:147]
    v_pk_mul_f32 v[148:149], v[140:141], v[148:149]
    v_pk_mul_f32 v[150:151], v[142:143], v[150:151]
    v_cvt_pk_bf16_f32 v128, v144, v145
    v_cvt_pk_bf16_f32 v129, v146, v147
    v_cvt_pk_bf16_f32 v130, v148, v149
    v_cvt_pk_bf16_f32 v131, v150, v151
    s_nop 0
    v_permlane16_swap_b32 v128, v130
    v_permlane16_swap_b32 v129, v131
    s_add_u32 s36, s34, 0
    buffer_store_dwordx4 v[128:131], v224, s[12:15], s36 offen
    v_pk_fma_f32 v[204:205], v[168:169], v[176:177], v[64:65] op_sel_hi:[1,0,1] neg_lo:[0,1,0] neg_hi:[0,1,0]
    v_pk_fma_f32 v[206:207], v[170:171], v[176:177], v[66:67] op_sel_hi:[1,0,1] neg_lo:[0,1,0] neg_hi:[0,1,0]
    v_pk_fma_f32 v[208:209], v[172:173], v[176:177], v[96:97] op_sel_hi:[1,0,1] neg_lo:[0,1,0] neg_hi:[0,1,0]
    v_pk_fma_f32 v[210:211], v[174:175], v[176:177], v[98:99] op_sel_hi:[1,0,1] neg_lo:[0,1,0] neg_hi:[0,1,0]
    v_pk_mul_f32 v[204:205], v[204:205], v[192:193] op_sel_hi:[1,0]
    v_pk_mul_f32 v[206:207], v[206:207], v[192:193] op_sel_hi:[1,0]
    v_pk_mul_f32 v[208:209], v[208:209], v[192:193] op_sel_hi:[1,0]
    v_pk_mul_f32 v[210:211], v[210:211], v[192:193] op_sel_hi:[1,0]
    v_exp_f32 v212, v204
    v_exp_f32 v213, v205
    v_exp_f32 v214, v206
    v_exp_f32 v215, v207
    v_exp_f32 v216, v208
    v_exp_f32 v217, v209
    v_exp_f32 v218, v210
    v_exp_f32 v219, v211
    v_pk_fma_f32 v[212:213], v[212:213], v[194:195], v[194:195]
    v_pk_fma_f32 v[214:215], v[214:215], v[194:195], v[194:195]
    v_pk_fma_f32 v[216:217], v[216:217], v[194:195], v[194:195]
    v_pk_fma_f32 v[218:219], v[218:219], v[194:195], v[194:195]
    v_rcp_f32 v212, v212
    v_rcp_f32 v213, v213
    v_rcp_f32 v214, v214
    v_rcp_f32 v215, v215
    v_rcp_f32 v216, v216
    v_rcp_f32 v217, v217
    v_rcp_f32 v218, v218
    v_rcp_f32 v219, v219
    v_pk_mul_f32 v[212:213], v[204:205], v[212:213]
    v_pk_mul_f32 v[214:215], v[206:207], v[214:215]
    v_pk_mul_f32 v[216:217], v[208:209], v[216:217]
    v_pk_mul_f32 v[218:219], v[210:211], v[218:219]
    v_cvt_pk_bf16_f32 v196, v212, v213
    v_cvt_pk_bf16_f32 v197, v214, v215
    v_cvt_pk_bf16_f32 v198, v216, v217
    v_cvt_pk_bf16_f32 v199, v218, v219
    s_nop 0
    v_permlane16_swap_b32 v196, v198
    v_permlane16_swap_b32 v197, v199
    s_add_u32 s36, s34, 0
    buffer_store_dwordx4 v[196:199], v225, s[12:15], s36 offen
    v_mul_f32 v192, s35, v179
    v_pk_fma_f32 v[136:137], v[160:161], v[178:179], v[4:5] op_sel_hi:[1,0,1] neg_lo:[0,1,0] neg_hi:[0,1,0]
    v_pk_fma_f32 v[138:139], v[162:163], v[178:179], v[6:7] op_sel_hi:[1,0,1] neg_lo:[0,1,0] neg_hi:[0,1,0]
    v_pk_fma_f32 v[140:141], v[164:165], v[178:179], v[36:37] op_sel_hi:[1,0,1] neg_lo:[0,1,0] neg_hi:[0,1,0]
    v_pk_fma_f32 v[142:143], v[166:167], v[178:179], v[38:39] op_sel_hi:[1,0,1] neg_lo:[0,1,0] neg_hi:[0,1,0]
    v_pk_mul_f32 v[136:137], v[136:137], v[192:193] op_sel_hi:[1,0]
    v_pk_mul_f32 v[138:139], v[138:139], v[192:193] op_sel_hi:[1,0]
    v_pk_mul_f32 v[140:141], v[140:141], v[192:193] op_sel_hi:[1,0]
    v_pk_mul_f32 v[142:143], v[142:143], v[192:193] op_sel_hi:[1,0]
    v_exp_f32 v144, v136
    v_exp_f32 v145, v137
    v_exp_f32 v146, v138
    v_exp_f32 v147, v139
    v_exp_f32 v148, v140
    v_exp_f32 v149, v141
    v_exp_f32 v150, v142
    v_exp_f32 v151, v143
    v_pk_fma_f32 v[144:145], v[144:145], v[194:195], v[194:195]
    v_pk_fma_f32 v[146:147], v[146:147], v[194:195], v[194:195]
    v_pk_fma_f32 v[148:149], v[148:149], v[194:195], v[194:195]
    v_pk_fma_f32 v[150:151], v[150:151], v[194:195], v[194:195]
    v_rcp_f32 v144, v144
    v_rcp_f32 v145, v145
    v_rcp_f32 v146, v146
    v_rcp_f32 v147, v147
    v_rcp_f32 v148, v148
    v_rcp_f32 v149, v149
    v_rcp_f32 v150, v150
    v_rcp_f32 v151, v151
    v_pk_mul_f32 v[144:145], v[136:137], v[144:145]
    v_pk_mul_f32 v[146:147], v[138:139], v[146:147]
    v_pk_mul_f32 v[148:149], v[140:141], v[148:149]
    v_pk_mul_f32 v[150:151], v[142:143], v[150:151]
    v_cvt_pk_bf16_f32 v128, v144, v145
    v_cvt_pk_bf16_f32 v129, v146, v147
    v_cvt_pk_bf16_f32 v130, v148, v149
    v_cvt_pk_bf16_f32 v131, v150, v151
    s_nop 0
    v_permlane16_swap_b32 v128, v130
    v_permlane16_swap_b32 v129, v131
    s_add_u32 s36, s34, 114688
    buffer_store_dwordx4 v[128:131], v224, s[12:15], s36 offen
    v_pk_fma_f32 v[204:205], v[168:169], v[178:179], v[68:69] op_sel_hi:[1,0,1] neg_lo:[0,1,0] neg_hi:[0,1,0]
    v_pk_fma_f32 v[206:207], v[170:171], v[178:179], v[70:71] op_sel_hi:[1,0,1] neg_lo:[0,1,0] neg_hi:[0,1,0]
    v_pk_fma_f32 v[208:209], v[172:173], v[178:179], v[100:101] op_sel_hi:[1,0,1] neg_lo:[0,1,0] neg_hi:[0,1,0]
    v_pk_fma_f32 v[210:211], v[174:175], v[178:179], v[102:103] op_sel_hi:[1,0,1] neg_lo:[0,1,0] neg_hi:[0,1,0]
    v_pk_mul_f32 v[204:205], v[204:205], v[192:193] op_sel_hi:[1,0]
    v_pk_mul_f32 v[206:207], v[206:207], v[192:193] op_sel_hi:[1,0]
    v_pk_mul_f32 v[208:209], v[208:209], v[192:193] op_sel_hi:[1,0]
    v_pk_mul_f32 v[210:211], v[210:211], v[192:193] op_sel_hi:[1,0]
    v_exp_f32 v212, v204
    v_exp_f32 v213, v205
    v_exp_f32 v214, v206
    v_exp_f32 v215, v207
    v_exp_f32 v216, v208
    v_exp_f32 v217, v209
    v_exp_f32 v218, v210
    v_exp_f32 v219, v211
    v_pk_fma_f32 v[212:213], v[212:213], v[194:195], v[194:195]
    v_pk_fma_f32 v[214:215], v[214:215], v[194:195], v[194:195]
    v_pk_fma_f32 v[216:217], v[216:217], v[194:195], v[194:195]
    v_pk_fma_f32 v[218:219], v[218:219], v[194:195], v[194:195]
    v_rcp_f32 v212, v212
    v_rcp_f32 v213, v213
    v_rcp_f32 v214, v214
    v_rcp_f32 v215, v215
    v_rcp_f32 v216, v216
    v_rcp_f32 v217, v217
    v_rcp_f32 v218, v218
    v_rcp_f32 v219, v219
    v_pk_mul_f32 v[212:213], v[204:205], v[212:213]
    v_pk_mul_f32 v[214:215], v[206:207], v[214:215]
    v_pk_mul_f32 v[216:217], v[208:209], v[216:217]
    v_pk_mul_f32 v[218:219], v[210:211], v[218:219]
    v_cvt_pk_bf16_f32 v196, v212, v213
    v_cvt_pk_bf16_f32 v197, v214, v215
    v_cvt_pk_bf16_f32 v198, v216, v217
    v_cvt_pk_bf16_f32 v199, v218, v219
    s_nop 0
    v_permlane16_swap_b32 v196, v198
    v_permlane16_swap_b32 v197, v199
    s_add_u32 s36, s34, 114688
    buffer_store_dwordx4 v[196:199], v225, s[12:15], s36 offen
    v_mul_f32 v192, s35, v181
    v_pk_fma_f32 v[136:137], v[160:161], v[180:181], v[8:9] op_sel_hi:[1,0,1] neg_lo:[0,1,0] neg_hi:[0,1,0]
    v_pk_fma_f32 v[138:139], v[162:163], v[180:181], v[10:11] op_sel_hi:[1,0,1] neg_lo:[0,1,0] neg_hi:[0,1,0]
    v_pk_fma_f32 v[140:141], v[164:165], v[180:181], v[40:41] op_sel_hi:[1,0,1] neg_lo:[0,1,0] neg_hi:[0,1,0]
    v_pk_fma_f32 v[142:143], v[166:167], v[180:181], v[42:43] op_sel_hi:[1,0,1] neg_lo:[0,1,0] neg_hi:[0,1,0]
    v_pk_mul_f32 v[136:137], v[136:137], v[192:193] op_sel_hi:[1,0]
    v_pk_mul_f32 v[138:139], v[138:139], v[192:193] op_sel_hi:[1,0]
    v_pk_mul_f32 v[140:141], v[140:141], v[192:193] op_sel_hi:[1,0]
    v_pk_mul_f32 v[142:143], v[142:143], v[192:193] op_sel_hi:[1,0]
    v_exp_f32 v144, v136
    v_exp_f32 v145, v137
    v_exp_f32 v146, v138
    v_exp_f32 v147, v139
    v_exp_f32 v148, v140
    v_exp_f32 v149, v141
    v_exp_f32 v150, v142
    v_exp_f32 v151, v143
    v_pk_fma_f32 v[144:145], v[144:145], v[194:195], v[194:195]
    v_pk_fma_f32 v[146:147], v[146:147], v[194:195], v[194:195]
    v_pk_fma_f32 v[148:149], v[148:149], v[194:195], v[194:195]
    v_pk_fma_f32 v[150:151], v[150:151], v[194:195], v[194:195]
    v_rcp_f32 v144, v144
    v_rcp_f32 v145, v145
    v_rcp_f32 v146, v146
    v_rcp_f32 v147, v147
    v_rcp_f32 v148, v148
    v_rcp_f32 v149, v149
    v_rcp_f32 v150, v150
    v_rcp_f32 v151, v151
    v_pk_mul_f32 v[144:145], v[136:137], v[144:145]
    v_pk_mul_f32 v[146:147], v[138:139], v[146:147]
    v_pk_mul_f32 v[148:149], v[140:141], v[148:149]
    v_pk_mul_f32 v[150:151], v[142:143], v[150:151]
    v_cvt_pk_bf16_f32 v128, v144, v145
    v_cvt_pk_bf16_f32 v129, v146, v147
    v_cvt_pk_bf16_f32 v130, v148, v149
    v_cvt_pk_bf16_f32 v131, v150, v151
    s_nop 0
    v_permlane16_swap_b32 v128, v130
    v_permlane16_swap_b32 v129, v131
    s_add_u32 s36, s34, 229376
    buffer_store_dwordx4 v[128:131], v224, s[12:15], s36 offen
    v_pk_fma_f32 v[204:205], v[168:169], v[180:181], v[72:73] op_sel_hi:[1,0,1] neg_lo:[0,1,0] neg_hi:[0,1,0]
    v_pk_fma_f32 v[206:207], v[170:171], v[180:181], v[74:75] op_sel_hi:[1,0,1] neg_lo:[0,1,0] neg_hi:[0,1,0]
    v_pk_fma_f32 v[208:209], v[172:173], v[180:181], v[104:105] op_sel_hi:[1,0,1] neg_lo:[0,1,0] neg_hi:[0,1,0]
    v_pk_fma_f32 v[210:211], v[174:175], v[180:181], v[106:107] op_sel_hi:[1,0,1] neg_lo:[0,1,0] neg_hi:[0,1,0]
    v_pk_mul_f32 v[204:205], v[204:205], v[192:193] op_sel_hi:[1,0]
    v_pk_mul_f32 v[206:207], v[206:207], v[192:193] op_sel_hi:[1,0]
    v_pk_mul_f32 v[208:209], v[208:209], v[192:193] op_sel_hi:[1,0]
    v_pk_mul_f32 v[210:211], v[210:211], v[192:193] op_sel_hi:[1,0]
    v_exp_f32 v212, v204
    v_exp_f32 v213, v205
    v_exp_f32 v214, v206
    v_exp_f32 v215, v207
    v_exp_f32 v216, v208
    v_exp_f32 v217, v209
    v_exp_f32 v218, v210
    v_exp_f32 v219, v211
    v_pk_fma_f32 v[212:213], v[212:213], v[194:195], v[194:195]
    v_pk_fma_f32 v[214:215], v[214:215], v[194:195], v[194:195]
    v_pk_fma_f32 v[216:217], v[216:217], v[194:195], v[194:195]
    v_pk_fma_f32 v[218:219], v[218:219], v[194:195], v[194:195]
    v_rcp_f32 v212, v212
    v_rcp_f32 v213, v213
    v_rcp_f32 v214, v214
    v_rcp_f32 v215, v215
    v_rcp_f32 v216, v216
    v_rcp_f32 v217, v217
    v_rcp_f32 v218, v218
    v_rcp_f32 v219, v219
    v_pk_mul_f32 v[212:213], v[204:205], v[212:213]
    v_pk_mul_f32 v[214:215], v[206:207], v[214:215]
    v_pk_mul_f32 v[216:217], v[208:209], v[216:217]
    v_pk_mul_f32 v[218:219], v[210:211], v[218:219]
    v_cvt_pk_bf16_f32 v196, v212, v213
    v_cvt_pk_bf16_f32 v197, v214, v215
    v_cvt_pk_bf16_f32 v198, v216, v217
    v_cvt_pk_bf16_f32 v199, v218, v219
    s_nop 0
    v_permlane16_swap_b32 v196, v198
    v_permlane16_swap_b32 v197, v199
    s_add_u32 s36, s34, 229376
    buffer_store_dwordx4 v[196:199], v225, s[12:15], s36 offen
    v_mul_f32 v192, s35, v183
    v_pk_fma_f32 v[136:137], v[160:161], v[182:183], v[12:13] op_sel_hi:[1,0,1] neg_lo:[0,1,0] neg_hi:[0,1,0]
    v_pk_fma_f32 v[138:139], v[162:163], v[182:183], v[14:15] op_sel_hi:[1,0,1] neg_lo:[0,1,0] neg_hi:[0,1,0]
    v_pk_fma_f32 v[140:141], v[164:165], v[182:183], v[44:45] op_sel_hi:[1,0,1] neg_lo:[0,1,0] neg_hi:[0,1,0]
    v_pk_fma_f32 v[142:143], v[166:167], v[182:183], v[46:47] op_sel_hi:[1,0,1] neg_lo:[0,1,0] neg_hi:[0,1,0]
    v_pk_mul_f32 v[136:137], v[136:137], v[192:193] op_sel_hi:[1,0]
    v_pk_mul_f32 v[138:139], v[138:139], v[192:193] op_sel_hi:[1,0]
    v_pk_mul_f32 v[140:141], v[140:141], v[192:193] op_sel_hi:[1,0]
    v_pk_mul_f32 v[142:143], v[142:143], v[192:193] op_sel_hi:[1,0]
    v_exp_f32 v144, v136
    v_exp_f32 v145, v137
    v_exp_f32 v146, v138
    v_exp_f32 v147, v139
    v_exp_f32 v148, v140
    v_exp_f32 v149, v141
    v_exp_f32 v150, v142
    v_exp_f32 v151, v143
    v_pk_fma_f32 v[144:145], v[144:145], v[194:195], v[194:195]
    v_pk_fma_f32 v[146:147], v[146:147], v[194:195], v[194:195]
    v_pk_fma_f32 v[148:149], v[148:149], v[194:195], v[194:195]
    v_pk_fma_f32 v[150:151], v[150:151], v[194:195], v[194:195]
    v_rcp_f32 v144, v144
    v_rcp_f32 v145, v145
    v_rcp_f32 v146, v146
    v_rcp_f32 v147, v147
    v_rcp_f32 v148, v148
    v_rcp_f32 v149, v149
    v_rcp_f32 v150, v150
    v_rcp_f32 v151, v151
    v_pk_mul_f32 v[144:145], v[136:137], v[144:145]
    v_pk_mul_f32 v[146:147], v[138:139], v[146:147]
    v_pk_mul_f32 v[148:149], v[140:141], v[148:149]
    v_pk_mul_f32 v[150:151], v[142:143], v[150:151]
    v_cvt_pk_bf16_f32 v128, v144, v145
    v_cvt_pk_bf16_f32 v129, v146, v147
    v_cvt_pk_bf16_f32 v130, v148, v149
    v_cvt_pk_bf16_f32 v131, v150, v151
    s_nop 0
    v_permlane16_swap_b32 v128, v130
    v_permlane16_swap_b32 v129, v131
    s_add_u32 s36, s34, 344064
    buffer_store_dwordx4 v[128:131], v224, s[12:15], s36 offen
    v_pk_fma_f32 v[204:205], v[168:169], v[182:183], v[76:77] op_sel_hi:[1,0,1] neg_lo:[0,1,0] neg_hi:[0,1,0]
    v_pk_fma_f32 v[206:207], v[170:171], v[182:183], v[78:79] op_sel_hi:[1,0,1] neg_lo:[0,1,0] neg_hi:[0,1,0]
    v_pk_fma_f32 v[208:209], v[172:173], v[182:183], v[108:109] op_sel_hi:[1,0,1] neg_lo:[0,1,0] neg_hi:[0,1,0]
    v_pk_fma_f32 v[210:211], v[174:175], v[182:183], v[110:111] op_sel_hi:[1,0,1] neg_lo:[0,1,0] neg_hi:[0,1,0]
    v_pk_mul_f32 v[204:205], v[204:205], v[192:193] op_sel_hi:[1,0]
    v_pk_mul_f32 v[206:207], v[206:207], v[192:193] op_sel_hi:[1,0]
    v_pk_mul_f32 v[208:209], v[208:209], v[192:193] op_sel_hi:[1,0]
    v_pk_mul_f32 v[210:211], v[210:211], v[192:193] op_sel_hi:[1,0]
    v_exp_f32 v212, v204
    v_exp_f32 v213, v205
    v_exp_f32 v214, v206
    v_exp_f32 v215, v207
    v_exp_f32 v216, v208
    v_exp_f32 v217, v209
    v_exp_f32 v218, v210
    v_exp_f32 v219, v211
    v_pk_fma_f32 v[212:213], v[212:213], v[194:195], v[194:195]
    v_pk_fma_f32 v[214:215], v[214:215], v[194:195], v[194:195]
    v_pk_fma_f32 v[216:217], v[216:217], v[194:195], v[194:195]
    v_pk_fma_f32 v[218:219], v[218:219], v[194:195], v[194:195]
    v_rcp_f32 v212, v212
    v_rcp_f32 v213, v213
    v_rcp_f32 v214, v214
    v_rcp_f32 v215, v215
    v_rcp_f32 v216, v216
    v_rcp_f32 v217, v217
    v_rcp_f32 v218, v218
    v_rcp_f32 v219, v219
    v_pk_mul_f32 v[212:213], v[204:205], v[212:213]
    v_pk_mul_f32 v[214:215], v[206:207], v[214:215]
    v_pk_mul_f32 v[216:217], v[208:209], v[216:217]
    v_pk_mul_f32 v[218:219], v[210:211], v[218:219]
    v_cvt_pk_bf16_f32 v196, v212, v213
    v_cvt_pk_bf16_f32 v197, v214, v215
    v_cvt_pk_bf16_f32 v198, v216, v217
    v_cvt_pk_bf16_f32 v199, v218, v219
    s_nop 0
    v_permlane16_swap_b32 v196, v198
    v_permlane16_swap_b32 v197, v199
    s_add_u32 s36, s34, 344064
    buffer_store_dwordx4 v[196:199], v225, s[12:15], s36 offen
    v_mul_f32 v192, s35, v185
    v_pk_fma_f32 v[136:137], v[160:161], v[184:185], v[16:17] op_sel_hi:[1,0,1] neg_lo:[0,1,0] neg_hi:[0,1,0]
    v_pk_fma_f32 v[138:139], v[162:163], v[184:185], v[18:19] op_sel_hi:[1,0,1] neg_lo:[0,1,0] neg_hi:[0,1,0]
    v_pk_fma_f32 v[140:141], v[164:165], v[184:185], v[48:49] op_sel_hi:[1,0,1] neg_lo:[0,1,0] neg_hi:[0,1,0]
    v_pk_fma_f32 v[142:143], v[166:167], v[184:185], v[50:51] op_sel_hi:[1,0,1] neg_lo:[0,1,0] neg_hi:[0,1,0]
    v_pk_mul_f32 v[136:137], v[136:137], v[192:193] op_sel_hi:[1,0]
    v_pk_mul_f32 v[138:139], v[138:139], v[192:193] op_sel_hi:[1,0]
    v_pk_mul_f32 v[140:141], v[140:141], v[192:193] op_sel_hi:[1,0]
    v_pk_mul_f32 v[142:143], v[142:143], v[192:193] op_sel_hi:[1,0]
    v_exp_f32 v144, v136
    v_exp_f32 v145, v137
    v_exp_f32 v146, v138
    v_exp_f32 v147, v139
    v_exp_f32 v148, v140
    v_exp_f32 v149, v141
    v_exp_f32 v150, v142
    v_exp_f32 v151, v143
    v_pk_fma_f32 v[144:145], v[144:145], v[194:195], v[194:195]
    v_pk_fma_f32 v[146:147], v[146:147], v[194:195], v[194:195]
    v_pk_fma_f32 v[148:149], v[148:149], v[194:195], v[194:195]
    v_pk_fma_f32 v[150:151], v[150:151], v[194:195], v[194:195]
    v_rcp_f32 v144, v144
    v_rcp_f32 v145, v145
    v_rcp_f32 v146, v146
    v_rcp_f32 v147, v147
    v_rcp_f32 v148, v148
    v_rcp_f32 v149, v149
    v_rcp_f32 v150, v150
    v_rcp_f32 v151, v151
    v_pk_mul_f32 v[144:145], v[136:137], v[144:145]
    v_pk_mul_f32 v[146:147], v[138:139], v[146:147]
    v_pk_mul_f32 v[148:149], v[140:141], v[148:149]
    v_pk_mul_f32 v[150:151], v[142:143], v[150:151]
    v_cvt_pk_bf16_f32 v128, v144, v145
    v_cvt_pk_bf16_f32 v129, v146, v147
    v_cvt_pk_bf16_f32 v130, v148, v149
    v_cvt_pk_bf16_f32 v131, v150, v151
    s_nop 0
    v_permlane16_swap_b32 v128, v130
    v_permlane16_swap_b32 v129, v131
    s_add_u32 s36, s34, 458752
    buffer_store_dwordx4 v[128:131], v224, s[12:15], s36 offen
    v_pk_fma_f32 v[204:205], v[168:169], v[184:185], v[80:81] op_sel_hi:[1,0,1] neg_lo:[0,1,0] neg_hi:[0,1,0]
    v_pk_fma_f32 v[206:207], v[170:171], v[184:185], v[82:83] op_sel_hi:[1,0,1] neg_lo:[0,1,0] neg_hi:[0,1,0]
    v_pk_fma_f32 v[208:209], v[172:173], v[184:185], v[112:113] op_sel_hi:[1,0,1] neg_lo:[0,1,0] neg_hi:[0,1,0]
    v_pk_fma_f32 v[210:211], v[174:175], v[184:185], v[114:115] op_sel_hi:[1,0,1] neg_lo:[0,1,0] neg_hi:[0,1,0]
    v_pk_mul_f32 v[204:205], v[204:205], v[192:193] op_sel_hi:[1,0]
    v_pk_mul_f32 v[206:207], v[206:207], v[192:193] op_sel_hi:[1,0]
    v_pk_mul_f32 v[208:209], v[208:209], v[192:193] op_sel_hi:[1,0]
    v_pk_mul_f32 v[210:211], v[210:211], v[192:193] op_sel_hi:[1,0]
    v_exp_f32 v212, v204
    v_exp_f32 v213, v205
    v_exp_f32 v214, v206
    v_exp_f32 v215, v207
    v_exp_f32 v216, v208
    v_exp_f32 v217, v209
    v_exp_f32 v218, v210
    v_exp_f32 v219, v211
    v_pk_fma_f32 v[212:213], v[212:213], v[194:195], v[194:195]
    v_pk_fma_f32 v[214:215], v[214:215], v[194:195], v[194:195]
    v_pk_fma_f32 v[216:217], v[216:217], v[194:195], v[194:195]
    v_pk_fma_f32 v[218:219], v[218:219], v[194:195], v[194:195]
    v_rcp_f32 v212, v212
    v_rcp_f32 v213, v213
    v_rcp_f32 v214, v214
    v_rcp_f32 v215, v215
    v_rcp_f32 v216, v216
    v_rcp_f32 v217, v217
    v_rcp_f32 v218, v218
    v_rcp_f32 v219, v219
    v_pk_mul_f32 v[212:213], v[204:205], v[212:213]
    v_pk_mul_f32 v[214:215], v[206:207], v[214:215]
    v_pk_mul_f32 v[216:217], v[208:209], v[216:217]
    v_pk_mul_f32 v[218:219], v[210:211], v[218:219]
    v_cvt_pk_bf16_f32 v196, v212, v213
    v_cvt_pk_bf16_f32 v197, v214, v215
    v_cvt_pk_bf16_f32 v198, v216, v217
    v_cvt_pk_bf16_f32 v199, v218, v219
    s_nop 0
    v_permlane16_swap_b32 v196, v198
    v_permlane16_swap_b32 v197, v199
    s_add_u32 s36, s34, 458752
    buffer_store_dwordx4 v[196:199], v225, s[12:15], s36 offen
    v_mul_f32 v192, s35, v187
    v_pk_fma_f32 v[136:137], v[160:161], v[186:187], v[20:21] op_sel_hi:[1,0,1] neg_lo:[0,1,0] neg_hi:[0,1,0]
    v_pk_fma_f32 v[138:139], v[162:163], v[186:187], v[22:23] op_sel_hi:[1,0,1] neg_lo:[0,1,0] neg_hi:[0,1,0]
    v_pk_fma_f32 v[140:141], v[164:165], v[186:187], v[52:53] op_sel_hi:[1,0,1] neg_lo:[0,1,0] neg_hi:[0,1,0]
    v_pk_fma_f32 v[142:143], v[166:167], v[186:187], v[54:55] op_sel_hi:[1,0,1] neg_lo:[0,1,0] neg_hi:[0,1,0]
    v_pk_mul_f32 v[136:137], v[136:137], v[192:193] op_sel_hi:[1,0]
    v_pk_mul_f32 v[138:139], v[138:139], v[192:193] op_sel_hi:[1,0]
    v_pk_mul_f32 v[140:141], v[140:141], v[192:193] op_sel_hi:[1,0]
    v_pk_mul_f32 v[142:143], v[142:143], v[192:193] op_sel_hi:[1,0]
    v_exp_f32 v144, v136
    v_exp_f32 v145, v137
    v_exp_f32 v146, v138
    v_exp_f32 v147, v139
    v_exp_f32 v148, v140
    v_exp_f32 v149, v141
    v_exp_f32 v150, v142
    v_exp_f32 v151, v143
    v_pk_fma_f32 v[144:145], v[144:145], v[194:195], v[194:195]
    v_pk_fma_f32 v[146:147], v[146:147], v[194:195], v[194:195]
    v_pk_fma_f32 v[148:149], v[148:149], v[194:195], v[194:195]
    v_pk_fma_f32 v[150:151], v[150:151], v[194:195], v[194:195]
    v_rcp_f32 v144, v144
    v_rcp_f32 v145, v145
    v_rcp_f32 v146, v146
    v_rcp_f32 v147, v147
    v_rcp_f32 v148, v148
    v_rcp_f32 v149, v149
    v_rcp_f32 v150, v150
    v_rcp_f32 v151, v151
    v_pk_mul_f32 v[144:145], v[136:137], v[144:145]
    v_pk_mul_f32 v[146:147], v[138:139], v[146:147]
    v_pk_mul_f32 v[148:149], v[140:141], v[148:149]
    v_pk_mul_f32 v[150:151], v[142:143], v[150:151]
    v_cvt_pk_bf16_f32 v128, v144, v145
    v_cvt_pk_bf16_f32 v129, v146, v147
    v_cvt_pk_bf16_f32 v130, v148, v149
    v_cvt_pk_bf16_f32 v131, v150, v151
    s_nop 0
    v_permlane16_swap_b32 v128, v130
    v_permlane16_swap_b32 v129, v131
    s_add_u32 s36, s34, 573440
    buffer_store_dwordx4 v[128:131], v224, s[12:15], s36 offen
    v_pk_fma_f32 v[204:205], v[168:169], v[186:187], v[84:85] op_sel_hi:[1,0,1] neg_lo:[0,1,0] neg_hi:[0,1,0]
    v_pk_fma_f32 v[206:207], v[170:171], v[186:187], v[86:87] op_sel_hi:[1,0,1] neg_lo:[0,1,0] neg_hi:[0,1,0]
    v_pk_fma_f32 v[208:209], v[172:173], v[186:187], v[116:117] op_sel_hi:[1,0,1] neg_lo:[0,1,0] neg_hi:[0,1,0]
    v_pk_fma_f32 v[210:211], v[174:175], v[186:187], v[118:119] op_sel_hi:[1,0,1] neg_lo:[0,1,0] neg_hi:[0,1,0]
    v_pk_mul_f32 v[204:205], v[204:205], v[192:193] op_sel_hi:[1,0]
    v_pk_mul_f32 v[206:207], v[206:207], v[192:193] op_sel_hi:[1,0]
    v_pk_mul_f32 v[208:209], v[208:209], v[192:193] op_sel_hi:[1,0]
    v_pk_mul_f32 v[210:211], v[210:211], v[192:193] op_sel_hi:[1,0]
    v_exp_f32 v212, v204
    v_exp_f32 v213, v205
    v_exp_f32 v214, v206
    v_exp_f32 v215, v207
    v_exp_f32 v216, v208
    v_exp_f32 v217, v209
    v_exp_f32 v218, v210
    v_exp_f32 v219, v211
    v_pk_fma_f32 v[212:213], v[212:213], v[194:195], v[194:195]
    v_pk_fma_f32 v[214:215], v[214:215], v[194:195], v[194:195]
    v_pk_fma_f32 v[216:217], v[216:217], v[194:195], v[194:195]
    v_pk_fma_f32 v[218:219], v[218:219], v[194:195], v[194:195]
    v_rcp_f32 v212, v212
    v_rcp_f32 v213, v213
    v_rcp_f32 v214, v214
    v_rcp_f32 v215, v215
    v_rcp_f32 v216, v216
    v_rcp_f32 v217, v217
    v_rcp_f32 v218, v218
    v_rcp_f32 v219, v219
    v_pk_mul_f32 v[212:213], v[204:205], v[212:213]
    v_pk_mul_f32 v[214:215], v[206:207], v[214:215]
    v_pk_mul_f32 v[216:217], v[208:209], v[216:217]
    v_pk_mul_f32 v[218:219], v[210:211], v[218:219]
    v_cvt_pk_bf16_f32 v196, v212, v213
    v_cvt_pk_bf16_f32 v197, v214, v215
    v_cvt_pk_bf16_f32 v198, v216, v217
    v_cvt_pk_bf16_f32 v199, v218, v219
    s_nop 0
    v_permlane16_swap_b32 v196, v198
    v_permlane16_swap_b32 v197, v199
    s_add_u32 s36, s34, 573440
    buffer_store_dwordx4 v[196:199], v225, s[12:15], s36 offen
    v_mul_f32 v192, s35, v189
    v_pk_fma_f32 v[136:137], v[160:161], v[188:189], v[24:25] op_sel_hi:[1,0,1] neg_lo:[0,1,0] neg_hi:[0,1,0]
    v_pk_fma_f32 v[138:139], v[162:163], v[188:189], v[26:27] op_sel_hi:[1,0,1] neg_lo:[0,1,0] neg_hi:[0,1,0]
    v_pk_fma_f32 v[140:141], v[164:165], v[188:189], v[56:57] op_sel_hi:[1,0,1] neg_lo:[0,1,0] neg_hi:[0,1,0]
    v_pk_fma_f32 v[142:143], v[166:167], v[188:189], v[58:59] op_sel_hi:[1,0,1] neg_lo:[0,1,0] neg_hi:[0,1,0]
    v_pk_mul_f32 v[136:137], v[136:137], v[192:193] op_sel_hi:[1,0]
    v_pk_mul_f32 v[138:139], v[138:139], v[192:193] op_sel_hi:[1,0]
    v_pk_mul_f32 v[140:141], v[140:141], v[192:193] op_sel_hi:[1,0]
    v_pk_mul_f32 v[142:143], v[142:143], v[192:193] op_sel_hi:[1,0]
    v_exp_f32 v144, v136
    v_exp_f32 v145, v137
    v_exp_f32 v146, v138
    v_exp_f32 v147, v139
    v_exp_f32 v148, v140
    v_exp_f32 v149, v141
    v_exp_f32 v150, v142
    v_exp_f32 v151, v143
    v_pk_fma_f32 v[144:145], v[144:145], v[194:195], v[194:195]
    v_pk_fma_f32 v[146:147], v[146:147], v[194:195], v[194:195]
    v_pk_fma_f32 v[148:149], v[148:149], v[194:195], v[194:195]
    v_pk_fma_f32 v[150:151], v[150:151], v[194:195], v[194:195]
    v_rcp_f32 v144, v144
    v_rcp_f32 v145, v145
    v_rcp_f32 v146, v146
    v_rcp_f32 v147, v147
    v_rcp_f32 v148, v148
    v_rcp_f32 v149, v149
    v_rcp_f32 v150, v150
    v_rcp_f32 v151, v151
    v_pk_mul_f32 v[144:145], v[136:137], v[144:145]
    v_pk_mul_f32 v[146:147], v[138:139], v[146:147]
    v_pk_mul_f32 v[148:149], v[140:141], v[148:149]
    v_pk_mul_f32 v[150:151], v[142:143], v[150:151]
    v_cvt_pk_bf16_f32 v128, v144, v145
    v_cvt_pk_bf16_f32 v129, v146, v147
    v_cvt_pk_bf16_f32 v130, v148, v149
    v_cvt_pk_bf16_f32 v131, v150, v151
    s_nop 0
    v_permlane16_swap_b32 v128, v130
    v_permlane16_swap_b32 v129, v131
    s_add_u32 s36, s34, 688128
    buffer_store_dwordx4 v[128:131], v224, s[12:15], s36 offen
    v_pk_fma_f32 v[204:205], v[168:169], v[188:189], v[88:89] op_sel_hi:[1,0,1] neg_lo:[0,1,0] neg_hi:[0,1,0]
    v_pk_fma_f32 v[206:207], v[170:171], v[188:189], v[90:91] op_sel_hi:[1,0,1] neg_lo:[0,1,0] neg_hi:[0,1,0]
    v_pk_fma_f32 v[208:209], v[172:173], v[188:189], v[120:121] op_sel_hi:[1,0,1] neg_lo:[0,1,0] neg_hi:[0,1,0]
    v_pk_fma_f32 v[210:211], v[174:175], v[188:189], v[122:123] op_sel_hi:[1,0,1] neg_lo:[0,1,0] neg_hi:[0,1,0]
    v_pk_mul_f32 v[204:205], v[204:205], v[192:193] op_sel_hi:[1,0]
    v_pk_mul_f32 v[206:207], v[206:207], v[192:193] op_sel_hi:[1,0]
    v_pk_mul_f32 v[208:209], v[208:209], v[192:193] op_sel_hi:[1,0]
    v_pk_mul_f32 v[210:211], v[210:211], v[192:193] op_sel_hi:[1,0]
    v_exp_f32 v212, v204
    v_exp_f32 v213, v205
    v_exp_f32 v214, v206
    v_exp_f32 v215, v207
    v_exp_f32 v216, v208
    v_exp_f32 v217, v209
    v_exp_f32 v218, v210
    v_exp_f32 v219, v211
    v_pk_fma_f32 v[212:213], v[212:213], v[194:195], v[194:195]
    v_pk_fma_f32 v[214:215], v[214:215], v[194:195], v[194:195]
    v_pk_fma_f32 v[216:217], v[216:217], v[194:195], v[194:195]
    v_pk_fma_f32 v[218:219], v[218:219], v[194:195], v[194:195]
    v_rcp_f32 v212, v212
    v_rcp_f32 v213, v213
    v_rcp_f32 v214, v214
    v_rcp_f32 v215, v215
    v_rcp_f32 v216, v216
    v_rcp_f32 v217, v217
    v_rcp_f32 v218, v218
    v_rcp_f32 v219, v219
    v_pk_mul_f32 v[212:213], v[204:205], v[212:213]
    v_pk_mul_f32 v[214:215], v[206:207], v[214:215]
    v_pk_mul_f32 v[216:217], v[208:209], v[216:217]
    v_pk_mul_f32 v[218:219], v[210:211], v[218:219]
    v_cvt_pk_bf16_f32 v196, v212, v213
    v_cvt_pk_bf16_f32 v197, v214, v215
    v_cvt_pk_bf16_f32 v198, v216, v217
    v_cvt_pk_bf16_f32 v199, v218, v219
    s_nop 0
    v_permlane16_swap_b32 v196, v198
    v_permlane16_swap_b32 v197, v199
    s_add_u32 s36, s34, 688128
    buffer_store_dwordx4 v[196:199], v225, s[12:15], s36 offen
    v_mul_f32 v192, s35, v191
    v_pk_fma_f32 v[136:137], v[160:161], v[190:191], v[28:29] op_sel_hi:[1,0,1] neg_lo:[0,1,0] neg_hi:[0,1,0]
    v_pk_fma_f32 v[138:139], v[162:163], v[190:191], v[30:31] op_sel_hi:[1,0,1] neg_lo:[0,1,0] neg_hi:[0,1,0]
    v_pk_fma_f32 v[140:141], v[164:165], v[190:191], v[60:61] op_sel_hi:[1,0,1] neg_lo:[0,1,0] neg_hi:[0,1,0]
    v_pk_fma_f32 v[142:143], v[166:167], v[190:191], v[62:63] op_sel_hi:[1,0,1] neg_lo:[0,1,0] neg_hi:[0,1,0]
    v_pk_mul_f32 v[136:137], v[136:137], v[192:193] op_sel_hi:[1,0]
    v_pk_mul_f32 v[138:139], v[138:139], v[192:193] op_sel_hi:[1,0]
    v_pk_mul_f32 v[140:141], v[140:141], v[192:193] op_sel_hi:[1,0]
    v_pk_mul_f32 v[142:143], v[142:143], v[192:193] op_sel_hi:[1,0]
    v_exp_f32 v144, v136
    v_exp_f32 v145, v137
    v_exp_f32 v146, v138
    v_exp_f32 v147, v139
    v_exp_f32 v148, v140
    v_exp_f32 v149, v141
    v_exp_f32 v150, v142
    v_exp_f32 v151, v143
    v_pk_fma_f32 v[144:145], v[144:145], v[194:195], v[194:195]
    v_pk_fma_f32 v[146:147], v[146:147], v[194:195], v[194:195]
    v_pk_fma_f32 v[148:149], v[148:149], v[194:195], v[194:195]
    v_pk_fma_f32 v[150:151], v[150:151], v[194:195], v[194:195]
    v_rcp_f32 v144, v144
    v_rcp_f32 v145, v145
    v_rcp_f32 v146, v146
    v_rcp_f32 v147, v147
    v_rcp_f32 v148, v148
    v_rcp_f32 v149, v149
    v_rcp_f32 v150, v150
    v_rcp_f32 v151, v151
    v_pk_mul_f32 v[144:145], v[136:137], v[144:145]
    v_pk_mul_f32 v[146:147], v[138:139], v[146:147]
    v_pk_mul_f32 v[148:149], v[140:141], v[148:149]
    v_pk_mul_f32 v[150:151], v[142:143], v[150:151]
    v_cvt_pk_bf16_f32 v128, v144, v145
    v_cvt_pk_bf16_f32 v129, v146, v147
    v_cvt_pk_bf16_f32 v130, v148, v149
    v_cvt_pk_bf16_f32 v131, v150, v151
    s_nop 0
    v_permlane16_swap_b32 v128, v130
    v_permlane16_swap_b32 v129, v131
    s_add_u32 s36, s34, 802816
    buffer_store_dwordx4 v[128:131], v224, s[12:15], s36 offen
    v_pk_fma_f32 v[204:205], v[168:169], v[190:191], v[92:93] op_sel_hi:[1,0,1] neg_lo:[0,1,0] neg_hi:[0,1,0]
    v_pk_fma_f32 v[206:207], v[170:171], v[190:191], v[94:95] op_sel_hi:[1,0,1] neg_lo:[0,1,0] neg_hi:[0,1,0]
    v_pk_fma_f32 v[208:209], v[172:173], v[190:191], v[124:125] op_sel_hi:[1,0,1] neg_lo:[0,1,0] neg_hi:[0,1,0]
    v_pk_fma_f32 v[210:211], v[174:175], v[190:191], v[126:127] op_sel_hi:[1,0,1] neg_lo:[0,1,0] neg_hi:[0,1,0]
    v_pk_mul_f32 v[204:205], v[204:205], v[192:193] op_sel_hi:[1,0]
    v_pk_mul_f32 v[206:207], v[206:207], v[192:193] op_sel_hi:[1,0]
    v_pk_mul_f32 v[208:209], v[208:209], v[192:193] op_sel_hi:[1,0]
    v_pk_mul_f32 v[210:211], v[210:211], v[192:193] op_sel_hi:[1,0]
    v_exp_f32 v212, v204
    v_exp_f32 v213, v205
    v_exp_f32 v214, v206
    v_exp_f32 v215, v207
    v_exp_f32 v216, v208
    v_exp_f32 v217, v209
    v_exp_f32 v218, v210
    v_exp_f32 v219, v211
    v_pk_fma_f32 v[212:213], v[212:213], v[194:195], v[194:195]
    v_pk_fma_f32 v[214:215], v[214:215], v[194:195], v[194:195]
    v_pk_fma_f32 v[216:217], v[216:217], v[194:195], v[194:195]
    v_pk_fma_f32 v[218:219], v[218:219], v[194:195], v[194:195]
    v_rcp_f32 v212, v212
    v_rcp_f32 v213, v213
    v_rcp_f32 v214, v214
    v_rcp_f32 v215, v215
    v_rcp_f32 v216, v216
    v_rcp_f32 v217, v217
    v_rcp_f32 v218, v218
    v_rcp_f32 v219, v219
    v_pk_mul_f32 v[212:213], v[204:205], v[212:213]
    v_pk_mul_f32 v[214:215], v[206:207], v[214:215]
    v_pk_mul_f32 v[216:217], v[208:209], v[216:217]
    v_pk_mul_f32 v[218:219], v[210:211], v[218:219]
    v_cvt_pk_bf16_f32 v196, v212, v213
    v_cvt_pk_bf16_f32 v197, v214, v215
    v_cvt_pk_bf16_f32 v198, v216, v217
    v_cvt_pk_bf16_f32 v199, v218, v219
    s_nop 0
    v_permlane16_swap_b32 v196, v198
    v_permlane16_swap_b32 v197, v199
    s_add_u32 s36, s34, 802816
    buffer_store_dwordx4 v[196:199], v225, s[12:15], s36 offen
    s_endpgm
ka_hi:
    s_sub_u32 s25, s25, 4
    s_and_b32 s21, s2, 63
    s_lshr_b32 s22, s2, 6
    s_lshr_b32 s23, s21, 2
    s_and_b32 s24, s21, 3
    s_lshl_b32 s26, s24, 3
    s_lshl_b32 s27, s23, 7
    s_add_u32 s27, s27, s26
    s_mul_i32 s28, s27, 1026
    s_add_u32 s29, s28, 32832
    s_add_u32 s30, s28, 65664
    s_add_u32 s31, s28, 98496
    s_lshl_b32 s33, s22, 7
    s_lshl_b32 s34, s25, 5
    s_add_u32 s33, s33, s34
    v_and_b32 v2, 31, v1
    v_add_u32 v2, s33, v2
    v_lshrrev_b32 v4, 5, v1
    v_mul_u32_u24 v3, 4104, v4
    v_lshl_add_u32 v3, v2, 1, v3
    s_waitcnt lgkmcnt(0)
    s_mov_b32 s12, s8
    s_mov_b32 s13, s9
    s_mov_b32 s14, 2101248
    s_mov_b32 s15, 0x20000
    s_mov_b32 s16, s10
    s_mov_b32 s17, s11
    s_mov_b32 s18, 2101248
    s_mov_b32 s19, 0x20000
    s_add_u32 s36, s6, 9437184
    s_addc_u32 s37, s7, 0
    s_mov_b32 s38, 4210688
    s_mov_b32 s39, 0x20000
    s_getpc_b64 s[40:41]
    s_add_u32 s40, s40, ka_kernel@rel32@lo+4
    s_addc_u32 s41, s41, ka_kernel@rel32@hi+12
    s_mov_b32 s42, code_end-ka_kernel
    s_mov_b32 s43, 0x20000
    s_mul_i32 s44, s25, 16384
    v_lshlrev_b32 v51, 7, v1
    v_add_u32 v51, s44, v51
    buffer_load_dword v52, v51, s[40:43], 0 offen
    v_add_u32 v51, 8192, v51
    buffer_load_dword v52, v51, s[40:43], 0 offen
    s_getpc_b64 s[44:45]
    s_add_u32 s44, s44, tab_f3@rel32@lo+4
    s_addc_u32 s45, s45, tab_f3@rel32@hi+12
    s_mov_b32 s46, 16384
    s_mov_b32 s47, 0x20000
    v_lshlrev_b32 v51, 7, v1
    s_lshl_b32 s56, s25, 13
    v_add_u32 v51, s56, v51
    buffer_load_dword v52, v51, s[44:47], 0 offen
    buffer_load_ushort v8, v3, s[12:15], s28 offen offset:0
    buffer_load_ushort v24, v3, s[16:19], s28 offen offset:0
    buffer_load_ushort v9, v3, s[12:15], s29 offen offset:0
    buffer_load_ushort v25, v3, s[16:19], s29 offen offset:0
    buffer_load_ushort v10, v3, s[12:15], s30 offen offset:0
    buffer_load_ushort v26, v3, s[16:19], s30 offen offset:0
    buffer_load_ushort v11, v3, s[12:15], s31 offen offset:0
    buffer_load_ushort v27, v3, s[16:19], s31 offen offset:0
    buffer_load_ushort v12, v3, s[12:15], s28 offen offset:1026
    buffer_load_ushort v28, v3, s[16:19], s28 offen offset:1026
    buffer_load_ushort v13, v3, s[12:15], s29 offen offset:1026
    buffer_load_ushort v29, v3, s[16:19], s29 offen offset:1026
    buffer_load_ushort v14, v3, s[12:15], s30 offen offset:1026
    buffer_load_ushort v30, v3, s[16:19], s30 offen offset:1026
    buffer_load_ushort v15, v3, s[12:15], s31 offen offset:1026
    buffer_load_ushort v31, v3, s[16:19], s31 offen offset:1026
    buffer_load_ushort v16, v3, s[12:15], s28 offen offset:2052
    buffer_load_ushort v32, v3, s[16:19], s28 offen offset:2052
    buffer_load_ushort v17, v3, s[12:15], s29 offen offset:2052
    buffer_load_ushort v33, v3, s[16:19], s29 offen offset:2052
    buffer_load_ushort v18, v3, s[12:15], s30 offen offset:2052
    buffer_load_ushort v34, v3, s[16:19], s30 offen offset:2052
    buffer_load_ushort v19, v3, s[12:15], s31 offen offset:2052
    buffer_load_ushort v35, v3, s[16:19], s31 offen offset:2052
    buffer_load_ushort v20, v3, s[12:15], s28 offen offset:3078
    buffer_load_ushort v36, v3, s[16:19], s28 offen offset:3078
    buffer_load_ushort v21, v3, s[12:15], s29 offen offset:3078
    buffer_load_ushort v37, v3, s[16:19], s29 offen offset:3078
    buffer_load_ushort v22, v3, s[12:15], s30 offen offset:3078
    buffer_load_ushort v38, v3, s[16:19], s30 offen offset:3078
    buffer_load_ushort v23, v3, s[12:15], s31 offen offset:3078
    buffer_load_ushort v39, v3, s[16:19], s31 offen offset:3078
    s_cmp_eq_u32 s22, 3
    s_cselect_b32 s40, 1, 0
    s_cmp_eq_u32 s25, 0
    s_cselect_b32 s40, s40, 0
    s_cmp_eq_u32 s40, 0
    s_cbranch_scc1 ka_noex1
    v_and_b32 v5, 7, v1
    v_bfe_u32 v6, v1, 3, 2
    v_lshl_add_u32 v5, v6, 5, v5
    v_add_u32 v5, s27, v5
    v_sub_u32 v6, 2048, v5
    v_and_b32 v6, 2047, v6
    v_mul_u32_u24 v5, 1026, v5
    v_mul_u32_u24 v6, 1026, v6
    buffer_load_ushort v40, v5, s[12:15], 0 offen offset:0
    buffer_load_ushort v41, v5, s[16:19], 0 offen offset:0
    buffer_load_ushort v42, v6, s[12:15], 0 offen offset:0
    buffer_load_ushort v43, v6, s[16:19], 0 offen offset:0
    buffer_load_ushort v44, v5, s[12:15], 0 offen offset:1024
    buffer_load_ushort v45, v5, s[16:19], 0 offen offset:1024
    buffer_load_ushort v46, v6, s[12:15], 0 offen offset:1024
    buffer_load_ushort v47, v6, s[16:19], 0 offen offset:1024
ka_noex1:
    s_cmp_ge_u32 s72, 28
    s_cbranch_scc1 ka_hitab
    s_mov_b32 s48, s4
    s_mov_b32 s49, s5
    s_mov_b32 s50, 4194304
    s_mov_b32 s51, 0x20000
    s_mov_b32 s52, s60
    s_mov_b32 s53, s61
    s_mov_b32 s54, 7340032
    s_mov_b32 s55, 0x20000
    s_lshr_b32 s56, s70, 2
    s_lshl_b32 s56, s56, 4
    s_and_b32 s57, s70, 1
    s_lshl_b32 s57, s57, 2
    s_add_u32 s56, s56, s57
    s_lshl_b32 s56, s56, 6
    s_lshr_b32 s57, s70, 1
    s_and_b32 s57, s57, 1
    s_lshl_b32 s57, s57, 5
    s_add_u32 s56, s56, s57
    s_lshl_b32 s57, s25, 3
    s_add_u32 s56, s56, s57
    s_lshl_b32 s56, s56, 11
    s_lshl_b32 s57, s71, 8
    v_lshrrev_b32 v76, 5, v1
    v_lshlrev_b32 v76, 3, v76
    v_bfe_u32 v77, v1, 4, 1
    v_lshlrev_b32 v77, 1, v77
    v_add_u32 v76, v76, v77
    v_bfe_u32 v77, v1, 3, 1
    v_add_u32 v76, v76, v77
    v_lshlrev_b32 v76, 17, v76
    v_and_b32 v77, 7, v1
    v_lshrrev_b32 v78, 4, v1
    v_or_b32 v79, 0, v78
    v_xor_b32 v79, v79, v77
    v_lshlrev_b32 v79, 4, v79
    v_add_u32 v79, v79, v76
    v_add_u32 v64, 0, v79
    v_or_b32 v79, 4, v78
    v_xor_b32 v79, v79, v77
    v_lshlrev_b32 v79, 4, v79
    v_add_u32 v79, v79, v76
    v_add_u32 v65, 1024, v79
    v_or_b32 v79, 0, v78
    v_xor_b32 v79, v79, v77
    v_lshlrev_b32 v79, 4, v79
    v_add_u32 v79, v79, v76
    v_add_u32 v66, 2048, v79
    v_or_b32 v79, 4, v78
    v_xor_b32 v79, v79, v77
    v_lshlrev_b32 v79, 4, v79
    v_add_u32 v79, v79, v76
    v_add_u32 v67, 3072, v79
    v_or_b32 v79, 0, v78
    v_xor_b32 v79, v79, v77
    v_lshlrev_b32 v79, 4, v79
    v_add_u32 v79, v79, v76
    v_add_u32 v68, 8192, v79
    v_or_b32 v79, 4, v78
    v_xor_b32 v79, v79, v77
    v_lshlrev_b32 v79, 4, v79
    v_add_u32 v79, v79, v76
    v_add_u32 v69, 9216, v79
    v_or_b32 v79, 0, v78
    v_xor_b32 v79, v79, v77
    v_lshlrev_b32 v79, 4, v79
    v_add_u32 v79, v79, v76
    v_add_u32 v70, 10240, v79
    v_or_b32 v79, 4, v78
    v_xor_b32 v79, v79, v77
    v_lshlrev_b32 v79, 4, v79
    v_add_u32 v79, v79, v76
    v_add_u32 v71, 11264, v79
    v_and_b32 v76, 15, v1
    v_lshrrev_b32 v77, 1, v76
    v_and_b32 v76, 1, v76
    v_lshlrev_b32 v76, 4, v76
    s_lshl_b32 s58, s25, 4
    v_add_u32 v79, s58, v78
    s_mov_b32 s59, 7168
    v_mul_lo_u32 v79, v79, s59
    v_add_u32 v79, v79, v76
    v_or_b32 v76, 0, v78
    v_xor_b32 v76, v76, v77
    v_lshlrev_b32 v76, 5, v76
    v_add_u32 v76, v76, v79
    v_add_u32 v72, 0, v76
    v_or_b32 v76, 0, v78
    v_xor_b32 v76, v76, v77
    v_lshlrev_b32 v76, 5, v76
    v_add_u32 v76, v76, v79
    v_add_u32 v73, 27648, v76
    v_or_b32 v76, 4, v78
    v_xor_b32 v76, v76, v77
    v_lshlrev_b32 v76, 5, v76
    v_add_u32 v76, v76, v79
    v_add_u32 v74, 55296, v76
    v_or_b32 v76, 4, v78
    v_xor_b32 v76, v76, v77
    v_lshlrev_b32 v76, 5, v76
    v_add_u32 v76, v76, v79
    v_add_u32 v75, 82944, v76
    s_lshl_b32 s58, s25, 13
    s_lshl_b32 s59, s25, 12
    s_add_u32 s59, s59, 32768
    s_mov_b32 s66, 0
    s_add_u32 m0, s66, s58
    s_nop 0
    buffer_load_dwordx4 v64, s[48:51], s56 offen offset:0 lds
    buffer_load_dwordx4 v65, s[48:51], s56 offen offset:1024 lds
    buffer_load_dwordx4 v66, s[48:51], s56 offen offset:2048 lds
    buffer_load_dwordx4 v67, s[48:51], s56 offen offset:3072 lds
    s_add_u32 m0, m0, 4096
    s_nop 0
    buffer_load_dwordx4 v68, s[48:51], s56 offen offset:0 lds
    buffer_load_dwordx4 v69, s[48:51], s56 offen offset:1024 lds
    buffer_load_dwordx4 v70, s[48:51], s56 offen offset:2048 lds
    buffer_load_dwordx4 v71, s[48:51], s56 offen offset:3072 lds
    s_add_u32 m0, s66, s59
    s_add_u32 s56, s56, 128
    s_add_u32 s66, s66, 49152
    buffer_load_dwordx4 v72, s[52:55], s57 offen lds
    buffer_load_dwordx4 v73, s[52:55], s57 offen offset:1024 lds
    buffer_load_dwordx4 v74, s[52:55], s57 offen offset:2048 lds
    buffer_load_dwordx4 v75, s[52:55], s57 offen offset:3072 lds
    s_add_u32 s57, s57, 458752
    s_cmp_eq_u32 s66, 147456
    s_cselect_b32 s66, 0, s66
    s_add_u32 m0, s66, s58
    s_nop 0
    buffer_load_dwordx4 v64, s[48:51], s56 offen offset:0 lds
    buffer_load_dwordx4 v65, s[48:51], s56 offen offset:1024 lds
    buffer_load_dwordx4 v66, s[48:51], s56 offen offset:2048 lds
    buffer_load_dwordx4 v67, s[48:51], s56 offen offset:3072 lds
    s_add_u32 m0, m0, 4096
    s_nop 0
    buffer_load_dwordx4 v68, s[48:51], s56 offen offset:0 lds
    buffer_load_dwordx4 v69, s[48:51], s56 offen offset:1024 lds
    buffer_load_dwordx4 v70, s[48:51], s56 offen offset:2048 lds
    buffer_load_dwordx4 v71, s[48:51], s56 offen offset:3072 lds
    s_add_u32 m0, s66, s59
    s_add_u32 s56, s56, 128
    s_add_u32 s66, s66, 49152
    buffer_load_dwordx4 v72, s[52:55], s57 offen lds
    buffer_load_dwordx4 v73, s[52:55], s57 offen offset:1024 lds
    buffer_load_dwordx4 v74, s[52:55], s57 offen offset:2048 lds
    buffer_load_dwordx4 v75, s[52:55], s57 offen offset:3072 lds
    s_add_u32 s57, s57, 458752
    s_cmp_eq_u32 s66, 147456
    s_cselect_b32 s66, 0, s66
    s_branch ka_hiw
ka_hitab:
    s_getpc_b64 s[48:49]
    s_add_u32 s48, s48, tab_f2@rel32@lo+4
    s_addc_u32 s49, s49, tab_f2@rel32@hi+12
    s_mov_b32 s50, 51200
    s_mov_b32 s51, 0x20000
    v_lshlrev_b32 v64, 4, v1
    s_add_u32 s56, s25, 0
    s_lshl_b32 s56, s56, 10
    s_mov_b32 m0, s56
    s_nop 0
    buffer_load_dwordx4 v64, s[48:51], s56 offen lds
    s_add_u32 s56, s25, 4
    s_lshl_b32 s56, s56, 10
    s_mov_b32 m0, s56
    s_nop 0
    buffer_load_dwordx4 v64, s[48:51], s56 offen lds
    s_add_u32 s56, s25, 8
    s_lshl_b32 s56, s56, 10
    s_mov_b32 m0, s56
    s_nop 0
    buffer_load_dwordx4 v64, s[48:51], s56 offen lds
    s_add_u32 s56, s25, 12
    s_lshl_b32 s56, s56, 10
    s_mov_b32 m0, s56
    s_nop 0
    buffer_load_dwordx4 v64, s[48:51], s56 offen lds
    s_add_u32 s56, s25, 16
    s_lshl_b32 s56, s56, 10
    s_mov_b32 m0, s56
    s_nop 0
    buffer_load_dwordx4 v64, s[48:51], s56 offen lds
    s_add_u32 s56, s25, 20
    s_lshl_b32 s56, s56, 10
    s_mov_b32 m0, s56
    s_nop 0
    buffer_load_dwordx4 v64, s[48:51], s56 offen lds
    s_add_u32 s56, s25, 24
    s_lshl_b32 s56, s56, 10
    s_mov_b32 m0, s56
    s_nop 0
    buffer_load_dwordx4 v64, s[48:51], s56 offen lds
    s_add_u32 s56, s25, 28
    s_lshl_b32 s56, s56, 10
    s_mov_b32 m0, s56
    s_nop 0
    buffer_load_dwordx4 v64, s[48:51], s56 offen lds
    s_add_u32 s56, s25, 32
    s_lshl_b32 s56, s56, 10
    s_mov_b32 m0, s56
    s_nop 0
    buffer_load_dwordx4 v64, s[48:51], s56 offen lds
    s_add_u32 s56, s25, 36
    s_lshl_b32 s56, s56, 10
    s_mov_b32 m0, s56
    s_nop 0
    buffer_load_dwordx4 v64, s[48:51], s56 offen lds
    s_add_u32 s56, s25, 40
    s_min_u32 s56, s56, 41
    s_lshl_b32 s56, s56, 10
    s_mov_b32 m0, s56
    s_nop 0
    buffer_load_dwordx4 v64, s[48:51], s56 offen lds
ka_hiw:
    s_lshr_b32 s34, s23, 1
    s_lshl_b32 s34, s34, 10
    s_and_b32 s35, s23, 1
    s_lshl_b32 s35, s35, 9
    s_add_u32 s34, s34, s35
    s_lshl_b32 s35, s26, 4
    s_add_u32 s35, s35, s34
    s_lshl_b32 s34, s25, 12
    s_add_u32 s34, s34, 131584
    v_and_b32 v48, 31, v1
    v_lshlrev_b32 v48, 7, v48
    v_lshrrev_b32 v49, 5, v1
    v_lshlrev_b32 v49, 6, v49
    v_add_u32 v48, v48, v49
    v_add_u32 v48, s34, v48
    v_lshlrev_b32 v49, 4, v1
    v_add_u32 v49, s34, v49
    v_lshrrev_b32 v4, 3, v1
    v_add_u32 v4, s33, v4
    v_lshlrev_b32 v4, 13, v4
    v_and_b32 v50, 7, v1
    v_lshlrev_b32 v50, 4, v50
    v_add_u32 v4, v4, v50
    s_waitcnt vmcnt(0)
    s_cmp_eq_u32 s40, 0
    s_cbranch_scc1 ka_noex2
    v_lshlrev_b32 v40, 16, v40
    v_lshlrev_b32 v41, 16, v41
    v_lshlrev_b32 v42, 16, v42
    v_lshlrev_b32 v43, 16, v43
    v_lshlrev_b32 v44, 16, v44
    v_lshlrev_b32 v45, 16, v45
    v_lshlrev_b32 v46, 16, v46
    v_lshlrev_b32 v47, 16, v47
    v_add_f32 v40, v40, v42
    v_sub_f32 v41, v41, v43
    v_add_f32 v44, v44, v46
    v_sub_f32 v45, v45, v47
    v_cmp_gt_u32 vcc, 32, v1
    v_mov_b32 v46, 0.5
    v_mov_b32 v47, -0.5
    v_cndmask_b32 v46, v47, v46, vcc
    v_mul_f32 v44, v44, v46
    v_mul_f32 v45, v45, v46
    v_fma_f32 v40, v40, 0.5, v44
    v_fma_f32 v41, v41, 0.5, v45
    v_mul_f32 v40, 0.5, v40
    v_mul_f32 v41, 0.5, v41
    v_cvt_pk_bf16_f32 v40, v40, v41
    v_and_b32 v5, 7, v1
    v_lshlrev_b32 v5, 4, v5
    v_bfe_u32 v6, v1, 3, 2
    v_lshl_add_u32 v5, v6, 2, v5
    v_mov_b32 v6, 4202496
    v_mov_b32 v7, 4194304
    v_cndmask_b32 v6, v7, v6, vcc
    v_add_u32 v5, v6, v5
    buffer_store_dword v40, v5, s[36:39], s35 offen sc1
ka_noex2:
    v_lshl_or_b32 v8, v24, 16, v8
    v_lshl_or_b32 v9, v25, 16, v9
    v_lshl_or_b32 v10, v26, 16, v10
    v_lshl_or_b32 v11, v27, 16, v11
    ds_write_b128 v48, v[8:11] offset:0
    v_lshl_or_b32 v12, v28, 16, v12
    v_lshl_or_b32 v13, v29, 16, v13
    v_lshl_or_b32 v14, v30, 16, v14
    v_lshl_or_b32 v15, v31, 16, v15
    ds_write_b128 v48, v[12:15] offset:16
    v_lshl_or_b32 v16, v32, 16, v16
    v_lshl_or_b32 v17, v33, 16, v17
    v_lshl_or_b32 v18, v34, 16, v18
    v_lshl_or_b32 v19, v35, 16, v19
    ds_write_b128 v48, v[16:19] offset:32
    v_lshl_or_b32 v20, v36, 16, v20
    v_lshl_or_b32 v21, v37, 16, v21
    v_lshl_or_b32 v22, v38, 16, v22
    v_lshl_or_b32 v23, v39, 16, v23
    ds_write_b128 v48, v[20:23] offset:48
    s_waitcnt lgkmcnt(0)
    ds_read_b128 v[24:27], v49 offset:0
    ds_read_b128 v[28:31], v49 offset:1024
    ds_read_b128 v[32:35], v49 offset:2048
    ds_read_b128 v[36:39], v49 offset:3072
    s_waitcnt lgkmcnt(3)
    s_add_u32 s34, s35, 0
    buffer_store_dwordx4 v[24:27], v4, s[36:39], s34 offen sc1
    s_waitcnt lgkmcnt(2)
    s_add_u32 s34, s35, 65536
    buffer_store_dwordx4 v[28:31], v4, s[36:39], s34 offen sc1
    s_waitcnt lgkmcnt(1)
    s_add_u32 s34, s35, 131072
    buffer_store_dwordx4 v[32:35], v4, s[36:39], s34 offen sc1
    s_waitcnt lgkmcnt(0)
    s_add_u32 s34, s35, 196608
    buffer_store_dwordx4 v[36:39], v4, s[36:39], s34 offen sc1
    s_add_u32 s40, s6, 4194304
    s_addc_u32 s41, s7, 0
    s_mov_b32 s42, 4210688
    s_mov_b32 s43, 0x20000
    s_mov_b32 s44, s6
    s_mov_b32 s45, s7
    s_mov_b32 s46, 16384
    s_mov_b32 s47, 0x20000
    v_and_b32 v80, 255, v0
    v_and_b32 v81, 1, v80
    v_lshlrev_b32 v81, 13, v81
    v_lshrrev_b32 v82, 1, v80
    v_lshlrev_b32 v82, 4, v82
    v_add_u32 v81, v81, v82
    v_add_u32 v81, 114688, v81
    v_lshrrev_b32 v82, 2, v80
    v_lshlrev_b32 v82, 14, v82
    v_and_b32 v83, 3, v80
    v_lshlrev_b32 v83, 4, v83
    v_add_u32 v82, v82, v83
    s_lshl_b32 s33, s73, 6
    s_add_u32 s26, s33, 1048576
    s_add_u32 s27, s33, 2097152
    s_add_u32 s28, s33, 3145728
    s_add_u32 s29, s33, 4194304
    v_lshlrev_b32 v83, 4, v1
    v_mov_b32 v104, 131072
    v_add_u32 v105, 131136, v83
    s_barrier
    ds_read_b128 v[84:87], v81 offset:0
    ds_read_b128 v[88:91], v81 offset:2048
    ds_read_b128 v[92:95], v81 offset:4096
    ds_read_b128 v[96:99], v81 offset:6144
    ds_read_b128 v[100:103], v104
    ds_read_b128 v[108:111], v105
    s_waitcnt lgkmcnt(5)
    buffer_store_dwordx4 v[84:87], v82, s[40:43], s33 offen sc1
    s_waitcnt lgkmcnt(4)
    buffer_store_dwordx4 v[88:91], v82, s[40:43], s26 offen sc1
    s_waitcnt lgkmcnt(3)
    buffer_store_dwordx4 v[92:95], v82, s[40:43], s27 offen sc1
    s_waitcnt lgkmcnt(2)
    buffer_store_dwordx4 v[96:99], v82, s[40:43], s28 offen sc1
    s_waitcnt lgkmcnt(0)
    s_cmp_eq_u32 s25, 0
    s_cbranch_scc0 ka_nony
    s_mov_b64 exec, 15
    buffer_store_dwordx4 v[108:111], v83, s[44:47], s33 offen sc1
    s_mov_b64 exec, -1
ka_nony:
    s_cmp_ge_u32 s72, 28
    s_cbranch_scc1 ka_f2hi
    s_barrier
    s_add_u32 m0, s66, s58
    s_nop 0
    buffer_load_dwordx4 v64, s[48:51], s56 offen offset:0 lds
    buffer_load_dwordx4 v65, s[48:51], s56 offen offset:1024 lds
    buffer_load_dwordx4 v66, s[48:51], s56 offen offset:2048 lds
    buffer_load_dwordx4 v67, s[48:51], s56 offen offset:3072 lds
    s_add_u32 m0, m0, 4096
    s_nop 0
    buffer_load_dwordx4 v68, s[48:51], s56 offen offset:0 lds
    buffer_load_dwordx4 v69, s[48:51], s56 offen offset:1024 lds
    buffer_load_dwordx4 v70, s[48:51], s56 offen offset:2048 lds
    buffer_load_dwordx4 v71, s[48:51], s56 offen offset:3072 lds
    s_add_u32 m0, s66, s59
    s_add_u32 s56, s56, 128
    s_add_u32 s66, s66, 49152
    buffer_load_dwordx4 v72, s[52:55], s57 offen lds
    buffer_load_dwordx4 v73, s[52:55], s57 offen offset:1024 lds
    buffer_load_dwordx4 v74, s[52:55], s57 offen offset:2048 lds
    buffer_load_dwordx4 v75, s[52:55], s57 offen offset:3072 lds
    s_add_u32 s57, s57, 458752
    s_cmp_eq_u32 s66, 147456
    s_cselect_b32 s66, 0, s66
    s_mul_i32 s26, s70, 28
    s_add_u32 s26, s26, s71
    s_lshl_b32 s27, s26, 4
    s_lshl_b32 s28, s25, 2
    s_add_u32 s27, s27, s28
    s_lshl_b32 s28, s27, 11
    s_lshl_b32 s27, s27, 8
    v_lshlrev_b32 v16, 4, v1
    v_lshrrev_b32 v17, 4, v1
    v_mul_u32_u24 v17, 3584, v17
    v_lshlrev_b32 v17, 8, v17
    v_and_b32 v18, 1, v1
    v_lshlrev_b32 v18, 4, v18
    v_add_u32 v17, v17, v18
    v_bfe_u32 v18, v1, 1, 3
    s_lshr_b32 s29, s25, 1
    s_lshl_b32 s29, s29, 2
    s_or_b32 s30, s29, 0
    v_xor_b32 v19, s30, v18
    v_lshlrev_b32 v19, 5, v19
    v_add_u32 v20, v17, v19
    s_or_b32 s30, s29, 1
    v_xor_b32 v19, s30, v18
    v_lshlrev_b32 v19, 5, v19
    v_add_u32 v21, v17, v19
    s_or_b32 s30, s29, 2
    v_xor_b32 v19, s30, v18
    v_lshlrev_b32 v19, 5, v19
    v_add_u32 v22, v17, v19
    s_or_b32 s30, s29, 3
    v_xor_b32 v19, s30, v18
    v_lshlrev_b32 v19, 5, v19
    v_add_u32 v23, v17, v19
    s_mov_b32 s12, s62
    s_mov_b32 s13, s63
    s_mov_b32 s14, 7340032
    s_mov_b32 s15, 0x20000
    s_add_u32 s16, s6, 41943040
    s_addc_u32 s17, s7, 0
    s_mov_b32 s18, 7340032
    s_mov_b32 s19, 0x20000
    s_add_u32 s36, s6, 37748736
    s_addc_u32 s37, s7, 0
    s_mov_b32 s38, 4194304
    s_mov_b32 s39, 0x20000
    s_lshl_b32 s30, s26, 2
    s_add_u32 s30, s30, s25
    s_lshl_b32 s30, s30, 10
    v_lshlrev_b32 v24, 4, v1
    v_add_u32 v24, s30, v24
    v_add_u32 v25, 917504, v24
    v_add_u32 v26, 917504, v25
    v_add_u32 v27, 917504, v26
    v_add_u32 v28, 917504, v27
    v_mov_b32 v100, -1
    v_mov_b32 v101, -1
    v_mov_b32 v102, -1
    v_mov_b32 v103, -1
    s_barrier
    s_add_u32 m0, s66, s58
    s_nop 0
    buffer_load_dwordx4 v64, s[48:51], s56 offen offset:0 lds
    buffer_load_dwordx4 v65, s[48:51], s56 offen offset:1024 lds
    buffer_load_dwordx4 v66, s[48:51], s56 offen offset:2048 lds
    buffer_load_dwordx4 v67, s[48:51], s56 offen offset:3072 lds
    s_add_u32 m0, m0, 4096
    s_nop 0
    buffer_load_dwordx4 v68, s[48:51], s56 offen offset:0 lds
    buffer_load_dwordx4 v69, s[48:51], s56 offen offset:1024 lds
    buffer_load_dwordx4 v70, s[48:51], s56 offen offset:2048 lds
    buffer_load_dwordx4 v71, s[48:51], s56 offen offset:3072 lds
    s_add_u32 m0, s66, s59
    s_add_u32 s56, s56, 128
    s_add_u32 s66, s66, 49152
    buffer_load_dwordx4 v72, s[52:55], s57 offen lds
    buffer_load_dwordx4 v73, s[52:55], s57 offen offset:1024 lds
    buffer_load_dwordx4 v74, s[52:55], s57 offen offset:2048 lds
    buffer_load_dwordx4 v75, s[52:55], s57 offen offset:3072 lds
    s_add_u32 s57, s57, 458752
    s_cmp_eq_u32 s66, 147456
    s_cselect_b32 s66, 0, s66
    s_waitcnt vmcnt(12)
    s_barrier
    s_add_u32 m0, s66, s58
    s_nop 0
    buffer_load_dwordx4 v64, s[48:51], s56 offen offset:0 lds
    buffer_load_dwordx4 v65, s[48:51], s56 offen offset:1024 lds
    buffer_load_dwordx4 v66, s[48:51], s56 offen offset:2048 lds
    buffer_load_dwordx4 v67, s[48:51], s56 offen offset:3072 lds
    s_add_u32 m0, m0, 4096
    s_nop 0
    buffer_load_dwordx4 v68, s[48:51], s56 offen offset:0 lds
    buffer_load_dwordx4 v69, s[48:51], s56 offen offset:1024 lds
    buffer_load_dwordx4 v70, s[48:51], s56 offen offset:2048 lds
    buffer_load_dwordx4 v71, s[48:51], s56 offen offset:3072 lds
    s_add_u32 m0, s66, s59
    s_add_u32 s56, s56, 128
    s_add_u32 s66, s66, 49152
    buffer_load_dwordx4 v72, s[52:55], s57 offen lds
    buffer_load_dwordx4 v73, s[52:55], s57 offen offset:1024 lds
    buffer_load_dwordx4 v74, s[52:55], s57 offen offset:2048 lds
    buffer_load_dwordx4 v75, s[52:55], s57 offen offset:3072 lds
    s_add_u32 s57, s57, 458752
    s_cmp_eq_u32 s66, 147456
    s_cselect_b32 s66, 0, s66
    s_waitcnt vmcnt(12)
    s_barrier
    s_add_u32 m0, s66, s58
    s_nop 0
    buffer_load_dwordx4 v64, s[48:51], s56 offen offset:0 lds
    buffer_load_dwordx4 v65, s[48:51], s56 offen offset:1024 lds
    buffer_load_dwordx4 v66, s[48:51], s56 offen offset:2048 lds
    buffer_load_dwordx4 v67, s[48:51], s56 offen offset:3072 lds
    s_add_u32 m0, m0, 4096
    s_nop 0
    buffer_load_dwordx4 v68, s[48:51], s56 offen offset:0 lds
    buffer_load_dwordx4 v69, s[48:51], s56 offen offset:1024 lds
    buffer_load_dwordx4 v70, s[48:51], s56 offen offset:2048 lds
    buffer_load_dwordx4 v71, s[48:51], s56 offen offset:3072 lds
    s_add_u32 m0, s66, s59
    s_add_u32 s56, s56, 128
    s_add_u32 s66, s66, 49152
    buffer_load_dwordx4 v72, s[52:55], s57 offen lds
    buffer_load_dwordx4 v73, s[52:55], s57 offen offset:1024 lds
    buffer_load_dwordx4 v74, s[52:55], s57 offen offset:2048 lds
    buffer_load_dwordx4 v75, s[52:55], s57 offen offset:3072 lds
    s_add_u32 s57, s57, 458752
    s_cmp_eq_u32 s66, 147456
    s_cselect_b32 s66, 0, s66
    s_waitcnt vmcnt(12)
    s_barrier
    s_add_u32 m0, s66, s58
    s_nop 0
    buffer_load_dwordx4 v64, s[48:51], s56 offen offset:0 lds
    buffer_load_dwordx4 v65, s[48:51], s56 offen offset:1024 lds
    buffer_load_dwordx4 v66, s[48:51], s56 offen offset:2048 lds
    buffer_load_dwordx4 v67, s[48:51], s56 offen offset:3072 lds
    s_add_u32 m0, m0, 4096
    s_nop 0
    buffer_load_dwordx4 v68, s[48:51], s56 offen offset:0 lds
    buffer_load_dwordx4 v69, s[48:51], s56 offen offset:1024 lds
    buffer_load_dwordx4 v70, s[48:51], s56 offen offset:2048 lds
    buffer_load_dwordx4 v71, s[48:51], s56 offen offset:3072 lds
    s_add_u32 m0, s66, s59
    s_add_u32 s56, s56, 128
    s_add_u32 s66, s66, 49152
    buffer_load_dwordx4 v72, s[52:55], s57 offen lds
    buffer_load_dwordx4 v73, s[52:55], s57 offen offset:1024 lds
    buffer_load_dwordx4 v74, s[52:55], s57 offen offset:2048 lds
    buffer_load_dwordx4 v75, s[52:55], s57 offen offset:3072 lds
    s_add_u32 s57, s57, 458752
    s_cmp_eq_u32 s66, 147456
    s_cselect_b32 s66, 0, s66
    s_waitcnt vmcnt(12)
    s_barrier
    s_add_u32 m0, s66, s58
    s_nop 0
    buffer_load_dwordx4 v64, s[48:51], s56 offen offset:0 lds
    buffer_load_dwordx4 v65, s[48:51], s56 offen offset:1024 lds
    buffer_load_dwordx4 v66, s[48:51], s56 offen offset:2048 lds
    buffer_load_dwordx4 v67, s[48:51], s56 offen offset:3072 lds
    s_add_u32 m0, m0, 4096
    s_nop 0
    buffer_load_dwordx4 v68, s[48:51], s56 offen offset:0 lds
    buffer_load_dwordx4 v69, s[48:51], s56 offen offset:1024 lds
    buffer_load_dwordx4 v70, s[48:51], s56 offen offset:2048 lds
    buffer_load_dwordx4 v71, s[48:51], s56 offen offset:3072 lds
    s_add_u32 m0, s66, s59
    s_add_u32 s56, s56, 128
    s_add_u32 s66, s66, 49152
    buffer_load_dwordx4 v72, s[52:55], s57 offen lds
    buffer_load_dwordx4 v73, s[52:55], s57 offen offset:1024 lds
    buffer_load_dwordx4 v74, s[52:55], s57 offen offset:2048 lds
    buffer_load_dwordx4 v75, s[52:55], s57 offen offset:3072 lds
    s_add_u32 s57, s57, 458752
    s_cmp_eq_u32 s66, 147456
    s_cselect_b32 s66, 0, s66
    s_waitcnt vmcnt(12)
    s_barrier
    s_add_u32 m0, s66, s58
    s_nop 0
    buffer_load_dwordx4 v64, s[48:51], s56 offen offset:0 lds
    buffer_load_dwordx4 v65, s[48:51], s56 offen offset:1024 lds
    buffer_load_dwordx4 v66, s[48:51], s56 offen offset:2048 lds
    buffer_load_dwordx4 v67, s[48:51], s56 offen offset:3072 lds
    s_add_u32 m0, m0, 4096
    s_nop 0
    buffer_load_dwordx4 v68, s[48:51], s56 offen offset:0 lds
    buffer_load_dwordx4 v69, s[48:51], s56 offen offset:1024 lds
    buffer_load_dwordx4 v70, s[48:51], s56 offen offset:2048 lds
    buffer_load_dwordx4 v71, s[48:51], s56 offen offset:3072 lds
    s_add_u32 m0, s66, s59
    s_add_u32 s56, s56, 128
    s_add_u32 s66, s66, 49152
    buffer_load_dwordx4 v72, s[52:55], s57 offen lds
    buffer_load_dwordx4 v73, s[52:55], s57 offen offset:1024 lds
    buffer_load_dwordx4 v74, s[52:55], s57 offen offset:2048 lds
    buffer_load_dwordx4 v75, s[52:55], s57 offen offset:3072 lds
    s_add_u32 s57, s57, 458752
    s_cmp_eq_u32 s66, 147456
    s_cselect_b32 s66, 0, s66
    s_waitcnt vmcnt(12)
    s_barrier
    s_add_u32 m0, s66, s58
    s_nop 0
    buffer_load_dwordx4 v64, s[48:51], s56 offen offset:0 lds
    buffer_load_dwordx4 v65, s[48:51], s56 offen offset:1024 lds
    buffer_load_dwordx4 v66, s[48:51], s56 offen offset:2048 lds
    buffer_load_dwordx4 v67, s[48:51], s56 offen offset:3072 lds
    s_add_u32 m0, m0, 4096
    s_nop 0
    buffer_load_dwordx4 v68, s[48:51], s56 offen offset:0 lds
    buffer_load_dwordx4 v69, s[48:51], s56 offen offset:1024 lds
    buffer_load_dwordx4 v70, s[48:51], s56 offen offset:2048 lds
    buffer_load_dwordx4 v71, s[48:51], s56 offen offset:3072 lds
    s_add_u32 m0, s66, s59
    s_add_u32 s56, s56, 128
    s_add_u32 s66, s66, 49152
    buffer_load_dwordx4 v72, s[52:55], s57 offen lds
    buffer_load_dwordx4 v73, s[52:55], s57 offen offset:1024 lds
    buffer_load_dwordx4 v74, s[52:55], s57 offen offset:2048 lds
    buffer_load_dwordx4 v75, s[52:55], s57 offen offset:3072 lds
    s_add_u32 s57, s57, 458752
    s_cmp_eq_u32 s66, 147456
    s_cselect_b32 s66, 0, s66
    s_waitcnt vmcnt(12)
    s_barrier
    s_add_u32 m0, s66, s58
    s_nop 0
    buffer_load_dwordx4 v64, s[48:51], s56 offen offset:0 lds
    buffer_load_dwordx4 v65, s[48:51], s56 offen offset:1024 lds
    buffer_load_dwordx4 v66, s[48:51], s56 offen offset:2048 lds
    buffer_load_dwordx4 v67, s[48:51], s56 offen offset:3072 lds
    s_add_u32 m0, m0, 4096
    s_nop 0
    buffer_load_dwordx4 v68, s[48:51], s56 offen offset:0 lds
    buffer_load_dwordx4 v69, s[48:51], s56 offen offset:1024 lds
    buffer_load_dwordx4 v70, s[48:51], s56 offen offset:2048 lds
    buffer_load_dwordx4 v71, s[48:51], s56 offen offset:3072 lds
    s_add_u32 m0, s66, s59
    s_add_u32 s56, s56, 128
    s_add_u32 s66, s66, 49152
    buffer_load_dwordx4 v72, s[52:55], s57 offen lds
    buffer_load_dwordx4 v73, s[52:55], s57 offen offset:1024 lds
    buffer_load_dwordx4 v74, s[52:55], s57 offen offset:2048 lds
    buffer_load_dwordx4 v75, s[52:55], s57 offen offset:3072 lds
    s_add_u32 s57, s57, 458752
    s_cmp_eq_u32 s66, 147456
    s_cselect_b32 s66, 0, s66
    s_waitcnt vmcnt(12)
    s_barrier
    s_add_u32 m0, s66, s58
    s_nop 0
    buffer_load_dwordx4 v64, s[48:51], s56 offen offset:0 lds
    buffer_load_dwordx4 v65, s[48:51], s56 offen offset:1024 lds
    buffer_load_dwordx4 v66, s[48:51], s56 offen offset:2048 lds
    buffer_load_dwordx4 v67, s[48:51], s56 offen offset:3072 lds
    s_add_u32 m0, m0, 4096
    s_nop 0
    buffer_load_dwordx4 v68, s[48:51], s56 offen offset:0 lds
    buffer_load_dwordx4 v69, s[48:51], s56 offen offset:1024 lds
    buffer_load_dwordx4 v70, s[48:51], s56 offen offset:2048 lds
    buffer_load_dwordx4 v71, s[48:51], s56 offen offset:3072 lds
    s_add_u32 m0, s66, s59
    s_add_u32 s56, s56, 128
    s_add_u32 s66, s66, 49152
    buffer_load_dwordx4 v72, s[52:55], s57 offen lds
    buffer_load_dwordx4 v73, s[52:55], s57 offen offset:1024 lds
    buffer_load_dwordx4 v74, s[52:55], s57 offen offset:2048 lds
    buffer_load_dwordx4 v75, s[52:55], s57 offen offset:3072 lds
    s_add_u32 s57, s57, 458752
    s_cmp_eq_u32 s66, 147456
    s_cselect_b32 s66, 0, s66
    s_waitcnt vmcnt(12)
    s_barrier
    s_add_u32 m0, s66, s58
    s_nop 0
    buffer_load_dwordx4 v64, s[48:51], s56 offen offset:0 lds
    buffer_load_dwordx4 v65, s[48:51], s56 offen offset:1024 lds
    buffer_load_dwordx4 v66, s[48:51], s56 offen offset:2048 lds
    buffer_load_dwordx4 v67, s[48:51], s56 offen offset:3072 lds
    s_add_u32 m0, m0, 4096
    s_nop 0
    buffer_load_dwordx4 v68, s[48:51], s56 offen offset:0 lds
    buffer_load_dwordx4 v69, s[48:51], s56 offen offset:1024 lds
    buffer_load_dwordx4 v70, s[48:51], s56 offen offset:2048 lds
    buffer_load_dwordx4 v71, s[48:51], s56 offen offset:3072 lds
    s_add_u32 m0, s66, s59
    s_add_u32 s56, s56, 128
    s_add_u32 s66, s66, 49152
    buffer_load_dwordx4 v72, s[52:55], s57 offen lds
    buffer_load_dwordx4 v73, s[52:55], s57 offen offset:1024 lds
    buffer_load_dwordx4 v74, s[52:55], s57 offen offset:2048 lds
    buffer_load_dwordx4 v75, s[52:55], s57 offen offset:3072 lds
    s_add_u32 s57, s57, 458752
    s_cmp_eq_u32 s66, 147456
    s_cselect_b32 s66, 0, s66
    s_lshl_b32 s30, s70, 5
    v_and_b32 v8, 7, v1
    v_lshlrev_b32 v8, 2, v8
    v_add_u32 v8, s30, v8
    global_load_dword v9, v8, s[64:65] sc1
    s_lshl_b32 s33, s70, 11
    s_lshl_b32 s30, s25, 9
    s_add_u32 s33, s33, s30
    v_lshlrev_b32 v10, 3, v1
    s_add_u32 s30, s30, 147456
    v_add_u32 v11, s30, v10
    s_waitcnt vmcnt(13)
    s_barrier
    s_add_u32 m0, s66, s58
    s_nop 0
    buffer_load_dwordx4 v64, s[48:51], s56 offen offset:0 lds
    buffer_load_dwordx4 v65, s[48:51], s56 offen offset:1024 lds
    buffer_load_dwordx4 v66, s[48:51], s56 offen offset:2048 lds
    buffer_load_dwordx4 v67, s[48:51], s56 offen offset:3072 lds
    s_add_u32 m0, m0, 4096
    s_nop 0
    buffer_load_dwordx4 v68, s[48:51], s56 offen offset:0 lds
    buffer_load_dwordx4 v69, s[48:51], s56 offen offset:1024 lds
    buffer_load_dwordx4 v70, s[48:51], s56 offen offset:2048 lds
    buffer_load_dwordx4 v71, s[48:51], s56 offen offset:3072 lds
    s_add_u32 m0, s66, s59
    s_add_u32 s56, s56, 128
    s_add_u32 s66, s66, 49152
    buffer_load_dwordx4 v72, s[52:55], s57 offen lds
    buffer_load_dwordx4 v73, s[52:55], s57 offen offset:1024 lds
    buffer_load_dwordx4 v74, s[52:55], s57 offen offset:2048 lds
    buffer_load_dwordx4 v75, s[52:55], s57 offen offset:3072 lds
    s_add_u32 s57, s57, 458752
    s_cmp_eq_u32 s66, 147456
    s_cselect_b32 s66, 0, s66
    s_waitcnt vmcnt(13)
    s_barrier
    s_add_u32 m0, s66, s58
    s_nop 0
    buffer_load_dwordx4 v64, s[48:51], s56 offen offset:0 lds
    buffer_load_dwordx4 v65, s[48:51], s56 offen offset:1024 lds
    buffer_load_dwordx4 v66, s[48:51], s56 offen offset:2048 lds
    buffer_load_dwordx4 v67, s[48:51], s56 offen offset:3072 lds
    s_add_u32 m0, m0, 4096
    s_nop 0
    buffer_load_dwordx4 v68, s[48:51], s56 offen offset:0 lds
    buffer_load_dwordx4 v69, s[48:51], s56 offen offset:1024 lds
    buffer_load_dwordx4 v70, s[48:51], s56 offen offset:2048 lds
    buffer_load_dwordx4 v71, s[48:51], s56 offen offset:3072 lds
    s_add_u32 m0, s66, s59
    s_add_u32 s56, s56, 128
    s_add_u32 s66, s66, 49152
    buffer_load_dwordx4 v72, s[52:55], s57 offen lds
    buffer_load_dwordx4 v73, s[52:55], s57 offen offset:1024 lds
    buffer_load_dwordx4 v74, s[52:55], s57 offen offset:2048 lds
    buffer_load_dwordx4 v75, s[52:55], s57 offen offset:3072 lds
    s_add_u32 s57, s57, 458752
    s_cmp_eq_u32 s66, 147456
    s_cselect_b32 s66, 0, s66
    s_waitcnt vmcnt(12)
    s_mov_b32 s31, 0
ka_spoll:
    v_cmp_gt_u32 vcc, 4, v9
    s_nop 3
    s_cmp_eq_u64 vcc, 0
    s_cbranch_scc1 ka_sready
    s_add_u32 s31, s31, 1
    s_cmp_ge_u32 s31, 400000
    s_cbranch_scc1 ka_sready
    s_sleep 1
    global_load_dword v9, v8, s[64:65] sc1
    s_waitcnt vmcnt(0)
    s_branch ka_spoll
ka_sready:
    buffer_load_dwordx2 v[12:13], v10, s[44:47], s33 offen sc1
    s_barrier
    s_add_u32 m0, s66, s58
    s_nop 0
    buffer_load_dwordx4 v64, s[48:51], s56 offen offset:0 lds
    buffer_load_dwordx4 v65, s[48:51], s56 offen offset:1024 lds
    buffer_load_dwordx4 v66, s[48:51], s56 offen offset:2048 lds
    buffer_load_dwordx4 v67, s[48:51], s56 offen offset:3072 lds
    s_add_u32 m0, m0, 4096
    s_nop 0
    buffer_load_dwordx4 v68, s[48:51], s56 offen offset:0 lds
    buffer_load_dwordx4 v69, s[48:51], s56 offen offset:1024 lds
    buffer_load_dwordx4 v70, s[48:51], s56 offen offset:2048 lds
    buffer_load_dwordx4 v71, s[48:51], s56 offen offset:3072 lds
    s_add_u32 m0, s66, s59
    s_add_u32 s56, s56, 128
    s_add_u32 s66, s66, 49152
    buffer_load_dwordx4 v72, s[52:55], s57 offen lds
    buffer_load_dwordx4 v73, s[52:55], s57 offen offset:1024 lds
    buffer_load_dwordx4 v74, s[52:55], s57 offen offset:2048 lds
    buffer_load_dwordx4 v75, s[52:55], s57 offen offset:3072 lds
    s_add_u32 s57, s57, 458752
    s_cmp_eq_u32 s66, 147456
    s_cselect_b32 s66, 0, s66
    s_add_u32 s30, s28, 0
    buffer_load_dwordx4 v[32:35], v16, s[12:15], s30 offen offset:0
    s_add_u32 s30, s28, 0
    buffer_load_dwordx4 v[36:39], v16, s[12:15], s30 offen offset:1024
    s_add_u32 s30, s28, 2048
    buffer_load_dwordx4 v[40:43], v16, s[12:15], s30 offen offset:0
    s_add_u32 s30, s28, 2048
    buffer_load_dwordx4 v[44:47], v16, s[12:15], s30 offen offset:1024
    s_add_u32 s30, s28, 4096
    buffer_load_dwordx4 v[48:51], v16, s[12:15], s30 offen offset:0
    s_add_u32 s30, s28, 4096
    buffer_load_dwordx4 v[52:55], v16, s[12:15], s30 offen offset:1024
    s_add_u32 s30, s28, 6144
    buffer_load_dwordx4 v[56:59], v16, s[12:15], s30 offen offset:0
    s_add_u32 s30, s28, 6144
    buffer_load_dwordx4 v[60:63], v16, s[12:15], s30 offen offset:1024
    s_waitcnt vmcnt(21)
    s_barrier
    s_waitcnt vmcnt(8)
    ds_write_b64 v11, v[12:13]
    s_waitcnt lgkmcnt(0)
    s_barrier
    s_barrier
    s_barrier
    s_waitcnt vmcnt(0)
    s_add_u32 s30, s27, 0
    buffer_store_dwordx4 v[32:35], v20, s[16:19], s30 offen
    s_add_u32 s30, s27, 3670016
    buffer_store_dwordx4 v[36:39], v20, s[16:19], s30 offen
    s_add_u32 s30, s27, 256
    buffer_store_dwordx4 v[40:43], v21, s[16:19], s30 offen
    s_add_u32 s30, s27, 3670272
    buffer_store_dwordx4 v[44:47], v21, s[16:19], s30 offen
    s_add_u32 s30, s27, 512
    buffer_store_dwordx4 v[48:51], v22, s[16:19], s30 offen
    s_add_u32 s30, s27, 3670528
    buffer_store_dwordx4 v[52:55], v22, s[16:19], s30 offen
    s_add_u32 s30, s27, 768
    buffer_store_dwordx4 v[56:59], v23, s[16:19], s30 offen
    s_add_u32 s30, s27, 3670784
    buffer_store_dwordx4 v[60:63], v23, s[16:19], s30 offen
    buffer_store_dwordx4 v[100:103], v24, s[36:39], 0 offen
    buffer_store_dwordx4 v[100:103], v25, s[36:39], 0 offen
    buffer_store_dwordx4 v[100:103], v26, s[36:39], 0 offen
    buffer_store_dwordx4 v[100:103], v27, s[36:39], 0 offen
    buffer_store_dwordx4 v[100:103], v28, s[36:39], 0 offen
    s_endpgm
ka_f2hi:
    s_add_u32 s25, s25, 4
    s_waitcnt vmcnt(0)
ka_f2lo:
    s_barrier
    s_and_b32 s20, s2, 7
    s_lshl_b32 s26, s20, 2
    s_sub_u32 s21, s72, 28
    s_add_u32 s26, s26, s21
    v_lshlrev_b32 v2, 4, v1
    v_lshlrev_b32 v3, 6, v1
    s_getpc_b64 s[16:17]
    s_add_u32 s16, s16, tab_f2@rel32@lo+4
    s_addc_u32 s17, s17, tab_f2@rel32@hi+12
    s_mov_b32 s18, 51200
    s_mov_b32 s19, 0x20000
    s_add_u32 s8, s6, 4194304
    s_addc_u32 s9, s7, 0
    s_mov_b32 s10, 4210688
    s_mov_b32 s11, 0x20000
    s_add_u32 s12, s6, 9437184
    s_addc_u32 s13, s7, 0
    s_mov_b32 s14, 4210688
    s_mov_b32 s15, 0x20000
    s_add_u32 s20, s6, 14680064
    s_addc_u32 s21, s7, 0
    s_mov_b32 s22, 4210688
    s_mov_b32 s23, 0x20000
    s_lshl_b32 s27, s26, 3
    s_add_u32 s27, s27, s25
    s_lshl_b32 s40, s27, 14
    s_lshl_b32 s41, s27, 14
    s_add_u32 s42, s40, 32
    s_add_u32 s43, s41, 8192
    s_mov_b32 s44, s42
    s_mov_b32 s45, s43
    s_mov_b32 s46, 2
    s_cmp_eq_u32 s27, 0
    s_cselect_b32 s41, 4202496, s41
    s_mov_b32 s28, 43008
    s_add_u32 s29, s28, 4096
    buffer_load_dwordx4 v[184:187], v2, s[16:19], s28 offen offset:0
    buffer_load_dwordx4 v[188:191], v2, s[16:19], s28 offen offset:1024
    buffer_load_dwordx4 v[192:195], v2, s[16:19], s28 offen offset:2048
    buffer_load_dwordx4 v[196:199], v2, s[16:19], s28 offen offset:3072
    buffer_load_dwordx4 v[200:203], v2, s[16:19], s29 offen offset:0
    buffer_load_dwordx4 v[204:207], v2, s[16:19], s29 offen offset:1024
    buffer_load_dwordx4 v[208:211], v2, s[16:19], s29 offen offset:2048
    buffer_load_dwordx4 v[212:215], v2, s[16:19], s29 offen offset:3072
    v_mov_b32 v4, v2
    s_mov_b32 s34, 0xffff0000
    s_mul_i32 s28, s25, 4352
    s_add_u32 s28, s28, 43008
    s_mul_i32 s29, s25, 8448
    s_add_u32 s29, s29, 77824
    v_lshrrev_b32 v5, 2, v1
    v_lshlrev_b32 v5, 4, v5
    v_and_b32 v6, 1, v1
    v_bfe_u32 v7, v1, 1, 1
    v_mul_u32_u24 v248, 2112, v6
    v_add_u32 v248, s28, v248
    v_mul_u32_u24 v249, 4160, v6
    v_add_u32 v249, s29, v249
    v_add_u32 v249, 128, v249
    v_cmp_eq_u32 vcc, 0, v7
    s_nop 1
    v_cndmask_b32 v248, v249, v248, vcc
    v_add_u32 v248, v5, v248
    v_lshlrev_b32 v5, 11, v7
    v_add_u32 v249, v5, v248
    v_add_u32 v250, s28, v2
    s_add_u32 s29, s29, 128
    v_add_u32 v251, s29, v2
    s_cmp_lg_u32 s25, 4
    s_cbranch_scc1 ka_f2go
    s_and_b32 s28, s73, 0xfc
    v_mov_b32 v6, s28
    v_mov_b32 v7, 1
    s_mov_b64 exec, 1
    global_atomic_add v6, v7, s[64:65] sc1
    s_mov_b64 exec, -1
    v_lshlrev_b32 v6, 2, v1
    s_mov_b32 s29, 0
ka_f2poll:
    s_sleep 64
    global_load_dword v7, v6, s[64:65] sc1
    s_add_u32 s29, s29, 1
    s_cmp_ge_u32 s29, 400000
    s_cbranch_scc1 ka_f2go
    s_waitcnt vmcnt(0)
    v_cmp_gt_u32 vcc, 4, v7
    s_nop 3
    s_cmp_lg_u64 vcc, 0
    s_cbranch_scc1 ka_f2poll
ka_f2go:
    s_waitcnt vmcnt(0)
    s_barrier
    s_and_b32 s47, s40, 0xffffc000
    buffer_load_dwordx4 v[40:43], v2, s[8:11], s47 offen offset:0 sc1
    buffer_load_dwordx4 v[44:47], v2, s[8:11], s47 offen offset:1024 sc1
    buffer_load_dwordx4 v[48:51], v2, s[8:11], s47 offen offset:2048 sc1
    buffer_load_dwordx4 v[52:55], v2, s[8:11], s47 offen offset:3072 sc1
    s_add_u32 s47, s47, 4096
    buffer_load_dwordx4 v[56:59], v2, s[8:11], s47 offen offset:0 sc1
    buffer_load_dwordx4 v[60:63], v2, s[8:11], s47 offen offset:1024 sc1
    buffer_load_dwordx4 v[64:67], v2, s[8:11], s47 offen offset:2048 sc1
    buffer_load_dwordx4 v[68:71], v2, s[8:11], s47 offen offset:3072 sc1
    s_add_u32 s47, s47, 4096
    buffer_load_dwordx4 v[72:75], v2, s[8:11], s47 offen offset:0 sc1
    buffer_load_dwordx4 v[76:79], v2, s[8:11], s47 offen offset:1024 sc1
    buffer_load_dwordx4 v[80:83], v2, s[8:11], s47 offen offset:2048 sc1
    buffer_load_dwordx4 v[84:87], v2, s[8:11], s47 offen offset:3072 sc1
    s_add_u32 s47, s47, 4096
    buffer_load_dwordx4 v[88:91], v2, s[8:11], s47 offen offset:0 sc1
    buffer_load_dwordx4 v[92:95], v2, s[8:11], s47 offen offset:1024 sc1
    buffer_load_dwordx4 v[96:99], v2, s[8:11], s47 offen offset:2048 sc1
    buffer_load_dwordx4 v[100:103], v2, s[8:11], s47 offen offset:3072 sc1
    s_add_u32 s50, s41, 4096
    buffer_load_dwordx4 v[152:155], v2, s[12:15], s41 offen offset:0 sc1
    buffer_load_dwordx4 v[156:159], v2, s[12:15], s41 offen offset:1024 sc1
    buffer_load_dwordx4 v[160:163], v2, s[12:15], s41 offen offset:2048 sc1
    buffer_load_dwordx4 v[164:167], v2, s[12:15], s41 offen offset:3072 sc1
    buffer_load_dwordx4 v[168:171], v2, s[12:15], s50 offen offset:0 sc1
    buffer_load_dwordx4 v[172:175], v2, s[12:15], s50 offen offset:1024 sc1
    buffer_load_dwordx4 v[176:179], v2, s[12:15], s50 offen offset:2048 sc1
    buffer_load_dwordx4 v[180:183], v2, s[12:15], s50 offen offset:3072 sc1
    s_waitcnt vmcnt(23)
    ds_write_b128 v248, v[40:43] offset:0
    s_waitcnt vmcnt(22)
    ds_write_b128 v248, v[44:47] offset:256
    s_waitcnt vmcnt(21)
    ds_write_b128 v248, v[48:51] offset:512
    s_waitcnt vmcnt(20)
    ds_write_b128 v248, v[52:55] offset:768
    s_waitcnt vmcnt(19)
    ds_write_b128 v248, v[56:59] offset:1024
    s_waitcnt vmcnt(18)
    ds_write_b128 v248, v[60:63] offset:1280
    s_waitcnt vmcnt(17)
    ds_write_b128 v248, v[64:67] offset:1536
    s_waitcnt vmcnt(16)
    ds_write_b128 v248, v[68:71] offset:1792
    s_waitcnt lgkmcnt(0)
    ds_read_b128 v[8:11], v250 offset:0
    ds_read_b128 v[12:15], v250 offset:2112
    ds_read_b128 v[24:27], v250 offset:1024
    ds_read_b128 v[28:31], v250 offset:3136
    s_waitcnt lgkmcnt(0)
    s_waitcnt vmcnt(15)
    ds_write_b128 v249, v[72:75] offset:0
    s_waitcnt vmcnt(14)
    ds_write_b128 v249, v[76:79] offset:256
    s_waitcnt vmcnt(13)
    ds_write_b128 v249, v[80:83] offset:512
    s_waitcnt vmcnt(12)
    ds_write_b128 v249, v[84:87] offset:768
    s_waitcnt vmcnt(11)
    ds_write_b128 v249, v[88:91] offset:1024
    s_waitcnt vmcnt(10)
    ds_write_b128 v249, v[92:95] offset:1280
    s_waitcnt vmcnt(9)
    ds_write_b128 v249, v[96:99] offset:1536
    s_waitcnt vmcnt(8)
    ds_write_b128 v249, v[100:103] offset:1792
    s_waitcnt lgkmcnt(0)
    ds_read_b128 v[16:19], v250 offset:0
    ds_read_b128 v[20:23], v250 offset:2112
    ds_read_b128 v[32:35], v250 offset:1024
    ds_read_b128 v[36:39], v250 offset:3136
    s_waitcnt lgkmcnt(0)
    v_lshlrev_b32 v7, 5, v1
    s_mov_b32 s55, s46
    s_cmp_eq_u32 s27, 0
    s_cbranch_scc0 kaf_col
    v_and_b32 v5, 31, v1
    v_lshrrev_b32 v6, 5, v1
    v_lshlrev_b32 v6, 7, v6
    v_add_u32 v5, v5, v6
    v_lshlrev_b32 v5, 2, v5
    v_add_u32 v252, 145408, v5
    v_add_u32 v253, 128, v252
    v_sub_u32 v254, 146048, v5
    v_add_u32 v255, 128, v254
    s_and_b32 s51, s40, 32
    s_lshl_b32 s51, s51, 8
    s_and_b32 s52, s40, 0xffffffc0
    s_add_u32 s51, s51, s52
    s_add_u32 s52, s51, 2048
    s_add_u32 s53, s51, 4096
    s_add_u32 s54, s51, 6144
    ds_read_b128 v[216:219], v4 offset:0
    ds_read_b128 v[220:223], v4 offset:1024
    ds_read_b128 v[224:227], v4 offset:2048
    s_waitcnt vmcnt(8)
    s_waitcnt lgkmcnt(0)
    v_mfma_f32_32x32x16_bf16 v[40:55], v[8:11], v[216:219], 0
    ds_read_b128 v[228:231], v4 offset:6144
    ds_read_b128 v[232:235], v4 offset:7168
    ds_read_b128 v[236:239], v4 offset:8192
    v_mfma_f32_32x32x16_bf16 v[56:71], v[8:11], v[220:223], 0
    v_mfma_f32_32x32x16_bf16 v[40:55], v[12:15], v[224:227], v[40:55]
    v_mfma_f32_32x32x16_bf16 v[56:71], v[12:15], v[216:219], v[56:71]
    s_waitcnt lgkmcnt(0)
    v_mfma_f32_32x32x16_bf16 v[40:55], v[16:19], v[228:231], v[40:55]
    ds_read_b128 v[216:219], v4 offset:3072
    ds_read_b128 v[220:223], v4 offset:4096
    ds_read_b128 v[224:227], v4 offset:5120
    v_mfma_f32_32x32x16_bf16 v[56:71], v[16:19], v[232:235], v[56:71]
    v_mfma_f32_32x32x16_bf16 v[40:55], v[20:23], v[236:239], v[40:55]
    v_mfma_f32_32x32x16_bf16 v[56:71], v[20:23], v[228:231], v[56:71]
    s_waitcnt lgkmcnt(0)
    v_mfma_f32_32x32x16_bf16 v[72:87], v[24:27], v[216:219], 0
    ds_read_b128 v[228:231], v4 offset:9216
    ds_read_b128 v[232:235], v4 offset:10240
    ds_read_b128 v[236:239], v4 offset:11264
    v_mfma_f32_32x32x16_bf16 v[88:103], v[24:27], v[220:223], 0
    s_nop 5
    v_mul_f32 v240, v56, v200
    v_mul_f32 v241, v56, v184
    v_fma_f32 v56, v40, v200, v241
    v_fma_f32 v40, v40, v184, -v240
    v_mul_f32 v242, v57, v201
    v_mfma_f32_32x32x16_bf16 v[72:87], v[28:31], v[224:227], v[72:87]
    v_mul_f32 v243, v57, v185
    v_fma_f32 v57, v41, v201, v243
    v_fma_f32 v41, v41, v185, -v242
    v_cvt_pk_bf16_f32 v104, v40, v41
    v_cvt_pk_bf16_f32 v108, v56, v57
    v_mfma_f32_32x32x16_bf16 v[88:103], v[28:31], v[216:219], v[88:103]
    v_mul_f32 v240, v58, v202
    v_mul_f32 v241, v58, v186
    v_fma_f32 v58, v42, v202, v241
    v_fma_f32 v42, v42, v186, -v240
    v_mul_f32 v242, v59, v203
    s_waitcnt lgkmcnt(0)
    v_mfma_f32_32x32x16_bf16 v[72:87], v[32:35], v[228:231], v[72:87]
    ds_read_b128 v[216:219], v4 offset:12288
    ds_read_b128 v[220:223], v4 offset:13312
    ds_read_b128 v[224:227], v4 offset:14336
    v_mul_f32 v243, v59, v187
    v_fma_f32 v59, v43, v203, v243
    v_mfma_f32_32x32x16_bf16 v[88:103], v[32:35], v[232:235], v[88:103]
    v_fma_f32 v43, v43, v187, -v242
    v_cvt_pk_bf16_f32 v105, v42, v43
    v_cvt_pk_bf16_f32 v109, v58, v59
    v_mul_f32 v240, v60, v204
    v_mul_f32 v241, v60, v188
    v_mfma_f32_32x32x16_bf16 v[72:87], v[36:39], v[236:239], v[72:87]
    v_fma_f32 v60, v44, v204, v241
    v_fma_f32 v44, v44, v188, -v240
    v_mul_f32 v242, v61, v205
    v_mul_f32 v243, v61, v189
    v_fma_f32 v61, v45, v205, v243
    v_mfma_f32_32x32x16_bf16 v[88:103], v[36:39], v[228:231], v[88:103]
    v_fma_f32 v45, v45, v189, -v242
    v_cvt_pk_bf16_f32 v106, v44, v45
    v_cvt_pk_bf16_f32 v110, v60, v61
    v_mul_f32 v240, v62, v206
    v_mul_f32 v241, v62, v190
    s_mov_b32 s47, 4194304
    s_add_u32 s48, s47, 4096
    buffer_load_dwordx4 v[8:11], v2, s[12:15], s47 offen offset:0 sc1
    buffer_load_dwordx4 v[12:15], v2, s[12:15], s47 offen offset:1024 sc1
    buffer_load_dwordx4 v[16:19], v2, s[12:15], s47 offen offset:2048 sc1
    buffer_load_dwordx4 v[20:23], v2, s[12:15], s47 offen offset:3072 sc1
    buffer_load_dwordx4 v[24:27], v2, s[12:15], s48 offen offset:0 sc1
    buffer_load_dwordx4 v[28:31], v2, s[12:15], s48 offen offset:1024 sc1
    buffer_load_dwordx4 v[32:35], v2, s[12:15], s48 offen offset:2048 sc1
    buffer_load_dwordx4 v[36:39], v2, s[12:15], s48 offen offset:3072 sc1
    v_fma_f32 v62, v46, v206, v241
    v_fma_f32 v46, v46, v190, -v240
    v_mul_f32 v242, v63, v207
    v_mul_f32 v243, v63, v191
    v_fma_f32 v63, v47, v207, v243
    v_fma_f32 v47, v47, v191, -v242
    v_cvt_pk_bf16_f32 v107, v46, v47
    v_cvt_pk_bf16_f32 v111, v62, v63
    v_mul_f32 v240, v64, v208
    v_mul_f32 v241, v64, v192
    v_fma_f32 v64, v48, v208, v241
    v_fma_f32 v48, v48, v192, -v240
    v_mul_f32 v242, v65, v209
    v_mul_f32 v243, v65, v193
    v_fma_f32 v65, v49, v209, v243
    v_fma_f32 v49, v49, v193, -v242
    v_cvt_pk_bf16_f32 v112, v48, v49
    v_cvt_pk_bf16_f32 v116, v64, v65
    v_mul_f32 v240, v66, v210
    v_mul_f32 v241, v66, v194
    v_fma_f32 v66, v50, v210, v241
    v_fma_f32 v50, v50, v194, -v240
    v_mul_f32 v242, v67, v211
    v_mul_f32 v243, v67, v195
    v_fma_f32 v67, v51, v211, v243
    v_fma_f32 v51, v51, v195, -v242
    v_cvt_pk_bf16_f32 v113, v50, v51
    v_cvt_pk_bf16_f32 v117, v66, v67
    v_mul_f32 v240, v68, v212
    v_mul_f32 v241, v68, v196
    v_fma_f32 v68, v52, v212, v241
    v_fma_f32 v52, v52, v196, -v240
    v_mul_f32 v242, v69, v213
    v_mul_f32 v243, v69, v197
    v_fma_f32 v69, v53, v213, v243
    v_fma_f32 v53, v53, v197, -v242
    v_cvt_pk_bf16_f32 v114, v52, v53
    v_cvt_pk_bf16_f32 v118, v68, v69
    v_mul_f32 v240, v70, v214
    v_mul_f32 v241, v70, v198
    v_fma_f32 v70, v54, v214, v241
    v_fma_f32 v54, v54, v198, -v240
    v_mul_f32 v242, v71, v215
    v_mul_f32 v243, v71, v199
    v_fma_f32 v71, v55, v215, v243
    v_fma_f32 v55, v55, v199, -v242
    v_cvt_pk_bf16_f32 v115, v54, v55
    v_cvt_pk_bf16_f32 v119, v70, v71
    s_waitcnt lgkmcnt(0)
    v_mfma_f32_32x32x16_bf16 v[40:55], v[216:219], v[104:107], 0
    ds_read_b128 v[228:231], v4 offset:15360
    ds_read_b128 v[232:235], v4 offset:16384
    ds_read_b128 v[236:239], v4 offset:17408
    v_mfma_f32_32x32x16_bf16 v[56:71], v[220:223], v[104:107], 0
    v_mul_f32 v240, v88, v200
    v_mul_f32 v241, v88, v184
    v_fma_f32 v88, v72, v200, v241
    v_fma_f32 v72, v72, v184, -v240
    v_mul_f32 v242, v89, v201
    v_mfma_f32_32x32x16_bf16 v[40:55], v[224:227], v[108:111], v[40:55]
    v_mul_f32 v243, v89, v185
    v_fma_f32 v89, v73, v201, v243
    v_fma_f32 v73, v73, v185, -v242
    v_cvt_pk_bf16_f32 v120, v72, v73
    v_cvt_pk_bf16_f32 v124, v88, v89
    v_mfma_f32_32x32x16_bf16 v[56:71], v[216:219], v[108:111], v[56:71]
    v_mul_f32 v240, v90, v202
    v_mul_f32 v241, v90, v186
    v_fma_f32 v90, v74, v202, v241
    v_fma_f32 v74, v74, v186, -v240
    v_mul_f32 v242, v91, v203
    s_waitcnt lgkmcnt(0)
    v_mfma_f32_32x32x16_bf16 v[40:55], v[228:231], v[112:115], v[40:55]
    ds_read_b128 v[216:219], v4 offset:18432
    ds_read_b128 v[220:223], v4 offset:19456
    ds_read_b128 v[224:227], v4 offset:20480
    v_mul_f32 v243, v91, v187
    v_fma_f32 v91, v75, v203, v243
    v_mfma_f32_32x32x16_bf16 v[56:71], v[232:235], v[112:115], v[56:71]
    v_fma_f32 v75, v75, v187, -v242
    v_cvt_pk_bf16_f32 v121, v74, v75
    v_cvt_pk_bf16_f32 v125, v90, v91
    v_mul_f32 v240, v92, v204
    v_mul_f32 v241, v92, v188
    v_mfma_f32_32x32x16_bf16 v[40:55], v[236:239], v[116:119], v[40:55]
    v_fma_f32 v92, v76, v204, v241
    v_fma_f32 v76, v76, v188, -v240
    v_mul_f32 v242, v93, v205
    v_mul_f32 v243, v93, v189
    v_fma_f32 v93, v77, v205, v243
    v_mfma_f32_32x32x16_bf16 v[56:71], v[228:231], v[116:119], v[56:71]
    v_fma_f32 v77, v77, v189, -v242
    v_cvt_pk_bf16_f32 v122, v76, v77
    v_cvt_pk_bf16_f32 v126, v92, v93
    v_mul_f32 v240, v94, v206
    v_mul_f32 v241, v94, v190
    v_fma_f32 v94, v78, v206, v241
    v_fma_f32 v78, v78, v190, -v240
    v_mul_f32 v242, v95, v207
    v_mul_f32 v243, v95, v191
    v_fma_f32 v95, v79, v207, v243
    v_fma_f32 v79, v79, v191, -v242
    v_cvt_pk_bf16_f32 v123, v78, v79
    v_cvt_pk_bf16_f32 v127, v94, v95
    v_mul_f32 v240, v96, v208
    v_mul_f32 v241, v96, v192
    v_fma_f32 v96, v80, v208, v241
    v_fma_f32 v80, v80, v192, -v240
    v_mul_f32 v242, v97, v209
    v_mul_f32 v243, v97, v193
    v_fma_f32 v97, v81, v209, v243
    v_fma_f32 v81, v81, v193, -v242
    v_cvt_pk_bf16_f32 v128, v80, v81
    v_cvt_pk_bf16_f32 v132, v96, v97
    v_mul_f32 v240, v98, v210
    v_mul_f32 v241, v98, v194
    v_fma_f32 v98, v82, v210, v241
    v_fma_f32 v82, v82, v194, -v240
    v_mul_f32 v242, v99, v211
    v_mul_f32 v243, v99, v195
    v_fma_f32 v99, v83, v211, v243
    v_fma_f32 v83, v83, v195, -v242
    v_cvt_pk_bf16_f32 v129, v82, v83
    v_cvt_pk_bf16_f32 v133, v98, v99
    v_mul_f32 v240, v100, v212
    v_mul_f32 v241, v100, v196
    v_fma_f32 v100, v84, v212, v241
    v_fma_f32 v84, v84, v196, -v240
    v_mul_f32 v242, v101, v213
    v_mul_f32 v243, v101, v197
    v_fma_f32 v101, v85, v213, v243
    v_fma_f32 v85, v85, v197, -v242
    v_cvt_pk_bf16_f32 v130, v84, v85
    v_cvt_pk_bf16_f32 v134, v100, v101
    v_mul_f32 v240, v102, v214
    v_mul_f32 v241, v102, v198
    v_fma_f32 v102, v86, v214, v241
    v_fma_f32 v86, v86, v198, -v240
    v_mul_f32 v242, v103, v215
    v_mul_f32 v243, v103, v199
    v_fma_f32 v103, v87, v215, v243
    v_fma_f32 v87, v87, v199, -v242
    v_cvt_pk_bf16_f32 v131, v86, v87
    v_cvt_pk_bf16_f32 v135, v102, v103
    s_waitcnt lgkmcnt(0)
    v_mfma_f32_32x32x16_bf16 v[40:55], v[216:219], v[120:123], v[40:55]
    ds_read_b128 v[228:231], v4 offset:21504
    ds_read_b128 v[232:235], v4 offset:22528
    ds_read_b128 v[236:239], v4 offset:23552
    v_mfma_f32_32x32x16_bf16 v[56:71], v[220:223], v[120:123], v[56:71]
    v_mfma_f32_32x32x16_bf16 v[40:55], v[224:227], v[124:127], v[40:55]
    v_mfma_f32_32x32x16_bf16 v[56:71], v[216:219], v[124:127], v[56:71]
    s_waitcnt lgkmcnt(0)
    v_mfma_f32_32x32x16_bf16 v[40:55], v[228:231], v[128:131], v[40:55]
    ds_read_b128 v[216:219], v4 offset:24576
    ds_read_b128 v[220:223], v4 offset:25600
    ds_read_b128 v[224:227], v4 offset:26624
    v_mfma_f32_32x32x16_bf16 v[56:71], v[232:235], v[128:131], v[56:71]
    v_mfma_f32_32x32x16_bf16 v[40:55], v[236:239], v[132:135], v[40:55]
    v_mfma_f32_32x32x16_bf16 v[56:71], v[228:231], v[132:135], v[56:71]
    s_waitcnt lgkmcnt(0)
    v_mfma_f32_32x32x16_bf16 v[72:87], v[216:219], v[104:107], 0
    ds_read_b128 v[228:231], v4 offset:27648
    ds_read_b128 v[232:235], v4 offset:28672
    ds_read_b128 v[236:239], v4 offset:29696
    v_mfma_f32_32x32x16_bf16 v[88:103], v[220:223], v[104:107], 0
    s_nop 5
    ds_write2st64_b32 v252, v40, v56 offset0:0 offset1:35
    ds_write2st64_b32 v253, v41, v57 offset0:0 offset1:35
    ds_write2st64_b32 v252, v42, v58 offset0:1 offset1:36
    ds_write2st64_b32 v253, v43, v59 offset0:1 offset1:36
    ds_write2st64_b32 v252, v44, v60 offset0:4 offset1:39
    v_mfma_f32_32x32x16_bf16 v[72:87], v[224:227], v[108:111], v[72:87]
    ds_write2st64_b32 v253, v45, v61 offset0:4 offset1:39
    ds_write2st64_b32 v252, v46, v62 offset0:5 offset1:40
    ds_write2st64_b32 v253, v47, v63 offset0:5 offset1:40
    ds_write2st64_b32 v252, v48, v64 offset0:8 offset1:43
    ds_write2st64_b32 v253, v49, v65 offset0:8 offset1:43
    v_mfma_f32_32x32x16_bf16 v[88:103], v[216:219], v[108:111], v[88:103]
    ds_write2st64_b32 v252, v50, v66 offset0:9 offset1:44
    ds_write2st64_b32 v253, v51, v67 offset0:9 offset1:44
    ds_write2st64_b32 v252, v52, v68 offset0:12 offset1:47
    ds_write2st64_b32 v253, v53, v69 offset0:12 offset1:47
    ds_write2st64_b32 v252, v54, v70 offset0:13 offset1:48
    s_waitcnt lgkmcnt(0)
    v_mfma_f32_32x32x16_bf16 v[72:87], v[228:231], v[112:115], v[72:87]
    ds_read_b128 v[216:219], v4 offset:30720
    ds_read_b128 v[220:223], v4 offset:31744
    ds_read_b128 v[224:227], v4 offset:32768
    ds_write2st64_b32 v253, v55, v71 offset0:13 offset1:48
    ds_write2st64_b32 v252, v40, v56 offset0:32 offset1:67
    v_mfma_f32_32x32x16_bf16 v[88:103], v[232:235], v[112:115], v[88:103]
    v_mfma_f32_32x32x16_bf16 v[72:87], v[236:239], v[116:119], v[72:87]
    v_mfma_f32_32x32x16_bf16 v[88:103], v[228:231], v[116:119], v[88:103]
    s_waitcnt lgkmcnt(0)
    v_mfma_f32_32x32x16_bf16 v[72:87], v[216:219], v[120:123], v[72:87]
    ds_read_b128 v[228:231], v4 offset:33792
    ds_read_b128 v[232:235], v4 offset:34816
    ds_read_b128 v[236:239], v4 offset:35840
    v_mfma_f32_32x32x16_bf16 v[88:103], v[220:223], v[120:123], v[88:103]
    v_mfma_f32_32x32x16_bf16 v[72:87], v[224:227], v[124:127], v[72:87]
    v_mfma_f32_32x32x16_bf16 v[88:103], v[216:219], v[124:127], v[88:103]
    s_waitcnt lgkmcnt(0)
    v_mfma_f32_32x32x16_bf16 v[72:87], v[228:231], v[128:131], v[72:87]
    ds_read_b128 v[216:219], v4 offset:12288
    ds_read_b128 v[220:223], v4 offset:14336
    ds_read_b128 v[224:227], v4 offset:13312
    v_mfma_f32_32x32x16_bf16 v[88:103], v[232:235], v[128:131], v[88:103]
    v_mfma_f32_32x32x16_bf16 v[72:87], v[236:239], v[132:135], v[72:87]
    v_mfma_f32_32x32x16_bf16 v[88:103], v[228:231], v[132:135], v[88:103]
    s_nop 11
    ds_write2st64_b32 v252, v72, v88 offset0:16 offset1:51
    ds_write2st64_b32 v253, v73, v89 offset0:16 offset1:51
    ds_write2st64_b32 v252, v74, v90 offset0:17 offset1:52
    ds_write2st64_b32 v253, v75, v91 offset0:17 offset1:52
    ds_write2st64_b32 v252, v76, v92 offset0:20 offset1:55
    ds_write2st64_b32 v253, v77, v93 offset0:20 offset1:55
    ds_write2st64_b32 v252, v78, v94 offset0:21 offset1:56
    ds_write2st64_b32 v253, v79, v95 offset0:21 offset1:56
    ds_write2st64_b32 v252, v80, v96 offset0:24 offset1:59
    ds_write2st64_b32 v253, v81, v97 offset0:24 offset1:59
    ds_write2st64_b32 v252, v82, v98 offset0:25 offset1:60
    ds_write2st64_b32 v253, v83, v99 offset0:25 offset1:60
    ds_write2st64_b32 v252, v84, v100 offset0:28 offset1:63
    ds_write2st64_b32 v253, v85, v101 offset0:28 offset1:63
    ds_write2st64_b32 v252, v86, v102 offset0:29 offset1:64
    ds_write2st64_b32 v253, v87, v103 offset0:29 offset1:64
    s_waitcnt vmcnt(0)
    ds_read2st64_b32 v[120:121], v255 offset0:29 offset1:64
    ds_read2st64_b32 v[122:123], v254 offset0:29 offset1:64
    ds_read2st64_b32 v[124:125], v255 offset0:28 offset1:63
    ds_read2st64_b32 v[126:127], v254 offset0:28 offset1:63
    s_waitcnt lgkmcnt(0)
    ds_read2st64_b32 v[128:129], v255 offset0:25 offset1:60
    ds_read2st64_b32 v[130:131], v254 offset0:25 offset1:60
    ds_read2st64_b32 v[132:133], v255 offset0:24 offset1:59
    ds_read2st64_b32 v[134:135], v254 offset0:24 offset1:59
    v_lshlrev_b32 v244, 16, v8
    v_and_b32 v245, s34, v8
    v_lshlrev_b32 v242, 16, v152
    v_and_b32 v243, s34, v152
    v_mul_f32 v240, v120, v244
    v_mul_f32 v241, v120, v245
    v_fma_f32 v240, v121, v245, v240
    v_fma_f32 v241, -v121, v244, v241
    v_fma_f32 v240, -v56, v243, v240
    v_fma_f32 v241, v40, v243, v241
    v_fma_f32 v40, v40, v242, v240
    v_fma_f32 v56, v56, v242, v241
    v_lshlrev_b32 v244, 16, v9
    v_and_b32 v245, s34, v9
    v_lshlrev_b32 v242, 16, v153
    v_and_b32 v243, s34, v153
    v_mul_f32 v240, v122, v244
    v_mul_f32 v241, v122, v245
    v_fma_f32 v240, v123, v245, v240
    v_fma_f32 v241, -v123, v244, v241
    v_fma_f32 v240, -v57, v243, v240
    v_fma_f32 v241, v41, v243, v241
    v_fma_f32 v41, v41, v242, v240
    v_fma_f32 v57, v57, v242, v241
    v_cvt_pk_bf16_f32 v136, v40, v41
    v_cvt_pk_bf16_f32 v140, v56, v57
    v_lshlrev_b32 v244, 16, v10
    v_and_b32 v245, s34, v10
    v_lshlrev_b32 v242, 16, v154
    v_and_b32 v243, s34, v154
    v_mul_f32 v240, v124, v244
    v_mul_f32 v241, v124, v245
    v_fma_f32 v240, v125, v245, v240
    v_fma_f32 v241, -v125, v244, v241
    v_fma_f32 v240, -v58, v243, v240
    v_fma_f32 v241, v42, v243, v241
    v_fma_f32 v42, v42, v242, v240
    v_fma_f32 v58, v58, v242, v241
    v_lshlrev_b32 v244, 16, v11
    v_and_b32 v245, s34, v11
    v_lshlrev_b32 v242, 16, v155
    v_and_b32 v243, s34, v155
    v_mul_f32 v240, v126, v244
    v_mul_f32 v241, v126, v245
    v_fma_f32 v240, v127, v245, v240
    v_fma_f32 v241, -v127, v244, v241
    v_fma_f32 v240, -v59, v243, v240
    v_fma_f32 v241, v43, v243, v241
    v_fma_f32 v43, v43, v242, v240
    v_fma_f32 v59, v59, v242, v241
    v_cvt_pk_bf16_f32 v137, v42, v43
    v_cvt_pk_bf16_f32 v141, v58, v59
    s_waitcnt lgkmcnt(0)
    ds_read2st64_b32 v[120:121], v255 offset0:21 offset1:56
    ds_read2st64_b32 v[122:123], v254 offset0:21 offset1:56
    ds_read2st64_b32 v[124:125], v255 offset0:20 offset1:55
    ds_read2st64_b32 v[126:127], v254 offset0:20 offset1:55
    v_lshlrev_b32 v244, 16, v12
    v_and_b32 v245, s34, v12
    v_lshlrev_b32 v242, 16, v156
    v_and_b32 v243, s34, v156
    v_mul_f32 v240, v128, v244
    v_mul_f32 v241, v128, v245
    v_fma_f32 v240, v129, v245, v240
    v_fma_f32 v241, -v129, v244, v241
    v_fma_f32 v240, -v60, v243, v240
    v_fma_f32 v241, v44, v243, v241
    v_fma_f32 v44, v44, v242, v240
    v_fma_f32 v60, v60, v242, v241
    v_lshlrev_b32 v244, 16, v13
    v_and_b32 v245, s34, v13
    v_lshlrev_b32 v242, 16, v157
    v_and_b32 v243, s34, v157
    v_mul_f32 v240, v130, v244
    v_mul_f32 v241, v130, v245
    v_fma_f32 v240, v131, v245, v240
    v_fma_f32 v241, -v131, v244, v241
    v_fma_f32 v240, -v61, v243, v240
    v_fma_f32 v241, v45, v243, v241
    v_fma_f32 v45, v45, v242, v240
    v_fma_f32 v61, v61, v242, v241
    v_cvt_pk_bf16_f32 v138, v44, v45
    v_cvt_pk_bf16_f32 v142, v60, v61
    v_lshlrev_b32 v244, 16, v14
    v_and_b32 v245, s34, v14
    v_lshlrev_b32 v242, 16, v158
    v_and_b32 v243, s34, v158
    v_mul_f32 v240, v132, v244
    v_mul_f32 v241, v132, v245
    v_fma_f32 v240, v133, v245, v240
    v_fma_f32 v241, -v133, v244, v241
    v_fma_f32 v240, -v62, v243, v240
    v_fma_f32 v241, v46, v243, v241
    v_fma_f32 v46, v46, v242, v240
    v_fma_f32 v62, v62, v242, v241
    v_lshlrev_b32 v244, 16, v15
    v_and_b32 v245, s34, v15
    v_lshlrev_b32 v242, 16, v159
    v_and_b32 v243, s34, v159
    v_mul_f32 v240, v134, v244
    v_mul_f32 v241, v134, v245
    v_fma_f32 v240, v135, v245, v240
    v_fma_f32 v241, -v135, v244, v241
    v_fma_f32 v240, -v63, v243, v240
    v_fma_f32 v241, v47, v243, v241
    v_fma_f32 v47, v47, v242, v240
    v_fma_f32 v63, v63, v242, v241
    v_cvt_pk_bf16_f32 v139, v46, v47
    v_cvt_pk_bf16_f32 v143, v62, v63
    s_waitcnt lgkmcnt(0)
    ds_read2st64_b32 v[128:129], v255 offset0:17 offset1:52
    ds_read2st64_b32 v[130:131], v254 offset0:17 offset1:52
    ds_read2st64_b32 v[132:133], v255 offset0:16 offset1:51
    ds_read2st64_b32 v[134:135], v254 offset0:16 offset1:51
    v_lshlrev_b32 v244, 16, v16
    v_and_b32 v245, s34, v16
    v_lshlrev_b32 v242, 16, v160
    v_and_b32 v243, s34, v160
    v_mul_f32 v240, v120, v244
    v_mul_f32 v241, v120, v245
    v_fma_f32 v240, v121, v245, v240
    v_fma_f32 v241, -v121, v244, v241
    v_fma_f32 v240, -v64, v243, v240
    v_fma_f32 v241, v48, v243, v241
    v_fma_f32 v48, v48, v242, v240
    v_fma_f32 v64, v64, v242, v241
    v_lshlrev_b32 v244, 16, v17
    v_and_b32 v245, s34, v17
    v_lshlrev_b32 v242, 16, v161
    v_and_b32 v243, s34, v161
    v_mul_f32 v240, v122, v244
    v_mul_f32 v241, v122, v245
    v_fma_f32 v240, v123, v245, v240
    v_fma_f32 v241, -v123, v244, v241
    v_fma_f32 v240, -v65, v243, v240
    v_fma_f32 v241, v49, v243, v241
    v_fma_f32 v49, v49, v242, v240
    v_fma_f32 v65, v65, v242, v241
    v_cvt_pk_bf16_f32 v144, v48, v49
    v_cvt_pk_bf16_f32 v148, v64, v65
    v_lshlrev_b32 v244, 16, v18
    v_and_b32 v245, s34, v18
    v_lshlrev_b32 v242, 16, v162
    v_and_b32 v243, s34, v162
    v_mul_f32 v240, v124, v244
    v_mul_f32 v241, v124, v245
    v_fma_f32 v240, v125, v245, v240
    v_fma_f32 v241, -v125, v244, v241
    v_fma_f32 v240, -v66, v243, v240
    v_fma_f32 v241, v50, v243, v241
    v_fma_f32 v50, v50, v242, v240
    v_fma_f32 v66, v66, v242, v241
    v_lshlrev_b32 v244, 16, v19
    v_and_b32 v245, s34, v19
    v_lshlrev_b32 v242, 16, v163
    v_and_b32 v243, s34, v163
    v_mul_f32 v240, v126, v244
    v_mul_f32 v241, v126, v245
    v_fma_f32 v240, v127, v245, v240
    v_fma_f32 v241, -v127, v244, v241
    v_fma_f32 v240, -v67, v243, v240
    v_fma_f32 v241, v51, v243, v241
    v_fma_f32 v51, v51, v242, v240
    v_fma_f32 v67, v67, v242, v241
    v_cvt_pk_bf16_f32 v145, v50, v51
    v_cvt_pk_bf16_f32 v149, v66, v67
    s_waitcnt lgkmcnt(0)
    v_lshlrev_b32 v244, 16, v20
    v_and_b32 v245, s34, v20
    v_lshlrev_b32 v242, 16, v164
    v_and_b32 v243, s34, v164
    v_mul_f32 v240, v128, v244
    v_mul_f32 v241, v128, v245
    v_fma_f32 v240, v129, v245, v240
    v_fma_f32 v241, -v129, v244, v241
    v_fma_f32 v240, -v68, v243, v240
    v_fma_f32 v241, v52, v243, v241
    v_fma_f32 v52, v52, v242, v240
    v_fma_f32 v68, v68, v242, v241
    v_lshlrev_b32 v244, 16, v21
    v_and_b32 v245, s34, v21
    v_lshlrev_b32 v242, 16, v165
    v_and_b32 v243, s34, v165
    v_mul_f32 v240, v130, v244
    v_mul_f32 v241, v130, v245
    v_fma_f32 v240, v131, v245, v240
    v_fma_f32 v241, -v131, v244, v241
    v_fma_f32 v240, -v69, v243, v240
    v_fma_f32 v241, v53, v243, v241
    v_fma_f32 v53, v53, v242, v240
    v_fma_f32 v69, v69, v242, v241
    v_cvt_pk_bf16_f32 v146, v52, v53
    v_cvt_pk_bf16_f32 v150, v68, v69
    v_lshlrev_b32 v244, 16, v22
    v_and_b32 v245, s34, v22
    v_lshlrev_b32 v242, 16, v166
    v_and_b32 v243, s34, v166
    v_mul_f32 v240, v132, v244
    v_mul_f32 v241, v132, v245
    v_fma_f32 v240, v133, v245, v240
    v_fma_f32 v241, -v133, v244, v241
    v_fma_f32 v240, -v70, v243, v240
    v_fma_f32 v241, v54, v243, v241
    v_fma_f32 v54, v54, v242, v240
    v_fma_f32 v70, v70, v242, v241
    v_lshlrev_b32 v244, 16, v23
    v_and_b32 v245, s34, v23
    v_lshlrev_b32 v242, 16, v167
    v_and_b32 v243, s34, v167
    v_mul_f32 v240, v134, v244
    v_mul_f32 v241, v134, v245
    v_fma_f32 v240, v135, v245, v240
    v_fma_f32 v241, -v135, v244, v241
    v_fma_f32 v240, -v71, v243, v240
    v_fma_f32 v241, v55, v243, v241
    v_fma_f32 v55, v55, v242, v240
    v_fma_f32 v71, v71, v242, v241
    v_cvt_pk_bf16_f32 v147, v54, v55
    v_cvt_pk_bf16_f32 v151, v70, v71
    s_waitcnt lgkmcnt(0)
    v_mfma_f32_32x32x16_bf16 v[40:55], v[136:139], v[216:219], 0
    ds_read_b128 v[228:231], v4 offset:15360
    ds_read_b128 v[232:235], v4 offset:17408
    ds_read_b128 v[236:239], v4 offset:16384
    v_mfma_f32_32x32x16_bf16 v[56:71], v[136:139], v[220:223], 0
    ds_read2st64_b32 v[120:121], v255 offset0:13 offset1:48
    ds_read2st64_b32 v[122:123], v254 offset0:13 offset1:48
    ds_read2st64_b32 v[124:125], v255 offset0:12 offset1:47
    ds_read2st64_b32 v[126:127], v254 offset0:12 offset1:47
    s_waitcnt lgkmcnt(0)
    v_mfma_f32_32x32x16_bf16 v[40:55], v[140:143], v[224:227], v[40:55]
    ds_read2st64_b32 v[128:129], v255 offset0:9 offset1:44
    ds_read2st64_b32 v[130:131], v254 offset0:9 offset1:44
    ds_read2st64_b32 v[132:133], v255 offset0:8 offset1:43
    ds_read2st64_b32 v[134:135], v254 offset0:8 offset1:43
    v_lshlrev_b32 v244, 16, v24
    v_mfma_f32_32x32x16_bf16 v[56:71], v[140:143], v[216:219], v[56:71]
    v_and_b32 v245, s34, v24
    v_lshlrev_b32 v242, 16, v168
    v_and_b32 v243, s34, v168
    v_mul_f32 v240, v120, v244
    v_mul_f32 v241, v120, v245
    s_waitcnt lgkmcnt(0)
    v_mfma_f32_32x32x16_bf16 v[40:55], v[144:147], v[228:231], v[40:55]
    ds_read_b128 v[216:219], v4 offset:18432
    ds_read_b128 v[220:223], v4 offset:20480
    ds_read_b128 v[224:227], v4 offset:19456
    v_fma_f32 v240, v121, v245, v240
    v_fma_f32 v241, -v121, v244, v241
    v_mfma_f32_32x32x16_bf16 v[56:71], v[144:147], v[232:235], v[56:71]
    v_fma_f32 v240, -v88, v243, v240
    v_fma_f32 v241, v72, v243, v241
    v_fma_f32 v72, v72, v242, v240
    v_fma_f32 v88, v88, v242, v241
    v_lshlrev_b32 v244, 16, v25
    v_mfma_f32_32x32x16_bf16 v[40:55], v[148:151], v[236:239], v[40:55]
    v_and_b32 v245, s34, v25
    v_lshlrev_b32 v242, 16, v169
    v_and_b32 v243, s34, v169
    v_mul_f32 v240, v122, v244
    v_mul_f32 v241, v122, v245
    v_mfma_f32_32x32x16_bf16 v[56:71], v[148:151], v[228:231], v[56:71]
    v_fma_f32 v240, v123, v245, v240
    v_fma_f32 v241, -v123, v244, v241
    v_fma_f32 v240, -v89, v243, v240
    v_fma_f32 v241, v73, v243, v241
    v_fma_f32 v73, v73, v242, v240
    v_fma_f32 v89, v89, v242, v241
    v_cvt_pk_bf16_f32 v104, v72, v73
    v_cvt_pk_bf16_f32 v108, v88, v89
    v_lshlrev_b32 v244, 16, v26
    v_and_b32 v245, s34, v26
    v_lshlrev_b32 v242, 16, v170
    v_and_b32 v243, s34, v170
    v_mul_f32 v240, v124, v244
    v_mul_f32 v241, v124, v245
    v_fma_f32 v240, v125, v245, v240
    v_fma_f32 v241, -v125, v244, v241
    v_fma_f32 v240, -v90, v243, v240
    v_fma_f32 v241, v74, v243, v241
    v_fma_f32 v74, v74, v242, v240
    v_fma_f32 v90, v90, v242, v241
    v_lshlrev_b32 v244, 16, v27
    v_and_b32 v245, s34, v27
    v_lshlrev_b32 v242, 16, v171
    v_and_b32 v243, s34, v171
    v_mul_f32 v240, v126, v244
    v_mul_f32 v241, v126, v245
    v_fma_f32 v240, v127, v245, v240
    v_fma_f32 v241, -v127, v244, v241
    v_fma_f32 v240, -v91, v243, v240
    v_fma_f32 v241, v75, v243, v241
    v_fma_f32 v75, v75, v242, v240
    v_fma_f32 v91, v91, v242, v241
    v_cvt_pk_bf16_f32 v105, v74, v75
    v_cvt_pk_bf16_f32 v109, v90, v91
    s_waitcnt lgkmcnt(0)
    ds_read2st64_b32 v[120:121], v255 offset0:5 offset1:40
    ds_read2st64_b32 v[122:123], v254 offset0:5 offset1:40
    ds_read2st64_b32 v[124:125], v255 offset0:4 offset1:39
    ds_read2st64_b32 v[126:127], v254 offset0:4 offset1:39
    v_lshlrev_b32 v244, 16, v28
    v_and_b32 v245, s34, v28
    v_lshlrev_b32 v242, 16, v172
    v_and_b32 v243, s34, v172
    v_mul_f32 v240, v128, v244
    v_mul_f32 v241, v128, v245
    v_fma_f32 v240, v129, v245, v240
    v_fma_f32 v241, -v129, v244, v241
    v_fma_f32 v240, -v92, v243, v240
    v_fma_f32 v241, v76, v243, v241
    v_fma_f32 v76, v76, v242, v240
    v_fma_f32 v92, v92, v242, v241
    v_lshlrev_b32 v244, 16, v29
    v_and_b32 v245, s34, v29
    v_lshlrev_b32 v242, 16, v173
    v_and_b32 v243, s34, v173
    v_mul_f32 v240, v130, v244
    v_mul_f32 v241, v130, v245
    v_fma_f32 v240, v131, v245, v240
    v_fma_f32 v241, -v131, v244, v241
    v_fma_f32 v240, -v93, v243, v240
    v_fma_f32 v241, v77, v243, v241
    v_fma_f32 v77, v77, v242, v240
    v_fma_f32 v93, v93, v242, v241
    v_cvt_pk_bf16_f32 v106, v76, v77
    v_cvt_pk_bf16_f32 v110, v92, v93
    v_lshlrev_b32 v244, 16, v30
    v_and_b32 v245, s34, v30
    v_lshlrev_b32 v242, 16, v174
    v_and_b32 v243, s34, v174
    v_mul_f32 v240, v132, v244
    v_mul_f32 v241, v132, v245
    v_fma_f32 v240, v133, v245, v240
    v_fma_f32 v241, -v133, v244, v241
    v_fma_f32 v240, -v94, v243, v240
    v_fma_f32 v241, v78, v243, v241
    v_fma_f32 v78, v78, v242, v240
    v_fma_f32 v94, v94, v242, v241
    v_lshlrev_b32 v244, 16, v31
    v_and_b32 v245, s34, v31
    v_lshlrev_b32 v242, 16, v175
    v_and_b32 v243, s34, v175
    v_mul_f32 v240, v134, v244
    v_mul_f32 v241, v134, v245
    v_fma_f32 v240, v135, v245, v240
    v_fma_f32 v241, -v135, v244, v241
    v_fma_f32 v240, -v95, v243, v240
    v_fma_f32 v241, v79, v243, v241
    v_fma_f32 v79, v79, v242, v240
    v_fma_f32 v95, v95, v242, v241
    v_cvt_pk_bf16_f32 v107, v78, v79
    v_cvt_pk_bf16_f32 v111, v94, v95
    s_waitcnt lgkmcnt(0)
    ds_read2st64_b32 v[128:129], v255 offset0:1 offset1:36
    ds_read2st64_b32 v[130:131], v254 offset0:1 offset1:36
    ds_read2st64_b32 v[132:133], v255 offset0:0 offset1:35
    ds_read2st64_b32 v[134:135], v254 offset0:0 offset1:35
    v_lshlrev_b32 v244, 16, v32
    v_and_b32 v245, s34, v32
    v_lshlrev_b32 v242, 16, v176
    v_and_b32 v243, s34, v176
    v_mul_f32 v240, v120, v244
    v_mul_f32 v241, v120, v245
    v_fma_f32 v240, v121, v245, v240
    v_fma_f32 v241, -v121, v244, v241
    v_fma_f32 v240, -v96, v243, v240
    v_fma_f32 v241, v80, v243, v241
    v_fma_f32 v80, v80, v242, v240
    v_fma_f32 v96, v96, v242, v241
    v_lshlrev_b32 v244, 16, v33
    v_and_b32 v245, s34, v33
    v_lshlrev_b32 v242, 16, v177
    v_and_b32 v243, s34, v177
    v_mul_f32 v240, v122, v244
    v_mul_f32 v241, v122, v245
    v_fma_f32 v240, v123, v245, v240
    v_fma_f32 v241, -v123, v244, v241
    v_fma_f32 v240, -v97, v243, v240
    v_fma_f32 v241, v81, v243, v241
    v_fma_f32 v81, v81, v242, v240
    v_fma_f32 v97, v97, v242, v241
    v_cvt_pk_bf16_f32 v112, v80, v81
    v_cvt_pk_bf16_f32 v116, v96, v97
    v_lshlrev_b32 v244, 16, v34
    v_and_b32 v245, s34, v34
    v_lshlrev_b32 v242, 16, v178
    v_and_b32 v243, s34, v178
    v_mul_f32 v240, v124, v244
    v_mul_f32 v241, v124, v245
    v_fma_f32 v240, v125, v245, v240
    v_fma_f32 v241, -v125, v244, v241
    v_fma_f32 v240, -v98, v243, v240
    v_fma_f32 v241, v82, v243, v241
    v_fma_f32 v82, v82, v242, v240
    v_fma_f32 v98, v98, v242, v241
    v_lshlrev_b32 v244, 16, v35
    v_and_b32 v245, s34, v35
    v_lshlrev_b32 v242, 16, v179
    v_and_b32 v243, s34, v179
    v_mul_f32 v240, v126, v244
    v_mul_f32 v241, v126, v245
    v_fma_f32 v240, v127, v245, v240
    v_fma_f32 v241, -v127, v244, v241
    v_fma_f32 v240, -v99, v243, v240
    v_fma_f32 v241, v83, v243, v241
    v_fma_f32 v83, v83, v242, v240
    v_fma_f32 v99, v99, v242, v241
    v_cvt_pk_bf16_f32 v113, v82, v83
    v_cvt_pk_bf16_f32 v117, v98, v99
    s_waitcnt lgkmcnt(0)
    v_lshlrev_b32 v244, 16, v36
    v_and_b32 v245, s34, v36
    v_lshlrev_b32 v242, 16, v180
    v_and_b32 v243, s34, v180
    v_mul_f32 v240, v128, v244
    v_mul_f32 v241, v128, v245
    v_fma_f32 v240, v129, v245, v240
    v_fma_f32 v241, -v129, v244, v241
    v_fma_f32 v240, -v100, v243, v240
    v_fma_f32 v241, v84, v243, v241
    v_fma_f32 v84, v84, v242, v240
    v_fma_f32 v100, v100, v242, v241
    v_lshlrev_b32 v244, 16, v37
    v_and_b32 v245, s34, v37
    v_lshlrev_b32 v242, 16, v181
    v_and_b32 v243, s34, v181
    v_mul_f32 v240, v130, v244
    v_mul_f32 v241, v130, v245
    v_fma_f32 v240, v131, v245, v240
    v_fma_f32 v241, -v131, v244, v241
    v_fma_f32 v240, -v101, v243, v240
    v_fma_f32 v241, v85, v243, v241
    v_fma_f32 v85, v85, v242, v240
    v_fma_f32 v101, v101, v242, v241
    v_cvt_pk_bf16_f32 v114, v84, v85
    v_cvt_pk_bf16_f32 v118, v100, v101
    v_lshlrev_b32 v244, 16, v38
    v_and_b32 v245, s34, v38
    v_lshlrev_b32 v242, 16, v182
    v_and_b32 v243, s34, v182
    v_mul_f32 v240, v132, v244
    v_mul_f32 v241, v132, v245
    v_fma_f32 v240, v133, v245, v240
    v_fma_f32 v241, -v133, v244, v241
    v_fma_f32 v240, -v102, v243, v240
    v_fma_f32 v241, v86, v243, v241
    v_fma_f32 v86, v86, v242, v240
    v_fma_f32 v102, v102, v242, v241
    v_lshlrev_b32 v244, 16, v39
    v_and_b32 v245, s34, v39
    v_lshlrev_b32 v242, 16, v183
    v_and_b32 v243, s34, v183
    v_mul_f32 v240, v134, v244
    v_mul_f32 v241, v134, v245
    v_fma_f32 v240, v135, v245, v240
    v_fma_f32 v241, -v135, v244, v241
    v_fma_f32 v240, -v103, v243, v240
    v_fma_f32 v241, v87, v243, v241
    v_fma_f32 v87, v87, v242, v240
    v_fma_f32 v103, v103, v242, v241
    v_cvt_pk_bf16_f32 v115, v86, v87
    v_cvt_pk_bf16_f32 v119, v102, v103
    s_waitcnt lgkmcnt(0)
    v_mfma_f32_32x32x16_bf16 v[40:55], v[104:107], v[216:219], v[40:55]
    ds_read_b128 v[228:231], v4 offset:21504
    ds_read_b128 v[232:235], v4 offset:23552
    ds_read_b128 v[236:239], v4 offset:22528
    v_mfma_f32_32x32x16_bf16 v[56:71], v[104:107], v[220:223], v[56:71]
    v_mfma_f32_32x32x16_bf16 v[40:55], v[108:111], v[224:227], v[40:55]
    v_mfma_f32_32x32x16_bf16 v[56:71], v[108:111], v[216:219], v[56:71]
    s_add_u32 s50, s43, 4096
    buffer_load_dwordx4 v[152:155], v2, s[12:15], s43 offen offset:0 sc1
    buffer_load_dwordx4 v[156:159], v2, s[12:15], s43 offen offset:1024 sc1
    buffer_load_dwordx4 v[160:163], v2, s[12:15], s43 offen offset:2048 sc1
    buffer_load_dwordx4 v[164:167], v2, s[12:15], s43 offen offset:3072 sc1
    buffer_load_dwordx4 v[168:171], v2, s[12:15], s50 offen offset:0 sc1
    buffer_load_dwordx4 v[172:175], v2, s[12:15], s50 offen offset:1024 sc1
    buffer_load_dwordx4 v[176:179], v2, s[12:15], s50 offen offset:2048 sc1
    buffer_load_dwordx4 v[180:183], v2, s[12:15], s50 offen offset:3072 sc1
    ds_read_b128 v[8:11], v251 offset:0
    ds_read_b128 v[12:15], v251 offset:4160
    ds_read_b128 v[24:27], v251 offset:1024
    ds_read_b128 v[28:31], v251 offset:5184
    ds_read_b128 v[16:19], v251 offset:2048
    ds_read_b128 v[20:23], v251 offset:6208
    ds_read_b128 v[32:35], v251 offset:3072
    ds_read_b128 v[36:39], v251 offset:7232
    s_waitcnt lgkmcnt(0)
    v_mfma_f32_32x32x16_bf16 v[40:55], v[112:115], v[228:231], v[40:55]
    ds_read_b128 v[216:219], v4 offset:24576
    ds_read_b128 v[220:223], v4 offset:26624
    ds_read_b128 v[224:227], v4 offset:25600
    v_mfma_f32_32x32x16_bf16 v[56:71], v[112:115], v[232:235], v[56:71]
    v_mfma_f32_32x32x16_bf16 v[40:55], v[116:119], v[236:239], v[40:55]
    v_mfma_f32_32x32x16_bf16 v[56:71], v[116:119], v[228:231], v[56:71]
    s_waitcnt lgkmcnt(0)
    v_mfma_f32_32x32x16_bf16 v[72:87], v[136:139], v[216:219], 0
    ds_read_b128 v[228:231], v4 offset:27648
    ds_read_b128 v[232:235], v4 offset:29696
    ds_read_b128 v[236:239], v4 offset:28672
    v_mfma_f32_32x32x16_bf16 v[88:103], v[136:139], v[220:223], 0
    s_nop 5
    v_mul_f32 v240, v56, v200
    v_mul_f32 v241, v56, v184
    v_fma_f32 v56, -v40, v200, v241
    v_fma_f32 v40, v40, v184, v240
    v_mul_f32 v242, v57, v201
    v_mfma_f32_32x32x16_bf16 v[72:87], v[140:143], v[224:227], v[72:87]
    v_mul_f32 v243, v57, v185
    v_fma_f32 v57, -v41, v201, v243
    v_fma_f32 v41, v41, v185, v242
    v_cvt_pk_bf16_f32 v120, v40, v41
    v_cvt_pk_bf16_f32 v124, v56, v57
    v_mfma_f32_32x32x16_bf16 v[88:103], v[140:143], v[216:219], v[88:103]
    v_mul_f32 v240, v58, v202
    v_mul_f32 v241, v58, v186
    v_fma_f32 v58, -v42, v202, v241
    v_fma_f32 v42, v42, v186, v240
    v_mul_f32 v242, v59, v203
    s_waitcnt lgkmcnt(0)
    v_mfma_f32_32x32x16_bf16 v[72:87], v[144:147], v[228:231], v[72:87]
    ds_read_b128 v[216:219], v4 offset:30720
    ds_read_b128 v[220:223], v4 offset:32768
    ds_read_b128 v[224:227], v4 offset:31744
    v_mul_f32 v243, v59, v187
    v_fma_f32 v59, -v43, v203, v243
    v_mfma_f32_32x32x16_bf16 v[88:103], v[144:147], v[232:235], v[88:103]
    v_fma_f32 v43, v43, v187, v242
    v_cvt_pk_bf16_f32 v121, v42, v43
    v_cvt_pk_bf16_f32 v125, v58, v59
    v_mul_f32 v240, v60, v204
    v_mul_f32 v241, v60, v188
    v_mfma_f32_32x32x16_bf16 v[72:87], v[148:151], v[236:239], v[72:87]
    v_fma_f32 v60, -v44, v204, v241
    v_fma_f32 v44, v44, v188, v240
    v_mul_f32 v242, v61, v205
    v_mul_f32 v243, v61, v189
    v_fma_f32 v61, -v45, v205, v243
    v_mfma_f32_32x32x16_bf16 v[88:103], v[148:151], v[228:231], v[88:103]
    v_fma_f32 v45, v45, v189, v242
    v_cvt_pk_bf16_f32 v122, v44, v45
    v_cvt_pk_bf16_f32 v126, v60, v61
    v_mul_f32 v240, v62, v206
    v_mul_f32 v241, v62, v190
    s_waitcnt lgkmcnt(0)
    v_mfma_f32_32x32x16_bf16 v[72:87], v[104:107], v[216:219], v[72:87]
    ds_read_b128 v[228:231], v4 offset:33792
    ds_read_b128 v[232:235], v4 offset:35840
    ds_read_b128 v[236:239], v4 offset:34816
    v_fma_f32 v62, -v46, v206, v241
    v_fma_f32 v46, v46, v190, v240
    v_mfma_f32_32x32x16_bf16 v[88:103], v[104:107], v[220:223], v[88:103]
    v_mul_f32 v242, v63, v207
    v_mul_f32 v243, v63, v191
    v_fma_f32 v63, -v47, v207, v243
    v_fma_f32 v47, v47, v191, v242
    v_cvt_pk_bf16_f32 v123, v46, v47
    v_mfma_f32_32x32x16_bf16 v[72:87], v[108:111], v[224:227], v[72:87]
    v_cvt_pk_bf16_f32 v127, v62, v63
    v_mul_f32 v240, v64, v208
    v_mul_f32 v241, v64, v192
    v_fma_f32 v64, -v48, v208, v241
    v_fma_f32 v48, v48, v192, v240
    v_mfma_f32_32x32x16_bf16 v[88:103], v[108:111], v[216:219], v[88:103]
    v_mul_f32 v242, v65, v209
    v_mul_f32 v243, v65, v193
    v_fma_f32 v65, -v49, v209, v243
    v_fma_f32 v49, v49, v193, v242
    v_cvt_pk_bf16_f32 v128, v48, v49
    s_waitcnt lgkmcnt(0)
    v_mfma_f32_32x32x16_bf16 v[72:87], v[112:115], v[228:231], v[72:87]
    ds_read_b128 v[216:219], v4 offset:0
    ds_read_b128 v[220:223], v4 offset:2048
    ds_read_b128 v[224:227], v4 offset:1024
    v_cvt_pk_bf16_f32 v132, v64, v65
    v_mul_f32 v240, v66, v210
    v_mfma_f32_32x32x16_bf16 v[88:103], v[112:115], v[232:235], v[88:103]
    v_mul_f32 v241, v66, v194
    v_fma_f32 v66, -v50, v210, v241
    v_fma_f32 v50, v50, v194, v240
    v_mul_f32 v242, v67, v211
    v_mul_f32 v243, v67, v195
    v_mfma_f32_32x32x16_bf16 v[72:87], v[116:119], v[236:239], v[72:87]
    v_fma_f32 v67, -v51, v211, v243
    v_fma_f32 v51, v51, v195, v242
    v_cvt_pk_bf16_f32 v129, v50, v51
    v_cvt_pk_bf16_f32 v133, v66, v67
    v_mul_f32 v240, v68, v212
    v_mfma_f32_32x32x16_bf16 v[88:103], v[116:119], v[228:231], v[88:103]
    v_mul_f32 v241, v68, v196
    v_fma_f32 v68, -v52, v212, v241
    v_fma_f32 v52, v52, v196, v240
    v_mul_f32 v242, v69, v213
    v_mul_f32 v243, v69, v197
    v_fma_f32 v69, -v53, v213, v243
    v_fma_f32 v53, v53, v197, v242
    v_cvt_pk_bf16_f32 v130, v52, v53
    v_cvt_pk_bf16_f32 v134, v68, v69
    v_mul_f32 v240, v70, v214
    v_mul_f32 v241, v70, v198
    v_fma_f32 v70, -v54, v214, v241
    v_fma_f32 v54, v54, v198, v240
    v_mul_f32 v242, v71, v215
    v_mul_f32 v243, v71, v199
    v_fma_f32 v71, -v55, v215, v243
    v_fma_f32 v55, v55, v199, v242
    v_cvt_pk_bf16_f32 v131, v54, v55
    v_cvt_pk_bf16_f32 v135, v70, v71
    s_waitcnt lgkmcnt(0)
    v_mfma_f32_32x32x16_bf16 v[40:55], v[216:219], v[120:123], 0
    ds_read_b128 v[228:231], v4 offset:6144
    ds_read_b128 v[232:235], v4 offset:8192
    ds_read_b128 v[236:239], v4 offset:7168
    v_mfma_f32_32x32x16_bf16 v[56:71], v[220:223], v[120:123], 0
    v_mul_f32 v240, v88, v200
    v_mul_f32 v241, v88, v184
    v_fma_f32 v88, -v72, v200, v241
    v_fma_f32 v72, v72, v184, v240
    v_mul_f32 v242, v89, v201
    v_mfma_f32_32x32x16_bf16 v[40:55], v[224:227], v[124:127], v[40:55]
    v_mul_f32 v243, v89, v185
    v_fma_f32 v89, -v73, v201, v243
    v_fma_f32 v73, v73, v185, v242
    v_cvt_pk_bf16_f32 v136, v72, v73
    v_cvt_pk_bf16_f32 v140, v88, v89
    v_mfma_f32_32x32x16_bf16 v[56:71], v[216:219], v[124:127], v[56:71]
    v_mul_f32 v240, v90, v202
    v_mul_f32 v241, v90, v186
    v_fma_f32 v90, -v74, v202, v241
    v_fma_f32 v74, v74, v186, v240
    v_mul_f32 v242, v91, v203
    s_waitcnt lgkmcnt(0)
    v_mfma_f32_32x32x16_bf16 v[40:55], v[228:231], v[128:131], v[40:55]
    ds_read_b128 v[216:219], v4 offset:36864
    ds_read_b128 v[220:223], v4 offset:37888
    ds_read_b128 v[224:227], v4 offset:38912
    v_mul_f32 v243, v91, v187
    v_fma_f32 v91, -v75, v203, v243
    v_mfma_f32_32x32x16_bf16 v[56:71], v[232:235], v[128:131], v[56:71]
    v_fma_f32 v75, v75, v187, v242
    v_cvt_pk_bf16_f32 v137, v74, v75
    v_cvt_pk_bf16_f32 v141, v90, v91
    v_mul_f32 v240, v92, v204
    v_mul_f32 v241, v92, v188
    v_mfma_f32_32x32x16_bf16 v[40:55], v[236:239], v[132:135], v[40:55]
    v_fma_f32 v92, -v76, v204, v241
    v_fma_f32 v76, v76, v188, v240
    v_mul_f32 v242, v93, v205
    v_mul_f32 v243, v93, v189
    v_fma_f32 v93, -v77, v205, v243
    v_mfma_f32_32x32x16_bf16 v[56:71], v[228:231], v[132:135], v[56:71]
    v_fma_f32 v77, v77, v189, v242
    v_cvt_pk_bf16_f32 v138, v76, v77
    v_cvt_pk_bf16_f32 v142, v92, v93
    v_mul_f32 v240, v94, v206
    v_mul_f32 v241, v94, v190
    v_fma_f32 v94, -v78, v206, v241
    v_fma_f32 v78, v78, v190, v240
    v_mul_f32 v242, v95, v207
    v_mul_f32 v243, v95, v191
    v_fma_f32 v95, -v79, v207, v243
    v_fma_f32 v79, v79, v191, v242
    v_cvt_pk_bf16_f32 v139, v78, v79
    v_cvt_pk_bf16_f32 v143, v94, v95
    v_mul_f32 v240, v96, v208
    v_mul_f32 v241, v96, v192
    v_fma_f32 v96, -v80, v208, v241
    v_fma_f32 v80, v80, v192, v240
    v_mul_f32 v242, v97, v209
    v_mul_f32 v243, v97, v193
    v_fma_f32 v97, -v81, v209, v243
    v_fma_f32 v81, v81, v193, v242
    v_cvt_pk_bf16_f32 v144, v80, v81
    v_cvt_pk_bf16_f32 v148, v96, v97
    v_mul_f32 v240, v98, v210
    v_mul_f32 v241, v98, v194
    v_fma_f32 v98, -v82, v210, v241
    v_fma_f32 v82, v82, v194, v240
    v_mul_f32 v242, v99, v211
    v_mul_f32 v243, v99, v195
    v_fma_f32 v99, -v83, v211, v243
    v_fma_f32 v83, v83, v195, v242
    v_cvt_pk_bf16_f32 v145, v82, v83
    v_cvt_pk_bf16_f32 v149, v98, v99
    v_mul_f32 v240, v100, v212
    v_mul_f32 v241, v100, v196
    v_fma_f32 v100, -v84, v212, v241
    v_fma_f32 v84, v84, v196, v240
    v_mul_f32 v242, v101, v213
    v_mul_f32 v243, v101, v197
    v_fma_f32 v101, -v85, v213, v243
    v_fma_f32 v85, v85, v197, v242
    v_cvt_pk_bf16_f32 v146, v84, v85
    v_cvt_pk_bf16_f32 v150, v100, v101
    v_mul_f32 v240, v102, v214
    v_mul_f32 v241, v102, v198
    v_fma_f32 v102, -v86, v214, v241
    v_fma_f32 v86, v86, v198, v240
    v_mul_f32 v242, v103, v215
    v_mul_f32 v243, v103, v199
    v_fma_f32 v103, -v87, v215, v243
    v_fma_f32 v87, v87, v199, v242
    v_cvt_pk_bf16_f32 v147, v86, v87
    v_cvt_pk_bf16_f32 v151, v102, v103
    s_waitcnt lgkmcnt(0)
    v_mfma_f32_32x32x16_bf16 v[72:87], v[216:219], v[136:139], 0
    ds_read_b128 v[228:231], v4 offset:39936
    ds_read_b128 v[232:235], v4 offset:40960
    ds_read_b128 v[236:239], v4 offset:41984
    v_mfma_f32_32x32x16_bf16 v[88:103], v[220:223], v[136:139], 0
    v_cvt_pk_bf16_f32 v104, v40, v41
    v_cvt_pk_bf16_f32 v105, v42, v43
    v_cvt_pk_bf16_f32 v106, v44, v45
    v_cvt_pk_bf16_f32 v107, v46, v47
    buffer_store_dwordx4 v[104:107], v7, s[20:23], s51 offen offset:0
    v_mfma_f32_32x32x16_bf16 v[72:87], v[224:227], v[140:143], v[72:87]
    v_cvt_pk_bf16_f32 v108, v48, v49
    v_cvt_pk_bf16_f32 v109, v50, v51
    v_cvt_pk_bf16_f32 v110, v52, v53
    v_cvt_pk_bf16_f32 v111, v54, v55
    buffer_store_dwordx4 v[108:111], v7, s[20:23], s53 offen offset:0
    v_mfma_f32_32x32x16_bf16 v[88:103], v[216:219], v[140:143], v[88:103]
    v_cvt_pk_bf16_f32 v112, v56, v57
    v_cvt_pk_bf16_f32 v113, v58, v59
    v_cvt_pk_bf16_f32 v114, v60, v61
    v_cvt_pk_bf16_f32 v115, v62, v63
    buffer_store_dwordx4 v[112:115], v7, s[20:23], s51 offen offset:16
    s_waitcnt lgkmcnt(0)
    v_mfma_f32_32x32x16_bf16 v[72:87], v[228:231], v[144:147], v[72:87]
    v_cvt_pk_bf16_f32 v116, v64, v65
    v_cvt_pk_bf16_f32 v117, v66, v67
    v_cvt_pk_bf16_f32 v118, v68, v69
    v_cvt_pk_bf16_f32 v119, v70, v71
    buffer_store_dwordx4 v[116:119], v7, s[20:23], s53 offen offset:16
    v_mfma_f32_32x32x16_bf16 v[88:103], v[232:235], v[144:147], v[88:103]
    v_mfma_f32_32x32x16_bf16 v[72:87], v[236:239], v[148:151], v[72:87]
    v_mfma_f32_32x32x16_bf16 v[88:103], v[228:231], v[148:151], v[88:103]
    s_nop 10
    v_cvt_pk_bf16_f32 v120, v72, v73
    v_cvt_pk_bf16_f32 v121, v74, v75
    v_cvt_pk_bf16_f32 v122, v76, v77
    v_cvt_pk_bf16_f32 v123, v78, v79
    buffer_store_dwordx4 v[120:123], v7, s[20:23], s52 offen offset:0
    v_cvt_pk_bf16_f32 v124, v80, v81
    v_cvt_pk_bf16_f32 v125, v82, v83
    v_cvt_pk_bf16_f32 v126, v84, v85
    v_cvt_pk_bf16_f32 v127, v86, v87
    buffer_store_dwordx4 v[124:127], v7, s[20:23], s54 offen offset:0
    v_cvt_pk_bf16_f32 v128, v88, v89
    v_cvt_pk_bf16_f32 v129, v90, v91
    v_cvt_pk_bf16_f32 v130, v92, v93
    v_cvt_pk_bf16_f32 v131, v94, v95
    buffer_store_dwordx4 v[128:131], v7, s[20:23], s52 offen offset:16
    v_cvt_pk_bf16_f32 v132, v96, v97
    v_cvt_pk_bf16_f32 v133, v98, v99
    v_cvt_pk_bf16_f32 v134, v100, v101
    v_cvt_pk_bf16_f32 v135, v102, v103
    buffer_store_dwordx4 v[132:135], v7, s[20:23], s54 offen offset:16
    s_mov_b32 s40, s42
    s_mov_b32 s41, s43
    s_mov_b32 s42, s44
    s_mov_b32 s43, s45
    s_sub_u32 s46, s46, 1
kaf_col:
    s_and_b32 s51, s40, 32
    s_lshl_b32 s51, s51, 8
    s_and_b32 s52, s40, 0xffffffc0
    s_add_u32 s51, s51, s52
    s_add_u32 s52, s51, 2048
    s_add_u32 s53, s51, 4096
    s_add_u32 s54, s51, 6144
    ds_read_b128 v[216:219], v4 offset:0
    ds_read_b128 v[220:223], v4 offset:1024
    ds_read_b128 v[224:227], v4 offset:2048
    s_waitcnt vmcnt(8)
    s_waitcnt lgkmcnt(0)
    v_mfma_f32_32x32x16_bf16 v[40:55], v[8:11], v[216:219], 0
    ds_read_b128 v[228:231], v4 offset:6144
    ds_read_b128 v[232:235], v4 offset:7168
    ds_read_b128 v[236:239], v4 offset:8192
    v_mfma_f32_32x32x16_bf16 v[56:71], v[8:11], v[220:223], 0
    v_mfma_f32_32x32x16_bf16 v[40:55], v[12:15], v[224:227], v[40:55]
    v_mfma_f32_32x32x16_bf16 v[56:71], v[12:15], v[216:219], v[56:71]
    s_waitcnt lgkmcnt(0)
    v_mfma_f32_32x32x16_bf16 v[40:55], v[16:19], v[228:231], v[40:55]
    ds_read_b128 v[216:219], v4 offset:3072
    ds_read_b128 v[220:223], v4 offset:4096
    ds_read_b128 v[224:227], v4 offset:5120
    v_mfma_f32_32x32x16_bf16 v[56:71], v[16:19], v[232:235], v[56:71]
    v_mfma_f32_32x32x16_bf16 v[40:55], v[20:23], v[236:239], v[40:55]
    v_mfma_f32_32x32x16_bf16 v[56:71], v[20:23], v[228:231], v[56:71]
    s_waitcnt lgkmcnt(0)
    v_mfma_f32_32x32x16_bf16 v[72:87], v[24:27], v[216:219], 0
    ds_read_b128 v[228:231], v4 offset:9216
    ds_read_b128 v[232:235], v4 offset:10240
    ds_read_b128 v[236:239], v4 offset:11264
    v_mfma_f32_32x32x16_bf16 v[88:103], v[24:27], v[220:223], 0
    s_nop 5
    v_mul_f32 v240, v56, v200
    v_mul_f32 v241, v56, v184
    v_fma_f32 v56, v40, v200, v241
    v_fma_f32 v40, v40, v184, -v240
    v_mul_f32 v242, v57, v201
    v_mfma_f32_32x32x16_bf16 v[72:87], v[28:31], v[224:227], v[72:87]
    v_mul_f32 v243, v57, v185
    v_fma_f32 v57, v41, v201, v243
    v_fma_f32 v41, v41, v185, -v242
    v_cvt_pk_bf16_f32 v104, v40, v41
    v_cvt_pk_bf16_f32 v108, v56, v57
    v_mfma_f32_32x32x16_bf16 v[88:103], v[28:31], v[216:219], v[88:103]
    v_mul_f32 v240, v58, v202
    v_mul_f32 v241, v58, v186
    v_fma_f32 v58, v42, v202, v241
    v_fma_f32 v42, v42, v186, -v240
    v_mul_f32 v242, v59, v203
    s_waitcnt lgkmcnt(0)
    v_mfma_f32_32x32x16_bf16 v[72:87], v[32:35], v[228:231], v[72:87]
    ds_read_b128 v[216:219], v4 offset:12288
    ds_read_b128 v[220:223], v4 offset:13312
    ds_read_b128 v[224:227], v4 offset:14336
    v_mul_f32 v243, v59, v187
    v_fma_f32 v59, v43, v203, v243
    v_mfma_f32_32x32x16_bf16 v[88:103], v[32:35], v[232:235], v[88:103]
    v_fma_f32 v43, v43, v187, -v242
    v_cvt_pk_bf16_f32 v105, v42, v43
    v_cvt_pk_bf16_f32 v109, v58, v59
    v_mul_f32 v240, v60, v204
    v_mul_f32 v241, v60, v188
    v_mfma_f32_32x32x16_bf16 v[72:87], v[36:39], v[236:239], v[72:87]
    v_fma_f32 v60, v44, v204, v241
    v_fma_f32 v44, v44, v188, -v240
    v_mul_f32 v242, v61, v205
    v_mul_f32 v243, v61, v189
    v_fma_f32 v61, v45, v205, v243
    v_mfma_f32_32x32x16_bf16 v[88:103], v[36:39], v[228:231], v[88:103]
    v_fma_f32 v45, v45, v189, -v242
    v_cvt_pk_bf16_f32 v106, v44, v45
    v_cvt_pk_bf16_f32 v110, v60, v61
    v_mul_f32 v240, v62, v206
    v_mul_f32 v241, v62, v190
    s_cmp_eq_u32 s46, s55
    s_cbranch_scc0 kaf_xg
    ds_read_b128 v[8:11], v251 offset:0
    ds_read_b128 v[12:15], v251 offset:4160
    ds_read_b128 v[24:27], v251 offset:1024
    ds_read_b128 v[28:31], v251 offset:5184
    ds_read_b128 v[16:19], v251 offset:2048
    ds_read_b128 v[20:23], v251 offset:6208
    ds_read_b128 v[32:35], v251 offset:3072
    ds_read_b128 v[36:39], v251 offset:7232
    s_branch kaf_xd
kaf_xg:
    s_cmp_lt_u32 s46, 2
    s_cbranch_scc1 kaf_xd
    s_add_u32 s47, s42, 4096
    s_add_u32 s48, s42, 8192
    s_add_u32 s49, s42, 12288
    buffer_load_dwordx4 v[8:11], v3, s[8:11], s42 offen offset:0 sc1
    buffer_load_dwordx4 v[12:15], v3, s[8:11], s42 offen offset:16 sc1
    buffer_load_dwordx4 v[16:19], v3, s[8:11], s48 offen offset:0 sc1
    buffer_load_dwordx4 v[20:23], v3, s[8:11], s48 offen offset:16 sc1
    buffer_load_dwordx4 v[24:27], v3, s[8:11], s47 offen offset:0 sc1
    buffer_load_dwordx4 v[28:31], v3, s[8:11], s47 offen offset:16 sc1
    buffer_load_dwordx4 v[32:35], v3, s[8:11], s49 offen offset:0 sc1
    buffer_load_dwordx4 v[36:39], v3, s[8:11], s49 offen offset:16 sc1
kaf_xd:
    v_fma_f32 v62, v46, v206, v241
    v_fma_f32 v46, v46, v190, -v240
    v_mul_f32 v242, v63, v207
    v_mul_f32 v243, v63, v191
    v_fma_f32 v63, v47, v207, v243
    v_fma_f32 v47, v47, v191, -v242
    v_cvt_pk_bf16_f32 v107, v46, v47
    v_cvt_pk_bf16_f32 v111, v62, v63
    v_mul_f32 v240, v64, v208
    v_mul_f32 v241, v64, v192
    v_fma_f32 v64, v48, v208, v241
    v_fma_f32 v48, v48, v192, -v240
    v_mul_f32 v242, v65, v209
    v_mul_f32 v243, v65, v193
    v_fma_f32 v65, v49, v209, v243
    v_fma_f32 v49, v49, v193, -v242
    v_cvt_pk_bf16_f32 v112, v48, v49
    v_cvt_pk_bf16_f32 v116, v64, v65
    v_mul_f32 v240, v66, v210
    v_mul_f32 v241, v66, v194
    v_fma_f32 v66, v50, v210, v241
    v_fma_f32 v50, v50, v194, -v240
    v_mul_f32 v242, v67, v211
    v_mul_f32 v243, v67, v195
    v_fma_f32 v67, v51, v211, v243
    v_fma_f32 v51, v51, v195, -v242
    v_cvt_pk_bf16_f32 v113, v50, v51
    v_cvt_pk_bf16_f32 v117, v66, v67
    v_mul_f32 v240, v68, v212
    v_mul_f32 v241, v68, v196
    v_fma_f32 v68, v52, v212, v241
    v_fma_f32 v52, v52, v196, -v240
    v_mul_f32 v242, v69, v213
    v_mul_f32 v243, v69, v197
    v_fma_f32 v69, v53, v213, v243
    v_fma_f32 v53, v53, v197, -v242
    v_cvt_pk_bf16_f32 v114, v52, v53
    v_cvt_pk_bf16_f32 v118, v68, v69
    v_mul_f32 v240, v70, v214
    v_mul_f32 v241, v70, v198
    v_fma_f32 v70, v54, v214, v241
    v_fma_f32 v54, v54, v198, -v240
    v_mul_f32 v242, v71, v215
    v_mul_f32 v243, v71, v199
    v_fma_f32 v71, v55, v215, v243
    v_fma_f32 v55, v55, v199, -v242
    v_cvt_pk_bf16_f32 v115, v54, v55
    v_cvt_pk_bf16_f32 v119, v70, v71
    s_waitcnt lgkmcnt(0)
    v_mfma_f32_32x32x16_bf16 v[40:55], v[216:219], v[104:107], 0
    ds_read_b128 v[228:231], v4 offset:15360
    ds_read_b128 v[232:235], v4 offset:16384
    ds_read_b128 v[236:239], v4 offset:17408
    v_mfma_f32_32x32x16_bf16 v[56:71], v[220:223], v[104:107], 0
    v_mul_f32 v240, v88, v200
    v_mul_f32 v241, v88, v184
    v_fma_f32 v88, v72, v200, v241
    v_fma_f32 v72, v72, v184, -v240
    v_mul_f32 v242, v89, v201
    v_mfma_f32_32x32x16_bf16 v[40:55], v[224:227], v[108:111], v[40:55]
    v_mul_f32 v243, v89, v185
    v_fma_f32 v89, v73, v201, v243
    v_fma_f32 v73, v73, v185, -v242
    v_cvt_pk_bf16_f32 v120, v72, v73
    v_cvt_pk_bf16_f32 v124, v88, v89
    v_mfma_f32_32x32x16_bf16 v[56:71], v[216:219], v[108:111], v[56:71]
    v_mul_f32 v240, v90, v202
    v_mul_f32 v241, v90, v186
    v_fma_f32 v90, v74, v202, v241
    v_fma_f32 v74, v74, v186, -v240
    v_mul_f32 v242, v91, v203
    s_waitcnt lgkmcnt(0)
    v_mfma_f32_32x32x16_bf16 v[40:55], v[228:231], v[112:115], v[40:55]
    ds_read_b128 v[216:219], v4 offset:18432
    ds_read_b128 v[220:223], v4 offset:19456
    ds_read_b128 v[224:227], v4 offset:20480
    v_mul_f32 v243, v91, v187
    v_fma_f32 v91, v75, v203, v243
    v_mfma_f32_32x32x16_bf16 v[56:71], v[232:235], v[112:115], v[56:71]
    v_fma_f32 v75, v75, v187, -v242
    v_cvt_pk_bf16_f32 v121, v74, v75
    v_cvt_pk_bf16_f32 v125, v90, v91
    v_mul_f32 v240, v92, v204
    v_mul_f32 v241, v92, v188
    v_mfma_f32_32x32x16_bf16 v[40:55], v[236:239], v[116:119], v[40:55]
    v_fma_f32 v92, v76, v204, v241
    v_fma_f32 v76, v76, v188, -v240
    v_mul_f32 v242, v93, v205
    v_mul_f32 v243, v93, v189
    v_fma_f32 v93, v77, v205, v243
    v_mfma_f32_32x32x16_bf16 v[56:71], v[228:231], v[116:119], v[56:71]
    v_fma_f32 v77, v77, v189, -v242
    v_cvt_pk_bf16_f32 v122, v76, v77
    v_cvt_pk_bf16_f32 v126, v92, v93
    v_mul_f32 v240, v94, v206
    v_mul_f32 v241, v94, v190
    v_fma_f32 v94, v78, v206, v241
    v_fma_f32 v78, v78, v190, -v240
    v_mul_f32 v242, v95, v207
    v_mul_f32 v243, v95, v191
    v_fma_f32 v95, v79, v207, v243
    v_fma_f32 v79, v79, v191, -v242
    v_cvt_pk_bf16_f32 v123, v78, v79
    v_cvt_pk_bf16_f32 v127, v94, v95
    v_mul_f32 v240, v96, v208
    v_mul_f32 v241, v96, v192
    v_fma_f32 v96, v80, v208, v241
    v_fma_f32 v80, v80, v192, -v240
    v_mul_f32 v242, v97, v209
    v_mul_f32 v243, v97, v193
    v_fma_f32 v97, v81, v209, v243
    v_fma_f32 v81, v81, v193, -v242
    v_cvt_pk_bf16_f32 v128, v80, v81
    v_cvt_pk_bf16_f32 v132, v96, v97
    v_mul_f32 v240, v98, v210
    v_mul_f32 v241, v98, v194
    v_fma_f32 v98, v82, v210, v241
    v_fma_f32 v82, v82, v194, -v240
    v_mul_f32 v242, v99, v211
    v_mul_f32 v243, v99, v195
    v_fma_f32 v99, v83, v211, v243
    v_fma_f32 v83, v83, v195, -v242
    v_cvt_pk_bf16_f32 v129, v82, v83
    v_cvt_pk_bf16_f32 v133, v98, v99
    v_mul_f32 v240, v100, v212
    v_mul_f32 v241, v100, v196
    v_fma_f32 v100, v84, v212, v241
    v_fma_f32 v84, v84, v196, -v240
    v_mul_f32 v242, v101, v213
    v_mul_f32 v243, v101, v197
    v_fma_f32 v101, v85, v213, v243
    v_fma_f32 v85, v85, v197, -v242
    v_cvt_pk_bf16_f32 v130, v84, v85
    v_cvt_pk_bf16_f32 v134, v100, v101
    v_mul_f32 v240, v102, v214
    v_mul_f32 v241, v102, v198
    v_fma_f32 v102, v86, v214, v241
    v_fma_f32 v86, v86, v198, -v240
    v_mul_f32 v242, v103, v215
    v_mul_f32 v243, v103, v199
    v_fma_f32 v103, v87, v215, v243
    v_fma_f32 v87, v87, v199, -v242
    v_cvt_pk_bf16_f32 v131, v86, v87
    v_cvt_pk_bf16_f32 v135, v102, v103
    s_waitcnt lgkmcnt(0)
    v_mfma_f32_32x32x16_bf16 v[40:55], v[216:219], v[120:123], v[40:55]
    ds_read_b128 v[228:231], v4 offset:21504
    ds_read_b128 v[232:235], v4 offset:22528
    ds_read_b128 v[236:239], v4 offset:23552
    v_mfma_f32_32x32x16_bf16 v[56:71], v[220:223], v[120:123], v[56:71]
    v_mfma_f32_32x32x16_bf16 v[40:55], v[224:227], v[124:127], v[40:55]
    v_mfma_f32_32x32x16_bf16 v[56:71], v[216:219], v[124:127], v[56:71]
    s_waitcnt lgkmcnt(0)
    v_mfma_f32_32x32x16_bf16 v[40:55], v[228:231], v[128:131], v[40:55]
    ds_read_b128 v[216:219], v4 offset:24576
    ds_read_b128 v[220:223], v4 offset:25600
    ds_read_b128 v[224:227], v4 offset:26624
    v_mfma_f32_32x32x16_bf16 v[56:71], v[232:235], v[128:131], v[56:71]
    v_mfma_f32_32x32x16_bf16 v[40:55], v[236:239], v[132:135], v[40:55]
    v_mfma_f32_32x32x16_bf16 v[56:71], v[228:231], v[132:135], v[56:71]
    s_waitcnt lgkmcnt(0)
    v_mfma_f32_32x32x16_bf16 v[72:87], v[216:219], v[104:107], 0
    ds_read_b128 v[228:231], v4 offset:27648
    ds_read_b128 v[232:235], v4 offset:28672
    ds_read_b128 v[236:239], v4 offset:29696
    v_mfma_f32_32x32x16_bf16 v[88:103], v[220:223], v[104:107], 0
    s_waitcnt vmcnt(0)
    v_lshlrev_b32 v242, 16, v152
    v_and_b32 v243, s34, v152
    s_nop 2
    v_mul_f32 v240, v56, v243
    v_mul_f32 v241, v56, v242
    v_mfma_f32_32x32x16_bf16 v[72:87], v[224:227], v[108:111], v[72:87]
    v_fma_f32 v56, v40, v243, v241
    v_fma_f32 v40, v40, v242, -v240
    v_lshlrev_b32 v246, 16, v153
    v_and_b32 v247, s34, v153
    v_mul_f32 v244, v57, v247
    v_mfma_f32_32x32x16_bf16 v[88:103], v[216:219], v[108:111], v[88:103]
    v_mul_f32 v245, v57, v246
    v_fma_f32 v57, v41, v247, v245
    v_fma_f32 v41, v41, v246, -v244
    v_cvt_pk_bf16_f32 v136, v40, v41
    v_cvt_pk_bf16_f32 v140, v56, v57
    s_waitcnt lgkmcnt(0)
    v_mfma_f32_32x32x16_bf16 v[72:87], v[228:231], v[112:115], v[72:87]
    ds_read_b128 v[216:219], v4 offset:30720
    ds_read_b128 v[220:223], v4 offset:31744
    ds_read_b128 v[224:227], v4 offset:32768
    v_lshlrev_b32 v242, 16, v154
    v_and_b32 v243, s34, v154
    v_mfma_f32_32x32x16_bf16 v[88:103], v[232:235], v[112:115], v[88:103]
    v_mul_f32 v240, v58, v243
    v_mul_f32 v241, v58, v242
    v_fma_f32 v58, v42, v243, v241
    v_fma_f32 v42, v42, v242, -v240
    v_lshlrev_b32 v246, 16, v155
    v_mfma_f32_32x32x16_bf16 v[72:87], v[236:239], v[116:119], v[72:87]
    v_and_b32 v247, s34, v155
    v_mul_f32 v244, v59, v247
    v_mul_f32 v245, v59, v246
    v_fma_f32 v59, v43, v247, v245
    v_fma_f32 v43, v43, v246, -v244
    v_mfma_f32_32x32x16_bf16 v[88:103], v[228:231], v[116:119], v[88:103]
    v_cvt_pk_bf16_f32 v137, v42, v43
    v_cvt_pk_bf16_f32 v141, v58, v59
    v_lshlrev_b32 v242, 16, v156
    v_and_b32 v243, s34, v156
    v_mul_f32 v240, v60, v243
    s_waitcnt lgkmcnt(0)
    v_mfma_f32_32x32x16_bf16 v[72:87], v[216:219], v[120:123], v[72:87]
    ds_read_b128 v[228:231], v4 offset:33792
    ds_read_b128 v[232:235], v4 offset:34816
    ds_read_b128 v[236:239], v4 offset:35840
    v_mul_f32 v241, v60, v242
    v_fma_f32 v60, v44, v243, v241
    v_mfma_f32_32x32x16_bf16 v[88:103], v[220:223], v[120:123], v[88:103]
    v_fma_f32 v44, v44, v242, -v240
    v_lshlrev_b32 v246, 16, v157
    v_and_b32 v247, s34, v157
    v_mul_f32 v244, v61, v247
    v_mul_f32 v245, v61, v246
    v_mfma_f32_32x32x16_bf16 v[72:87], v[224:227], v[124:127], v[72:87]
    v_fma_f32 v61, v45, v247, v245
    v_fma_f32 v45, v45, v246, -v244
    v_cvt_pk_bf16_f32 v138, v44, v45
    v_cvt_pk_bf16_f32 v142, v60, v61
    v_lshlrev_b32 v242, 16, v158
    v_mfma_f32_32x32x16_bf16 v[88:103], v[216:219], v[124:127], v[88:103]
    v_and_b32 v243, s34, v158
    v_mul_f32 v240, v62, v243
    v_mul_f32 v241, v62, v242
    v_fma_f32 v62, v46, v243, v241
    v_fma_f32 v46, v46, v242, -v240
    s_waitcnt lgkmcnt(0)
    v_mfma_f32_32x32x16_bf16 v[72:87], v[228:231], v[128:131], v[72:87]
    ds_read_b128 v[216:219], v4 offset:12288
    ds_read_b128 v[220:223], v4 offset:14336
    ds_read_b128 v[224:227], v4 offset:13312
    v_lshlrev_b32 v246, 16, v159
    v_and_b32 v247, s34, v159
    v_mfma_f32_32x32x16_bf16 v[88:103], v[232:235], v[128:131], v[88:103]
    v_mul_f32 v244, v63, v247
    v_mul_f32 v245, v63, v246
    v_fma_f32 v63, v47, v247, v245
    v_fma_f32 v47, v47, v246, -v244
    v_cvt_pk_bf16_f32 v139, v46, v47
    v_mfma_f32_32x32x16_bf16 v[72:87], v[236:239], v[132:135], v[72:87]
    v_cvt_pk_bf16_f32 v143, v62, v63
    v_lshlrev_b32 v242, 16, v160
    v_and_b32 v243, s34, v160
    v_mul_f32 v240, v64, v243
    v_mul_f32 v241, v64, v242
    v_mfma_f32_32x32x16_bf16 v[88:103], v[228:231], v[132:135], v[88:103]
    v_fma_f32 v64, v48, v243, v241
    v_fma_f32 v48, v48, v242, -v240
    v_lshlrev_b32 v246, 16, v161
    v_and_b32 v247, s34, v161
    v_mul_f32 v244, v65, v247
    v_mul_f32 v245, v65, v246
    v_fma_f32 v65, v49, v247, v245
    v_fma_f32 v49, v49, v246, -v244
    v_cvt_pk_bf16_f32 v144, v48, v49
    v_cvt_pk_bf16_f32 v148, v64, v65
    v_lshlrev_b32 v242, 16, v162
    v_and_b32 v243, s34, v162
    v_mul_f32 v240, v66, v243
    v_mul_f32 v241, v66, v242
    v_fma_f32 v66, v50, v243, v241
    v_fma_f32 v50, v50, v242, -v240
    v_lshlrev_b32 v246, 16, v163
    v_and_b32 v247, s34, v163
    v_mul_f32 v244, v67, v247
    v_mul_f32 v245, v67, v246
    v_fma_f32 v67, v51, v247, v245
    v_fma_f32 v51, v51, v246, -v244
    v_cvt_pk_bf16_f32 v145, v50, v51
    v_cvt_pk_bf16_f32 v149, v66, v67
    v_lshlrev_b32 v242, 16, v164
    v_and_b32 v243, s34, v164
    v_mul_f32 v240, v68, v243
    v_mul_f32 v241, v68, v242
    v_fma_f32 v68, v52, v243, v241
    v_fma_f32 v52, v52, v242, -v240
    v_lshlrev_b32 v246, 16, v165
    v_and_b32 v247, s34, v165
    v_mul_f32 v244, v69, v247
    v_mul_f32 v245, v69, v246
    v_fma_f32 v69, v53, v247, v245
    v_fma_f32 v53, v53, v246, -v244
    v_cvt_pk_bf16_f32 v146, v52, v53
    v_cvt_pk_bf16_f32 v150, v68, v69
    v_lshlrev_b32 v242, 16, v166
    v_and_b32 v243, s34, v166
    v_mul_f32 v240, v70, v243
    v_mul_f32 v241, v70, v242
    v_fma_f32 v70, v54, v243, v241
    v_fma_f32 v54, v54, v242, -v240
    v_lshlrev_b32 v246, 16, v167
    v_and_b32 v247, s34, v167
    v_mul_f32 v244, v71, v247
    v_mul_f32 v245, v71, v246
    v_fma_f32 v71, v55, v247, v245
    v_fma_f32 v55, v55, v246, -v244
    v_cvt_pk_bf16_f32 v147, v54, v55
    v_cvt_pk_bf16_f32 v151, v70, v71
    s_waitcnt lgkmcnt(0)
    v_mfma_f32_32x32x16_bf16 v[40:55], v[136:139], v[216:219], 0
    ds_read_b128 v[228:231], v4 offset:15360
    ds_read_b128 v[232:235], v4 offset:17408
    ds_read_b128 v[236:239], v4 offset:16384
    v_mfma_f32_32x32x16_bf16 v[56:71], v[136:139], v[220:223], 0
    v_lshlrev_b32 v242, 16, v168
    v_and_b32 v243, s34, v168
    v_mul_f32 v240, v88, v243
    v_mul_f32 v241, v88, v242
    v_fma_f32 v88, v72, v243, v241
    v_mfma_f32_32x32x16_bf16 v[40:55], v[140:143], v[224:227], v[40:55]
    v_fma_f32 v72, v72, v242, -v240
    v_lshlrev_b32 v246, 16, v169
    v_and_b32 v247, s34, v169
    v_mul_f32 v244, v89, v247
    v_mul_f32 v245, v89, v246
    v_mfma_f32_32x32x16_bf16 v[56:71], v[140:143], v[216:219], v[56:71]
    v_fma_f32 v89, v73, v247, v245
    v_fma_f32 v73, v73, v246, -v244
    v_cvt_pk_bf16_f32 v104, v72, v73
    v_cvt_pk_bf16_f32 v108, v88, v89
    v_lshlrev_b32 v242, 16, v170
    s_waitcnt lgkmcnt(0)
    v_mfma_f32_32x32x16_bf16 v[40:55], v[144:147], v[228:231], v[40:55]
    ds_read_b128 v[216:219], v4 offset:18432
    ds_read_b128 v[220:223], v4 offset:20480
    ds_read_b128 v[224:227], v4 offset:19456
    v_and_b32 v243, s34, v170
    v_mul_f32 v240, v90, v243
    v_mfma_f32_32x32x16_bf16 v[56:71], v[144:147], v[232:235], v[56:71]
    v_mul_f32 v241, v90, v242
    v_fma_f32 v90, v74, v243, v241
    v_fma_f32 v74, v74, v242, -v240
    v_lshlrev_b32 v246, 16, v171
    v_and_b32 v247, s34, v171
    v_mfma_f32_32x32x16_bf16 v[40:55], v[148:151], v[236:239], v[40:55]
    v_mul_f32 v244, v91, v247
    v_mul_f32 v245, v91, v246
    v_fma_f32 v91, v75, v247, v245
    v_fma_f32 v75, v75, v246, -v244
    v_cvt_pk_bf16_f32 v105, v74, v75
    v_mfma_f32_32x32x16_bf16 v[56:71], v[148:151], v[228:231], v[56:71]
    v_cvt_pk_bf16_f32 v109, v90, v91
    v_lshlrev_b32 v242, 16, v172
    v_and_b32 v243, s34, v172
    v_mul_f32 v240, v92, v243
    v_mul_f32 v241, v92, v242
    v_fma_f32 v92, v76, v243, v241
    v_fma_f32 v76, v76, v242, -v240
    v_lshlrev_b32 v246, 16, v173
    v_and_b32 v247, s34, v173
    v_mul_f32 v244, v93, v247
    v_mul_f32 v245, v93, v246
    v_fma_f32 v93, v77, v247, v245
    v_fma_f32 v77, v77, v246, -v244
    v_cvt_pk_bf16_f32 v106, v76, v77
    v_cvt_pk_bf16_f32 v110, v92, v93
    v_lshlrev_b32 v242, 16, v174
    v_and_b32 v243, s34, v174
    v_mul_f32 v240, v94, v243
    v_mul_f32 v241, v94, v242
    v_fma_f32 v94, v78, v243, v241
    v_fma_f32 v78, v78, v242, -v240
    v_lshlrev_b32 v246, 16, v175
    v_and_b32 v247, s34, v175
    v_mul_f32 v244, v95, v247
    v_mul_f32 v245, v95, v246
    v_fma_f32 v95, v79, v247, v245
    v_fma_f32 v79, v79, v246, -v244
    v_cvt_pk_bf16_f32 v107, v78, v79
    v_cvt_pk_bf16_f32 v111, v94, v95
    v_lshlrev_b32 v242, 16, v176
    v_and_b32 v243, s34, v176
    v_mul_f32 v240, v96, v243
    v_mul_f32 v241, v96, v242
    v_fma_f32 v96, v80, v243, v241
    v_fma_f32 v80, v80, v242, -v240
    v_lshlrev_b32 v246, 16, v177
    v_and_b32 v247, s34, v177
    v_mul_f32 v244, v97, v247
    v_mul_f32 v245, v97, v246
    v_fma_f32 v97, v81, v247, v245
    v_fma_f32 v81, v81, v246, -v244
    v_cvt_pk_bf16_f32 v112, v80, v81
    v_cvt_pk_bf16_f32 v116, v96, v97
    v_lshlrev_b32 v242, 16, v178
    v_and_b32 v243, s34, v178
    v_mul_f32 v240, v98, v243
    v_mul_f32 v241, v98, v242
    v_fma_f32 v98, v82, v243, v241
    v_fma_f32 v82, v82, v242, -v240
    v_lshlrev_b32 v246, 16, v179
    v_and_b32 v247, s34, v179
    v_mul_f32 v244, v99, v247
    v_mul_f32 v245, v99, v246
    v_fma_f32 v99, v83, v247, v245
    v_fma_f32 v83, v83, v246, -v244
    v_cvt_pk_bf16_f32 v113, v82, v83
    v_cvt_pk_bf16_f32 v117, v98, v99
    v_lshlrev_b32 v242, 16, v180
    v_and_b32 v243, s34, v180
    v_mul_f32 v240, v100, v243
    v_mul_f32 v241, v100, v242
    v_fma_f32 v100, v84, v243, v241
    v_fma_f32 v84, v84, v242, -v240
    v_lshlrev_b32 v246, 16, v181
    v_and_b32 v247, s34, v181
    v_mul_f32 v244, v101, v247
    v_mul_f32 v245, v101, v246
    v_fma_f32 v101, v85, v247, v245
    v_fma_f32 v85, v85, v246, -v244
    v_cvt_pk_bf16_f32 v114, v84, v85
    v_cvt_pk_bf16_f32 v118, v100, v101
    v_lshlrev_b32 v242, 16, v182
    v_and_b32 v243, s34, v182
    v_mul_f32 v240, v102, v243
    v_mul_f32 v241, v102, v242
    v_fma_f32 v102, v86, v243, v241
    v_fma_f32 v86, v86, v242, -v240
    v_lshlrev_b32 v246, 16, v183
    v_and_b32 v247, s34, v183
    v_mul_f32 v244, v103, v247
    v_mul_f32 v245, v103, v246
    v_fma_f32 v103, v87, v247, v245
    v_fma_f32 v87, v87, v246, -v244
    v_cvt_pk_bf16_f32 v115, v86, v87
    v_cvt_pk_bf16_f32 v119, v102, v103
    s_waitcnt lgkmcnt(0)
    v_mfma_f32_32x32x16_bf16 v[40:55], v[104:107], v[216:219], v[40:55]
    ds_read_b128 v[228:231], v4 offset:21504
    ds_read_b128 v[232:235], v4 offset:23552
    ds_read_b128 v[236:239], v4 offset:22528
    v_mfma_f32_32x32x16_bf16 v[56:71], v[104:107], v[220:223], v[56:71]
    v_mfma_f32_32x32x16_bf16 v[40:55], v[108:111], v[224:227], v[40:55]
    v_mfma_f32_32x32x16_bf16 v[56:71], v[108:111], v[216:219], v[56:71]
    s_cmp_lt_u32 s46, 2
    s_cbranch_scc1 kaf_wd
    s_add_u32 s50, s43, 4096
    buffer_load_dwordx4 v[152:155], v2, s[12:15], s43 offen offset:0 sc1
    buffer_load_dwordx4 v[156:159], v2, s[12:15], s43 offen offset:1024 sc1
    buffer_load_dwordx4 v[160:163], v2, s[12:15], s43 offen offset:2048 sc1
    buffer_load_dwordx4 v[164:167], v2, s[12:15], s43 offen offset:3072 sc1
    buffer_load_dwordx4 v[168:171], v2, s[12:15], s50 offen offset:0 sc1
    buffer_load_dwordx4 v[172:175], v2, s[12:15], s50 offen offset:1024 sc1
    buffer_load_dwordx4 v[176:179], v2, s[12:15], s50 offen offset:2048 sc1
    buffer_load_dwordx4 v[180:183], v2, s[12:15], s50 offen offset:3072 sc1
kaf_wd:
    s_waitcnt lgkmcnt(0)
    v_mfma_f32_32x32x16_bf16 v[40:55], v[112:115], v[228:231], v[40:55]
    ds_read_b128 v[216:219], v4 offset:24576
    ds_read_b128 v[220:223], v4 offset:26624
    ds_read_b128 v[224:227], v4 offset:25600
    v_mfma_f32_32x32x16_bf16 v[56:71], v[112:115], v[232:235], v[56:71]
    v_mfma_f32_32x32x16_bf16 v[40:55], v[116:119], v[236:239], v[40:55]
    v_mfma_f32_32x32x16_bf16 v[56:71], v[116:119], v[228:231], v[56:71]
    s_waitcnt lgkmcnt(0)
    v_mfma_f32_32x32x16_bf16 v[72:87], v[136:139], v[216:219], 0
    ds_read_b128 v[228:231], v4 offset:27648
    ds_read_b128 v[232:235], v4 offset:29696
    ds_read_b128 v[236:239], v4 offset:28672
    v_mfma_f32_32x32x16_bf16 v[88:103], v[136:139], v[220:223], 0
    s_nop 5
    v_mul_f32 v240, v56, v200
    v_mul_f32 v241, v56, v184
    v_fma_f32 v56, -v40, v200, v241
    v_fma_f32 v40, v40, v184, v240
    v_mul_f32 v242, v57, v201
    v_mfma_f32_32x32x16_bf16 v[72:87], v[140:143], v[224:227], v[72:87]
    v_mul_f32 v243, v57, v185
    v_fma_f32 v57, -v41, v201, v243
    v_fma_f32 v41, v41, v185, v242
    v_cvt_pk_bf16_f32 v120, v40, v41
    v_cvt_pk_bf16_f32 v124, v56, v57
    v_mfma_f32_32x32x16_bf16 v[88:103], v[140:143], v[216:219], v[88:103]
    v_mul_f32 v240, v58, v202
    v_mul_f32 v241, v58, v186
    v_fma_f32 v58, -v42, v202, v241
    v_fma_f32 v42, v42, v186, v240
    v_mul_f32 v242, v59, v203
    s_waitcnt lgkmcnt(0)
    v_mfma_f32_32x32x16_bf16 v[72:87], v[144:147], v[228:231], v[72:87]
    ds_read_b128 v[216:219], v4 offset:30720
    ds_read_b128 v[220:223], v4 offset:32768
    ds_read_b128 v[224:227], v4 offset:31744
    v_mul_f32 v243, v59, v187
    v_fma_f32 v59, -v43, v203, v243
    v_mfma_f32_32x32x16_bf16 v[88:103], v[144:147], v[232:235], v[88:103]
    v_fma_f32 v43, v43, v187, v242
    v_cvt_pk_bf16_f32 v121, v42, v43
    v_cvt_pk_bf16_f32 v125, v58, v59
    v_mul_f32 v240, v60, v204
    v_mul_f32 v241, v60, v188
    v_mfma_f32_32x32x16_bf16 v[72:87], v[148:151], v[236:239], v[72:87]
    v_fma_f32 v60, -v44, v204, v241
    v_fma_f32 v44, v44, v188, v240
    v_mul_f32 v242, v61, v205
    v_mul_f32 v243, v61, v189
    v_fma_f32 v61, -v45, v205, v243
    v_mfma_f32_32x32x16_bf16 v[88:103], v[148:151], v[228:231], v[88:103]
    v_fma_f32 v45, v45, v189, v242
    v_cvt_pk_bf16_f32 v122, v44, v45
    v_cvt_pk_bf16_f32 v126, v60, v61
    v_mul_f32 v240, v62, v206
    v_mul_f32 v241, v62, v190
    s_waitcnt lgkmcnt(0)
    v_mfma_f32_32x32x16_bf16 v[72:87], v[104:107], v[216:219], v[72:87]
    ds_read_b128 v[228:231], v4 offset:33792
    ds_read_b128 v[232:235], v4 offset:35840
    ds_read_b128 v[236:239], v4 offset:34816
    v_fma_f32 v62, -v46, v206, v241
    v_fma_f32 v46, v46, v190, v240
    v_mfma_f32_32x32x16_bf16 v[88:103], v[104:107], v[220:223], v[88:103]
    v_mul_f32 v242, v63, v207
    v_mul_f32 v243, v63, v191
    v_fma_f32 v63, -v47, v207, v243
    v_fma_f32 v47, v47, v191, v242
    v_cvt_pk_bf16_f32 v123, v46, v47
    v_mfma_f32_32x32x16_bf16 v[72:87], v[108:111], v[224:227], v[72:87]
    v_cvt_pk_bf16_f32 v127, v62, v63
    v_mul_f32 v240, v64, v208
    v_mul_f32 v241, v64, v192
    v_fma_f32 v64, -v48, v208, v241
    v_fma_f32 v48, v48, v192, v240
    v_mfma_f32_32x32x16_bf16 v[88:103], v[108:111], v[216:219], v[88:103]
    v_mul_f32 v242, v65, v209
    v_mul_f32 v243, v65, v193
    v_fma_f32 v65, -v49, v209, v243
    v_fma_f32 v49, v49, v193, v242
    v_cvt_pk_bf16_f32 v128, v48, v49
    s_waitcnt lgkmcnt(0)
    v_mfma_f32_32x32x16_bf16 v[72:87], v[112:115], v[228:231], v[72:87]
    ds_read_b128 v[216:219], v4 offset:0
    ds_read_b128 v[220:223], v4 offset:2048
    ds_read_b128 v[224:227], v4 offset:1024
    v_cvt_pk_bf16_f32 v132, v64, v65
    v_mul_f32 v240, v66, v210
    v_mfma_f32_32x32x16_bf16 v[88:103], v[112:115], v[232:235], v[88:103]
    v_mul_f32 v241, v66, v194
    v_fma_f32 v66, -v50, v210, v241
    v_fma_f32 v50, v50, v194, v240
    v_mul_f32 v242, v67, v211
    v_mul_f32 v243, v67, v195
    v_mfma_f32_32x32x16_bf16 v[72:87], v[116:119], v[236:239], v[72:87]
    v_fma_f32 v67, -v51, v211, v243
    v_fma_f32 v51, v51, v195, v242
    v_cvt_pk_bf16_f32 v129, v50, v51
    v_cvt_pk_bf16_f32 v133, v66, v67
    v_mul_f32 v240, v68, v212
    v_mfma_f32_32x32x16_bf16 v[88:103], v[116:119], v[228:231], v[88:103]
    v_mul_f32 v241, v68, v196
    v_fma_f32 v68, -v52, v212, v241
    v_fma_f32 v52, v52, v196, v240
    v_mul_f32 v242, v69, v213
    v_mul_f32 v243, v69, v197
    v_fma_f32 v69, -v53, v213, v243
    v_fma_f32 v53, v53, v197, v242
    v_cvt_pk_bf16_f32 v130, v52, v53
    v_cvt_pk_bf16_f32 v134, v68, v69
    v_mul_f32 v240, v70, v214
    v_mul_f32 v241, v70, v198
    v_fma_f32 v70, -v54, v214, v241
    v_fma_f32 v54, v54, v198, v240
    v_mul_f32 v242, v71, v215
    v_mul_f32 v243, v71, v199
    v_fma_f32 v71, -v55, v215, v243
    v_fma_f32 v55, v55, v199, v242
    v_cvt_pk_bf16_f32 v131, v54, v55
    v_cvt_pk_bf16_f32 v135, v70, v71
    s_waitcnt lgkmcnt(0)
    v_mfma_f32_32x32x16_bf16 v[40:55], v[216:219], v[120:123], 0
    ds_read_b128 v[228:231], v4 offset:6144
    ds_read_b128 v[232:235], v4 offset:8192
    ds_read_b128 v[236:239], v4 offset:7168
    v_mfma_f32_32x32x16_bf16 v[56:71], v[220:223], v[120:123], 0
    v_mul_f32 v240, v88, v200
    v_mul_f32 v241, v88, v184
    v_fma_f32 v88, -v72, v200, v241
    v_fma_f32 v72, v72, v184, v240
    v_mul_f32 v242, v89, v201
    v_mfma_f32_32x32x16_bf16 v[40:55], v[224:227], v[124:127], v[40:55]
    v_mul_f32 v243, v89, v185
    v_fma_f32 v89, -v73, v201, v243
    v_fma_f32 v73, v73, v185, v242
    v_cvt_pk_bf16_f32 v136, v72, v73
    v_cvt_pk_bf16_f32 v140, v88, v89
    v_mfma_f32_32x32x16_bf16 v[56:71], v[216:219], v[124:127], v[56:71]
    v_mul_f32 v240, v90, v202
    v_mul_f32 v241, v90, v186
    v_fma_f32 v90, -v74, v202, v241
    v_fma_f32 v74, v74, v186, v240
    v_mul_f32 v242, v91, v203
    s_waitcnt lgkmcnt(0)
    v_mfma_f32_32x32x16_bf16 v[40:55], v[228:231], v[128:131], v[40:55]
    ds_read_b128 v[216:219], v4 offset:36864
    ds_read_b128 v[220:223], v4 offset:37888
    ds_read_b128 v[224:227], v4 offset:38912
    v_mul_f32 v243, v91, v187
    v_fma_f32 v91, -v75, v203, v243
    v_mfma_f32_32x32x16_bf16 v[56:71], v[232:235], v[128:131], v[56:71]
    v_fma_f32 v75, v75, v187, v242
    v_cvt_pk_bf16_f32 v137, v74, v75
    v_cvt_pk_bf16_f32 v141, v90, v91
    v_mul_f32 v240, v92, v204
    v_mul_f32 v241, v92, v188
    v_mfma_f32_32x32x16_bf16 v[40:55], v[236:239], v[132:135], v[40:55]
    v_fma_f32 v92, -v76, v204, v241
    v_fma_f32 v76, v76, v188, v240
    v_mul_f32 v242, v93, v205
    v_mul_f32 v243, v93, v189
    v_fma_f32 v93, -v77, v205, v243
    v_mfma_f32_32x32x16_bf16 v[56:71], v[228:231], v[132:135], v[56:71]
    v_fma_f32 v77, v77, v189, v242
    v_cvt_pk_bf16_f32 v138, v76, v77
    v_cvt_pk_bf16_f32 v142, v92, v93
    v_mul_f32 v240, v94, v206
    v_mul_f32 v241, v94, v190
    v_fma_f32 v94, -v78, v206, v241
    v_fma_f32 v78, v78, v190, v240
    v_mul_f32 v242, v95, v207
    v_mul_f32 v243, v95, v191
    v_fma_f32 v95, -v79, v207, v243
    v_fma_f32 v79, v79, v191, v242
    v_cvt_pk_bf16_f32 v139, v78, v79
    v_cvt_pk_bf16_f32 v143, v94, v95
    v_mul_f32 v240, v96, v208
    v_mul_f32 v241, v96, v192
    v_fma_f32 v96, -v80, v208, v241
    v_fma_f32 v80, v80, v192, v240
    v_mul_f32 v242, v97, v209
    v_mul_f32 v243, v97, v193
    v_fma_f32 v97, -v81, v209, v243
    v_fma_f32 v81, v81, v193, v242
    v_cvt_pk_bf16_f32 v144, v80, v81
    v_cvt_pk_bf16_f32 v148, v96, v97
    v_mul_f32 v240, v98, v210
    v_mul_f32 v241, v98, v194
    v_fma_f32 v98, -v82, v210, v241
    v_fma_f32 v82, v82, v194, v240
    v_mul_f32 v242, v99, v211
    v_mul_f32 v243, v99, v195
    v_fma_f32 v99, -v83, v211, v243
    v_fma_f32 v83, v83, v195, v242
    v_cvt_pk_bf16_f32 v145, v82, v83
    v_cvt_pk_bf16_f32 v149, v98, v99
    v_mul_f32 v240, v100, v212
    v_mul_f32 v241, v100, v196
    v_fma_f32 v100, -v84, v212, v241
    v_fma_f32 v84, v84, v196, v240
    v_mul_f32 v242, v101, v213
    v_mul_f32 v243, v101, v197
    v_fma_f32 v101, -v85, v213, v243
    v_fma_f32 v85, v85, v197, v242
    v_cvt_pk_bf16_f32 v146, v84, v85
    v_cvt_pk_bf16_f32 v150, v100, v101
    v_mul_f32 v240, v102, v214
    v_mul_f32 v241, v102, v198
    v_fma_f32 v102, -v86, v214, v241
    v_fma_f32 v86, v86, v198, v240
    v_mul_f32 v242, v103, v215
    v_mul_f32 v243, v103, v199
    v_fma_f32 v103, -v87, v215, v243
    v_fma_f32 v87, v87, v199, v242
    v_cvt_pk_bf16_f32 v147, v86, v87
    v_cvt_pk_bf16_f32 v151, v102, v103
    s_waitcnt lgkmcnt(0)
    v_mfma_f32_32x32x16_bf16 v[72:87], v[216:219], v[136:139], 0
    ds_read_b128 v[228:231], v4 offset:39936
    ds_read_b128 v[232:235], v4 offset:40960
    ds_read_b128 v[236:239], v4 offset:41984
    v_mfma_f32_32x32x16_bf16 v[88:103], v[220:223], v[136:139], 0
    v_cvt_pk_bf16_f32 v104, v40, v41
    v_cvt_pk_bf16_f32 v105, v42, v43
    v_cvt_pk_bf16_f32 v106, v44, v45
    v_cvt_pk_bf16_f32 v107, v46, v47
    buffer_store_dwordx4 v[104:107], v7, s[20:23], s51 offen offset:0
    v_mfma_f32_32x32x16_bf16 v[72:87], v[224:227], v[140:143], v[72:87]
    v_cvt_pk_bf16_f32 v108, v48, v49
    v_cvt_pk_bf16_f32 v109, v50, v51
    v_cvt_pk_bf16_f32 v110, v52, v53
    v_cvt_pk_bf16_f32 v111, v54, v55
    buffer_store_dwordx4 v[108:111], v7, s[20:23], s53 offen offset:0
    v_mfma_f32_32x32x16_bf16 v[88:103], v[216:219], v[140:143], v[88:103]
    v_cvt_pk_bf16_f32 v112, v56, v57
    v_cvt_pk_bf16_f32 v113, v58, v59
    v_cvt_pk_bf16_f32 v114, v60, v61
    v_cvt_pk_bf16_f32 v115, v62, v63
    buffer_store_dwordx4 v[112:115], v7, s[20:23], s51 offen offset:16
    s_waitcnt lgkmcnt(0)
    v_mfma_f32_32x32x16_bf16 v[72:87], v[228:231], v[144:147], v[72:87]
    v_cvt_pk_bf16_f32 v116, v64, v65
    v_cvt_pk_bf16_f32 v117, v66, v67
    v_cvt_pk_bf16_f32 v118, v68, v69
    v_cvt_pk_bf16_f32 v119, v70, v71
    buffer_store_dwordx4 v[116:119], v7, s[20:23], s53 offen offset:16
    v_mfma_f32_32x32x16_bf16 v[88:103], v[232:235], v[144:147], v[88:103]
    v_mfma_f32_32x32x16_bf16 v[72:87], v[236:239], v[148:151], v[72:87]
    v_mfma_f32_32x32x16_bf16 v[88:103], v[228:231], v[148:151], v[88:103]
    s_nop 10
    v_cvt_pk_bf16_f32 v120, v72, v73
    v_cvt_pk_bf16_f32 v121, v74, v75
    v_cvt_pk_bf16_f32 v122, v76, v77
    v_cvt_pk_bf16_f32 v123, v78, v79
    buffer_store_dwordx4 v[120:123], v7, s[20:23], s52 offen offset:0
    v_cvt_pk_bf16_f32 v124, v80, v81
    v_cvt_pk_bf16_f32 v125, v82, v83
    v_cvt_pk_bf16_f32 v126, v84, v85
    v_cvt_pk_bf16_f32 v127, v86, v87
    buffer_store_dwordx4 v[124:127], v7, s[20:23], s54 offen offset:0
    v_cvt_pk_bf16_f32 v128, v88, v89
    v_cvt_pk_bf16_f32 v129, v90, v91
    v_cvt_pk_bf16_f32 v130, v92, v93
    v_cvt_pk_bf16_f32 v131, v94, v95
    buffer_store_dwordx4 v[128:131], v7, s[20:23], s52 offen offset:16
    v_cvt_pk_bf16_f32 v132, v96, v97
    v_cvt_pk_bf16_f32 v133, v98, v99
    v_cvt_pk_bf16_f32 v134, v100, v101
    v_cvt_pk_bf16_f32 v135, v102, v103
    buffer_store_dwordx4 v[132:135], v7, s[20:23], s54 offen offset:16
    s_mov_b32 s40, s42
    s_mov_b32 s41, s43
    s_mov_b32 s42, s44
    s_mov_b32 s43, s45
    s_sub_u32 s46, s46, 1
    s_cmp_lg_u32 s46, 0
    s_cbranch_scc1 kaf_col
    s_endpgm
ka_done:
    s_endpgm
.globl k3_kernel
.p2align 8
.type k3_kernel,@function
k3_kernel:
    s_cmp_ge_u32 s2, 256
    s_cbranch_scc1 k3_done
    s_and_b32 s20, s2, 7
    s_lshr_b32 s21, s2, 3
    s_lshr_b32 s22, s20, 1
    s_lshl_b32 s22, s22, 2
    s_and_b32 s23, s21, 3
    s_add_u32 s22, s22, s23
    s_lshr_b32 s23, s21, 2
    s_and_b32 s24, s20, 1
    s_lshl_b32 s20, s20, 5
    s_add_u32 s20, s20, s21
    s_load_dwordx2 s[6:7], s[0:1], 40
    s_load_dwordx2 s[8:9], s[0:1], 64
    s_load_dwordx2 s[4:5], s[0:1], 0
    s_load_dwordx4 s[52:55], s[0:1], 48
    v_readfirstlane_b32 s25, v0
    s_nop 3
    s_lshr_b32 s25, s25, 6
    v_and_b32 v1, 63, v0
    s_cmp_ge_u32 s25, 4
    s_cbranch_scc1 g4_loader
    v_mov_b32 v72, v1
    v_lshlrev_b32 v77, 4, v1
    v_add_u32 v188, 114688, v77
    s_lshl_b32 s33, s22, 3
    s_lshl_b32 s28, s25, 1
    s_add_u32 s33, s33, s28
    s_mul_i32 s33, s33, 112
    s_mul_i32 s28, s24, 56
    s_add_u32 s33, s33, s28
    s_lshl_b32 s33, s33, 10
    s_waitcnt lgkmcnt(0)
    s_add_u32 s56, s8, 20971520
    s_addc_u32 s57, s9, 0
    s_mov_b32 s58, 14680064
    s_mov_b32 s59, 0x20000
    buffer_load_dwordx4 v[80:83], v77, s[56:59], s33 offen offset:0
    buffer_load_dwordx4 v[84:87], v188, s[56:59], s33 offen offset:0
    buffer_load_dwordx4 v[88:91], v77, s[56:59], s33 offen offset:1024
    buffer_load_dwordx4 v[92:95], v188, s[56:59], s33 offen offset:1024
    s_add_u32 s33, s33, 2048
    buffer_load_dwordx4 v[96:99], v77, s[56:59], s33 offen offset:0
    buffer_load_dwordx4 v[100:103], v188, s[56:59], s33 offen offset:0
    buffer_load_dwordx4 v[104:107], v77, s[56:59], s33 offen offset:1024
    buffer_load_dwordx4 v[108:111], v188, s[56:59], s33 offen offset:1024
    s_add_u32 s33, s33, 2048
    buffer_load_dwordx4 v[112:115], v77, s[56:59], s33 offen offset:0
    buffer_load_dwordx4 v[116:119], v188, s[56:59], s33 offen offset:0
    buffer_load_dwordx4 v[120:123], v77, s[56:59], s33 offen offset:1024
    buffer_load_dwordx4 v[124:127], v188, s[56:59], s33 offen offset:1024
    s_add_u32 s33, s33, 2048
    v_and_b32 v73, 15, v72
    v_lshrrev_b32 v74, 4, v72
    v_lshrrev_b32 v75, 2, v73
    v_and_b32 v76, 1, v74
    v_lshlrev_b32 v76, 2, v76
    v_or_b32 v76, v76, v75
    v_lshlrev_b32 v74, 3, v74
    v_add_u32 v74, v74, v75
    v_lshlrev_b32 v74, 8, v74
    v_and_b32 v73, 3, v73
    v_lshlrev_b32 v73, 3, v73
    v_add_u32 v74, v74, v73
    v_xor_b32 v73, 0, v76
    v_lshlrev_b32 v73, 5, v73
    v_add_u32 v64, v73, v74
    v_xor_b32 v73, 1, v76
    v_lshlrev_b32 v73, 5, v73
    v_add_u32 v65, v73, v74
    v_xor_b32 v73, 2, v76
    v_lshlrev_b32 v73, 5, v73
    v_add_u32 v66, v73, v74
    v_xor_b32 v73, 3, v76
    v_lshlrev_b32 v73, 5, v73
    v_add_u32 v67, v73, v74
    v_xor_b32 v73, 4, v76
    v_lshlrev_b32 v73, 5, v73
    v_add_u32 v68, v73, v74
    v_xor_b32 v73, 5, v76
    v_lshlrev_b32 v73, 5, v73
    v_add_u32 v69, v73, v74
    v_xor_b32 v73, 6, v76
    v_lshlrev_b32 v73, 5, v73
    v_add_u32 v70, v73, v74
    v_xor_b32 v73, 7, v76
    v_lshlrev_b32 v73, 5, v73
    v_add_u32 v71, v73, v74
    v_accvgpr_write_b32 a32, 0
    v_accvgpr_write_b32 a33, 0
    v_accvgpr_write_b32 a34, 0
    v_accvgpr_write_b32 a35, 0
    v_accvgpr_write_b32 a36, 0
    v_accvgpr_write_b32 a37, 0
    v_accvgpr_write_b32 a38, 0
    v_accvgpr_write_b32 a39, 0
    v_accvgpr_write_b32 a40, 0
    v_accvgpr_write_b32 a41, 0
    v_accvgpr_write_b32 a42, 0
    v_accvgpr_write_b32 a43, 0
    v_accvgpr_write_b32 a44, 0
    v_accvgpr_write_b32 a45, 0
    v_accvgpr_write_b32 a46, 0
    v_accvgpr_write_b32 a47, 0
    v_accvgpr_write_b32 a48, 0
    v_accvgpr_write_b32 a49, 0
    v_accvgpr_write_b32 a50, 0
    v_accvgpr_write_b32 a51, 0
    v_accvgpr_write_b32 a52, 0
    v_accvgpr_write_b32 a53, 0
    v_accvgpr_write_b32 a54, 0
    v_accvgpr_write_b32 a55, 0
    v_accvgpr_write_b32 a56, 0
    v_accvgpr_write_b32 a57, 0
    v_accvgpr_write_b32 a58, 0
    v_accvgpr_write_b32 a59, 0
    v_accvgpr_write_b32 a60, 0
    v_accvgpr_write_b32 a61, 0
    v_accvgpr_write_b32 a62, 0
    v_accvgpr_write_b32 a63, 0
    v_and_b32 v74, 15, v72
    v_lshrrev_b32 v75, 4, v72
    v_and_b32 v76, 1, v75
    v_lshlrev_b32 v76, 1, v76
    v_lshrrev_b32 v75, 1, v75
    v_or_b32 v75, v75, v76
    v_lshlrev_b32 v75, 4, v75
    v_lshlrev_b32 v79, 11, v74
    v_add_u32 v79, v79, v75
    v_bfe_u32 v76, v74, 2, 1
    v_lshlrev_b32 v76, 3, v76
    v_and_b32 v78, 3, v74
    v_add_u32 v78, v78, v76
    v_lshlrev_b32 v78, 6, v78
    v_lshrrev_b32 v76, 3, v74
    v_add_u32 v78, v78, v76
    v_lshlrev_b32 v78, 11, v78
    v_add_u32 v78, v78, v75
    s_lshl_b32 s28, s22, 4
    s_lshl_b32 s29, s25, 2
    s_add_u32 s28, s28, s29
    s_lshl_b32 s29, s24, 1
    s_add_u32 s28, s28, s29
    s_lshr_b32 s29, s28, 7
    s_lshl_b32 s29, s29, 4
    s_lshr_b32 s30, s28, 5
    s_and_b32 s30, s30, 1
    s_lshl_b32 s30, s30, 2
    s_add_u32 s29, s29, s30
    s_lshl_b32 s29, s29, 6
    s_lshr_b32 s30, s28, 6
    s_and_b32 s30, s30, 1
    s_lshl_b32 s30, s30, 5
    s_add_u32 s29, s29, s30
    s_and_b32 s30, s28, 31
    s_add_u32 s29, s29, s30
    s_lshl_b32 s29, s29, 11
    s_lshl_b32 s30, s23, 8
    s_add_u32 s40, s29, s30
    s_lshl_b32 s28, s28, 14
    s_add_u32 s42, s28, s30
    s_lshl_b32 s26, s22, 3
    s_add_u32 s26, s26, s23
    s_lshl_b32 s26, s26, 1
    s_add_u32 s26, s26, s24
    s_xor_b32 s27, s26, 1
    s_lshl_b32 s26, s26, 14
    s_lshl_b32 s27, s27, 14
    s_lshl_b32 s28, s25, 12
    s_add_u32 s26, s26, s28
    s_add_u32 s27, s27, s28
    s_mov_b32 s12, s4
    s_mov_b32 s13, s5
    s_mov_b32 s14, 4194304
    s_mov_b32 s15, 0x20000
    s_add_u32 s16, s8, 56623104
    s_addc_u32 s17, s9, 0
    s_mov_b32 s18, 4194304
    s_mov_b32 s19, 0x20000
    s_mov_b32 s36, s52
    s_mov_b32 s37, s53
    s_mov_b32 s38, 4194304
    s_mov_b32 s39, 0x20000
    s_add_u32 s48, s8, 37748736
    s_addc_u32 s49, s9, 0
    s_mov_b32 s50, 4194304
    s_mov_b32 s51, 0x20000
    v_accvgpr_write_b32 a0, 0
    v_accvgpr_write_b32 a1, 0
    v_accvgpr_write_b32 a2, 0
    v_accvgpr_write_b32 a3, 0
    v_accvgpr_write_b32 a4, 0
    v_accvgpr_write_b32 a5, 0
    v_accvgpr_write_b32 a6, 0
    v_accvgpr_write_b32 a7, 0
    v_accvgpr_write_b32 a8, 0
    v_accvgpr_write_b32 a9, 0
    v_accvgpr_write_b32 a10, 0
    v_accvgpr_write_b32 a11, 0
    v_accvgpr_write_b32 a12, 0
    v_accvgpr_write_b32 a13, 0
    v_accvgpr_write_b32 a14, 0
    v_accvgpr_write_b32 a15, 0
    v_accvgpr_write_b32 a16, 0
    v_accvgpr_write_b32 a17, 0
    v_accvgpr_write_b32 a18, 0
    v_accvgpr_write_b32 a19, 0
    v_accvgpr_write_b32 a20, 0
    v_accvgpr_write_b32 a21, 0
    v_accvgpr_write_b32 a22, 0
    v_accvgpr_write_b32 a23, 0
    v_accvgpr_write_b32 a24, 0
    v_accvgpr_write_b32 a25, 0
    v_accvgpr_write_b32 a26, 0
    v_accvgpr_write_b32 a27, 0
    v_accvgpr_write_b32 a28, 0
    v_accvgpr_write_b32 a29, 0
    v_accvgpr_write_b32 a30, 0
    v_accvgpr_write_b32 a31, 0
    v_add_u32 v176, 65536, v64
    v_add_u32 v177, 65536, v65
    v_add_u32 v178, 65536, v66
    v_add_u32 v179, 65536, v67
    v_add_u32 v180, 65536, v68
    v_add_u32 v181, 65536, v69
    v_add_u32 v182, 65536, v70
    v_add_u32 v183, 65536, v71
    s_barrier
    ds_read_b64_tr_b16 v[0:1], v64 offset:0
    ds_read_b64_tr_b16 v[2:3], v64 offset:1024
    ds_read_b64_tr_b16 v[4:5], v65 offset:0
    ds_read_b64_tr_b16 v[6:7], v65 offset:1024
    ds_read_b64_tr_b16 v[8:9], v66 offset:0
    ds_read_b64_tr_b16 v[10:11], v66 offset:1024
    ds_read_b64_tr_b16 v[12:13], v67 offset:0
    ds_read_b64_tr_b16 v[14:15], v67 offset:1024
    ds_read_b64_tr_b16 v[16:17], v68 offset:0
    ds_read_b64_tr_b16 v[18:19], v68 offset:1024
    ds_read_b64_tr_b16 v[20:21], v69 offset:0
    ds_read_b64_tr_b16 v[22:23], v69 offset:1024
    ds_read_b64_tr_b16 v[24:25], v70 offset:0
    ds_read_b64_tr_b16 v[26:27], v70 offset:1024
    ds_read_b64_tr_b16 v[28:29], v71 offset:0
    ds_read_b64_tr_b16 v[30:31], v71 offset:1024
    s_waitcnt vmcnt(8) lgkmcnt(14)
    v_mfma_f32_16x16x32_bf16 a[0:3], v[0:3], v[80:83], a[0:3]
    ds_read_b64_tr_b16 v[32:33], v64 offset:8192
    v_mfma_f32_16x16x32_bf16 a[4:7], v[0:3], v[84:87], a[4:7]
    ds_read_b64_tr_b16 v[34:35], v64 offset:9216
    s_waitcnt lgkmcnt(14)
    v_mfma_f32_16x16x32_bf16 a[12:15], v[4:7], v[84:87], a[12:15]
    ds_read_b64_tr_b16 v[36:37], v65 offset:8192
    v_mfma_f32_16x16x32_bf16 a[8:11], v[4:7], v[80:83], a[8:11]
    ds_read_b64_tr_b16 v[38:39], v65 offset:9216
    buffer_load_dwordx4 v[128:131], v77, s[56:59], s33 offen offset:0
    s_waitcnt lgkmcnt(14)
    v_mfma_f32_16x16x32_bf16 a[16:19], v[8:11], v[80:83], a[16:19]
    ds_read_b64_tr_b16 v[40:41], v66 offset:8192
    v_mfma_f32_16x16x32_bf16 a[20:23], v[8:11], v[84:87], a[20:23]
    ds_read_b64_tr_b16 v[42:43], v66 offset:9216
    buffer_load_dwordx4 v[132:135], v188, s[56:59], s33 offen offset:0
    s_waitcnt lgkmcnt(14)
    v_mfma_f32_16x16x32_bf16 a[28:31], v[12:15], v[84:87], a[28:31]
    ds_read_b64_tr_b16 v[44:45], v67 offset:8192
    v_mfma_f32_16x16x32_bf16 a[24:27], v[12:15], v[80:83], a[24:27]
    ds_read_b64_tr_b16 v[46:47], v67 offset:9216
    buffer_load_dwordx4 v[136:139], v77, s[56:59], s33 offen offset:1024
    s_waitcnt lgkmcnt(14)
    v_mfma_f32_16x16x32_bf16 a[32:35], v[16:19], v[80:83], a[32:35]
    ds_read_b64_tr_b16 v[48:49], v68 offset:8192
    v_mfma_f32_16x16x32_bf16 a[36:39], v[16:19], v[84:87], a[36:39]
    ds_read_b64_tr_b16 v[50:51], v68 offset:9216
    buffer_load_dwordx4 v[140:143], v188, s[56:59], s33 offen offset:1024
    s_waitcnt lgkmcnt(14)
    v_mfma_f32_16x16x32_bf16 a[44:47], v[20:23], v[84:87], a[44:47]
    ds_read_b64_tr_b16 v[52:53], v69 offset:8192
    v_mfma_f32_16x16x32_bf16 a[40:43], v[20:23], v[80:83], a[40:43]
    ds_read_b64_tr_b16 v[54:55], v69 offset:9216
    s_add_u32 s33, s33, 2048
    s_waitcnt lgkmcnt(14)
    v_mfma_f32_16x16x32_bf16 a[48:51], v[24:27], v[80:83], a[48:51]
    ds_read_b64_tr_b16 v[56:57], v70 offset:8192
    v_mfma_f32_16x16x32_bf16 a[52:55], v[24:27], v[84:87], a[52:55]
    ds_read_b64_tr_b16 v[58:59], v70 offset:9216
    s_waitcnt lgkmcnt(14)
    v_mfma_f32_16x16x32_bf16 a[60:63], v[28:31], v[84:87], a[60:63]
    ds_read_b64_tr_b16 v[60:61], v71 offset:8192
    v_mfma_f32_16x16x32_bf16 a[56:59], v[28:31], v[80:83], a[56:59]
    ds_read_b64_tr_b16 v[62:63], v71 offset:9216
    s_waitcnt lgkmcnt(14)
    v_mfma_f32_16x16x32_bf16 a[0:3], v[32:35], v[88:91], a[0:3]
    ds_read_b64_tr_b16 v[0:1], v64 offset:16384
    v_mfma_f32_16x16x32_bf16 a[4:7], v[32:35], v[92:95], a[4:7]
    ds_read_b64_tr_b16 v[2:3], v64 offset:17408
    s_waitcnt lgkmcnt(14)
    v_mfma_f32_16x16x32_bf16 a[12:15], v[36:39], v[92:95], a[12:15]
    ds_read_b64_tr_b16 v[4:5], v65 offset:16384
    v_mfma_f32_16x16x32_bf16 a[8:11], v[36:39], v[88:91], a[8:11]
    ds_read_b64_tr_b16 v[6:7], v65 offset:17408
    s_waitcnt lgkmcnt(14)
    v_mfma_f32_16x16x32_bf16 a[16:19], v[40:43], v[88:91], a[16:19]
    ds_read_b64_tr_b16 v[8:9], v66 offset:16384
    v_mfma_f32_16x16x32_bf16 a[20:23], v[40:43], v[92:95], a[20:23]
    ds_read_b64_tr_b16 v[10:11], v66 offset:17408
    s_waitcnt lgkmcnt(14)
    v_mfma_f32_16x16x32_bf16 a[28:31], v[44:47], v[92:95], a[28:31]
    ds_read_b64_tr_b16 v[12:13], v67 offset:16384
    v_mfma_f32_16x16x32_bf16 a[24:27], v[44:47], v[88:91], a[24:27]
    ds_read_b64_tr_b16 v[14:15], v67 offset:17408
    s_waitcnt lgkmcnt(14)
    v_mfma_f32_16x16x32_bf16 a[32:35], v[48:51], v[88:91], a[32:35]
    ds_read_b64_tr_b16 v[16:17], v68 offset:16384
    v_mfma_f32_16x16x32_bf16 a[36:39], v[48:51], v[92:95], a[36:39]
    ds_read_b64_tr_b16 v[18:19], v68 offset:17408
    s_waitcnt lgkmcnt(14)
    v_mfma_f32_16x16x32_bf16 a[44:47], v[52:55], v[92:95], a[44:47]
    ds_read_b64_tr_b16 v[20:21], v69 offset:16384
    v_mfma_f32_16x16x32_bf16 a[40:43], v[52:55], v[88:91], a[40:43]
    ds_read_b64_tr_b16 v[22:23], v69 offset:17408
    s_waitcnt lgkmcnt(14)
    v_mfma_f32_16x16x32_bf16 a[48:51], v[56:59], v[88:91], a[48:51]
    ds_read_b64_tr_b16 v[24:25], v70 offset:16384
    v_mfma_f32_16x16x32_bf16 a[52:55], v[56:59], v[92:95], a[52:55]
    ds_read_b64_tr_b16 v[26:27], v70 offset:17408
    s_waitcnt lgkmcnt(14)
    v_mfma_f32_16x16x32_bf16 a[60:63], v[60:63], v[92:95], a[60:63]
    ds_read_b64_tr_b16 v[28:29], v71 offset:16384
    v_mfma_f32_16x16x32_bf16 a[56:59], v[60:63], v[88:91], a[56:59]
    ds_read_b64_tr_b16 v[30:31], v71 offset:17408
    s_waitcnt vmcnt(8) lgkmcnt(14)
    v_mfma_f32_16x16x32_bf16 a[0:3], v[0:3], v[96:99], a[0:3]
    ds_read_b64_tr_b16 v[32:33], v64 offset:24576
    v_mfma_f32_16x16x32_bf16 a[4:7], v[0:3], v[100:103], a[4:7]
    ds_read_b64_tr_b16 v[34:35], v64 offset:25600
    s_waitcnt lgkmcnt(14)
    v_mfma_f32_16x16x32_bf16 a[12:15], v[4:7], v[100:103], a[12:15]
    ds_read_b64_tr_b16 v[36:37], v65 offset:24576
    v_mfma_f32_16x16x32_bf16 a[8:11], v[4:7], v[96:99], a[8:11]
    ds_read_b64_tr_b16 v[38:39], v65 offset:25600
    buffer_load_dwordx4 v[80:83], v77, s[56:59], s33 offen offset:0
    s_waitcnt lgkmcnt(14)
    v_mfma_f32_16x16x32_bf16 a[16:19], v[8:11], v[96:99], a[16:19]
    ds_read_b64_tr_b16 v[40:41], v66 offset:24576
    v_mfma_f32_16x16x32_bf16 a[20:23], v[8:11], v[100:103], a[20:23]
    ds_read_b64_tr_b16 v[42:43], v66 offset:25600
    buffer_load_dwordx4 v[84:87], v188, s[56:59], s33 offen offset:0
    s_waitcnt lgkmcnt(14)
    v_mfma_f32_16x16x32_bf16 a[28:31], v[12:15], v[100:103], a[28:31]
    ds_read_b64_tr_b16 v[44:45], v67 offset:24576
    v_mfma_f32_16x16x32_bf16 a[24:27], v[12:15], v[96:99], a[24:27]
    ds_read_b64_tr_b16 v[46:47], v67 offset:25600
    buffer_load_dwordx4 v[88:91], v77, s[56:59], s33 offen offset:1024
    s_waitcnt lgkmcnt(14)
    v_mfma_f32_16x16x32_bf16 a[32:35], v[16:19], v[96:99], a[32:35]
    ds_read_b64_tr_b16 v[48:49], v68 offset:24576
    v_mfma_f32_16x16x32_bf16 a[36:39], v[16:19], v[100:103], a[36:39]
    ds_read_b64_tr_b16 v[50:51], v68 offset:25600
    buffer_load_dwordx4 v[92:95], v188, s[56:59], s33 offen offset:1024
    s_waitcnt lgkmcnt(14)
    v_mfma_f32_16x16x32_bf16 a[44:47], v[20:23], v[100:103], a[44:47]
    ds_read_b64_tr_b16 v[52:53], v69 offset:24576
    v_mfma_f32_16x16x32_bf16 a[40:43], v[20:23], v[96:99], a[40:43]
    ds_read_b64_tr_b16 v[54:55], v69 offset:25600
    s_add_u32 s33, s33, 2048
    s_waitcnt lgkmcnt(14)
    v_mfma_f32_16x16x32_bf16 a[48:51], v[24:27], v[96:99], a[48:51]
    ds_read_b64_tr_b16 v[56:57], v70 offset:24576
    v_mfma_f32_16x16x32_bf16 a[52:55], v[24:27], v[100:103], a[52:55]
    ds_read_b64_tr_b16 v[58:59], v70 offset:25600
    s_waitcnt lgkmcnt(14)
    v_mfma_f32_16x16x32_bf16 a[60:63], v[28:31], v[100:103], a[60:63]
    ds_read_b64_tr_b16 v[60:61], v71 offset:24576
    v_mfma_f32_16x16x32_bf16 a[56:59], v[28:31], v[96:99], a[56:59]
    ds_read_b64_tr_b16 v[62:63], v71 offset:25600
    s_waitcnt lgkmcnt(14)
    v_mfma_f32_16x16x32_bf16 a[0:3], v[32:35], v[104:107], a[0:3]
    s_barrier
    ds_read_b64_tr_b16 v[0:1], v64 offset:32768
    v_mfma_f32_16x16x32_bf16 a[4:7], v[32:35], v[108:111], a[4:7]
    ds_read_b64_tr_b16 v[2:3], v64 offset:33792
    s_waitcnt lgkmcnt(14)
    v_mfma_f32_16x16x32_bf16 a[12:15], v[36:39], v[108:111], a[12:15]
    ds_read_b64_tr_b16 v[4:5], v65 offset:32768
    v_mfma_f32_16x16x32_bf16 a[8:11], v[36:39], v[104:107], a[8:11]
    ds_read_b64_tr_b16 v[6:7], v65 offset:33792
    s_waitcnt lgkmcnt(14)
    v_mfma_f32_16x16x32_bf16 a[16:19], v[40:43], v[104:107], a[16:19]
    ds_read_b64_tr_b16 v[8:9], v66 offset:32768
    v_mfma_f32_16x16x32_bf16 a[20:23], v[40:43], v[108:111], a[20:23]
    ds_read_b64_tr_b16 v[10:11], v66 offset:33792
    s_waitcnt lgkmcnt(14)
    v_mfma_f32_16x16x32_bf16 a[28:31], v[44:47], v[108:111], a[28:31]
    ds_read_b64_tr_b16 v[12:13], v67 offset:32768
    v_mfma_f32_16x16x32_bf16 a[24:27], v[44:47], v[104:107], a[24:27]
    ds_read_b64_tr_b16 v[14:15], v67 offset:33792
    s_waitcnt lgkmcnt(14)
    v_mfma_f32_16x16x32_bf16 a[32:35], v[48:51], v[104:107], a[32:35]
    ds_read_b64_tr_b16 v[16:17], v68 offset:32768
    v_mfma_f32_16x16x32_bf16 a[36:39], v[48:51], v[108:111], a[36:39]
    ds_read_b64_tr_b16 v[18:19], v68 offset:33792
    s_waitcnt lgkmcnt(14)
    v_mfma_f32_16x16x32_bf16 a[44:47], v[52:55], v[108:111], a[44:47]
    ds_read_b64_tr_b16 v[20:21], v69 offset:32768
    v_mfma_f32_16x16x32_bf16 a[40:43], v[52:55], v[104:107], a[40:43]
    ds_read_b64_tr_b16 v[22:23], v69 offset:33792
    s_waitcnt lgkmcnt(14)
    v_mfma_f32_16x16x32_bf16 a[48:51], v[56:59], v[104:107], a[48:51]
    ds_read_b64_tr_b16 v[24:25], v70 offset:32768
    v_mfma_f32_16x16x32_bf16 a[52:55], v[56:59], v[108:111], a[52:55]
    ds_read_b64_tr_b16 v[26:27], v70 offset:33792
    s_waitcnt lgkmcnt(14)
    v_mfma_f32_16x16x32_bf16 a[60:63], v[60:63], v[108:111], a[60:63]
    ds_read_b64_tr_b16 v[28:29], v71 offset:32768
    v_mfma_f32_16x16x32_bf16 a[56:59], v[60:63], v[104:107], a[56:59]
    ds_read_b64_tr_b16 v[30:31], v71 offset:33792
    s_waitcnt vmcnt(8) lgkmcnt(14)
    v_mfma_f32_16x16x32_bf16 a[0:3], v[0:3], v[112:115], a[0:3]
    ds_read_b64_tr_b16 v[32:33], v64 offset:40960
    v_mfma_f32_16x16x32_bf16 a[4:7], v[0:3], v[116:119], a[4:7]
    ds_read_b64_tr_b16 v[34:35], v64 offset:41984
    s_waitcnt lgkmcnt(14)
    v_mfma_f32_16x16x32_bf16 a[12:15], v[4:7], v[116:119], a[12:15]
    ds_read_b64_tr_b16 v[36:37], v65 offset:40960
    v_mfma_f32_16x16x32_bf16 a[8:11], v[4:7], v[112:115], a[8:11]
    ds_read_b64_tr_b16 v[38:39], v65 offset:41984
    buffer_load_dwordx4 v[96:99], v77, s[56:59], s33 offen offset:0
    s_waitcnt lgkmcnt(14)
    v_mfma_f32_16x16x32_bf16 a[16:19], v[8:11], v[112:115], a[16:19]
    ds_read_b64_tr_b16 v[40:41], v66 offset:40960
    v_mfma_f32_16x16x32_bf16 a[20:23], v[8:11], v[116:119], a[20:23]
    ds_read_b64_tr_b16 v[42:43], v66 offset:41984
    buffer_load_dwordx4 v[100:103], v188, s[56:59], s33 offen offset:0
    s_waitcnt lgkmcnt(14)
    v_mfma_f32_16x16x32_bf16 a[28:31], v[12:15], v[116:119], a[28:31]
    ds_read_b64_tr_b16 v[44:45], v67 offset:40960
    v_mfma_f32_16x16x32_bf16 a[24:27], v[12:15], v[112:115], a[24:27]
    ds_read_b64_tr_b16 v[46:47], v67 offset:41984
    buffer_load_dwordx4 v[104:107], v77, s[56:59], s33 offen offset:1024
    s_waitcnt lgkmcnt(14)
    v_mfma_f32_16x16x32_bf16 a[32:35], v[16:19], v[112:115], a[32:35]
    ds_read_b64_tr_b16 v[48:49], v68 offset:40960
    v_mfma_f32_16x16x32_bf16 a[36:39], v[16:19], v[116:119], a[36:39]
    ds_read_b64_tr_b16 v[50:51], v68 offset:41984
    buffer_load_dwordx4 v[108:111], v188, s[56:59], s33 offen offset:1024
    s_waitcnt lgkmcnt(14)
    v_mfma_f32_16x16x32_bf16 a[44:47], v[20:23], v[116:119], a[44:47]
    ds_read_b64_tr_b16 v[52:53], v69 offset:40960
    v_mfma_f32_16x16x32_bf16 a[40:43], v[20:23], v[112:115], a[40:43]
    ds_read_b64_tr_b16 v[54:55], v69 offset:41984
    s_add_u32 s33, s33, 2048
    s_waitcnt lgkmcnt(14)
    v_mfma_f32_16x16x32_bf16 a[48:51], v[24:27], v[112:115], a[48:51]
    ds_read_b64_tr_b16 v[56:57], v70 offset:40960
    v_mfma_f32_16x16x32_bf16 a[52:55], v[24:27], v[116:119], a[52:55]
    ds_read_b64_tr_b16 v[58:59], v70 offset:41984
    s_waitcnt lgkmcnt(14)
    v_mfma_f32_16x16x32_bf16 a[60:63], v[28:31], v[116:119], a[60:63]
    ds_read_b64_tr_b16 v[60:61], v71 offset:40960
    v_mfma_f32_16x16x32_bf16 a[56:59], v[28:31], v[112:115], a[56:59]
    ds_read_b64_tr_b16 v[62:63], v71 offset:41984
    s_waitcnt lgkmcnt(14)
    v_mfma_f32_16x16x32_bf16 a[0:3], v[32:35], v[120:123], a[0:3]
    ds_read_b64_tr_b16 v[0:1], v64 offset:49152
    v_mfma_f32_16x16x32_bf16 a[4:7], v[32:35], v[124:127], a[4:7]
    ds_read_b64_tr_b16 v[2:3], v64 offset:50176
    s_waitcnt lgkmcnt(14)
    v_mfma_f32_16x16x32_bf16 a[12:15], v[36:39], v[124:127], a[12:15]
    ds_read_b64_tr_b16 v[4:5], v65 offset:49152
    v_mfma_f32_16x16x32_bf16 a[8:11], v[36:39], v[120:123], a[8:11]
    ds_read_b64_tr_b16 v[6:7], v65 offset:50176
    s_waitcnt lgkmcnt(14)
    v_mfma_f32_16x16x32_bf16 a[16:19], v[40:43], v[120:123], a[16:19]
    ds_read_b64_tr_b16 v[8:9], v66 offset:49152
    v_mfma_f32_16x16x32_bf16 a[20:23], v[40:43], v[124:127], a[20:23]
    ds_read_b64_tr_b16 v[10:11], v66 offset:50176
    s_waitcnt lgkmcnt(14)
    v_mfma_f32_16x16x32_bf16 a[28:31], v[44:47], v[124:127], a[28:31]
    ds_read_b64_tr_b16 v[12:13], v67 offset:49152
    v_mfma_f32_16x16x32_bf16 a[24:27], v[44:47], v[120:123], a[24:27]
    ds_read_b64_tr_b16 v[14:15], v67 offset:50176
    s_waitcnt lgkmcnt(14)
    v_mfma_f32_16x16x32_bf16 a[32:35], v[48:51], v[120:123], a[32:35]
    ds_read_b64_tr_b16 v[16:17], v68 offset:49152
    v_mfma_f32_16x16x32_bf16 a[36:39], v[48:51], v[124:127], a[36:39]
    ds_read_b64_tr_b16 v[18:19], v68 offset:50176
    s_waitcnt lgkmcnt(14)
    v_mfma_f32_16x16x32_bf16 a[44:47], v[52:55], v[124:127], a[44:47]
    ds_read_b64_tr_b16 v[20:21], v69 offset:49152
    v_mfma_f32_16x16x32_bf16 a[40:43], v[52:55], v[120:123], a[40:43]
    ds_read_b64_tr_b16 v[22:23], v69 offset:50176
    s_waitcnt lgkmcnt(14)
    v_mfma_f32_16x16x32_bf16 a[48:51], v[56:59], v[120:123], a[48:51]
    ds_read_b64_tr_b16 v[24:25], v70 offset:49152
    v_mfma_f32_16x16x32_bf16 a[52:55], v[56:59], v[124:127], a[52:55]
    ds_read_b64_tr_b16 v[26:27], v70 offset:50176
    s_waitcnt lgkmcnt(14)
    v_mfma_f32_16x16x32_bf16 a[60:63], v[60:63], v[124:127], a[60:63]
    ds_read_b64_tr_b16 v[28:29], v71 offset:49152
    v_mfma_f32_16x16x32_bf16 a[56:59], v[60:63], v[120:123], a[56:59]
    ds_read_b64_tr_b16 v[30:31], v71 offset:50176
    s_waitcnt vmcnt(8) lgkmcnt(14)
    v_mfma_f32_16x16x32_bf16 a[0:3], v[0:3], v[128:131], a[0:3]
    ds_read_b64_tr_b16 v[32:33], v64 offset:57344
    v_mfma_f32_16x16x32_bf16 a[4:7], v[0:3], v[132:135], a[4:7]
    ds_read_b64_tr_b16 v[34:35], v64 offset:58368
    s_waitcnt lgkmcnt(14)
    v_mfma_f32_16x16x32_bf16 a[12:15], v[4:7], v[132:135], a[12:15]
    ds_read_b64_tr_b16 v[36:37], v65 offset:57344
    v_mfma_f32_16x16x32_bf16 a[8:11], v[4:7], v[128:131], a[8:11]
    ds_read_b64_tr_b16 v[38:39], v65 offset:58368
    buffer_load_dwordx4 v[112:115], v77, s[56:59], s33 offen offset:0
    s_waitcnt lgkmcnt(14)
    v_mfma_f32_16x16x32_bf16 a[16:19], v[8:11], v[128:131], a[16:19]
    ds_read_b64_tr_b16 v[40:41], v66 offset:57344
    v_mfma_f32_16x16x32_bf16 a[20:23], v[8:11], v[132:135], a[20:23]
    ds_read_b64_tr_b16 v[42:43], v66 offset:58368
    buffer_load_dwordx4 v[116:119], v188, s[56:59], s33 offen offset:0
    s_waitcnt lgkmcnt(14)
    v_mfma_f32_16x16x32_bf16 a[28:31], v[12:15], v[132:135], a[28:31]
    ds_read_b64_tr_b16 v[44:45], v67 offset:57344
    v_mfma_f32_16x16x32_bf16 a[24:27], v[12:15], v[128:131], a[24:27]
    ds_read_b64_tr_b16 v[46:47], v67 offset:58368
    buffer_load_dwordx4 v[120:123], v77, s[56:59], s33 offen offset:1024
    s_waitcnt lgkmcnt(14)
    v_mfma_f32_16x16x32_bf16 a[32:35], v[16:19], v[128:131], a[32:35]
    ds_read_b64_tr_b16 v[48:49], v68 offset:57344
    v_mfma_f32_16x16x32_bf16 a[36:39], v[16:19], v[132:135], a[36:39]
    ds_read_b64_tr_b16 v[50:51], v68 offset:58368
    buffer_load_dwordx4 v[124:127], v188, s[56:59], s33 offen offset:1024
    s_waitcnt lgkmcnt(14)
    v_mfma_f32_16x16x32_bf16 a[44:47], v[20:23], v[132:135], a[44:47]
    ds_read_b64_tr_b16 v[52:53], v69 offset:57344
    v_mfma_f32_16x16x32_bf16 a[40:43], v[20:23], v[128:131], a[40:43]
    ds_read_b64_tr_b16 v[54:55], v69 offset:58368
    s_add_u32 s33, s33, 2048
    s_waitcnt lgkmcnt(14)
    v_mfma_f32_16x16x32_bf16 a[48:51], v[24:27], v[128:131], a[48:51]
    ds_read_b64_tr_b16 v[56:57], v70 offset:57344
    v_mfma_f32_16x16x32_bf16 a[52:55], v[24:27], v[132:135], a[52:55]
    ds_read_b64_tr_b16 v[58:59], v70 offset:58368
    s_waitcnt lgkmcnt(14)
    v_mfma_f32_16x16x32_bf16 a[60:63], v[28:31], v[132:135], a[60:63]
    ds_read_b64_tr_b16 v[60:61], v71 offset:57344
    v_mfma_f32_16x16x32_bf16 a[56:59], v[28:31], v[128:131], a[56:59]
    ds_read_b64_tr_b16 v[62:63], v71 offset:58368
    s_waitcnt lgkmcnt(14)
    v_mfma_f32_16x16x32_bf16 a[0:3], v[32:35], v[136:139], a[0:3]
    s_barrier
    ds_read_b64_tr_b16 v[0:1], v176 offset:0
    v_mfma_f32_16x16x32_bf16 a[4:7], v[32:35], v[140:143], a[4:7]
    ds_read_b64_tr_b16 v[2:3], v176 offset:1024
    s_waitcnt lgkmcnt(14)
    v_mfma_f32_16x16x32_bf16 a[12:15], v[36:39], v[140:143], a[12:15]
    ds_read_b64_tr_b16 v[4:5], v177 offset:0
    v_mfma_f32_16x16x32_bf16 a[8:11], v[36:39], v[136:139], a[8:11]
    ds_read_b64_tr_b16 v[6:7], v177 offset:1024
    s_waitcnt lgkmcnt(14)
    v_mfma_f32_16x16x32_bf16 a[16:19], v[40:43], v[136:139], a[16:19]
    ds_read_b64_tr_b16 v[8:9], v178 offset:0
    v_mfma_f32_16x16x32_bf16 a[20:23], v[40:43], v[140:143], a[20:23]
    ds_read_b64_tr_b16 v[10:11], v178 offset:1024
    s_waitcnt lgkmcnt(14)
    v_mfma_f32_16x16x32_bf16 a[28:31], v[44:47], v[140:143], a[28:31]
    ds_read_b64_tr_b16 v[12:13], v179 offset:0
    v_mfma_f32_16x16x32_bf16 a[24:27], v[44:47], v[136:139], a[24:27]
    ds_read_b64_tr_b16 v[14:15], v179 offset:1024
    s_waitcnt lgkmcnt(14)
    v_mfma_f32_16x16x32_bf16 a[32:35], v[48:51], v[136:139], a[32:35]
    ds_read_b64_tr_b16 v[16:17], v180 offset:0
    v_mfma_f32_16x16x32_bf16 a[36:39], v[48:51], v[140:143], a[36:39]
    ds_read_b64_tr_b16 v[18:19], v180 offset:1024
    s_waitcnt lgkmcnt(14)
    v_mfma_f32_16x16x32_bf16 a[44:47], v[52:55], v[140:143], a[44:47]
    ds_read_b64_tr_b16 v[20:21], v181 offset:0
    v_mfma_f32_16x16x32_bf16 a[40:43], v[52:55], v[136:139], a[40:43]
    ds_read_b64_tr_b16 v[22:23], v181 offset:1024
    s_waitcnt lgkmcnt(14)
    v_mfma_f32_16x16x32_bf16 a[48:51], v[56:59], v[136:139], a[48:51]
    ds_read_b64_tr_b16 v[24:25], v182 offset:0
    v_mfma_f32_16x16x32_bf16 a[52:55], v[56:59], v[140:143], a[52:55]
    ds_read_b64_tr_b16 v[26:27], v182 offset:1024
    s_waitcnt lgkmcnt(14)
    v_mfma_f32_16x16x32_bf16 a[60:63], v[60:63], v[140:143], a[60:63]
    ds_read_b64_tr_b16 v[28:29], v183 offset:0
    v_mfma_f32_16x16x32_bf16 a[56:59], v[60:63], v[136:139], a[56:59]
    ds_read_b64_tr_b16 v[30:31], v183 offset:1024
    s_mov_b32 s30, 0
g4_cloop:
    s_waitcnt vmcnt(8) lgkmcnt(14)
    v_mfma_f32_16x16x32_bf16 a[0:3], v[0:3], v[80:83], a[0:3]
    ds_read_b64_tr_b16 v[32:33], v176 offset:8192
    v_mfma_f32_16x16x32_bf16 a[4:7], v[0:3], v[84:87], a[4:7]
    ds_read_b64_tr_b16 v[34:35], v176 offset:9216
    s_waitcnt lgkmcnt(14)
    v_mfma_f32_16x16x32_bf16 a[12:15], v[4:7], v[84:87], a[12:15]
    ds_read_b64_tr_b16 v[36:37], v177 offset:8192
    v_mfma_f32_16x16x32_bf16 a[8:11], v[4:7], v[80:83], a[8:11]
    ds_read_b64_tr_b16 v[38:39], v177 offset:9216
    buffer_load_dwordx4 v[128:131], v77, s[56:59], s33 offen offset:0
    s_waitcnt lgkmcnt(14)
    v_mfma_f32_16x16x32_bf16 a[16:19], v[8:11], v[80:83], a[16:19]
    ds_read_b64_tr_b16 v[40:41], v178 offset:8192
    v_mfma_f32_16x16x32_bf16 a[20:23], v[8:11], v[84:87], a[20:23]
    ds_read_b64_tr_b16 v[42:43], v178 offset:9216
    buffer_load_dwordx4 v[132:135], v188, s[56:59], s33 offen offset:0
    s_waitcnt lgkmcnt(14)
    v_mfma_f32_16x16x32_bf16 a[28:31], v[12:15], v[84:87], a[28:31]
    ds_read_b64_tr_b16 v[44:45], v179 offset:8192
    v_mfma_f32_16x16x32_bf16 a[24:27], v[12:15], v[80:83], a[24:27]
    ds_read_b64_tr_b16 v[46:47], v179 offset:9216
    buffer_load_dwordx4 v[136:139], v77, s[56:59], s33 offen offset:1024
    s_waitcnt lgkmcnt(14)
    v_mfma_f32_16x16x32_bf16 a[32:35], v[16:19], v[80:83], a[32:35]
    ds_read_b64_tr_b16 v[48:49], v180 offset:8192
    v_mfma_f32_16x16x32_bf16 a[36:39], v[16:19], v[84:87], a[36:39]
    ds_read_b64_tr_b16 v[50:51], v180 offset:9216
    buffer_load_dwordx4 v[140:143], v188, s[56:59], s33 offen offset:1024
    s_waitcnt lgkmcnt(14)
    v_mfma_f32_16x16x32_bf16 a[44:47], v[20:23], v[84:87], a[44:47]
    ds_read_b64_tr_b16 v[52:53], v181 offset:8192
    v_mfma_f32_16x16x32_bf16 a[40:43], v[20:23], v[80:83], a[40:43]
    ds_read_b64_tr_b16 v[54:55], v181 offset:9216
    s_add_u32 s33, s33, 2048
    s_waitcnt lgkmcnt(14)
    v_mfma_f32_16x16x32_bf16 a[48:51], v[24:27], v[80:83], a[48:51]
    ds_read_b64_tr_b16 v[56:57], v182 offset:8192
    v_mfma_f32_16x16x32_bf16 a[52:55], v[24:27], v[84:87], a[52:55]
    ds_read_b64_tr_b16 v[58:59], v182 offset:9216
    s_waitcnt lgkmcnt(14)
    v_mfma_f32_16x16x32_bf16 a[60:63], v[28:31], v[84:87], a[60:63]
    ds_read_b64_tr_b16 v[60:61], v183 offset:8192
    v_mfma_f32_16x16x32_bf16 a[56:59], v[28:31], v[80:83], a[56:59]
    ds_read_b64_tr_b16 v[62:63], v183 offset:9216
    s_waitcnt lgkmcnt(14)
    v_mfma_f32_16x16x32_bf16 a[0:3], v[32:35], v[88:91], a[0:3]
    ds_read_b64_tr_b16 v[0:1], v176 offset:16384
    v_mfma_f32_16x16x32_bf16 a[4:7], v[32:35], v[92:95], a[4:7]
    ds_read_b64_tr_b16 v[2:3], v176 offset:17408
    s_waitcnt lgkmcnt(14)
    v_mfma_f32_16x16x32_bf16 a[12:15], v[36:39], v[92:95], a[12:15]
    ds_read_b64_tr_b16 v[4:5], v177 offset:16384
    v_mfma_f32_16x16x32_bf16 a[8:11], v[36:39], v[88:91], a[8:11]
    ds_read_b64_tr_b16 v[6:7], v177 offset:17408
    s_waitcnt lgkmcnt(14)
    v_mfma_f32_16x16x32_bf16 a[16:19], v[40:43], v[88:91], a[16:19]
    ds_read_b64_tr_b16 v[8:9], v178 offset:16384
    v_mfma_f32_16x16x32_bf16 a[20:23], v[40:43], v[92:95], a[20:23]
    ds_read_b64_tr_b16 v[10:11], v178 offset:17408
    s_waitcnt lgkmcnt(14)
    v_mfma_f32_16x16x32_bf16 a[28:31], v[44:47], v[92:95], a[28:31]
    ds_read_b64_tr_b16 v[12:13], v179 offset:16384
    v_mfma_f32_16x16x32_bf16 a[24:27], v[44:47], v[88:91], a[24:27]
    ds_read_b64_tr_b16 v[14:15], v179 offset:17408
    s_waitcnt lgkmcnt(14)
    v_mfma_f32_16x16x32_bf16 a[32:35], v[48:51], v[88:91], a[32:35]
    ds_read_b64_tr_b16 v[16:17], v180 offset:16384
    v_mfma_f32_16x16x32_bf16 a[36:39], v[48:51], v[92:95], a[36:39]
    ds_read_b64_tr_b16 v[18:19], v180 offset:17408
    s_waitcnt lgkmcnt(14)
    v_mfma_f32_16x16x32_bf16 a[44:47], v[52:55], v[92:95], a[44:47]
    ds_read_b64_tr_b16 v[20:21], v181 offset:16384
    v_mfma_f32_16x16x32_bf16 a[40:43], v[52:55], v[88:91], a[40:43]
    ds_read_b64_tr_b16 v[22:23], v181 offset:17408
    s_waitcnt lgkmcnt(14)
    v_mfma_f32_16x16x32_bf16 a[48:51], v[56:59], v[88:91], a[48:51]
    ds_read_b64_tr_b16 v[24:25], v182 offset:16384
    v_mfma_f32_16x16x32_bf16 a[52:55], v[56:59], v[92:95], a[52:55]
    ds_read_b64_tr_b16 v[26:27], v182 offset:17408
    s_waitcnt lgkmcnt(14)
    v_mfma_f32_16x16x32_bf16 a[60:63], v[60:63], v[92:95], a[60:63]
    ds_read_b64_tr_b16 v[28:29], v183 offset:16384
    v_mfma_f32_16x16x32_bf16 a[56:59], v[60:63], v[88:91], a[56:59]
    ds_read_b64_tr_b16 v[30:31], v183 offset:17408
    s_waitcnt vmcnt(8) lgkmcnt(14)
    v_mfma_f32_16x16x32_bf16 a[0:3], v[0:3], v[96:99], a[0:3]
    ds_read_b64_tr_b16 v[32:33], v176 offset:24576
    v_mfma_f32_16x16x32_bf16 a[4:7], v[0:3], v[100:103], a[4:7]
    ds_read_b64_tr_b16 v[34:35], v176 offset:25600
    s_waitcnt lgkmcnt(14)
    v_mfma_f32_16x16x32_bf16 a[12:15], v[4:7], v[100:103], a[12:15]
    ds_read_b64_tr_b16 v[36:37], v177 offset:24576
    v_mfma_f32_16x16x32_bf16 a[8:11], v[4:7], v[96:99], a[8:11]
    ds_read_b64_tr_b16 v[38:39], v177 offset:25600
    buffer_load_dwordx4 v[80:83], v77, s[56:59], s33 offen offset:0
    s_waitcnt lgkmcnt(14)
    v_mfma_f32_16x16x32_bf16 a[16:19], v[8:11], v[96:99], a[16:19]
    ds_read_b64_tr_b16 v[40:41], v178 offset:24576
    v_mfma_f32_16x16x32_bf16 a[20:23], v[8:11], v[100:103], a[20:23]
    ds_read_b64_tr_b16 v[42:43], v178 offset:25600
    buffer_load_dwordx4 v[84:87], v188, s[56:59], s33 offen offset:0
    s_waitcnt lgkmcnt(14)
    v_mfma_f32_16x16x32_bf16 a[28:31], v[12:15], v[100:103], a[28:31]
    ds_read_b64_tr_b16 v[44:45], v179 offset:24576
    v_mfma_f32_16x16x32_bf16 a[24:27], v[12:15], v[96:99], a[24:27]
    ds_read_b64_tr_b16 v[46:47], v179 offset:25600
    buffer_load_dwordx4 v[88:91], v77, s[56:59], s33 offen offset:1024
    s_waitcnt lgkmcnt(14)
    v_mfma_f32_16x16x32_bf16 a[32:35], v[16:19], v[96:99], a[32:35]
    ds_read_b64_tr_b16 v[48:49], v180 offset:24576
    v_mfma_f32_16x16x32_bf16 a[36:39], v[16:19], v[100:103], a[36:39]
    ds_read_b64_tr_b16 v[50:51], v180 offset:25600
    buffer_load_dwordx4 v[92:95], v188, s[56:59], s33 offen offset:1024
    s_waitcnt lgkmcnt(14)
    v_mfma_f32_16x16x32_bf16 a[44:47], v[20:23], v[100:103], a[44:47]
    ds_read_b64_tr_b16 v[52:53], v181 offset:24576
    v_mfma_f32_16x16x32_bf16 a[40:43], v[20:23], v[96:99], a[40:43]
    ds_read_b64_tr_b16 v[54:55], v181 offset:25600
    s_add_u32 s33, s33, 2048
    s_waitcnt lgkmcnt(14)
    v_mfma_f32_16x16x32_bf16 a[48:51], v[24:27], v[96:99], a[48:51]
    ds_read_b64_tr_b16 v[56:57], v182 offset:24576
    v_mfma_f32_16x16x32_bf16 a[52:55], v[24:27], v[100:103], a[52:55]
    ds_read_b64_tr_b16 v[58:59], v182 offset:25600
    s_waitcnt lgkmcnt(14)
    v_mfma_f32_16x16x32_bf16 a[60:63], v[28:31], v[100:103], a[60:63]
    ds_read_b64_tr_b16 v[60:61], v183 offset:24576
    v_mfma_f32_16x16x32_bf16 a[56:59], v[28:31], v[96:99], a[56:59]
    ds_read_b64_tr_b16 v[62:63], v183 offset:25600
    s_waitcnt lgkmcnt(14)
    v_mfma_f32_16x16x32_bf16 a[0:3], v[32:35], v[104:107], a[0:3]
    s_barrier
    ds_read_b64_tr_b16 v[0:1], v176 offset:32768
    v_mfma_f32_16x16x32_bf16 a[4:7], v[32:35], v[108:111], a[4:7]
    ds_read_b64_tr_b16 v[2:3], v176 offset:33792
    s_waitcnt lgkmcnt(14)
    v_mfma_f32_16x16x32_bf16 a[12:15], v[36:39], v[108:111], a[12:15]
    ds_read_b64_tr_b16 v[4:5], v177 offset:32768
    v_mfma_f32_16x16x32_bf16 a[8:11], v[36:39], v[104:107], a[8:11]
    ds_read_b64_tr_b16 v[6:7], v177 offset:33792
    s_waitcnt lgkmcnt(14)
    v_mfma_f32_16x16x32_bf16 a[16:19], v[40:43], v[104:107], a[16:19]
    ds_read_b64_tr_b16 v[8:9], v178 offset:32768
    v_mfma_f32_16x16x32_bf16 a[20:23], v[40:43], v[108:111], a[20:23]
    ds_read_b64_tr_b16 v[10:11], v178 offset:33792
    s_waitcnt lgkmcnt(14)
    v_mfma_f32_16x16x32_bf16 a[28:31], v[44:47], v[108:111], a[28:31]
    ds_read_b64_tr_b16 v[12:13], v179 offset:32768
    v_mfma_f32_16x16x32_bf16 a[24:27], v[44:47], v[104:107], a[24:27]
    ds_read_b64_tr_b16 v[14:15], v179 offset:33792
    s_waitcnt lgkmcnt(14)
    v_mfma_f32_16x16x32_bf16 a[32:35], v[48:51], v[104:107], a[32:35]
    ds_read_b64_tr_b16 v[16:17], v180 offset:32768
    v_mfma_f32_16x16x32_bf16 a[36:39], v[48:51], v[108:111], a[36:39]
    ds_read_b64_tr_b16 v[18:19], v180 offset:33792
    s_waitcnt lgkmcnt(14)
    v_mfma_f32_16x16x32_bf16 a[44:47], v[52:55], v[108:111], a[44:47]
    ds_read_b64_tr_b16 v[20:21], v181 offset:32768
    v_mfma_f32_16x16x32_bf16 a[40:43], v[52:55], v[104:107], a[40:43]
    ds_read_b64_tr_b16 v[22:23], v181 offset:33792
    s_waitcnt lgkmcnt(14)
    v_mfma_f32_16x16x32_bf16 a[48:51], v[56:59], v[104:107], a[48:51]
    ds_read_b64_tr_b16 v[24:25], v182 offset:32768
    v_mfma_f32_16x16x32_bf16 a[52:55], v[56:59], v[108:111], a[52:55]
    ds_read_b64_tr_b16 v[26:27], v182 offset:33792
    s_waitcnt lgkmcnt(14)
    v_mfma_f32_16x16x32_bf16 a[60:63], v[60:63], v[108:111], a[60:63]
    ds_read_b64_tr_b16 v[28:29], v183 offset:32768
    v_mfma_f32_16x16x32_bf16 a[56:59], v[60:63], v[104:107], a[56:59]
    ds_read_b64_tr_b16 v[30:31], v183 offset:33792
    s_waitcnt vmcnt(8) lgkmcnt(14)
    v_mfma_f32_16x16x32_bf16 a[0:3], v[0:3], v[112:115], a[0:3]
    ds_read_b64_tr_b16 v[32:33], v176 offset:40960
    v_mfma_f32_16x16x32_bf16 a[4:7], v[0:3], v[116:119], a[4:7]
    ds_read_b64_tr_b16 v[34:35], v176 offset:41984
    s_waitcnt lgkmcnt(14)
    v_mfma_f32_16x16x32_bf16 a[12:15], v[4:7], v[116:119], a[12:15]
    ds_read_b64_tr_b16 v[36:37], v177 offset:40960
    v_mfma_f32_16x16x32_bf16 a[8:11], v[4:7], v[112:115], a[8:11]
    ds_read_b64_tr_b16 v[38:39], v177 offset:41984
    buffer_load_dwordx4 v[96:99], v77, s[56:59], s33 offen offset:0
    s_waitcnt lgkmcnt(14)
    v_mfma_f32_16x16x32_bf16 a[16:19], v[8:11], v[112:115], a[16:19]
    ds_read_b64_tr_b16 v[40:41], v178 offset:40960
    v_mfma_f32_16x16x32_bf16 a[20:23], v[8:11], v[116:119], a[20:23]
    ds_read_b64_tr_b16 v[42:43], v178 offset:41984
    buffer_load_dwordx4 v[100:103], v188, s[56:59], s33 offen offset:0
    s_waitcnt lgkmcnt(14)
    v_mfma_f32_16x16x32_bf16 a[28:31], v[12:15], v[116:119], a[28:31]
    ds_read_b64_tr_b16 v[44:45], v179 offset:40960
    v_mfma_f32_16x16x32_bf16 a[24:27], v[12:15], v[112:115], a[24:27]
    ds_read_b64_tr_b16 v[46:47], v179 offset:41984
    buffer_load_dwordx4 v[104:107], v77, s[56:59], s33 offen offset:1024
    s_waitcnt lgkmcnt(14)
    v_mfma_f32_16x16x32_bf16 a[32:35], v[16:19], v[112:115], a[32:35]
    ds_read_b64_tr_b16 v[48:49], v180 offset:40960
    v_mfma_f32_16x16x32_bf16 a[36:39], v[16:19], v[116:119], a[36:39]
    ds_read_b64_tr_b16 v[50:51], v180 offset:41984
    buffer_load_dwordx4 v[108:111], v188, s[56:59], s33 offen offset:1024
    s_waitcnt lgkmcnt(14)
    v_mfma_f32_16x16x32_bf16 a[44:47], v[20:23], v[116:119], a[44:47]
    ds_read_b64_tr_b16 v[52:53], v181 offset:40960
    v_mfma_f32_16x16x32_bf16 a[40:43], v[20:23], v[112:115], a[40:43]
    ds_read_b64_tr_b16 v[54:55], v181 offset:41984
    s_add_u32 s33, s33, 2048
    s_waitcnt lgkmcnt(14)
    v_mfma_f32_16x16x32_bf16 a[48:51], v[24:27], v[112:115], a[48:51]
    ds_read_b64_tr_b16 v[56:57], v182 offset:40960
    v_mfma_f32_16x16x32_bf16 a[52:55], v[24:27], v[116:119], a[52:55]
    ds_read_b64_tr_b16 v[58:59], v182 offset:41984
    s_waitcnt lgkmcnt(14)
    v_mfma_f32_16x16x32_bf16 a[60:63], v[28:31], v[116:119], a[60:63]
    ds_read_b64_tr_b16 v[60:61], v183 offset:40960
    v_mfma_f32_16x16x32_bf16 a[56:59], v[28:31], v[112:115], a[56:59]
    ds_read_b64_tr_b16 v[62:63], v183 offset:41984
    s_waitcnt lgkmcnt(14)
    v_mfma_f32_16x16x32_bf16 a[0:3], v[32:35], v[120:123], a[0:3]
    ds_read_b64_tr_b16 v[0:1], v176 offset:49152
    v_mfma_f32_16x16x32_bf16 a[4:7], v[32:35], v[124:127], a[4:7]
    ds_read_b64_tr_b16 v[2:3], v176 offset:50176
    s_waitcnt lgkmcnt(14)
    v_mfma_f32_16x16x32_bf16 a[12:15], v[36:39], v[124:127], a[12:15]
    ds_read_b64_tr_b16 v[4:5], v177 offset:49152
    v_mfma_f32_16x16x32_bf16 a[8:11], v[36:39], v[120:123], a[8:11]
    ds_read_b64_tr_b16 v[6:7], v177 offset:50176
    s_waitcnt lgkmcnt(14)
    v_mfma_f32_16x16x32_bf16 a[16:19], v[40:43], v[120:123], a[16:19]
    ds_read_b64_tr_b16 v[8:9], v178 offset:49152
    v_mfma_f32_16x16x32_bf16 a[20:23], v[40:43], v[124:127], a[20:23]
    ds_read_b64_tr_b16 v[10:11], v178 offset:50176
    s_waitcnt lgkmcnt(14)
    v_mfma_f32_16x16x32_bf16 a[28:31], v[44:47], v[124:127], a[28:31]
    ds_read_b64_tr_b16 v[12:13], v179 offset:49152
    v_mfma_f32_16x16x32_bf16 a[24:27], v[44:47], v[120:123], a[24:27]
    ds_read_b64_tr_b16 v[14:15], v179 offset:50176
    s_waitcnt lgkmcnt(14)
    v_mfma_f32_16x16x32_bf16 a[32:35], v[48:51], v[120:123], a[32:35]
    ds_read_b64_tr_b16 v[16:17], v180 offset:49152
    v_mfma_f32_16x16x32_bf16 a[36:39], v[48:51], v[124:127], a[36:39]
    ds_read_b64_tr_b16 v[18:19], v180 offset:50176
    s_waitcnt lgkmcnt(14)
    v_mfma_f32_16x16x32_bf16 a[44:47], v[52:55], v[124:127], a[44:47]
    ds_read_b64_tr_b16 v[20:21], v181 offset:49152
    v_mfma_f32_16x16x32_bf16 a[40:43], v[52:55], v[120:123], a[40:43]
    ds_read_b64_tr_b16 v[22:23], v181 offset:50176
    s_waitcnt lgkmcnt(14)
    v_mfma_f32_16x16x32_bf16 a[48:51], v[56:59], v[120:123], a[48:51]
    ds_read_b64_tr_b16 v[24:25], v182 offset:49152
    v_mfma_f32_16x16x32_bf16 a[52:55], v[56:59], v[124:127], a[52:55]
    ds_read_b64_tr_b16 v[26:27], v182 offset:50176
    s_waitcnt lgkmcnt(14)
    v_mfma_f32_16x16x32_bf16 a[60:63], v[60:63], v[124:127], a[60:63]
    ds_read_b64_tr_b16 v[28:29], v183 offset:49152
    v_mfma_f32_16x16x32_bf16 a[56:59], v[60:63], v[120:123], a[56:59]
    ds_read_b64_tr_b16 v[30:31], v183 offset:50176
    s_waitcnt vmcnt(8) lgkmcnt(14)
    v_mfma_f32_16x16x32_bf16 a[0:3], v[0:3], v[128:131], a[0:3]
    ds_read_b64_tr_b16 v[32:33], v176 offset:57344
    v_mfma_f32_16x16x32_bf16 a[4:7], v[0:3], v[132:135], a[4:7]
    ds_read_b64_tr_b16 v[34:35], v176 offset:58368
    s_waitcnt lgkmcnt(14)
    v_mfma_f32_16x16x32_bf16 a[12:15], v[4:7], v[132:135], a[12:15]
    ds_read_b64_tr_b16 v[36:37], v177 offset:57344
    v_mfma_f32_16x16x32_bf16 a[8:11], v[4:7], v[128:131], a[8:11]
    ds_read_b64_tr_b16 v[38:39], v177 offset:58368
    buffer_load_dwordx4 v[112:115], v77, s[56:59], s33 offen offset:0
    s_waitcnt lgkmcnt(14)
    v_mfma_f32_16x16x32_bf16 a[16:19], v[8:11], v[128:131], a[16:19]
    ds_read_b64_tr_b16 v[40:41], v178 offset:57344
    v_mfma_f32_16x16x32_bf16 a[20:23], v[8:11], v[132:135], a[20:23]
    ds_read_b64_tr_b16 v[42:43], v178 offset:58368
    buffer_load_dwordx4 v[116:119], v188, s[56:59], s33 offen offset:0
    s_waitcnt lgkmcnt(14)
    v_mfma_f32_16x16x32_bf16 a[28:31], v[12:15], v[132:135], a[28:31]
    ds_read_b64_tr_b16 v[44:45], v179 offset:57344
    v_mfma_f32_16x16x32_bf16 a[24:27], v[12:15], v[128:131], a[24:27]
    ds_read_b64_tr_b16 v[46:47], v179 offset:58368
    buffer_load_dwordx4 v[120:123], v77, s[56:59], s33 offen offset:1024
    s_waitcnt lgkmcnt(14)
    v_mfma_f32_16x16x32_bf16 a[32:35], v[16:19], v[128:131], a[32:35]
    ds_read_b64_tr_b16 v[48:49], v180 offset:57344
    v_mfma_f32_16x16x32_bf16 a[36:39], v[16:19], v[132:135], a[36:39]
    ds_read_b64_tr_b16 v[50:51], v180 offset:58368
    buffer_load_dwordx4 v[124:127], v188, s[56:59], s33 offen offset:1024
    s_waitcnt lgkmcnt(14)
    v_mfma_f32_16x16x32_bf16 a[44:47], v[20:23], v[132:135], a[44:47]
    ds_read_b64_tr_b16 v[52:53], v181 offset:57344
    v_mfma_f32_16x16x32_bf16 a[40:43], v[20:23], v[128:131], a[40:43]
    ds_read_b64_tr_b16 v[54:55], v181 offset:58368
    s_add_u32 s33, s33, 2048
    s_waitcnt lgkmcnt(14)
    v_mfma_f32_16x16x32_bf16 a[48:51], v[24:27], v[128:131], a[48:51]
    ds_read_b64_tr_b16 v[56:57], v182 offset:57344
    v_mfma_f32_16x16x32_bf16 a[52:55], v[24:27], v[132:135], a[52:55]
    ds_read_b64_tr_b16 v[58:59], v182 offset:58368
    s_waitcnt lgkmcnt(14)
    v_mfma_f32_16x16x32_bf16 a[60:63], v[28:31], v[132:135], a[60:63]
    ds_read_b64_tr_b16 v[60:61], v183 offset:57344
    v_mfma_f32_16x16x32_bf16 a[56:59], v[28:31], v[128:131], a[56:59]
    ds_read_b64_tr_b16 v[62:63], v183 offset:58368
    s_waitcnt lgkmcnt(14)
    v_mfma_f32_16x16x32_bf16 a[0:3], v[32:35], v[136:139], a[0:3]
    s_barrier
    ds_read_b64_tr_b16 v[0:1], v64 offset:0
    v_mfma_f32_16x16x32_bf16 a[4:7], v[32:35], v[140:143], a[4:7]
    ds_read_b64_tr_b16 v[2:3], v64 offset:1024
    s_waitcnt lgkmcnt(14)
    v_mfma_f32_16x16x32_bf16 a[12:15], v[36:39], v[140:143], a[12:15]
    ds_read_b64_tr_b16 v[4:5], v65 offset:0
    v_mfma_f32_16x16x32_bf16 a[8:11], v[36:39], v[136:139], a[8:11]
    ds_read_b64_tr_b16 v[6:7], v65 offset:1024
    s_waitcnt lgkmcnt(14)
    v_mfma_f32_16x16x32_bf16 a[16:19], v[40:43], v[136:139], a[16:19]
    ds_read_b64_tr_b16 v[8:9], v66 offset:0
    v_mfma_f32_16x16x32_bf16 a[20:23], v[40:43], v[140:143], a[20:23]
    ds_read_b64_tr_b16 v[10:11], v66 offset:1024
    s_waitcnt lgkmcnt(14)
    v_mfma_f32_16x16x32_bf16 a[28:31], v[44:47], v[140:143], a[28:31]
    ds_read_b64_tr_b16 v[12:13], v67 offset:0
    v_mfma_f32_16x16x32_bf16 a[24:27], v[44:47], v[136:139], a[24:27]
    ds_read_b64_tr_b16 v[14:15], v67 offset:1024
    s_waitcnt lgkmcnt(14)
    v_mfma_f32_16x16x32_bf16 a[32:35], v[48:51], v[136:139], a[32:35]
    ds_read_b64_tr_b16 v[16:17], v68 offset:0
    v_mfma_f32_16x16x32_bf16 a[36:39], v[48:51], v[140:143], a[36:39]
    ds_read_b64_tr_b16 v[18:19], v68 offset:1024
    s_waitcnt lgkmcnt(14)
    v_mfma_f32_16x16x32_bf16 a[44:47], v[52:55], v[140:143], a[44:47]
    ds_read_b64_tr_b16 v[20:21], v69 offset:0
    v_mfma_f32_16x16x32_bf16 a[40:43], v[52:55], v[136:139], a[40:43]
    ds_read_b64_tr_b16 v[22:23], v69 offset:1024
    s_waitcnt lgkmcnt(14)
    v_mfma_f32_16x16x32_bf16 a[48:51], v[56:59], v[136:139], a[48:51]
    ds_read_b64_tr_b16 v[24:25], v70 offset:0
    v_mfma_f32_16x16x32_bf16 a[52:55], v[56:59], v[140:143], a[52:55]
    ds_read_b64_tr_b16 v[26:27], v70 offset:1024
    s_waitcnt lgkmcnt(14)
    v_mfma_f32_16x16x32_bf16 a[60:63], v[60:63], v[140:143], a[60:63]
    ds_read_b64_tr_b16 v[28:29], v71 offset:0
    v_mfma_f32_16x16x32_bf16 a[56:59], v[60:63], v[136:139], a[56:59]
    ds_read_b64_tr_b16 v[30:31], v71 offset:1024
    s_waitcnt vmcnt(8) lgkmcnt(14)
    v_mfma_f32_16x16x32_bf16 a[0:3], v[0:3], v[80:83], a[0:3]
    ds_read_b64_tr_b16 v[32:33], v64 offset:8192
    v_mfma_f32_16x16x32_bf16 a[4:7], v[0:3], v[84:87], a[4:7]
    ds_read_b64_tr_b16 v[34:35], v64 offset:9216
    s_waitcnt lgkmcnt(14)
    v_mfma_f32_16x16x32_bf16 a[12:15], v[4:7], v[84:87], a[12:15]
    ds_read_b64_tr_b16 v[36:37], v65 offset:8192
    v_mfma_f32_16x16x32_bf16 a[8:11], v[4:7], v[80:83], a[8:11]
    ds_read_b64_tr_b16 v[38:39], v65 offset:9216
    buffer_load_dwordx4 v[128:131], v77, s[56:59], s33 offen offset:0
    s_waitcnt lgkmcnt(14)
    v_mfma_f32_16x16x32_bf16 a[16:19], v[8:11], v[80:83], a[16:19]
    ds_read_b64_tr_b16 v[40:41], v66 offset:8192
    v_mfma_f32_16x16x32_bf16 a[20:23], v[8:11], v[84:87], a[20:23]
    ds_read_b64_tr_b16 v[42:43], v66 offset:9216
    buffer_load_dwordx4 v[132:135], v188, s[56:59], s33 offen offset:0
    s_waitcnt lgkmcnt(14)
    v_mfma_f32_16x16x32_bf16 a[28:31], v[12:15], v[84:87], a[28:31]
    ds_read_b64_tr_b16 v[44:45], v67 offset:8192
    v_mfma_f32_16x16x32_bf16 a[24:27], v[12:15], v[80:83], a[24:27]
    ds_read_b64_tr_b16 v[46:47], v67 offset:9216
    buffer_load_dwordx4 v[136:139], v77, s[56:59], s33 offen offset:1024
    s_waitcnt lgkmcnt(14)
    v_mfma_f32_16x16x32_bf16 a[32:35], v[16:19], v[80:83], a[32:35]
    ds_read_b64_tr_b16 v[48:49], v68 offset:8192
    v_mfma_f32_16x16x32_bf16 a[36:39], v[16:19], v[84:87], a[36:39]
    ds_read_b64_tr_b16 v[50:51], v68 offset:9216
    buffer_load_dwordx4 v[140:143], v188, s[56:59], s33 offen offset:1024
    s_waitcnt lgkmcnt(14)
    v_mfma_f32_16x16x32_bf16 a[44:47], v[20:23], v[84:87], a[44:47]
    ds_read_b64_tr_b16 v[52:53], v69 offset:8192
    v_mfma_f32_16x16x32_bf16 a[40:43], v[20:23], v[80:83], a[40:43]
    ds_read_b64_tr_b16 v[54:55], v69 offset:9216
    s_add_u32 s33, s33, 2048
    s_waitcnt lgkmcnt(14)
    v_mfma_f32_16x16x32_bf16 a[48:51], v[24:27], v[80:83], a[48:51]
    ds_read_b64_tr_b16 v[56:57], v70 offset:8192
    v_mfma_f32_16x16x32_bf16 a[52:55], v[24:27], v[84:87], a[52:55]
    ds_read_b64_tr_b16 v[58:59], v70 offset:9216
    s_waitcnt lgkmcnt(14)
    v_mfma_f32_16x16x32_bf16 a[60:63], v[28:31], v[84:87], a[60:63]
    ds_read_b64_tr_b16 v[60:61], v71 offset:8192
    v_mfma_f32_16x16x32_bf16 a[56:59], v[28:31], v[80:83], a[56:59]
    ds_read_b64_tr_b16 v[62:63], v71 offset:9216
    s_waitcnt lgkmcnt(14)
    v_mfma_f32_16x16x32_bf16 a[0:3], v[32:35], v[88:91], a[0:3]
    ds_read_b64_tr_b16 v[0:1], v64 offset:16384
    v_mfma_f32_16x16x32_bf16 a[4:7], v[32:35], v[92:95], a[4:7]
    ds_read_b64_tr_b16 v[2:3], v64 offset:17408
    s_waitcnt lgkmcnt(14)
    v_mfma_f32_16x16x32_bf16 a[12:15], v[36:39], v[92:95], a[12:15]
    ds_read_b64_tr_b16 v[4:5], v65 offset:16384
    v_mfma_f32_16x16x32_bf16 a[8:11], v[36:39], v[88:91], a[8:11]
    ds_read_b64_tr_b16 v[6:7], v65 offset:17408
    s_waitcnt lgkmcnt(14)
    v_mfma_f32_16x16x32_bf16 a[16:19], v[40:43], v[88:91], a[16:19]
    ds_read_b64_tr_b16 v[8:9], v66 offset:16384
    v_mfma_f32_16x16x32_bf16 a[20:23], v[40:43], v[92:95], a[20:23]
    ds_read_b64_tr_b16 v[10:11], v66 offset:17408
    s_waitcnt lgkmcnt(14)
    v_mfma_f32_16x16x32_bf16 a[28:31], v[44:47], v[92:95], a[28:31]
    ds_read_b64_tr_b16 v[12:13], v67 offset:16384
    v_mfma_f32_16x16x32_bf16 a[24:27], v[44:47], v[88:91], a[24:27]
    ds_read_b64_tr_b16 v[14:15], v67 offset:17408
    s_waitcnt lgkmcnt(14)
    v_mfma_f32_16x16x32_bf16 a[32:35], v[48:51], v[88:91], a[32:35]
    ds_read_b64_tr_b16 v[16:17], v68 offset:16384
    v_mfma_f32_16x16x32_bf16 a[36:39], v[48:51], v[92:95], a[36:39]
    ds_read_b64_tr_b16 v[18:19], v68 offset:17408
    s_waitcnt lgkmcnt(14)
    v_mfma_f32_16x16x32_bf16 a[44:47], v[52:55], v[92:95], a[44:47]
    ds_read_b64_tr_b16 v[20:21], v69 offset:16384
    v_mfma_f32_16x16x32_bf16 a[40:43], v[52:55], v[88:91], a[40:43]
    ds_read_b64_tr_b16 v[22:23], v69 offset:17408
    s_waitcnt lgkmcnt(14)
    v_mfma_f32_16x16x32_bf16 a[48:51], v[56:59], v[88:91], a[48:51]
    ds_read_b64_tr_b16 v[24:25], v70 offset:16384
    v_mfma_f32_16x16x32_bf16 a[52:55], v[56:59], v[92:95], a[52:55]
    ds_read_b64_tr_b16 v[26:27], v70 offset:17408
    s_waitcnt lgkmcnt(14)
    v_mfma_f32_16x16x32_bf16 a[60:63], v[60:63], v[92:95], a[60:63]
    ds_read_b64_tr_b16 v[28:29], v71 offset:16384
    v_mfma_f32_16x16x32_bf16 a[56:59], v[60:63], v[88:91], a[56:59]
    ds_read_b64_tr_b16 v[30:31], v71 offset:17408
    s_waitcnt vmcnt(8) lgkmcnt(14)
    v_mfma_f32_16x16x32_bf16 a[0:3], v[0:3], v[96:99], a[0:3]
    ds_read_b64_tr_b16 v[32:33], v64 offset:24576
    v_mfma_f32_16x16x32_bf16 a[4:7], v[0:3], v[100:103], a[4:7]
    ds_read_b64_tr_b16 v[34:35], v64 offset:25600
    s_waitcnt lgkmcnt(14)
    v_mfma_f32_16x16x32_bf16 a[12:15], v[4:7], v[100:103], a[12:15]
    ds_read_b64_tr_b16 v[36:37], v65 offset:24576
    v_mfma_f32_16x16x32_bf16 a[8:11], v[4:7], v[96:99], a[8:11]
    ds_read_b64_tr_b16 v[38:39], v65 offset:25600
    buffer_load_dwordx4 v[80:83], v77, s[56:59], s33 offen offset:0
    s_waitcnt lgkmcnt(14)
    v_mfma_f32_16x16x32_bf16 a[16:19], v[8:11], v[96:99], a[16:19]
    ds_read_b64_tr_b16 v[40:41], v66 offset:24576
    v_mfma_f32_16x16x32_bf16 a[20:23], v[8:11], v[100:103], a[20:23]
    ds_read_b64_tr_b16 v[42:43], v66 offset:25600
    buffer_load_dwordx4 v[84:87], v188, s[56:59], s33 offen offset:0
    s_waitcnt lgkmcnt(14)
    v_mfma_f32_16x16x32_bf16 a[28:31], v[12:15], v[100:103], a[28:31]
    ds_read_b64_tr_b16 v[44:45], v67 offset:24576
    v_mfma_f32_16x16x32_bf16 a[24:27], v[12:15], v[96:99], a[24:27]
    ds_read_b64_tr_b16 v[46:47], v67 offset:25600
    buffer_load_dwordx4 v[88:91], v77, s[56:59], s33 offen offset:1024
    s_waitcnt lgkmcnt(14)
    v_mfma_f32_16x16x32_bf16 a[32:35], v[16:19], v[96:99], a[32:35]
    ds_read_b64_tr_b16 v[48:49], v68 offset:24576
    v_mfma_f32_16x16x32_bf16 a[36:39], v[16:19], v[100:103], a[36:39]
    ds_read_b64_tr_b16 v[50:51], v68 offset:25600
    buffer_load_dwordx4 v[92:95], v188, s[56:59], s33 offen offset:1024
    s_waitcnt lgkmcnt(14)
    v_mfma_f32_16x16x32_bf16 a[44:47], v[20:23], v[100:103], a[44:47]
    ds_read_b64_tr_b16 v[52:53], v69 offset:24576
    v_mfma_f32_16x16x32_bf16 a[40:43], v[20:23], v[96:99], a[40:43]
    ds_read_b64_tr_b16 v[54:55], v69 offset:25600
    s_add_u32 s33, s33, 2048
    s_waitcnt lgkmcnt(14)
    v_mfma_f32_16x16x32_bf16 a[48:51], v[24:27], v[96:99], a[48:51]
    ds_read_b64_tr_b16 v[56:57], v70 offset:24576
    v_mfma_f32_16x16x32_bf16 a[52:55], v[24:27], v[100:103], a[52:55]
    ds_read_b64_tr_b16 v[58:59], v70 offset:25600
    s_waitcnt lgkmcnt(14)
    v_mfma_f32_16x16x32_bf16 a[60:63], v[28:31], v[100:103], a[60:63]
    ds_read_b64_tr_b16 v[60:61], v71 offset:24576
    v_mfma_f32_16x16x32_bf16 a[56:59], v[28:31], v[96:99], a[56:59]
    ds_read_b64_tr_b16 v[62:63], v71 offset:25600
    s_waitcnt lgkmcnt(14)
    v_mfma_f32_16x16x32_bf16 a[0:3], v[32:35], v[104:107], a[0:3]
    s_barrier
    ds_read_b64_tr_b16 v[0:1], v64 offset:32768
    v_mfma_f32_16x16x32_bf16 a[4:7], v[32:35], v[108:111], a[4:7]
    ds_read_b64_tr_b16 v[2:3], v64 offset:33792
    s_waitcnt lgkmcnt(14)
    v_mfma_f32_16x16x32_bf16 a[12:15], v[36:39], v[108:111], a[12:15]
    ds_read_b64_tr_b16 v[4:5], v65 offset:32768
    v_mfma_f32_16x16x32_bf16 a[8:11], v[36:39], v[104:107], a[8:11]
    ds_read_b64_tr_b16 v[6:7], v65 offset:33792
    s_waitcnt lgkmcnt(14)
    v_mfma_f32_16x16x32_bf16 a[16:19], v[40:43], v[104:107], a[16:19]
    ds_read_b64_tr_b16 v[8:9], v66 offset:32768
    v_mfma_f32_16x16x32_bf16 a[20:23], v[40:43], v[108:111], a[20:23]
    ds_read_b64_tr_b16 v[10:11], v66 offset:33792
    s_waitcnt lgkmcnt(14)
    v_mfma_f32_16x16x32_bf16 a[28:31], v[44:47], v[108:111], a[28:31]
    ds_read_b64_tr_b16 v[12:13], v67 offset:32768
    v_mfma_f32_16x16x32_bf16 a[24:27], v[44:47], v[104:107], a[24:27]
    ds_read_b64_tr_b16 v[14:15], v67 offset:33792
    s_waitcnt lgkmcnt(14)
    v_mfma_f32_16x16x32_bf16 a[32:35], v[48:51], v[104:107], a[32:35]
    ds_read_b64_tr_b16 v[16:17], v68 offset:32768
    v_mfma_f32_16x16x32_bf16 a[36:39], v[48:51], v[108:111], a[36:39]
    ds_read_b64_tr_b16 v[18:19], v68 offset:33792
    s_waitcnt lgkmcnt(14)
    v_mfma_f32_16x16x32_bf16 a[44:47], v[52:55], v[108:111], a[44:47]
    ds_read_b64_tr_b16 v[20:21], v69 offset:32768
    v_mfma_f32_16x16x32_bf16 a[40:43], v[52:55], v[104:107], a[40:43]
    ds_read_b64_tr_b16 v[22:23], v69 offset:33792
    s_waitcnt lgkmcnt(14)
    v_mfma_f32_16x16x32_bf16 a[48:51], v[56:59], v[104:107], a[48:51]
    ds_read_b64_tr_b16 v[24:25], v70 offset:32768
    v_mfma_f32_16x16x32_bf16 a[52:55], v[56:59], v[108:111], a[52:55]
    ds_read_b64_tr_b16 v[26:27], v70 offset:33792
    s_waitcnt lgkmcnt(14)
    v_mfma_f32_16x16x32_bf16 a[60:63], v[60:63], v[108:111], a[60:63]
    ds_read_b64_tr_b16 v[28:29], v71 offset:32768
    v_mfma_f32_16x16x32_bf16 a[56:59], v[60:63], v[104:107], a[56:59]
    ds_read_b64_tr_b16 v[30:31], v71 offset:33792
    s_waitcnt vmcnt(8) lgkmcnt(14)
    v_mfma_f32_16x16x32_bf16 a[0:3], v[0:3], v[112:115], a[0:3]
    ds_read_b64_tr_b16 v[32:33], v64 offset:40960
    v_mfma_f32_16x16x32_bf16 a[4:7], v[0:3], v[116:119], a[4:7]
    ds_read_b64_tr_b16 v[34:35], v64 offset:41984
    s_waitcnt lgkmcnt(14)
    v_mfma_f32_16x16x32_bf16 a[12:15], v[4:7], v[116:119], a[12:15]
    ds_read_b64_tr_b16 v[36:37], v65 offset:40960
    v_mfma_f32_16x16x32_bf16 a[8:11], v[4:7], v[112:115], a[8:11]
    ds_read_b64_tr_b16 v[38:39], v65 offset:41984
    buffer_load_dwordx4 v[96:99], v77, s[56:59], s33 offen offset:0
    s_waitcnt lgkmcnt(14)
    v_mfma_f32_16x16x32_bf16 a[16:19], v[8:11], v[112:115], a[16:19]
    ds_read_b64_tr_b16 v[40:41], v66 offset:40960
    v_mfma_f32_16x16x32_bf16 a[20:23], v[8:11], v[116:119], a[20:23]
    ds_read_b64_tr_b16 v[42:43], v66 offset:41984
    buffer_load_dwordx4 v[100:103], v188, s[56:59], s33 offen offset:0
    s_waitcnt lgkmcnt(14)
    v_mfma_f32_16x16x32_bf16 a[28:31], v[12:15], v[116:119], a[28:31]
    ds_read_b64_tr_b16 v[44:45], v67 offset:40960
    v_mfma_f32_16x16x32_bf16 a[24:27], v[12:15], v[112:115], a[24:27]
    ds_read_b64_tr_b16 v[46:47], v67 offset:41984
    buffer_load_dwordx4 v[104:107], v77, s[56:59], s33 offen offset:1024
    s_waitcnt lgkmcnt(14)
    v_mfma_f32_16x16x32_bf16 a[32:35], v[16:19], v[112:115], a[32:35]
    ds_read_b64_tr_b16 v[48:49], v68 offset:40960
    v_mfma_f32_16x16x32_bf16 a[36:39], v[16:19], v[116:119], a[36:39]
    ds_read_b64_tr_b16 v[50:51], v68 offset:41984
    buffer_load_dwordx4 v[108:111], v188, s[56:59], s33 offen offset:1024
    s_waitcnt lgkmcnt(14)
    v_mfma_f32_16x16x32_bf16 a[44:47], v[20:23], v[116:119], a[44:47]
    ds_read_b64_tr_b16 v[52:53], v69 offset:40960
    v_mfma_f32_16x16x32_bf16 a[40:43], v[20:23], v[112:115], a[40:43]
    ds_read_b64_tr_b16 v[54:55], v69 offset:41984
    s_add_u32 s33, s33, 2048
    s_waitcnt lgkmcnt(14)
    v_mfma_f32_16x16x32_bf16 a[48:51], v[24:27], v[112:115], a[48:51]
    ds_read_b64_tr_b16 v[56:57], v70 offset:40960
    v_mfma_f32_16x16x32_bf16 a[52:55], v[24:27], v[116:119], a[52:55]
    ds_read_b64_tr_b16 v[58:59], v70 offset:41984
    s_waitcnt lgkmcnt(14)
    v_mfma_f32_16x16x32_bf16 a[60:63], v[28:31], v[116:119], a[60:63]
    ds_read_b64_tr_b16 v[60:61], v71 offset:40960
    v_mfma_f32_16x16x32_bf16 a[56:59], v[28:31], v[112:115], a[56:59]
    ds_read_b64_tr_b16 v[62:63], v71 offset:41984
    s_waitcnt lgkmcnt(14)
    v_mfma_f32_16x16x32_bf16 a[0:3], v[32:35], v[120:123], a[0:3]
    ds_read_b64_tr_b16 v[0:1], v64 offset:49152
    v_mfma_f32_16x16x32_bf16 a[4:7], v[32:35], v[124:127], a[4:7]
    ds_read_b64_tr_b16 v[2:3], v64 offset:50176
    s_waitcnt lgkmcnt(14)
    v_mfma_f32_16x16x32_bf16 a[12:15], v[36:39], v[124:127], a[12:15]
    ds_read_b64_tr_b16 v[4:5], v65 offset:49152
    v_mfma_f32_16x16x32_bf16 a[8:11], v[36:39], v[120:123], a[8:11]
    ds_read_b64_tr_b16 v[6:7], v65 offset:50176
    s_waitcnt lgkmcnt(14)
    v_mfma_f32_16x16x32_bf16 a[16:19], v[40:43], v[120:123], a[16:19]
    ds_read_b64_tr_b16 v[8:9], v66 offset:49152
    v_mfma_f32_16x16x32_bf16 a[20:23], v[40:43], v[124:127], a[20:23]
    ds_read_b64_tr_b16 v[10:11], v66 offset:50176
    s_waitcnt lgkmcnt(14)
    v_mfma_f32_16x16x32_bf16 a[28:31], v[44:47], v[124:127], a[28:31]
    ds_read_b64_tr_b16 v[12:13], v67 offset:49152
    v_mfma_f32_16x16x32_bf16 a[24:27], v[44:47], v[120:123], a[24:27]
    ds_read_b64_tr_b16 v[14:15], v67 offset:50176
    s_waitcnt lgkmcnt(14)
    v_mfma_f32_16x16x32_bf16 a[32:35], v[48:51], v[120:123], a[32:35]
    ds_read_b64_tr_b16 v[16:17], v68 offset:49152
    v_mfma_f32_16x16x32_bf16 a[36:39], v[48:51], v[124:127], a[36:39]
    ds_read_b64_tr_b16 v[18:19], v68 offset:50176
    s_waitcnt lgkmcnt(14)
    v_mfma_f32_16x16x32_bf16 a[44:47], v[52:55], v[124:127], a[44:47]
    ds_read_b64_tr_b16 v[20:21], v69 offset:49152
    v_mfma_f32_16x16x32_bf16 a[40:43], v[52:55], v[120:123], a[40:43]
    ds_read_b64_tr_b16 v[22:23], v69 offset:50176
    s_waitcnt lgkmcnt(14)
    v_mfma_f32_16x16x32_bf16 a[48:51], v[56:59], v[120:123], a[48:51]
    ds_read_b64_tr_b16 v[24:25], v70 offset:49152
    v_mfma_f32_16x16x32_bf16 a[52:55], v[56:59], v[124:127], a[52:55]
    ds_read_b64_tr_b16 v[26:27], v70 offset:50176
    s_waitcnt lgkmcnt(14)
    v_mfma_f32_16x16x32_bf16 a[60:63], v[60:63], v[124:127], a[60:63]
    ds_read_b64_tr_b16 v[28:29], v71 offset:49152
    v_mfma_f32_16x16x32_bf16 a[56:59], v[60:63], v[120:123], a[56:59]
    ds_read_b64_tr_b16 v[30:31], v71 offset:50176
    s_waitcnt vmcnt(8) lgkmcnt(14)
    v_mfma_f32_16x16x32_bf16 a[0:3], v[0:3], v[128:131], a[0:3]
    ds_read_b64_tr_b16 v[32:33], v64 offset:57344
    v_mfma_f32_16x16x32_bf16 a[4:7], v[0:3], v[132:135], a[4:7]
    ds_read_b64_tr_b16 v[34:35], v64 offset:58368
    s_waitcnt lgkmcnt(14)
    v_mfma_f32_16x16x32_bf16 a[12:15], v[4:7], v[132:135], a[12:15]
    ds_read_b64_tr_b16 v[36:37], v65 offset:57344
    v_mfma_f32_16x16x32_bf16 a[8:11], v[4:7], v[128:131], a[8:11]
    ds_read_b64_tr_b16 v[38:39], v65 offset:58368
    buffer_load_dwordx4 v[112:115], v77, s[56:59], s33 offen offset:0
    s_waitcnt lgkmcnt(14)
    v_mfma_f32_16x16x32_bf16 a[16:19], v[8:11], v[128:131], a[16:19]
    ds_read_b64_tr_b16 v[40:41], v66 offset:57344
    v_mfma_f32_16x16x32_bf16 a[20:23], v[8:11], v[132:135], a[20:23]
    ds_read_b64_tr_b16 v[42:43], v66 offset:58368
    buffer_load_dwordx4 v[116:119], v188, s[56:59], s33 offen offset:0
    s_waitcnt lgkmcnt(14)
    v_mfma_f32_16x16x32_bf16 a[28:31], v[12:15], v[132:135], a[28:31]
    ds_read_b64_tr_b16 v[44:45], v67 offset:57344
    v_mfma_f32_16x16x32_bf16 a[24:27], v[12:15], v[128:131], a[24:27]
    ds_read_b64_tr_b16 v[46:47], v67 offset:58368
    buffer_load_dwordx4 v[120:123], v77, s[56:59], s33 offen offset:1024
    s_waitcnt lgkmcnt(14)
    v_mfma_f32_16x16x32_bf16 a[32:35], v[16:19], v[128:131], a[32:35]
    ds_read_b64_tr_b16 v[48:49], v68 offset:57344
    v_mfma_f32_16x16x32_bf16 a[36:39], v[16:19], v[132:135], a[36:39]
    ds_read_b64_tr_b16 v[50:51], v68 offset:58368
    buffer_load_dwordx4 v[124:127], v188, s[56:59], s33 offen offset:1024
    s_waitcnt lgkmcnt(14)
    v_mfma_f32_16x16x32_bf16 a[44:47], v[20:23], v[132:135], a[44:47]
    ds_read_b64_tr_b16 v[52:53], v69 offset:57344
    v_mfma_f32_16x16x32_bf16 a[40:43], v[20:23], v[128:131], a[40:43]
    ds_read_b64_tr_b16 v[54:55], v69 offset:58368
    s_add_u32 s33, s33, 2048
    s_waitcnt lgkmcnt(14)
    v_mfma_f32_16x16x32_bf16 a[48:51], v[24:27], v[128:131], a[48:51]
    ds_read_b64_tr_b16 v[56:57], v70 offset:57344
    v_mfma_f32_16x16x32_bf16 a[52:55], v[24:27], v[132:135], a[52:55]
    ds_read_b64_tr_b16 v[58:59], v70 offset:58368
    s_waitcnt lgkmcnt(14)
    v_mfma_f32_16x16x32_bf16 a[60:63], v[28:31], v[132:135], a[60:63]
    ds_read_b64_tr_b16 v[60:61], v71 offset:57344
    v_mfma_f32_16x16x32_bf16 a[56:59], v[28:31], v[128:131], a[56:59]
    ds_read_b64_tr_b16 v[62:63], v71 offset:58368
    s_waitcnt lgkmcnt(14)
    v_mfma_f32_16x16x32_bf16 a[0:3], v[32:35], v[136:139], a[0:3]
    s_barrier
    ds_read_b64_tr_b16 v[0:1], v176 offset:0
    v_mfma_f32_16x16x32_bf16 a[4:7], v[32:35], v[140:143], a[4:7]
    ds_read_b64_tr_b16 v[2:3], v176 offset:1024
    s_waitcnt lgkmcnt(14)
    v_mfma_f32_16x16x32_bf16 a[12:15], v[36:39], v[140:143], a[12:15]
    ds_read_b64_tr_b16 v[4:5], v177 offset:0
    v_mfma_f32_16x16x32_bf16 a[8:11], v[36:39], v[136:139], a[8:11]
    ds_read_b64_tr_b16 v[6:7], v177 offset:1024
    s_waitcnt lgkmcnt(14)
    v_mfma_f32_16x16x32_bf16 a[16:19], v[40:43], v[136:139], a[16:19]
    ds_read_b64_tr_b16 v[8:9], v178 offset:0
    v_mfma_f32_16x16x32_bf16 a[20:23], v[40:43], v[140:143], a[20:23]
    ds_read_b64_tr_b16 v[10:11], v178 offset:1024
    s_waitcnt lgkmcnt(14)
    v_mfma_f32_16x16x32_bf16 a[28:31], v[44:47], v[140:143], a[28:31]
    ds_read_b64_tr_b16 v[12:13], v179 offset:0
    v_mfma_f32_16x16x32_bf16 a[24:27], v[44:47], v[136:139], a[24:27]
    ds_read_b64_tr_b16 v[14:15], v179 offset:1024
    s_waitcnt lgkmcnt(14)
    v_mfma_f32_16x16x32_bf16 a[32:35], v[48:51], v[136:139], a[32:35]
    ds_read_b64_tr_b16 v[16:17], v180 offset:0
    v_mfma_f32_16x16x32_bf16 a[36:39], v[48:51], v[140:143], a[36:39]
    ds_read_b64_tr_b16 v[18:19], v180 offset:1024
    s_waitcnt lgkmcnt(14)
    v_mfma_f32_16x16x32_bf16 a[44:47], v[52:55], v[140:143], a[44:47]
    ds_read_b64_tr_b16 v[20:21], v181 offset:0
    v_mfma_f32_16x16x32_bf16 a[40:43], v[52:55], v[136:139], a[40:43]
    ds_read_b64_tr_b16 v[22:23], v181 offset:1024
    s_waitcnt lgkmcnt(14)
    v_mfma_f32_16x16x32_bf16 a[48:51], v[56:59], v[136:139], a[48:51]
    ds_read_b64_tr_b16 v[24:25], v182 offset:0
    v_mfma_f32_16x16x32_bf16 a[52:55], v[56:59], v[140:143], a[52:55]
    ds_read_b64_tr_b16 v[26:27], v182 offset:1024
    s_waitcnt lgkmcnt(14)
    v_mfma_f32_16x16x32_bf16 a[60:63], v[60:63], v[140:143], a[60:63]
    ds_read_b64_tr_b16 v[28:29], v183 offset:0
    v_mfma_f32_16x16x32_bf16 a[56:59], v[60:63], v[136:139], a[56:59]
    ds_read_b64_tr_b16 v[30:31], v183 offset:1024
    s_add_u32 s30, s30, 1
    s_cmp_lt_u32 s30, 2
    s_cbranch_scc1 g4_cloop
    s_waitcnt vmcnt(8) lgkmcnt(14)
    v_mfma_f32_16x16x32_bf16 a[0:3], v[0:3], v[80:83], a[0:3]
    ds_read_b64_tr_b16 v[32:33], v176 offset:8192
    v_mfma_f32_16x16x32_bf16 a[4:7], v[0:3], v[84:87], a[4:7]
    ds_read_b64_tr_b16 v[34:35], v176 offset:9216
    s_waitcnt lgkmcnt(14)
    v_mfma_f32_16x16x32_bf16 a[12:15], v[4:7], v[84:87], a[12:15]
    ds_read_b64_tr_b16 v[36:37], v177 offset:8192
    v_mfma_f32_16x16x32_bf16 a[8:11], v[4:7], v[80:83], a[8:11]
    ds_read_b64_tr_b16 v[38:39], v177 offset:9216
    buffer_load_dwordx4 v[128:131], v77, s[56:59], s33 offen offset:0
    s_waitcnt lgkmcnt(14)
    v_mfma_f32_16x16x32_bf16 a[16:19], v[8:11], v[80:83], a[16:19]
    ds_read_b64_tr_b16 v[40:41], v178 offset:8192
    v_mfma_f32_16x16x32_bf16 a[20:23], v[8:11], v[84:87], a[20:23]
    ds_read_b64_tr_b16 v[42:43], v178 offset:9216
    buffer_load_dwordx4 v[132:135], v188, s[56:59], s33 offen offset:0
    s_waitcnt lgkmcnt(14)
    v_mfma_f32_16x16x32_bf16 a[28:31], v[12:15], v[84:87], a[28:31]
    ds_read_b64_tr_b16 v[44:45], v179 offset:8192
    v_mfma_f32_16x16x32_bf16 a[24:27], v[12:15], v[80:83], a[24:27]
    ds_read_b64_tr_b16 v[46:47], v179 offset:9216
    buffer_load_dwordx4 v[136:139], v77, s[56:59], s33 offen offset:1024
    s_waitcnt lgkmcnt(14)
    v_mfma_f32_16x16x32_bf16 a[32:35], v[16:19], v[80:83], a[32:35]
    ds_read_b64_tr_b16 v[48:49], v180 offset:8192
    v_mfma_f32_16x16x32_bf16 a[36:39], v[16:19], v[84:87], a[36:39]
    ds_read_b64_tr_b16 v[50:51], v180 offset:9216
    buffer_load_dwordx4 v[140:143], v188, s[56:59], s33 offen offset:1024
    s_waitcnt lgkmcnt(14)
    v_mfma_f32_16x16x32_bf16 a[44:47], v[20:23], v[84:87], a[44:47]
    ds_read_b64_tr_b16 v[52:53], v181 offset:8192
    v_mfma_f32_16x16x32_bf16 a[40:43], v[20:23], v[80:83], a[40:43]
    ds_read_b64_tr_b16 v[54:55], v181 offset:9216
    s_add_u32 s33, s33, 2048
    s_waitcnt lgkmcnt(14)
    v_mfma_f32_16x16x32_bf16 a[48:51], v[24:27], v[80:83], a[48:51]
    ds_read_b64_tr_b16 v[56:57], v182 offset:8192
    v_mfma_f32_16x16x32_bf16 a[52:55], v[24:27], v[84:87], a[52:55]
    ds_read_b64_tr_b16 v[58:59], v182 offset:9216
    s_waitcnt lgkmcnt(14)
    v_mfma_f32_16x16x32_bf16 a[60:63], v[28:31], v[84:87], a[60:63]
    ds_read_b64_tr_b16 v[60:61], v183 offset:8192
    v_mfma_f32_16x16x32_bf16 a[56:59], v[28:31], v[80:83], a[56:59]
    ds_read_b64_tr_b16 v[62:63], v183 offset:9216
    s_waitcnt lgkmcnt(14)
    v_mfma_f32_16x16x32_bf16 a[0:3], v[32:35], v[88:91], a[0:3]
    ds_read_b64_tr_b16 v[0:1], v176 offset:16384
    v_mfma_f32_16x16x32_bf16 a[4:7], v[32:35], v[92:95], a[4:7]
    ds_read_b64_tr_b16 v[2:3], v176 offset:17408
    s_waitcnt lgkmcnt(14)
    v_mfma_f32_16x16x32_bf16 a[12:15], v[36:39], v[92:95], a[12:15]
    ds_read_b64_tr_b16 v[4:5], v177 offset:16384
    v_mfma_f32_16x16x32_bf16 a[8:11], v[36:39], v[88:91], a[8:11]
    ds_read_b64_tr_b16 v[6:7], v177 offset:17408
    s_waitcnt lgkmcnt(14)
    v_mfma_f32_16x16x32_bf16 a[16:19], v[40:43], v[88:91], a[16:19]
    ds_read_b64_tr_b16 v[8:9], v178 offset:16384
    v_mfma_f32_16x16x32_bf16 a[20:23], v[40:43], v[92:95], a[20:23]
    ds_read_b64_tr_b16 v[10:11], v178 offset:17408
    s_waitcnt lgkmcnt(14)
    v_mfma_f32_16x16x32_bf16 a[28:31], v[44:47], v[92:95], a[28:31]
    ds_read_b64_tr_b16 v[12:13], v179 offset:16384
    v_mfma_f32_16x16x32_bf16 a[24:27], v[44:47], v[88:91], a[24:27]
    ds_read_b64_tr_b16 v[14:15], v179 offset:17408
    s_waitcnt lgkmcnt(14)
    v_mfma_f32_16x16x32_bf16 a[32:35], v[48:51], v[88:91], a[32:35]
    ds_read_b64_tr_b16 v[16:17], v180 offset:16384
    v_mfma_f32_16x16x32_bf16 a[36:39], v[48:51], v[92:95], a[36:39]
    ds_read_b64_tr_b16 v[18:19], v180 offset:17408
    s_waitcnt lgkmcnt(14)
    v_mfma_f32_16x16x32_bf16 a[44:47], v[52:55], v[92:95], a[44:47]
    ds_read_b64_tr_b16 v[20:21], v181 offset:16384
    v_mfma_f32_16x16x32_bf16 a[40:43], v[52:55], v[88:91], a[40:43]
    ds_read_b64_tr_b16 v[22:23], v181 offset:17408
    s_waitcnt lgkmcnt(14)
    v_mfma_f32_16x16x32_bf16 a[48:51], v[56:59], v[88:91], a[48:51]
    ds_read_b64_tr_b16 v[24:25], v182 offset:16384
    v_mfma_f32_16x16x32_bf16 a[52:55], v[56:59], v[92:95], a[52:55]
    ds_read_b64_tr_b16 v[26:27], v182 offset:17408
    s_waitcnt lgkmcnt(14)
    v_mfma_f32_16x16x32_bf16 a[60:63], v[60:63], v[92:95], a[60:63]
    ds_read_b64_tr_b16 v[28:29], v183 offset:16384
    v_mfma_f32_16x16x32_bf16 a[56:59], v[60:63], v[88:91], a[56:59]
    ds_read_b64_tr_b16 v[30:31], v183 offset:17408
    s_waitcnt vmcnt(8) lgkmcnt(14)
    v_mfma_f32_16x16x32_bf16 a[0:3], v[0:3], v[96:99], a[0:3]
    ds_read_b64_tr_b16 v[32:33], v176 offset:24576
    v_mfma_f32_16x16x32_bf16 a[4:7], v[0:3], v[100:103], a[4:7]
    ds_read_b64_tr_b16 v[34:35], v176 offset:25600
    s_waitcnt lgkmcnt(14)
    v_mfma_f32_16x16x32_bf16 a[12:15], v[4:7], v[100:103], a[12:15]
    ds_read_b64_tr_b16 v[36:37], v177 offset:24576
    v_mfma_f32_16x16x32_bf16 a[8:11], v[4:7], v[96:99], a[8:11]
    ds_read_b64_tr_b16 v[38:39], v177 offset:25600
    buffer_load_dwordx4 v[80:83], v77, s[56:59], s33 offen offset:0
    s_waitcnt lgkmcnt(14)
    v_mfma_f32_16x16x32_bf16 a[16:19], v[8:11], v[96:99], a[16:19]
    ds_read_b64_tr_b16 v[40:41], v178 offset:24576
    v_mfma_f32_16x16x32_bf16 a[20:23], v[8:11], v[100:103], a[20:23]
    ds_read_b64_tr_b16 v[42:43], v178 offset:25600
    buffer_load_dwordx4 v[84:87], v188, s[56:59], s33 offen offset:0
    s_waitcnt lgkmcnt(14)
    v_mfma_f32_16x16x32_bf16 a[28:31], v[12:15], v[100:103], a[28:31]
    ds_read_b64_tr_b16 v[44:45], v179 offset:24576
    v_mfma_f32_16x16x32_bf16 a[24:27], v[12:15], v[96:99], a[24:27]
    ds_read_b64_tr_b16 v[46:47], v179 offset:25600
    buffer_load_dwordx4 v[88:91], v77, s[56:59], s33 offen offset:1024
    s_waitcnt lgkmcnt(14)
    v_mfma_f32_16x16x32_bf16 a[32:35], v[16:19], v[96:99], a[32:35]
    ds_read_b64_tr_b16 v[48:49], v180 offset:24576
    v_mfma_f32_16x16x32_bf16 a[36:39], v[16:19], v[100:103], a[36:39]
    ds_read_b64_tr_b16 v[50:51], v180 offset:25600
    buffer_load_dwordx4 v[92:95], v188, s[56:59], s33 offen offset:1024
    s_waitcnt lgkmcnt(14)
    v_mfma_f32_16x16x32_bf16 a[44:47], v[20:23], v[100:103], a[44:47]
    ds_read_b64_tr_b16 v[52:53], v181 offset:24576
    v_mfma_f32_16x16x32_bf16 a[40:43], v[20:23], v[96:99], a[40:43]
    ds_read_b64_tr_b16 v[54:55], v181 offset:25600
    s_add_u32 s33, s33, 2048
    s_waitcnt lgkmcnt(14)
    v_mfma_f32_16x16x32_bf16 a[48:51], v[24:27], v[96:99], a[48:51]
    ds_read_b64_tr_b16 v[56:57], v182 offset:24576
    v_mfma_f32_16x16x32_bf16 a[52:55], v[24:27], v[100:103], a[52:55]
    ds_read_b64_tr_b16 v[58:59], v182 offset:25600
    s_waitcnt lgkmcnt(14)
    v_mfma_f32_16x16x32_bf16 a[60:63], v[28:31], v[100:103], a[60:63]
    ds_read_b64_tr_b16 v[60:61], v183 offset:24576
    v_mfma_f32_16x16x32_bf16 a[56:59], v[28:31], v[96:99], a[56:59]
    ds_read_b64_tr_b16 v[62:63], v183 offset:25600
    s_waitcnt lgkmcnt(14)
    v_mfma_f32_16x16x32_bf16 a[0:3], v[32:35], v[104:107], a[0:3]
    s_barrier
    ds_read_b64_tr_b16 v[0:1], v176 offset:32768
    v_mfma_f32_16x16x32_bf16 a[4:7], v[32:35], v[108:111], a[4:7]
    ds_read_b64_tr_b16 v[2:3], v176 offset:33792
    s_waitcnt lgkmcnt(14)
    v_mfma_f32_16x16x32_bf16 a[12:15], v[36:39], v[108:111], a[12:15]
    ds_read_b64_tr_b16 v[4:5], v177 offset:32768
    v_mfma_f32_16x16x32_bf16 a[8:11], v[36:39], v[104:107], a[8:11]
    ds_read_b64_tr_b16 v[6:7], v177 offset:33792
    s_waitcnt lgkmcnt(14)
    v_mfma_f32_16x16x32_bf16 a[16:19], v[40:43], v[104:107], a[16:19]
    ds_read_b64_tr_b16 v[8:9], v178 offset:32768
    v_mfma_f32_16x16x32_bf16 a[20:23], v[40:43], v[108:111], a[20:23]
    ds_read_b64_tr_b16 v[10:11], v178 offset:33792
    s_waitcnt lgkmcnt(14)
    v_mfma_f32_16x16x32_bf16 a[28:31], v[44:47], v[108:111], a[28:31]
    ds_read_b64_tr_b16 v[12:13], v179 offset:32768
    v_mfma_f32_16x16x32_bf16 a[24:27], v[44:47], v[104:107], a[24:27]
    ds_read_b64_tr_b16 v[14:15], v179 offset:33792
    s_waitcnt lgkmcnt(14)
    v_mfma_f32_16x16x32_bf16 a[32:35], v[48:51], v[104:107], a[32:35]
    ds_read_b64_tr_b16 v[16:17], v180 offset:32768
    v_mfma_f32_16x16x32_bf16 a[36:39], v[48:51], v[108:111], a[36:39]
    ds_read_b64_tr_b16 v[18:19], v180 offset:33792
    s_waitcnt lgkmcnt(14)
    v_mfma_f32_16x16x32_bf16 a[44:47], v[52:55], v[108:111], a[44:47]
    ds_read_b64_tr_b16 v[20:21], v181 offset:32768
    v_mfma_f32_16x16x32_bf16 a[40:43], v[52:55], v[104:107], a[40:43]
    ds_read_b64_tr_b16 v[22:23], v181 offset:33792
    s_waitcnt lgkmcnt(14)
    v_mfma_f32_16x16x32_bf16 a[48:51], v[56:59], v[104:107], a[48:51]
    ds_read_b64_tr_b16 v[24:25], v182 offset:32768
    v_mfma_f32_16x16x32_bf16 a[52:55], v[56:59], v[108:111], a[52:55]
    ds_read_b64_tr_b16 v[26:27], v182 offset:33792
    s_waitcnt lgkmcnt(14)
    v_mfma_f32_16x16x32_bf16 a[60:63], v[60:63], v[108:111], a[60:63]
    ds_read_b64_tr_b16 v[28:29], v183 offset:32768
    v_mfma_f32_16x16x32_bf16 a[56:59], v[60:63], v[104:107], a[56:59]
    ds_read_b64_tr_b16 v[30:31], v183 offset:33792
    s_waitcnt vmcnt(8) lgkmcnt(14)
    v_mfma_f32_16x16x32_bf16 a[0:3], v[0:3], v[112:115], a[0:3]
    ds_read_b64_tr_b16 v[32:33], v176 offset:40960
    v_mfma_f32_16x16x32_bf16 a[4:7], v[0:3], v[116:119], a[4:7]
    ds_read_b64_tr_b16 v[34:35], v176 offset:41984
    s_waitcnt lgkmcnt(14)
    v_mfma_f32_16x16x32_bf16 a[12:15], v[4:7], v[116:119], a[12:15]
    ds_read_b64_tr_b16 v[36:37], v177 offset:40960
    v_mfma_f32_16x16x32_bf16 a[8:11], v[4:7], v[112:115], a[8:11]
    ds_read_b64_tr_b16 v[38:39], v177 offset:41984
    buffer_load_dwordx4 v[96:99], v77, s[56:59], s33 offen offset:0
    s_waitcnt lgkmcnt(14)
    v_mfma_f32_16x16x32_bf16 a[16:19], v[8:11], v[112:115], a[16:19]
    ds_read_b64_tr_b16 v[40:41], v178 offset:40960
    v_mfma_f32_16x16x32_bf16 a[20:23], v[8:11], v[116:119], a[20:23]
    ds_read_b64_tr_b16 v[42:43], v178 offset:41984
    buffer_load_dwordx4 v[100:103], v188, s[56:59], s33 offen offset:0
    s_waitcnt lgkmcnt(14)
    v_mfma_f32_16x16x32_bf16 a[28:31], v[12:15], v[116:119], a[28:31]
    ds_read_b64_tr_b16 v[44:45], v179 offset:40960
    v_mfma_f32_16x16x32_bf16 a[24:27], v[12:15], v[112:115], a[24:27]
    ds_read_b64_tr_b16 v[46:47], v179 offset:41984
    buffer_load_dwordx4 v[104:107], v77, s[56:59], s33 offen offset:1024
    s_waitcnt lgkmcnt(14)
    v_mfma_f32_16x16x32_bf16 a[32:35], v[16:19], v[112:115], a[32:35]
    ds_read_b64_tr_b16 v[48:49], v180 offset:40960
    v_mfma_f32_16x16x32_bf16 a[36:39], v[16:19], v[116:119], a[36:39]
    ds_read_b64_tr_b16 v[50:51], v180 offset:41984
    buffer_load_dwordx4 v[108:111], v188, s[56:59], s33 offen offset:1024
    s_waitcnt lgkmcnt(14)
    v_mfma_f32_16x16x32_bf16 a[44:47], v[20:23], v[116:119], a[44:47]
    ds_read_b64_tr_b16 v[52:53], v181 offset:40960
    v_mfma_f32_16x16x32_bf16 a[40:43], v[20:23], v[112:115], a[40:43]
    ds_read_b64_tr_b16 v[54:55], v181 offset:41984
    s_add_u32 s33, s33, 2048
    s_waitcnt lgkmcnt(14)
    v_mfma_f32_16x16x32_bf16 a[48:51], v[24:27], v[112:115], a[48:51]
    ds_read_b64_tr_b16 v[56:57], v182 offset:40960
    v_mfma_f32_16x16x32_bf16 a[52:55], v[24:27], v[116:119], a[52:55]
    ds_read_b64_tr_b16 v[58:59], v182 offset:41984
    s_waitcnt lgkmcnt(14)
    v_mfma_f32_16x16x32_bf16 a[60:63], v[28:31], v[116:119], a[60:63]
    ds_read_b64_tr_b16 v[60:61], v183 offset:40960
    v_mfma_f32_16x16x32_bf16 a[56:59], v[28:31], v[112:115], a[56:59]
    ds_read_b64_tr_b16 v[62:63], v183 offset:41984
    s_waitcnt lgkmcnt(14)
    v_mfma_f32_16x16x32_bf16 a[0:3], v[32:35], v[120:123], a[0:3]
    ds_read_b64_tr_b16 v[0:1], v176 offset:49152
    v_mfma_f32_16x16x32_bf16 a[4:7], v[32:35], v[124:127], a[4:7]
    ds_read_b64_tr_b16 v[2:3], v176 offset:50176
    s_waitcnt lgkmcnt(14)
    v_mfma_f32_16x16x32_bf16 a[12:15], v[36:39], v[124:127], a[12:15]
    ds_read_b64_tr_b16 v[4:5], v177 offset:49152
    v_mfma_f32_16x16x32_bf16 a[8:11], v[36:39], v[120:123], a[8:11]
    ds_read_b64_tr_b16 v[6:7], v177 offset:50176
    s_waitcnt lgkmcnt(14)
    v_mfma_f32_16x16x32_bf16 a[16:19], v[40:43], v[120:123], a[16:19]
    ds_read_b64_tr_b16 v[8:9], v178 offset:49152
    v_mfma_f32_16x16x32_bf16 a[20:23], v[40:43], v[124:127], a[20:23]
    ds_read_b64_tr_b16 v[10:11], v178 offset:50176
    s_waitcnt lgkmcnt(14)
    v_mfma_f32_16x16x32_bf16 a[28:31], v[44:47], v[124:127], a[28:31]
    ds_read_b64_tr_b16 v[12:13], v179 offset:49152
    v_mfma_f32_16x16x32_bf16 a[24:27], v[44:47], v[120:123], a[24:27]
    ds_read_b64_tr_b16 v[14:15], v179 offset:50176
    s_waitcnt lgkmcnt(14)
    v_mfma_f32_16x16x32_bf16 a[32:35], v[48:51], v[120:123], a[32:35]
    ds_read_b64_tr_b16 v[16:17], v180 offset:49152
    v_mfma_f32_16x16x32_bf16 a[36:39], v[48:51], v[124:127], a[36:39]
    ds_read_b64_tr_b16 v[18:19], v180 offset:50176
    s_waitcnt lgkmcnt(14)
    v_mfma_f32_16x16x32_bf16 a[44:47], v[52:55], v[124:127], a[44:47]
    ds_read_b64_tr_b16 v[20:21], v181 offset:49152
    v_mfma_f32_16x16x32_bf16 a[40:43], v[52:55], v[120:123], a[40:43]
    ds_read_b64_tr_b16 v[22:23], v181 offset:50176
    s_waitcnt lgkmcnt(14)
    v_mfma_f32_16x16x32_bf16 a[48:51], v[56:59], v[120:123], a[48:51]
    ds_read_b64_tr_b16 v[24:25], v182 offset:49152
    v_mfma_f32_16x16x32_bf16 a[52:55], v[56:59], v[124:127], a[52:55]
    ds_read_b64_tr_b16 v[26:27], v182 offset:50176
    s_waitcnt lgkmcnt(14)
    v_mfma_f32_16x16x32_bf16 a[60:63], v[60:63], v[124:127], a[60:63]
    ds_read_b64_tr_b16 v[28:29], v183 offset:49152
    v_mfma_f32_16x16x32_bf16 a[56:59], v[60:63], v[120:123], a[56:59]
    ds_read_b64_tr_b16 v[30:31], v183 offset:50176
    s_waitcnt vmcnt(8) lgkmcnt(14)
    v_mfma_f32_16x16x32_bf16 a[0:3], v[0:3], v[128:131], a[0:3]
    ds_read_b64_tr_b16 v[32:33], v176 offset:57344
    v_mfma_f32_16x16x32_bf16 a[4:7], v[0:3], v[132:135], a[4:7]
    ds_read_b64_tr_b16 v[34:35], v176 offset:58368
    s_waitcnt lgkmcnt(14)
    v_mfma_f32_16x16x32_bf16 a[12:15], v[4:7], v[132:135], a[12:15]
    ds_read_b64_tr_b16 v[36:37], v177 offset:57344
    v_mfma_f32_16x16x32_bf16 a[8:11], v[4:7], v[128:131], a[8:11]
    ds_read_b64_tr_b16 v[38:39], v177 offset:58368
    buffer_load_dwordx4 v[112:115], v77, s[56:59], s33 offen offset:0
    s_waitcnt lgkmcnt(14)
    v_mfma_f32_16x16x32_bf16 a[16:19], v[8:11], v[128:131], a[16:19]
    ds_read_b64_tr_b16 v[40:41], v178 offset:57344
    v_mfma_f32_16x16x32_bf16 a[20:23], v[8:11], v[132:135], a[20:23]
    ds_read_b64_tr_b16 v[42:43], v178 offset:58368
    buffer_load_dwordx4 v[116:119], v188, s[56:59], s33 offen offset:0
    s_waitcnt lgkmcnt(14)
    v_mfma_f32_16x16x32_bf16 a[28:31], v[12:15], v[132:135], a[28:31]
    ds_read_b64_tr_b16 v[44:45], v179 offset:57344
    v_mfma_f32_16x16x32_bf16 a[24:27], v[12:15], v[128:131], a[24:27]
    ds_read_b64_tr_b16 v[46:47], v179 offset:58368
    buffer_load_dwordx4 v[120:123], v77, s[56:59], s33 offen offset:1024
    s_waitcnt lgkmcnt(14)
    v_mfma_f32_16x16x32_bf16 a[32:35], v[16:19], v[128:131], a[32:35]
    ds_read_b64_tr_b16 v[48:49], v180 offset:57344
    v_mfma_f32_16x16x32_bf16 a[36:39], v[16:19], v[132:135], a[36:39]
    ds_read_b64_tr_b16 v[50:51], v180 offset:58368
    buffer_load_dwordx4 v[124:127], v188, s[56:59], s33 offen offset:1024
    s_waitcnt lgkmcnt(14)
    v_mfma_f32_16x16x32_bf16 a[44:47], v[20:23], v[132:135], a[44:47]
    ds_read_b64_tr_b16 v[52:53], v181 offset:57344
    v_mfma_f32_16x16x32_bf16 a[40:43], v[20:23], v[128:131], a[40:43]
    ds_read_b64_tr_b16 v[54:55], v181 offset:58368
    s_add_u32 s33, s33, 2048
    s_waitcnt lgkmcnt(14)
    v_mfma_f32_16x16x32_bf16 a[48:51], v[24:27], v[128:131], a[48:51]
    ds_read_b64_tr_b16 v[56:57], v182 offset:57344
    v_mfma_f32_16x16x32_bf16 a[52:55], v[24:27], v[132:135], a[52:55]
    ds_read_b64_tr_b16 v[58:59], v182 offset:58368
    s_waitcnt lgkmcnt(14)
    v_mfma_f32_16x16x32_bf16 a[60:63], v[28:31], v[132:135], a[60:63]
    ds_read_b64_tr_b16 v[60:61], v183 offset:57344
    v_mfma_f32_16x16x32_bf16 a[56:59], v[28:31], v[128:131], a[56:59]
    ds_read_b64_tr_b16 v[62:63], v183 offset:58368
    s_waitcnt lgkmcnt(14)
    v_mfma_f32_16x16x32_bf16 a[0:3], v[32:35], v[136:139], a[0:3]
    s_barrier
    ds_read_b64_tr_b16 v[0:1], v64 offset:0
    v_mfma_f32_16x16x32_bf16 a[4:7], v[32:35], v[140:143], a[4:7]
    ds_read_b64_tr_b16 v[2:3], v64 offset:1024
    s_waitcnt lgkmcnt(14)
    v_mfma_f32_16x16x32_bf16 a[12:15], v[36:39], v[140:143], a[12:15]
    ds_read_b64_tr_b16 v[4:5], v65 offset:0
    v_mfma_f32_16x16x32_bf16 a[8:11], v[36:39], v[136:139], a[8:11]
    ds_read_b64_tr_b16 v[6:7], v65 offset:1024
    s_waitcnt lgkmcnt(14)
    v_mfma_f32_16x16x32_bf16 a[16:19], v[40:43], v[136:139], a[16:19]
    ds_read_b64_tr_b16 v[8:9], v66 offset:0
    v_mfma_f32_16x16x32_bf16 a[20:23], v[40:43], v[140:143], a[20:23]
    ds_read_b64_tr_b16 v[10:11], v66 offset:1024
    s_waitcnt lgkmcnt(14)
    v_mfma_f32_16x16x32_bf16 a[28:31], v[44:47], v[140:143], a[28:31]
    ds_read_b64_tr_b16 v[12:13], v67 offset:0
    v_mfma_f32_16x16x32_bf16 a[24:27], v[44:47], v[136:139], a[24:27]
    ds_read_b64_tr_b16 v[14:15], v67 offset:1024
    s_waitcnt lgkmcnt(14)
    v_mfma_f32_16x16x32_bf16 a[32:35], v[48:51], v[136:139], a[32:35]
    ds_read_b64_tr_b16 v[16:17], v68 offset:0
    v_mfma_f32_16x16x32_bf16 a[36:39], v[48:51], v[140:143], a[36:39]
    ds_read_b64_tr_b16 v[18:19], v68 offset:1024
    s_waitcnt lgkmcnt(14)
    v_mfma_f32_16x16x32_bf16 a[44:47], v[52:55], v[140:143], a[44:47]
    ds_read_b64_tr_b16 v[20:21], v69 offset:0
    v_mfma_f32_16x16x32_bf16 a[40:43], v[52:55], v[136:139], a[40:43]
    ds_read_b64_tr_b16 v[22:23], v69 offset:1024
    s_waitcnt lgkmcnt(14)
    v_mfma_f32_16x16x32_bf16 a[48:51], v[56:59], v[136:139], a[48:51]
    ds_read_b64_tr_b16 v[24:25], v70 offset:0
    v_mfma_f32_16x16x32_bf16 a[52:55], v[56:59], v[140:143], a[52:55]
    ds_read_b64_tr_b16 v[26:27], v70 offset:1024
    s_waitcnt lgkmcnt(14)
    v_mfma_f32_16x16x32_bf16 a[60:63], v[60:63], v[140:143], a[60:63]
    ds_read_b64_tr_b16 v[28:29], v71 offset:0
    v_mfma_f32_16x16x32_bf16 a[56:59], v[60:63], v[136:139], a[56:59]
    ds_read_b64_tr_b16 v[30:31], v71 offset:1024
    s_waitcnt vmcnt(8) lgkmcnt(14)
    v_mfma_f32_16x16x32_bf16 a[0:3], v[0:3], v[80:83], a[0:3]
    ds_read_b64_tr_b16 v[32:33], v64 offset:8192
    v_mfma_f32_16x16x32_bf16 a[4:7], v[0:3], v[84:87], a[4:7]
    ds_read_b64_tr_b16 v[34:35], v64 offset:9216
    s_waitcnt lgkmcnt(14)
    v_mfma_f32_16x16x32_bf16 a[12:15], v[4:7], v[84:87], a[12:15]
    ds_read_b64_tr_b16 v[36:37], v65 offset:8192
    v_mfma_f32_16x16x32_bf16 a[8:11], v[4:7], v[80:83], a[8:11]
    ds_read_b64_tr_b16 v[38:39], v65 offset:9216
    buffer_load_dwordx4 v[128:131], v77, s[56:59], s33 offen offset:0
    s_waitcnt lgkmcnt(14)
    v_mfma_f32_16x16x32_bf16 a[16:19], v[8:11], v[80:83], a[16:19]
    ds_read_b64_tr_b16 v[40:41], v66 offset:8192
    v_mfma_f32_16x16x32_bf16 a[20:23], v[8:11], v[84:87], a[20:23]
    ds_read_b64_tr_b16 v[42:43], v66 offset:9216
    buffer_load_dwordx4 v[132:135], v188, s[56:59], s33 offen offset:0
    s_waitcnt lgkmcnt(14)
    v_mfma_f32_16x16x32_bf16 a[28:31], v[12:15], v[84:87], a[28:31]
    ds_read_b64_tr_b16 v[44:45], v67 offset:8192
    v_mfma_f32_16x16x32_bf16 a[24:27], v[12:15], v[80:83], a[24:27]
    ds_read_b64_tr_b16 v[46:47], v67 offset:9216
    buffer_load_dwordx4 v[136:139], v77, s[56:59], s33 offen offset:1024
    s_waitcnt lgkmcnt(14)
    v_mfma_f32_16x16x32_bf16 a[32:35], v[16:19], v[80:83], a[32:35]
    ds_read_b64_tr_b16 v[48:49], v68 offset:8192
    v_mfma_f32_16x16x32_bf16 a[36:39], v[16:19], v[84:87], a[36:39]
    ds_read_b64_tr_b16 v[50:51], v68 offset:9216
    buffer_load_dwordx4 v[140:143], v188, s[56:59], s33 offen offset:1024
    s_waitcnt lgkmcnt(14)
    v_mfma_f32_16x16x32_bf16 a[44:47], v[20:23], v[84:87], a[44:47]
    ds_read_b64_tr_b16 v[52:53], v69 offset:8192
    v_mfma_f32_16x16x32_bf16 a[40:43], v[20:23], v[80:83], a[40:43]
    ds_read_b64_tr_b16 v[54:55], v69 offset:9216
    s_add_u32 s33, s33, 2048
    s_waitcnt lgkmcnt(14)
    v_mfma_f32_16x16x32_bf16 a[48:51], v[24:27], v[80:83], a[48:51]
    ds_read_b64_tr_b16 v[56:57], v70 offset:8192
    v_mfma_f32_16x16x32_bf16 a[52:55], v[24:27], v[84:87], a[52:55]
    ds_read_b64_tr_b16 v[58:59], v70 offset:9216
    buffer_load_dwordx4 v[160:163], v79, s[16:19], s42 offen offset:0 sc1
    s_waitcnt lgkmcnt(14)
    v_mfma_f32_16x16x32_bf16 a[60:63], v[28:31], v[84:87], a[60:63]
    ds_read_b64_tr_b16 v[60:61], v71 offset:8192
    v_mfma_f32_16x16x32_bf16 a[56:59], v[28:31], v[80:83], a[56:59]
    ds_read_b64_tr_b16 v[62:63], v71 offset:9216
    buffer_load_dwordx4 v[164:167], v79, s[16:19], s42 offen offset:64 sc1
    buffer_load_dwordx4 v[168:171], v79, s[16:19], s42 offen offset:128 sc1
    buffer_load_dwordx4 v[172:175], v79, s[16:19], s42 offen offset:192 sc1
    buffer_load_dwordx4 v[144:147], v78, s[12:15], s40 offen offset:0
    buffer_load_dwordx4 v[148:151], v78, s[12:15], s40 offen offset:64
    buffer_load_dwordx4 v[152:155], v78, s[12:15], s40 offen offset:128
    buffer_load_dwordx4 v[156:159], v78, s[12:15], s40 offen offset:192
    s_waitcnt lgkmcnt(14)
    v_mfma_f32_16x16x32_bf16 a[0:3], v[32:35], v[88:91], a[0:3]
    ds_read_b64_tr_b16 v[0:1], v64 offset:16384
    v_mfma_f32_16x16x32_bf16 a[4:7], v[32:35], v[92:95], a[4:7]
    ds_read_b64_tr_b16 v[2:3], v64 offset:17408
    s_waitcnt lgkmcnt(14)
    v_mfma_f32_16x16x32_bf16 a[12:15], v[36:39], v[92:95], a[12:15]
    ds_read_b64_tr_b16 v[4:5], v65 offset:16384
    v_mfma_f32_16x16x32_bf16 a[8:11], v[36:39], v[88:91], a[8:11]
    ds_read_b64_tr_b16 v[6:7], v65 offset:17408
    s_waitcnt lgkmcnt(14)
    v_mfma_f32_16x16x32_bf16 a[16:19], v[40:43], v[88:91], a[16:19]
    ds_read_b64_tr_b16 v[8:9], v66 offset:16384
    v_mfma_f32_16x16x32_bf16 a[20:23], v[40:43], v[92:95], a[20:23]
    ds_read_b64_tr_b16 v[10:11], v66 offset:17408
    s_waitcnt lgkmcnt(14)
    v_mfma_f32_16x16x32_bf16 a[28:31], v[44:47], v[92:95], a[28:31]
    ds_read_b64_tr_b16 v[12:13], v67 offset:16384
    v_mfma_f32_16x16x32_bf16 a[24:27], v[44:47], v[88:91], a[24:27]
    ds_read_b64_tr_b16 v[14:15], v67 offset:17408
    s_waitcnt lgkmcnt(14)
    v_mfma_f32_16x16x32_bf16 a[32:35], v[48:51], v[88:91], a[32:35]
    ds_read_b64_tr_b16 v[16:17], v68 offset:16384
    v_mfma_f32_16x16x32_bf16 a[36:39], v[48:51], v[92:95], a[36:39]
    ds_read_b64_tr_b16 v[18:19], v68 offset:17408
    s_waitcnt lgkmcnt(14)
    v_mfma_f32_16x16x32_bf16 a[44:47], v[52:55], v[92:95], a[44:47]
    ds_read_b64_tr_b16 v[20:21], v69 offset:16384
    v_mfma_f32_16x16x32_bf16 a[40:43], v[52:55], v[88:91], a[40:43]
    ds_read_b64_tr_b16 v[22:23], v69 offset:17408
    s_waitcnt lgkmcnt(14)
    v_mfma_f32_16x16x32_bf16 a[48:51], v[56:59], v[88:91], a[48:51]
    ds_read_b64_tr_b16 v[24:25], v70 offset:16384
    v_mfma_f32_16x16x32_bf16 a[52:55], v[56:59], v[92:95], a[52:55]
    ds_read_b64_tr_b16 v[26:27], v70 offset:17408
    s_waitcnt lgkmcnt(14)
    v_mfma_f32_16x16x32_bf16 a[60:63], v[60:63], v[92:95], a[60:63]
    ds_read_b64_tr_b16 v[28:29], v71 offset:16384
    v_mfma_f32_16x16x32_bf16 a[56:59], v[60:63], v[88:91], a[56:59]
    ds_read_b64_tr_b16 v[30:31], v71 offset:17408
    s_waitcnt vmcnt(16) lgkmcnt(14)
    v_mfma_f32_16x16x32_bf16 a[0:3], v[0:3], v[96:99], a[0:3]
    ds_read_b64_tr_b16 v[32:33], v64 offset:24576
    v_mfma_f32_16x16x32_bf16 a[4:7], v[0:3], v[100:103], a[4:7]
    ds_read_b64_tr_b16 v[34:35], v64 offset:25600
    s_waitcnt lgkmcnt(14)
    v_mfma_f32_16x16x32_bf16 a[12:15], v[4:7], v[100:103], a[12:15]
    ds_read_b64_tr_b16 v[36:37], v65 offset:24576
    v_mfma_f32_16x16x32_bf16 a[8:11], v[4:7], v[96:99], a[8:11]
    ds_read_b64_tr_b16 v[38:39], v65 offset:25600
    s_waitcnt lgkmcnt(14)
    v_mfma_f32_16x16x32_bf16 a[16:19], v[8:11], v[96:99], a[16:19]
    ds_read_b64_tr_b16 v[40:41], v66 offset:24576
    v_mfma_f32_16x16x32_bf16 a[20:23], v[8:11], v[100:103], a[20:23]
    ds_read_b64_tr_b16 v[42:43], v66 offset:25600
    s_waitcnt lgkmcnt(14)
    v_mfma_f32_16x16x32_bf16 a[28:31], v[12:15], v[100:103], a[28:31]
    ds_read_b64_tr_b16 v[44:45], v67 offset:24576
    v_mfma_f32_16x16x32_bf16 a[24:27], v[12:15], v[96:99], a[24:27]
    ds_read_b64_tr_b16 v[46:47], v67 offset:25600
    s_waitcnt lgkmcnt(14)
    v_mfma_f32_16x16x32_bf16 a[32:35], v[16:19], v[96:99], a[32:35]
    ds_read_b64_tr_b16 v[48:49], v68 offset:24576
    v_mfma_f32_16x16x32_bf16 a[36:39], v[16:19], v[100:103], a[36:39]
    ds_read_b64_tr_b16 v[50:51], v68 offset:25600
    s_waitcnt lgkmcnt(14)
    v_mfma_f32_16x16x32_bf16 a[44:47], v[20:23], v[100:103], a[44:47]
    ds_read_b64_tr_b16 v[52:53], v69 offset:24576
    v_mfma_f32_16x16x32_bf16 a[40:43], v[20:23], v[96:99], a[40:43]
    ds_read_b64_tr_b16 v[54:55], v69 offset:25600
    s_waitcnt lgkmcnt(14)
    v_mfma_f32_16x16x32_bf16 a[48:51], v[24:27], v[96:99], a[48:51]
    ds_read_b64_tr_b16 v[56:57], v70 offset:24576
    v_mfma_f32_16x16x32_bf16 a[52:55], v[24:27], v[100:103], a[52:55]
    ds_read_b64_tr_b16 v[58:59], v70 offset:25600
    s_waitcnt lgkmcnt(14)
    v_mfma_f32_16x16x32_bf16 a[60:63], v[28:31], v[100:103], a[60:63]
    ds_read_b64_tr_b16 v[60:61], v71 offset:24576
    v_mfma_f32_16x16x32_bf16 a[56:59], v[28:31], v[96:99], a[56:59]
    ds_read_b64_tr_b16 v[62:63], v71 offset:25600
    s_waitcnt lgkmcnt(14)
    v_mfma_f32_16x16x32_bf16 a[0:3], v[32:35], v[104:107], a[0:3]
    s_barrier
    ds_read_b64_tr_b16 v[0:1], v64 offset:32768
    v_mfma_f32_16x16x32_bf16 a[4:7], v[32:35], v[108:111], a[4:7]
    ds_read_b64_tr_b16 v[2:3], v64 offset:33792
    s_waitcnt lgkmcnt(14)
    v_mfma_f32_16x16x32_bf16 a[12:15], v[36:39], v[108:111], a[12:15]
    ds_read_b64_tr_b16 v[4:5], v65 offset:32768
    v_mfma_f32_16x16x32_bf16 a[8:11], v[36:39], v[104:107], a[8:11]
    ds_read_b64_tr_b16 v[6:7], v65 offset:33792
    s_waitcnt lgkmcnt(14)
    v_mfma_f32_16x16x32_bf16 a[16:19], v[40:43], v[104:107], a[16:19]
    ds_read_b64_tr_b16 v[8:9], v66 offset:32768
    v_mfma_f32_16x16x32_bf16 a[20:23], v[40:43], v[108:111], a[20:23]
    ds_read_b64_tr_b16 v[10:11], v66 offset:33792
    s_waitcnt lgkmcnt(14)
    v_mfma_f32_16x16x32_bf16 a[28:31], v[44:47], v[108:111], a[28:31]
    ds_read_b64_tr_b16 v[12:13], v67 offset:32768
    v_mfma_f32_16x16x32_bf16 a[24:27], v[44:47], v[104:107], a[24:27]
    ds_read_b64_tr_b16 v[14:15], v67 offset:33792
    s_waitcnt lgkmcnt(14)
    v_mfma_f32_16x16x32_bf16 a[32:35], v[48:51], v[104:107], a[32:35]
    ds_read_b64_tr_b16 v[16:17], v68 offset:32768
    v_mfma_f32_16x16x32_bf16 a[36:39], v[48:51], v[108:111], a[36:39]
    ds_read_b64_tr_b16 v[18:19], v68 offset:33792
    s_waitcnt lgkmcnt(14)
    v_mfma_f32_16x16x32_bf16 a[44:47], v[52:55], v[108:111], a[44:47]
    ds_read_b64_tr_b16 v[20:21], v69 offset:32768
    v_mfma_f32_16x16x32_bf16 a[40:43], v[52:55], v[104:107], a[40:43]
    ds_read_b64_tr_b16 v[22:23], v69 offset:33792
    s_waitcnt lgkmcnt(14)
    v_mfma_f32_16x16x32_bf16 a[48:51], v[56:59], v[104:107], a[48:51]
    ds_read_b64_tr_b16 v[24:25], v70 offset:32768
    v_mfma_f32_16x16x32_bf16 a[52:55], v[56:59], v[108:111], a[52:55]
    ds_read_b64_tr_b16 v[26:27], v70 offset:33792
    s_waitcnt lgkmcnt(14)
    v_mfma_f32_16x16x32_bf16 a[60:63], v[60:63], v[108:111], a[60:63]
    ds_read_b64_tr_b16 v[28:29], v71 offset:32768
    v_mfma_f32_16x16x32_bf16 a[56:59], v[60:63], v[104:107], a[56:59]
    ds_read_b64_tr_b16 v[30:31], v71 offset:33792
    s_waitcnt vmcnt(12) lgkmcnt(14)
    v_mfma_f32_16x16x32_bf16 a[0:3], v[0:3], v[112:115], a[0:3]
    ds_read_b64_tr_b16 v[32:33], v64 offset:40960
    v_mfma_f32_16x16x32_bf16 a[4:7], v[0:3], v[116:119], a[4:7]
    ds_read_b64_tr_b16 v[34:35], v64 offset:41984
    s_waitcnt lgkmcnt(14)
    v_mfma_f32_16x16x32_bf16 a[12:15], v[4:7], v[116:119], a[12:15]
    ds_read_b64_tr_b16 v[36:37], v65 offset:40960
    v_mfma_f32_16x16x32_bf16 a[8:11], v[4:7], v[112:115], a[8:11]
    ds_read_b64_tr_b16 v[38:39], v65 offset:41984
    s_waitcnt lgkmcnt(14)
    v_mfma_f32_16x16x32_bf16 a[16:19], v[8:11], v[112:115], a[16:19]
    ds_read_b64_tr_b16 v[40:41], v66 offset:40960
    v_mfma_f32_16x16x32_bf16 a[20:23], v[8:11], v[116:119], a[20:23]
    ds_read_b64_tr_b16 v[42:43], v66 offset:41984
    s_waitcnt lgkmcnt(14)
    v_mfma_f32_16x16x32_bf16 a[28:31], v[12:15], v[116:119], a[28:31]
    ds_read_b64_tr_b16 v[44:45], v67 offset:40960
    v_mfma_f32_16x16x32_bf16 a[24:27], v[12:15], v[112:115], a[24:27]
    ds_read_b64_tr_b16 v[46:47], v67 offset:41984
    s_waitcnt lgkmcnt(14)
    v_mfma_f32_16x16x32_bf16 a[32:35], v[16:19], v[112:115], a[32:35]
    ds_read_b64_tr_b16 v[48:49], v68 offset:40960
    v_mfma_f32_16x16x32_bf16 a[36:39], v[16:19], v[116:119], a[36:39]
    ds_read_b64_tr_b16 v[50:51], v68 offset:41984
    s_waitcnt lgkmcnt(14)
    v_mfma_f32_16x16x32_bf16 a[44:47], v[20:23], v[116:119], a[44:47]
    ds_read_b64_tr_b16 v[52:53], v69 offset:40960
    v_mfma_f32_16x16x32_bf16 a[40:43], v[20:23], v[112:115], a[40:43]
    ds_read_b64_tr_b16 v[54:55], v69 offset:41984
    s_waitcnt lgkmcnt(14)
    v_mfma_f32_16x16x32_bf16 a[48:51], v[24:27], v[112:115], a[48:51]
    ds_read_b64_tr_b16 v[56:57], v70 offset:40960
    v_mfma_f32_16x16x32_bf16 a[52:55], v[24:27], v[116:119], a[52:55]
    ds_read_b64_tr_b16 v[58:59], v70 offset:41984
    s_waitcnt lgkmcnt(14)
    v_mfma_f32_16x16x32_bf16 a[60:63], v[28:31], v[116:119], a[60:63]
    ds_read_b64_tr_b16 v[60:61], v71 offset:40960
    v_mfma_f32_16x16x32_bf16 a[56:59], v[28:31], v[112:115], a[56:59]
    ds_read_b64_tr_b16 v[62:63], v71 offset:41984
    s_waitcnt lgkmcnt(14)
    v_mfma_f32_16x16x32_bf16 a[0:3], v[32:35], v[120:123], a[0:3]
    ds_read_b64_tr_b16 v[0:1], v64 offset:49152
    v_mfma_f32_16x16x32_bf16 a[4:7], v[32:35], v[124:127], a[4:7]
    ds_read_b64_tr_b16 v[2:3], v64 offset:50176
    s_waitcnt lgkmcnt(14)
    v_mfma_f32_16x16x32_bf16 a[12:15], v[36:39], v[124:127], a[12:15]
    ds_read_b64_tr_b16 v[4:5], v65 offset:49152
    v_mfma_f32_16x16x32_bf16 a[8:11], v[36:39], v[120:123], a[8:11]
    ds_read_b64_tr_b16 v[6:7], v65 offset:50176
    s_waitcnt lgkmcnt(14)
    v_mfma_f32_16x16x32_bf16 a[16:19], v[40:43], v[120:123], a[16:19]
    ds_read_b64_tr_b16 v[8:9], v66 offset:49152
    v_mfma_f32_16x16x32_bf16 a[20:23], v[40:43], v[124:127], a[20:23]
    ds_read_b64_tr_b16 v[10:11], v66 offset:50176
    s_waitcnt lgkmcnt(14)
    v_mfma_f32_16x16x32_bf16 a[28:31], v[44:47], v[124:127], a[28:31]
    ds_read_b64_tr_b16 v[12:13], v67 offset:49152
    v_mfma_f32_16x16x32_bf16 a[24:27], v[44:47], v[120:123], a[24:27]
    ds_read_b64_tr_b16 v[14:15], v67 offset:50176
    s_waitcnt lgkmcnt(14)
    v_mfma_f32_16x16x32_bf16 a[32:35], v[48:51], v[120:123], a[32:35]
    ds_read_b64_tr_b16 v[16:17], v68 offset:49152
    v_mfma_f32_16x16x32_bf16 a[36:39], v[48:51], v[124:127], a[36:39]
    ds_read_b64_tr_b16 v[18:19], v68 offset:50176
    s_waitcnt lgkmcnt(14)
    v_mfma_f32_16x16x32_bf16 a[44:47], v[52:55], v[124:127], a[44:47]
    ds_read_b64_tr_b16 v[20:21], v69 offset:49152
    v_mfma_f32_16x16x32_bf16 a[40:43], v[52:55], v[120:123], a[40:43]
    ds_read_b64_tr_b16 v[22:23], v69 offset:50176
    s_waitcnt lgkmcnt(14)
    v_mfma_f32_16x16x32_bf16 a[48:51], v[56:59], v[120:123], a[48:51]
    ds_read_b64_tr_b16 v[24:25], v70 offset:49152
    v_mfma_f32_16x16x32_bf16 a[52:55], v[56:59], v[124:127], a[52:55]
    ds_read_b64_tr_b16 v[26:27], v70 offset:50176
    s_waitcnt lgkmcnt(14)
    v_mfma_f32_16x16x32_bf16 a[60:63], v[60:63], v[124:127], a[60:63]
    ds_read_b64_tr_b16 v[28:29], v71 offset:49152
    v_mfma_f32_16x16x32_bf16 a[56:59], v[60:63], v[120:123], a[56:59]
    ds_read_b64_tr_b16 v[30:31], v71 offset:50176
    s_waitcnt vmcnt(8) lgkmcnt(14)
    v_mfma_f32_16x16x32_bf16 a[0:3], v[0:3], v[128:131], a[0:3]
    ds_read_b64_tr_b16 v[32:33], v64 offset:57344
    v_mfma_f32_16x16x32_bf16 a[4:7], v[0:3], v[132:135], a[4:7]
    ds_read_b64_tr_b16 v[34:35], v64 offset:58368
    s_waitcnt lgkmcnt(14)
    v_mfma_f32_16x16x32_bf16 a[12:15], v[4:7], v[132:135], a[12:15]
    ds_read_b64_tr_b16 v[36:37], v65 offset:57344
    v_mfma_f32_16x16x32_bf16 a[8:11], v[4:7], v[128:131], a[8:11]
    ds_read_b64_tr_b16 v[38:39], v65 offset:58368
    s_waitcnt lgkmcnt(14)
    v_mfma_f32_16x16x32_bf16 a[16:19], v[8:11], v[128:131], a[16:19]
    ds_read_b64_tr_b16 v[40:41], v66 offset:57344
    v_mfma_f32_16x16x32_bf16 a[20:23], v[8:11], v[132:135], a[20:23]
    ds_read_b64_tr_b16 v[42:43], v66 offset:58368
    s_waitcnt lgkmcnt(14)
    v_mfma_f32_16x16x32_bf16 a[28:31], v[12:15], v[132:135], a[28:31]
    ds_read_b64_tr_b16 v[44:45], v67 offset:57344
    v_mfma_f32_16x16x32_bf16 a[24:27], v[12:15], v[128:131], a[24:27]
    ds_read_b64_tr_b16 v[46:47], v67 offset:58368
    s_waitcnt lgkmcnt(14)
    v_mfma_f32_16x16x32_bf16 a[32:35], v[16:19], v[128:131], a[32:35]
    ds_read_b64_tr_b16 v[48:49], v68 offset:57344
    v_mfma_f32_16x16x32_bf16 a[36:39], v[16:19], v[132:135], a[36:39]
    ds_read_b64_tr_b16 v[50:51], v68 offset:58368
    s_waitcnt lgkmcnt(14)
    v_mfma_f32_16x16x32_bf16 a[44:47], v[20:23], v[132:135], a[44:47]
    ds_read_b64_tr_b16 v[52:53], v69 offset:57344
    v_mfma_f32_16x16x32_bf16 a[40:43], v[20:23], v[128:131], a[40:43]
    ds_read_b64_tr_b16 v[54:55], v69 offset:58368
    s_waitcnt lgkmcnt(14)
    v_mfma_f32_16x16x32_bf16 a[48:51], v[24:27], v[128:131], a[48:51]
    ds_read_b64_tr_b16 v[56:57], v70 offset:57344
    v_mfma_f32_16x16x32_bf16 a[52:55], v[24:27], v[132:135], a[52:55]
    ds_read_b64_tr_b16 v[58:59], v70 offset:58368
    s_waitcnt lgkmcnt(14)
    v_mfma_f32_16x16x32_bf16 a[60:63], v[28:31], v[132:135], a[60:63]
    ds_read_b64_tr_b16 v[60:61], v71 offset:57344
    v_mfma_f32_16x16x32_bf16 a[56:59], v[28:31], v[128:131], a[56:59]
    ds_read_b64_tr_b16 v[62:63], v71 offset:58368
    s_waitcnt lgkmcnt(14)
    v_mfma_f32_16x16x32_bf16 a[0:3], v[32:35], v[136:139], a[0:3]
    v_mfma_f32_16x16x32_bf16 a[4:7], v[32:35], v[140:143], a[4:7]
    s_waitcnt lgkmcnt(12)
    v_mfma_f32_16x16x32_bf16 a[12:15], v[36:39], v[140:143], a[12:15]
    v_mfma_f32_16x16x32_bf16 a[8:11], v[36:39], v[136:139], a[8:11]
    s_waitcnt lgkmcnt(10)
    v_mfma_f32_16x16x32_bf16 a[16:19], v[40:43], v[136:139], a[16:19]
    v_mfma_f32_16x16x32_bf16 a[20:23], v[40:43], v[140:143], a[20:23]
    s_waitcnt lgkmcnt(8)
    v_mfma_f32_16x16x32_bf16 a[28:31], v[44:47], v[140:143], a[28:31]
    v_mfma_f32_16x16x32_bf16 a[24:27], v[44:47], v[136:139], a[24:27]
    s_waitcnt lgkmcnt(6)
    v_mfma_f32_16x16x32_bf16 a[32:35], v[48:51], v[136:139], a[32:35]
    v_mfma_f32_16x16x32_bf16 a[36:39], v[48:51], v[140:143], a[36:39]
    s_waitcnt lgkmcnt(4)
    v_mfma_f32_16x16x32_bf16 a[44:47], v[52:55], v[140:143], a[44:47]
    v_mfma_f32_16x16x32_bf16 a[40:43], v[52:55], v[136:139], a[40:43]
    s_waitcnt lgkmcnt(2)
    v_mfma_f32_16x16x32_bf16 a[48:51], v[56:59], v[136:139], a[48:51]
    v_mfma_f32_16x16x32_bf16 a[52:55], v[56:59], v[140:143], a[52:55]
    s_waitcnt lgkmcnt(0)
    v_mfma_f32_16x16x32_bf16 a[60:63], v[60:63], v[140:143], a[60:63]
    v_mfma_f32_16x16x32_bf16 a[56:59], v[60:63], v[136:139], a[56:59]
    s_mov_b32 s34, 0xfffffffe
    s_mov_b32 s35, 0xbfb8aa3b
    s_cmp_eq_u32 s24, 0
    s_cbranch_scc1 g4_kh0
    v_accvgpr_read_b32 v80, a0
    v_accvgpr_read_b32 v81, a1
    v_accvgpr_read_b32 v82, a2
    v_accvgpr_read_b32 v83, a3
    v_accvgpr_read_b32 v84, a8
    v_accvgpr_read_b32 v85, a9
    v_accvgpr_read_b32 v86, a10
    v_accvgpr_read_b32 v87, a11
    v_cvt_pk_bf16_f32 v0, v80, v81
    v_cvt_pk_bf16_f32 v1, v82, v83
    v_cvt_pk_bf16_f32 v2, v84, v85
    v_cvt_pk_bf16_f32 v3, v86, v87
    v_min_u32 v0, s34, v0
    v_min_u32 v1, s34, v1
    v_min_u32 v2, s34, v2
    v_min_u32 v3, s34, v3
    buffer_store_dwordx4 v[0:3], v77, s[48:51], s26 offen offset:0 sc1
    v_accvgpr_read_b32 v88, a16
    v_accvgpr_read_b32 v89, a17
    v_accvgpr_read_b32 v90, a18
    v_accvgpr_read_b32 v91, a19
    v_accvgpr_read_b32 v92, a24
    v_accvgpr_read_b32 v93, a25
    v_accvgpr_read_b32 v94, a26
    v_accvgpr_read_b32 v95, a27
    v_cvt_pk_bf16_f32 v4, v88, v89
    v_cvt_pk_bf16_f32 v5, v90, v91
    v_cvt_pk_bf16_f32 v6, v92, v93
    v_cvt_pk_bf16_f32 v7, v94, v95
    v_min_u32 v4, s34, v4
    v_min_u32 v5, s34, v5
    v_min_u32 v6, s34, v6
    v_min_u32 v7, s34, v7
    buffer_store_dwordx4 v[4:7], v77, s[48:51], s26 offen offset:1024 sc1
    v_accvgpr_read_b32 v96, a32
    v_accvgpr_read_b32 v97, a33
    v_accvgpr_read_b32 v98, a34
    v_accvgpr_read_b32 v99, a35
    v_accvgpr_read_b32 v100, a40
    v_accvgpr_read_b32 v101, a41
    v_accvgpr_read_b32 v102, a42
    v_accvgpr_read_b32 v103, a43
    v_cvt_pk_bf16_f32 v8, v96, v97
    v_cvt_pk_bf16_f32 v9, v98, v99
    v_cvt_pk_bf16_f32 v10, v100, v101
    v_cvt_pk_bf16_f32 v11, v102, v103
    v_min_u32 v8, s34, v8
    v_min_u32 v9, s34, v9
    v_min_u32 v10, s34, v10
    v_min_u32 v11, s34, v11
    buffer_store_dwordx4 v[8:11], v77, s[48:51], s26 offen offset:2048 sc1
    v_accvgpr_read_b32 v104, a48
    v_accvgpr_read_b32 v105, a49
    v_accvgpr_read_b32 v106, a50
    v_accvgpr_read_b32 v107, a51
    v_accvgpr_read_b32 v108, a56
    v_accvgpr_read_b32 v109, a57
    v_accvgpr_read_b32 v110, a58
    v_accvgpr_read_b32 v111, a59
    v_cvt_pk_bf16_f32 v12, v104, v105
    v_cvt_pk_bf16_f32 v13, v106, v107
    v_cvt_pk_bf16_f32 v14, v108, v109
    v_cvt_pk_bf16_f32 v15, v110, v111
    v_min_u32 v12, s34, v12
    v_min_u32 v13, s34, v13
    v_min_u32 v14, s34, v14
    v_min_u32 v15, s34, v15
    buffer_store_dwordx4 v[12:15], v77, s[48:51], s26 offen offset:3072 sc1
    buffer_load_dwordx4 v[32:35], v77, s[48:51], s27 offen offset:0 sc1
    buffer_load_dwordx4 v[36:39], v77, s[48:51], s27 offen offset:1024 sc1
    buffer_load_dwordx4 v[40:43], v77, s[48:51], s27 offen offset:2048 sc1
    buffer_load_dwordx4 v[44:47], v77, s[48:51], s27 offen offset:3072 sc1
    v_accvgpr_read_b32 v80, a4
    v_accvgpr_read_b32 v81, a5
    v_accvgpr_read_b32 v82, a6
    v_accvgpr_read_b32 v83, a7
    v_accvgpr_read_b32 v84, a12
    v_accvgpr_read_b32 v85, a13
    v_accvgpr_read_b32 v86, a14
    v_accvgpr_read_b32 v87, a15
    v_accvgpr_read_b32 v88, a20
    v_accvgpr_read_b32 v89, a21
    v_accvgpr_read_b32 v90, a22
    v_accvgpr_read_b32 v91, a23
    v_accvgpr_read_b32 v92, a28
    v_accvgpr_read_b32 v93, a29
    v_accvgpr_read_b32 v94, a30
    v_accvgpr_read_b32 v95, a31
    v_accvgpr_read_b32 v96, a36
    v_accvgpr_read_b32 v97, a37
    v_accvgpr_read_b32 v98, a38
    v_accvgpr_read_b32 v99, a39
    v_accvgpr_read_b32 v100, a44
    v_accvgpr_read_b32 v101, a45
    v_accvgpr_read_b32 v102, a46
    v_accvgpr_read_b32 v103, a47
    v_accvgpr_read_b32 v104, a52
    v_accvgpr_read_b32 v105, a53
    v_accvgpr_read_b32 v106, a54
    v_accvgpr_read_b32 v107, a55
    v_accvgpr_read_b32 v108, a60
    v_accvgpr_read_b32 v109, a61
    v_accvgpr_read_b32 v110, a62
    v_accvgpr_read_b32 v111, a63
    s_branch g4_sent
g4_kh0:
    v_accvgpr_read_b32 v80, a4
    v_accvgpr_read_b32 v81, a5
    v_accvgpr_read_b32 v82, a6
    v_accvgpr_read_b32 v83, a7
    v_accvgpr_read_b32 v84, a12
    v_accvgpr_read_b32 v85, a13
    v_accvgpr_read_b32 v86, a14
    v_accvgpr_read_b32 v87, a15
    v_cvt_pk_bf16_f32 v0, v80, v81
    v_cvt_pk_bf16_f32 v1, v82, v83
    v_cvt_pk_bf16_f32 v2, v84, v85
    v_cvt_pk_bf16_f32 v3, v86, v87
    v_min_u32 v0, s34, v0
    v_min_u32 v1, s34, v1
    v_min_u32 v2, s34, v2
    v_min_u32 v3, s34, v3
    buffer_store_dwordx4 v[0:3], v77, s[48:51], s26 offen offset:0 sc1
    v_accvgpr_read_b32 v88, a20
    v_accvgpr_read_b32 v89, a21
    v_accvgpr_read_b32 v90, a22
    v_accvgpr_read_b32 v91, a23
    v_accvgpr_read_b32 v92, a28
    v_accvgpr_read_b32 v93, a29
    v_accvgpr_read_b32 v94, a30
    v_accvgpr_read_b32 v95, a31
    v_cvt_pk_bf16_f32 v4, v88, v89
    v_cvt_pk_bf16_f32 v5, v90, v91
    v_cvt_pk_bf16_f32 v6, v92, v93
    v_cvt_pk_bf16_f32 v7, v94, v95
    v_min_u32 v4, s34, v4
    v_min_u32 v5, s34, v5
    v_min_u32 v6, s34, v6
    v_min_u32 v7, s34, v7
    buffer_store_dwordx4 v[4:7], v77, s[48:51], s26 offen offset:1024 sc1
    v_accvgpr_read_b32 v96, a36
    v_accvgpr_read_b32 v97, a37
    v_accvgpr_read_b32 v98, a38
    v_accvgpr_read_b32 v99, a39
    v_accvgpr_read_b32 v100, a44
    v_accvgpr_read_b32 v101, a45
    v_accvgpr_read_b32 v102, a46
    v_accvgpr_read_b32 v103, a47
    v_cvt_pk_bf16_f32 v8, v96, v97
    v_cvt_pk_bf16_f32 v9, v98, v99
    v_cvt_pk_bf16_f32 v10, v100, v101
    v_cvt_pk_bf16_f32 v11, v102, v103
    v_min_u32 v8, s34, v8
    v_min_u32 v9, s34, v9
    v_min_u32 v10, s34, v10
    v_min_u32 v11, s34, v11
    buffer_store_dwordx4 v[8:11], v77, s[48:51], s26 offen offset:2048 sc1
    v_accvgpr_read_b32 v104, a52
    v_accvgpr_read_b32 v105, a53
    v_accvgpr_read_b32 v106, a54
    v_accvgpr_read_b32 v107, a55
    v_accvgpr_read_b32 v108, a60
    v_accvgpr_read_b32 v109, a61
    v_accvgpr_read_b32 v110, a62
    v_accvgpr_read_b32 v111, a63
    v_cvt_pk_bf16_f32 v12, v104, v105
    v_cvt_pk_bf16_f32 v13, v106, v107
    v_cvt_pk_bf16_f32 v14, v108, v109
    v_cvt_pk_bf16_f32 v15, v110, v111
    v_min_u32 v12, s34, v12
    v_min_u32 v13, s34, v13
    v_min_u32 v14, s34, v14
    v_min_u32 v15, s34, v15
    buffer_store_dwordx4 v[12:15], v77, s[48:51], s26 offen offset:3072 sc1
    buffer_load_dwordx4 v[32:35], v77, s[48:51], s27 offen offset:0 sc1
    buffer_load_dwordx4 v[36:39], v77, s[48:51], s27 offen offset:1024 sc1
    buffer_load_dwordx4 v[40:43], v77, s[48:51], s27 offen offset:2048 sc1
    buffer_load_dwordx4 v[44:47], v77, s[48:51], s27 offen offset:3072 sc1
    v_accvgpr_read_b32 v80, a0
    v_accvgpr_read_b32 v81, a1
    v_accvgpr_read_b32 v82, a2
    v_accvgpr_read_b32 v83, a3
    v_accvgpr_read_b32 v84, a8
    v_accvgpr_read_b32 v85, a9
    v_accvgpr_read_b32 v86, a10
    v_accvgpr_read_b32 v87, a11
    v_accvgpr_read_b32 v88, a16
    v_accvgpr_read_b32 v89, a17
    v_accvgpr_read_b32 v90, a18
    v_accvgpr_read_b32 v91, a19
    v_accvgpr_read_b32 v92, a24
    v_accvgpr_read_b32 v93, a25
    v_accvgpr_read_b32 v94, a26
    v_accvgpr_read_b32 v95, a27
    v_accvgpr_read_b32 v96, a32
    v_accvgpr_read_b32 v97, a33
    v_accvgpr_read_b32 v98, a34
    v_accvgpr_read_b32 v99, a35
    v_accvgpr_read_b32 v100, a40
    v_accvgpr_read_b32 v101, a41
    v_accvgpr_read_b32 v102, a42
    v_accvgpr_read_b32 v103, a43
    v_accvgpr_read_b32 v104, a48
    v_accvgpr_read_b32 v105, a49
    v_accvgpr_read_b32 v106, a50
    v_accvgpr_read_b32 v107, a51
    v_accvgpr_read_b32 v108, a56
    v_accvgpr_read_b32 v109, a57
    v_accvgpr_read_b32 v110, a58
    v_accvgpr_read_b32 v111, a59
g4_sent:
    s_mov_b32 s70, 0
    s_waitcnt vmcnt(8)
    s_mov_b32 s34, 0xffff0000
    s_mov_b32 s71, 0x00003f80
    s_mov_b32 s72, 0x3f800000
    v_and_b32 v16, 0xffff, v160
    v_and_b32 v17, s34, v160
    v_lshlrev_b32 v128, 16, v144
    v_and_b32 v129, s34, v144
    v_and_b32 v18, 0xffff, v161
    v_and_b32 v19, s34, v161
    v_lshlrev_b32 v130, 16, v145
    v_and_b32 v131, s34, v145
    v_and_b32 v20, 0xffff, v162
    v_and_b32 v21, s34, v162
    v_lshlrev_b32 v132, 16, v146
    v_and_b32 v133, s34, v146
    v_and_b32 v22, 0xffff, v163
    v_and_b32 v23, s34, v163
    v_lshlrev_b32 v134, 16, v147
    v_and_b32 v135, s34, v147
    v_and_b32 v24, 0xffff, v164
    v_and_b32 v25, s34, v164
    v_lshlrev_b32 v136, 16, v148
    v_and_b32 v137, s34, v148
    v_and_b32 v26, 0xffff, v165
    v_and_b32 v27, s34, v165
    v_lshlrev_b32 v138, 16, v149
    v_and_b32 v139, s34, v149
    v_and_b32 v28, 0xffff, v166
    v_and_b32 v29, s34, v166
    v_lshlrev_b32 v140, 16, v150
    v_and_b32 v141, s34, v150
    v_and_b32 v30, 0xffff, v167
    v_and_b32 v31, s34, v167
    v_lshlrev_b32 v142, 16, v151
    v_and_b32 v143, s34, v151
    v_and_b32 v48, 0xffff, v168
    v_and_b32 v49, s34, v168
    v_lshlrev_b32 v176, 16, v152
    v_and_b32 v177, s34, v152
    v_and_b32 v50, 0xffff, v169
    v_and_b32 v51, s34, v169
    v_lshlrev_b32 v178, 16, v153
    v_and_b32 v179, s34, v153
    v_and_b32 v52, 0xffff, v170
    v_and_b32 v53, s34, v170
    v_lshlrev_b32 v180, 16, v154
    v_and_b32 v181, s34, v154
    v_and_b32 v54, 0xffff, v171
    v_and_b32 v55, s34, v171
    v_lshlrev_b32 v182, 16, v155
    v_and_b32 v183, s34, v155
    v_and_b32 v56, 0xffff, v172
    v_and_b32 v57, s34, v172
    v_lshlrev_b32 v184, 16, v156
    v_and_b32 v185, s34, v156
    v_and_b32 v58, 0xffff, v173
    v_and_b32 v59, s34, v173
    v_lshlrev_b32 v186, 16, v157
    v_and_b32 v187, s34, v157
    v_and_b32 v60, 0xffff, v174
    v_and_b32 v61, s34, v174
    v_lshlrev_b32 v188, 16, v158
    v_and_b32 v189, s34, v158
    v_and_b32 v62, 0xffff, v175
    v_and_b32 v63, s34, v175
    v_lshlrev_b32 v190, 16, v159
    v_and_b32 v191, s34, v159
g4_chk:
    s_waitcnt vmcnt(0)
    v_max3_u32 v73, v32, v33, v34
    v_max3_u32 v73, v73, v35, v36
    v_max3_u32 v73, v73, v37, v38
    v_max3_u32 v73, v73, v39, v40
    v_max3_u32 v73, v73, v41, v42
    v_max3_u32 v73, v73, v43, v44
    v_max3_u32 v73, v73, v45, v46
    v_max_u32 v73, v73, v47
    v_cmp_eq_u32 vcc, -1, v73
    s_nop 4
    s_cbranch_vccz g4_got
    s_add_u32 s70, s70, 1
    s_cmp_ge_u32 s70, 400000
    s_cbranch_scc1 g4_got
    buffer_load_dwordx4 v[32:35], v77, s[48:51], s27 offen offset:0 sc1
    buffer_load_dwordx4 v[36:39], v77, s[48:51], s27 offen offset:1024 sc1
    buffer_load_dwordx4 v[40:43], v77, s[48:51], s27 offen offset:2048 sc1
    buffer_load_dwordx4 v[44:47], v77, s[48:51], s27 offen offset:3072 sc1
    s_branch g4_chk
g4_got:
    s_mov_b32 s34, 0xffff0000
    v_dot2_f32_bf16 v80, v32, s71, v80
    v_dot2_f32_bf16 v81, v32, s72, v81
    v_dot2_f32_bf16 v82, v33, s71, v82
    v_dot2_f32_bf16 v83, v33, s72, v83
    v_dot2_f32_bf16 v84, v34, s71, v84
    v_dot2_f32_bf16 v85, v34, s72, v85
    v_dot2_f32_bf16 v86, v35, s71, v86
    v_dot2_f32_bf16 v87, v35, s72, v87
    s_nop 1
    v_cvt_pk_bf16_f32 v120, v80, v81
    v_cvt_pk_bf16_f32 v121, v82, v83
    v_cvt_pk_bf16_f32 v122, v84, v85
    v_cvt_pk_bf16_f32 v123, v86, v87
    v_lshlrev_b32 v80, 16, v120
    v_and_b32 v81, s34, v120
    v_lshlrev_b32 v82, 16, v121
    v_and_b32 v83, s34, v121
    v_lshlrev_b32 v84, 16, v122
    v_and_b32 v85, s34, v122
    v_lshlrev_b32 v86, 16, v123
    v_and_b32 v87, s34, v123
    v_mul_f32 v112, s35, v80
    v_mul_f32 v113, s35, v81
    v_mul_f32 v114, s35, v82
    v_mul_f32 v115, s35, v83
    v_mul_f32 v116, s35, v84
    v_mul_f32 v117, s35, v85
    v_mul_f32 v118, s35, v86
    v_mul_f32 v119, s35, v87
    v_exp_f32 v112, v112
    v_exp_f32 v113, v113
    v_exp_f32 v114, v114
    v_exp_f32 v115, v115
    v_exp_f32 v116, v116
    v_exp_f32 v117, v117
    v_exp_f32 v118, v118
    v_exp_f32 v119, v119
    v_add_f32 v112, 1.0, v112
    v_add_f32 v113, 1.0, v113
    v_add_f32 v114, 1.0, v114
    v_add_f32 v115, 1.0, v115
    v_add_f32 v116, 1.0, v116
    v_add_f32 v117, 1.0, v117
    v_add_f32 v118, 1.0, v118
    v_add_f32 v119, 1.0, v119
    v_rcp_f32 v112, v112
    v_rcp_f32 v113, v113
    v_rcp_f32 v114, v114
    v_rcp_f32 v115, v115
    v_rcp_f32 v116, v116
    v_rcp_f32 v117, v117
    v_rcp_f32 v118, v118
    v_rcp_f32 v119, v119
    v_mul_f32 v112, v80, v112
    v_mul_f32 v113, v81, v113
    v_mul_f32 v114, v82, v114
    v_mul_f32 v115, v83, v115
    v_mul_f32 v116, v84, v116
    v_mul_f32 v117, v85, v117
    v_mul_f32 v118, v86, v118
    v_mul_f32 v119, v87, v119
    v_cvt_pk_bf16_f32 v120, v112, v113
    v_cvt_pk_bf16_f32 v121, v114, v115
    v_cvt_pk_bf16_f32 v122, v116, v117
    v_cvt_pk_bf16_f32 v123, v118, v119
    s_nop 0
    v_permlane16_swap_b32 v120, v122
    v_permlane16_swap_b32 v121, v123
    s_nop 0
    v_dot2_f32_bf16 v112, v120, v16, 0
    v_dot2_f32_bf16 v113, v120, v17, 0
    v_dot2_f32_bf16 v114, v121, v18, 0
    v_dot2_f32_bf16 v115, v121, v19, 0
    v_dot2_f32_bf16 v116, v122, v20, 0
    v_dot2_f32_bf16 v117, v122, v21, 0
    v_dot2_f32_bf16 v118, v123, v22, 0
    v_dot2_f32_bf16 v119, v123, v23, 0
    s_nop 1
    v_cvt_pk_bf16_f32 v120, v112, v113
    v_cvt_pk_bf16_f32 v121, v114, v115
    v_cvt_pk_bf16_f32 v122, v116, v117
    v_cvt_pk_bf16_f32 v123, v118, v119
    s_nop 1
    v_dot2_f32_bf16 v112, v120, s71, v128
    v_dot2_f32_bf16 v113, v120, s72, v129
    v_dot2_f32_bf16 v114, v121, s71, v130
    v_dot2_f32_bf16 v115, v121, s72, v131
    v_dot2_f32_bf16 v116, v122, s71, v132
    v_dot2_f32_bf16 v117, v122, s72, v133
    v_dot2_f32_bf16 v118, v123, s71, v134
    v_dot2_f32_bf16 v119, v123, s72, v135
    s_nop 1
    v_cvt_pk_bf16_f32 v160, v112, v113
    v_cvt_pk_bf16_f32 v161, v114, v115
    v_cvt_pk_bf16_f32 v162, v116, v117
    v_cvt_pk_bf16_f32 v163, v118, v119
    buffer_store_dwordx4 v[160:163], v78, s[36:39], s40 offen offset:0
    v_dot2_f32_bf16 v88, v36, s71, v88
    v_dot2_f32_bf16 v89, v36, s72, v89
    v_dot2_f32_bf16 v90, v37, s71, v90
    v_dot2_f32_bf16 v91, v37, s72, v91
    v_dot2_f32_bf16 v92, v38, s71, v92
    v_dot2_f32_bf16 v93, v38, s72, v93
    v_dot2_f32_bf16 v94, v39, s71, v94
    v_dot2_f32_bf16 v95, v39, s72, v95
    s_nop 1
    v_cvt_pk_bf16_f32 v120, v88, v89
    v_cvt_pk_bf16_f32 v121, v90, v91
    v_cvt_pk_bf16_f32 v122, v92, v93
    v_cvt_pk_bf16_f32 v123, v94, v95
    v_lshlrev_b32 v88, 16, v120
    v_and_b32 v89, s34, v120
    v_lshlrev_b32 v90, 16, v121
    v_and_b32 v91, s34, v121
    v_lshlrev_b32 v92, 16, v122
    v_and_b32 v93, s34, v122
    v_lshlrev_b32 v94, 16, v123
    v_and_b32 v95, s34, v123
    v_mul_f32 v112, s35, v88
    v_mul_f32 v113, s35, v89
    v_mul_f32 v114, s35, v90
    v_mul_f32 v115, s35, v91
    v_mul_f32 v116, s35, v92
    v_mul_f32 v117, s35, v93
    v_mul_f32 v118, s35, v94
    v_mul_f32 v119, s35, v95
    v_exp_f32 v112, v112
    v_exp_f32 v113, v113
    v_exp_f32 v114, v114
    v_exp_f32 v115, v115
    v_exp_f32 v116, v116
    v_exp_f32 v117, v117
    v_exp_f32 v118, v118
    v_exp_f32 v119, v119
    v_add_f32 v112, 1.0, v112
    v_add_f32 v113, 1.0, v113
    v_add_f32 v114, 1.0, v114
    v_add_f32 v115, 1.0, v115
    v_add_f32 v116, 1.0, v116
    v_add_f32 v117, 1.0, v117
    v_add_f32 v118, 1.0, v118
    v_add_f32 v119, 1.0, v119
    v_rcp_f32 v112, v112
    v_rcp_f32 v113, v113
    v_rcp_f32 v114, v114
    v_rcp_f32 v115, v115
    v_rcp_f32 v116, v116
    v_rcp_f32 v117, v117
    v_rcp_f32 v118, v118
    v_rcp_f32 v119, v119
    v_mul_f32 v112, v88, v112
    v_mul_f32 v113, v89, v113
    v_mul_f32 v114, v90, v114
    v_mul_f32 v115, v91, v115
    v_mul_f32 v116, v92, v116
    v_mul_f32 v117, v93, v117
    v_mul_f32 v118, v94, v118
    v_mul_f32 v119, v95, v119
    v_cvt_pk_bf16_f32 v120, v112, v113
    v_cvt_pk_bf16_f32 v121, v114, v115
    v_cvt_pk_bf16_f32 v122, v116, v117
    v_cvt_pk_bf16_f32 v123, v118, v119
    s_nop 0
    v_permlane16_swap_b32 v120, v122
    v_permlane16_swap_b32 v121, v123
    s_nop 0
    v_dot2_f32_bf16 v112, v120, v24, 0
    v_dot2_f32_bf16 v113, v120, v25, 0
    v_dot2_f32_bf16 v114, v121, v26, 0
    v_dot2_f32_bf16 v115, v121, v27, 0
    v_dot2_f32_bf16 v116, v122, v28, 0
    v_dot2_f32_bf16 v117, v122, v29, 0
    v_dot2_f32_bf16 v118, v123, v30, 0
    v_dot2_f32_bf16 v119, v123, v31, 0
    s_nop 1
    v_cvt_pk_bf16_f32 v120, v112, v113
    v_cvt_pk_bf16_f32 v121, v114, v115
    v_cvt_pk_bf16_f32 v122, v116, v117
    v_cvt_pk_bf16_f32 v123, v118, v119
    s_nop 1
    v_dot2_f32_bf16 v112, v120, s71, v136
    v_dot2_f32_bf16 v113, v120, s72, v137
    v_dot2_f32_bf16 v114, v121, s71, v138
    v_dot2_f32_bf16 v115, v121, s72, v139
    v_dot2_f32_bf16 v116, v122, s71, v140
    v_dot2_f32_bf16 v117, v122, s72, v141
    v_dot2_f32_bf16 v118, v123, s71, v142
    v_dot2_f32_bf16 v119, v123, s72, v143
    s_nop 1
    v_cvt_pk_bf16_f32 v164, v112, v113
    v_cvt_pk_bf16_f32 v165, v114, v115
    v_cvt_pk_bf16_f32 v166, v116, v117
    v_cvt_pk_bf16_f32 v167, v118, v119
    buffer_store_dwordx4 v[164:167], v78, s[36:39], s40 offen offset:64
    v_dot2_f32_bf16 v96, v40, s71, v96
    v_dot2_f32_bf16 v97, v40, s72, v97
    v_dot2_f32_bf16 v98, v41, s71, v98
    v_dot2_f32_bf16 v99, v41, s72, v99
    v_dot2_f32_bf16 v100, v42, s71, v100
    v_dot2_f32_bf16 v101, v42, s72, v101
    v_dot2_f32_bf16 v102, v43, s71, v102
    v_dot2_f32_bf16 v103, v43, s72, v103
    s_nop 1
    v_cvt_pk_bf16_f32 v120, v96, v97
    v_cvt_pk_bf16_f32 v121, v98, v99
    v_cvt_pk_bf16_f32 v122, v100, v101
    v_cvt_pk_bf16_f32 v123, v102, v103
    v_lshlrev_b32 v96, 16, v120
    v_and_b32 v97, s34, v120
    v_lshlrev_b32 v98, 16, v121
    v_and_b32 v99, s34, v121
    v_lshlrev_b32 v100, 16, v122
    v_and_b32 v101, s34, v122
    v_lshlrev_b32 v102, 16, v123
    v_and_b32 v103, s34, v123
    v_mul_f32 v112, s35, v96
    v_mul_f32 v113, s35, v97
    v_mul_f32 v114, s35, v98
    v_mul_f32 v115, s35, v99
    v_mul_f32 v116, s35, v100
    v_mul_f32 v117, s35, v101
    v_mul_f32 v118, s35, v102
    v_mul_f32 v119, s35, v103
    v_exp_f32 v112, v112
    v_exp_f32 v113, v113
    v_exp_f32 v114, v114
    v_exp_f32 v115, v115
    v_exp_f32 v116, v116
    v_exp_f32 v117, v117
    v_exp_f32 v118, v118
    v_exp_f32 v119, v119
    v_add_f32 v112, 1.0, v112
    v_add_f32 v113, 1.0, v113
    v_add_f32 v114, 1.0, v114
    v_add_f32 v115, 1.0, v115
    v_add_f32 v116, 1.0, v116
    v_add_f32 v117, 1.0, v117
    v_add_f32 v118, 1.0, v118
    v_add_f32 v119, 1.0, v119
    v_rcp_f32 v112, v112
    v_rcp_f32 v113, v113
    v_rcp_f32 v114, v114
    v_rcp_f32 v115, v115
    v_rcp_f32 v116, v116
    v_rcp_f32 v117, v117
    v_rcp_f32 v118, v118
    v_rcp_f32 v119, v119
    v_mul_f32 v112, v96, v112
    v_mul_f32 v113, v97, v113
    v_mul_f32 v114, v98, v114
    v_mul_f32 v115, v99, v115
    v_mul_f32 v116, v100, v116
    v_mul_f32 v117, v101, v117
    v_mul_f32 v118, v102, v118
    v_mul_f32 v119, v103, v119
    v_cvt_pk_bf16_f32 v120, v112, v113
    v_cvt_pk_bf16_f32 v121, v114, v115
    v_cvt_pk_bf16_f32 v122, v116, v117
    v_cvt_pk_bf16_f32 v123, v118, v119
    s_nop 0
    v_permlane16_swap_b32 v120, v122
    v_permlane16_swap_b32 v121, v123
    s_nop 0
    v_dot2_f32_bf16 v112, v120, v48, 0
    v_dot2_f32_bf16 v113, v120, v49, 0
    v_dot2_f32_bf16 v114, v121, v50, 0
    v_dot2_f32_bf16 v115, v121, v51, 0
    v_dot2_f32_bf16 v116, v122, v52, 0
    v_dot2_f32_bf16 v117, v122, v53, 0
    v_dot2_f32_bf16 v118, v123, v54, 0
    v_dot2_f32_bf16 v119, v123, v55, 0
    s_nop 1
    v_cvt_pk_bf16_f32 v120, v112, v113
    v_cvt_pk_bf16_f32 v121, v114, v115
    v_cvt_pk_bf16_f32 v122, v116, v117
    v_cvt_pk_bf16_f32 v123, v118, v119
    s_nop 1
    v_dot2_f32_bf16 v112, v120, s71, v176
    v_dot2_f32_bf16 v113, v120, s72, v177
    v_dot2_f32_bf16 v114, v121, s71, v178
    v_dot2_f32_bf16 v115, v121, s72, v179
    v_dot2_f32_bf16 v116, v122, s71, v180
    v_dot2_f32_bf16 v117, v122, s72, v181
    v_dot2_f32_bf16 v118, v123, s71, v182
    v_dot2_f32_bf16 v119, v123, s72, v183
    s_nop 1
    v_cvt_pk_bf16_f32 v168, v112, v113
    v_cvt_pk_bf16_f32 v169, v114, v115
    v_cvt_pk_bf16_f32 v170, v116, v117
    v_cvt_pk_bf16_f32 v171, v118, v119
    buffer_store_dwordx4 v[168:171], v78, s[36:39], s40 offen offset:128
    v_dot2_f32_bf16 v104, v44, s71, v104
    v_dot2_f32_bf16 v105, v44, s72, v105
    v_dot2_f32_bf16 v106, v45, s71, v106
    v_dot2_f32_bf16 v107, v45, s72, v107
    v_dot2_f32_bf16 v108, v46, s71, v108
    v_dot2_f32_bf16 v109, v46, s72, v109
    v_dot2_f32_bf16 v110, v47, s71, v110
    v_dot2_f32_bf16 v111, v47, s72, v111
    s_nop 1
    v_cvt_pk_bf16_f32 v120, v104, v105
    v_cvt_pk_bf16_f32 v121, v106, v107
    v_cvt_pk_bf16_f32 v122, v108, v109
    v_cvt_pk_bf16_f32 v123, v110, v111
    v_lshlrev_b32 v104, 16, v120
    v_and_b32 v105, s34, v120
    v_lshlrev_b32 v106, 16, v121
    v_and_b32 v107, s34, v121
    v_lshlrev_b32 v108, 16, v122
    v_and_b32 v109, s34, v122
    v_lshlrev_b32 v110, 16, v123
    v_and_b32 v111, s34, v123
    v_mul_f32 v112, s35, v104
    v_mul_f32 v113, s35, v105
    v_mul_f32 v114, s35, v106
    v_mul_f32 v115, s35, v107
    v_mul_f32 v116, s35, v108
    v_mul_f32 v117, s35, v109
    v_mul_f32 v118, s35, v110
    v_mul_f32 v119, s35, v111
    v_exp_f32 v112, v112
    v_exp_f32 v113, v113
    v_exp_f32 v114, v114
    v_exp_f32 v115, v115
    v_exp_f32 v116, v116
    v_exp_f32 v117, v117
    v_exp_f32 v118, v118
    v_exp_f32 v119, v119
    v_add_f32 v112, 1.0, v112
    v_add_f32 v113, 1.0, v113
    v_add_f32 v114, 1.0, v114
    v_add_f32 v115, 1.0, v115
    v_add_f32 v116, 1.0, v116
    v_add_f32 v117, 1.0, v117
    v_add_f32 v118, 1.0, v118
    v_add_f32 v119, 1.0, v119
    v_rcp_f32 v112, v112
    v_rcp_f32 v113, v113
    v_rcp_f32 v114, v114
    v_rcp_f32 v115, v115
    v_rcp_f32 v116, v116
    v_rcp_f32 v117, v117
    v_rcp_f32 v118, v118
    v_rcp_f32 v119, v119
    v_mul_f32 v112, v104, v112
    v_mul_f32 v113, v105, v113
    v_mul_f32 v114, v106, v114
    v_mul_f32 v115, v107, v115
    v_mul_f32 v116, v108, v116
    v_mul_f32 v117, v109, v117
    v_mul_f32 v118, v110, v118
    v_mul_f32 v119, v111, v119
    v_cvt_pk_bf16_f32 v120, v112, v113
    v_cvt_pk_bf16_f32 v121, v114, v115
    v_cvt_pk_bf16_f32 v122, v116, v117
    v_cvt_pk_bf16_f32 v123, v118, v119
    s_nop 0
    v_permlane16_swap_b32 v120, v122
    v_permlane16_swap_b32 v121, v123
    s_nop 0
    v_dot2_f32_bf16 v112, v120, v56, 0
    v_dot2_f32_bf16 v113, v120, v57, 0
    v_dot2_f32_bf16 v114, v121, v58, 0
    v_dot2_f32_bf16 v115, v121, v59, 0
    v_dot2_f32_bf16 v116, v122, v60, 0
    v_dot2_f32_bf16 v117, v122, v61, 0
    v_dot2_f32_bf16 v118, v123, v62, 0
    v_dot2_f32_bf16 v119, v123, v63, 0
    s_nop 1
    v_cvt_pk_bf16_f32 v120, v112, v113
    v_cvt_pk_bf16_f32 v121, v114, v115
    v_cvt_pk_bf16_f32 v122, v116, v117
    v_cvt_pk_bf16_f32 v123, v118, v119
    s_nop 1
    v_dot2_f32_bf16 v112, v120, s71, v184
    v_dot2_f32_bf16 v113, v120, s72, v185
    v_dot2_f32_bf16 v114, v121, s71, v186
    v_dot2_f32_bf16 v115, v121, s72, v187
    v_dot2_f32_bf16 v116, v122, s71, v188
    v_dot2_f32_bf16 v117, v122, s72, v189
    v_dot2_f32_bf16 v118, v123, s71, v190
    v_dot2_f32_bf16 v119, v123, s72, v191
    s_nop 1
    v_cvt_pk_bf16_f32 v172, v112, v113
    v_cvt_pk_bf16_f32 v173, v114, v115
    v_cvt_pk_bf16_f32 v174, v116, v117
    v_cvt_pk_bf16_f32 v175, v118, v119
    buffer_store_dwordx4 v[172:175], v78, s[36:39], s40 offen offset:192
    s_endpgm
g4_loader:
    s_sub_u32 s25, s25, 4
    v_lshlrev_b32 v188, 4, v1
    s_lshl_b32 s26, s25, 12
    s_mul_i32 s41, s23, 917504
    s_mul_i32 s28, s24, 458752
    s_add_u32 s41, s41, s28
    s_add_u32 s41, s41, s26
    s_mov_b32 s31, 0
    s_add_u32 s27, s26, 131072
    s_waitcnt lgkmcnt(0)
    s_add_u32 s16, s8, 41943040
    s_addc_u32 s17, s9, 0
    s_mov_b32 s18, 7340032
    s_mov_b32 s19, 0x20000
    s_add_u32 m0, s31, s26
    s_add_u32 s31, s31, 16384
    buffer_load_dwordx4 v188, s[16:19], s41 offen offset:0 lds
    buffer_load_dwordx4 v188, s[16:19], s41 offen offset:1024 lds
    buffer_load_dwordx4 v188, s[16:19], s41 offen offset:2048 lds
    buffer_load_dwordx4 v188, s[16:19], s41 offen offset:3072 lds
    s_add_u32 s41, s41, 16384
    s_add_u32 m0, s31, s26
    s_add_u32 s31, s31, 16384
    buffer_load_dwordx4 v188, s[16:19], s41 offen offset:0 lds
    buffer_load_dwordx4 v188, s[16:19], s41 offen offset:1024 lds
    buffer_load_dwordx4 v188, s[16:19], s41 offen offset:2048 lds
    buffer_load_dwordx4 v188, s[16:19], s41 offen offset:3072 lds
    s_add_u32 s41, s41, 16384
    s_cmp_eq_u32 s31, 131072
    s_cselect_b32 s31, 0, s31
    v_mov_b32 v72, v1
    s_add_u32 s44, s8, 14680064
    s_addc_u32 s45, s9, 0
    s_mov_b32 s46, 4210688
    s_mov_b32 s47, 0x20000
    s_lshl_b32 s60, s25, 6
    v_add_u32 v176, s60, v72
    v_lshrrev_b32 v186, 1, v176
    v_lshlrev_b32 v186, 13, v186
    v_and_b32 v177, 1, v176
    v_lshlrev_b32 v177, 4, v177
    v_add_u32 v186, v186, v177
    s_lshl_b32 s60, s20, 5
    s_add_u32 s61, s60, 1048576
    s_add_u32 s62, s60, 2097152
    s_add_u32 s63, s60, 3145728
    s_add_u32 s64, s60, 16
    s_lshl_b32 s65, s25, 2
    s_add_u32 s64, s64, s65
    v_mov_b32 v187, 0
    buffer_load_dwordx4 v[144:147], v186, s[44:47], s60 offen
    buffer_load_dwordx4 v[148:151], v186, s[44:47], s61 offen
    buffer_load_dwordx4 v[152:155], v186, s[44:47], s62 offen
    buffer_load_dwordx4 v[156:159], v186, s[44:47], s63 offen
    buffer_load_dword v182, v187, s[44:47], s64 offen
    v_and_b32 v183, 1, v176
    v_lshlrev_b32 v183, 13, v183
    v_lshrrev_b32 v177, 1, v176
    v_lshlrev_b32 v177, 4, v177
    v_add_u32 v183, v183, v177
    v_add_u32 v183, 147456, v183
    v_and_b32 v184, 31, v72
    v_lshlrev_b32 v184, 4, v184
    v_lshrrev_b32 v177, 5, v72
    v_lshlrev_b32 v177, 11, v177
    v_add_u32 v184, v184, v177
    s_add_u32 s65, s65, 147456
    v_add_u32 v184, s65, v184
    v_lshlrev_b32 v185, 4, v72
    v_add_u32 v185, 131072, v185
    s_mov_b32 s67, 0x05040100
    s_mov_b32 s68, 0x07060302
    s_mov_b32 s69, 0xffff0000
    s_getpc_b64 s[48:49]
    s_add_u32 s48, s48, tab_f3@rel32@lo+4
    s_addc_u32 s49, s49, tab_f3@rel32@hi+12
    s_mov_b32 s50, 16384
    s_mov_b32 s51, 0x20000
    s_mov_b32 m0, s27
    s_nop 0
    buffer_load_dwordx4 v188, s[48:51], s26 offen offset:0 lds
    buffer_load_dwordx4 v188, s[48:51], s26 offen offset:1024 lds
    buffer_load_dwordx4 v188, s[48:51], s26 offen offset:2048 lds
    buffer_load_dwordx4 v188, s[48:51], s26 offen offset:3072 lds
    s_add_u32 m0, s31, s26
    s_add_u32 s31, s31, 16384
    buffer_load_dwordx4 v188, s[16:19], s41 offen offset:0 lds
    buffer_load_dwordx4 v188, s[16:19], s41 offen offset:1024 lds
    buffer_load_dwordx4 v188, s[16:19], s41 offen offset:2048 lds
    buffer_load_dwordx4 v188, s[16:19], s41 offen offset:3072 lds
    s_add_u32 s41, s41, 16384
    s_add_u32 m0, s31, s26
    s_add_u32 s31, s31, 16384
    buffer_load_dwordx4 v188, s[16:19], s41 offen offset:0 lds
    buffer_load_dwordx4 v188, s[16:19], s41 offen offset:1024 lds
    buffer_load_dwordx4 v188, s[16:19], s41 offen offset:2048 lds
    buffer_load_dwordx4 v188, s[16:19], s41 offen offset:3072 lds
    s_add_u32 s41, s41, 16384
    s_cmp_eq_u32 s31, 131072
    s_cselect_b32 s31, 0, s31
    s_add_u32 m0, s31, s26
    s_add_u32 s31, s31, 16384
    buffer_load_dwordx4 v188, s[16:19], s41 offen offset:0 lds
    buffer_load_dwordx4 v188, s[16:19], s41 offen offset:1024 lds
    buffer_load_dwordx4 v188, s[16:19], s41 offen offset:2048 lds
    buffer_load_dwordx4 v188, s[16:19], s41 offen offset:3072 lds
    s_add_u32 s41, s41, 16384
    s_add_u32 m0, s31, s26
    s_add_u32 s31, s31, 16384
    buffer_load_dwordx4 v188, s[16:19], s41 offen offset:0 lds
    buffer_load_dwordx4 v188, s[16:19], s41 offen offset:1024 lds
    buffer_load_dwordx4 v188, s[16:19], s41 offen offset:2048 lds
    buffer_load_dwordx4 v188, s[16:19], s41 offen offset:3072 lds
    s_add_u32 s41, s41, 16384
    s_cmp_eq_u32 s31, 131072
    s_cselect_b32 s31, 0, s31
    s_add_u32 s12, s8, 56623104
    s_addc_u32 s13, s9, 0
    s_mov_b32 s14, 4194304
    s_mov_b32 s15, 0x20000
    s_waitcnt vmcnt(25)
    s_barrier
    s_waitcnt vmcnt(20)
    ds_write_b128 v183, v[144:147] offset:0
    ds_write_b128 v183, v[148:151] offset:2048
    ds_write_b128 v183, v[152:155] offset:4096
    ds_write_b128 v183, v[156:159] offset:6144
    s_waitcnt lgkmcnt(0)
    s_waitcnt vmcnt(8)
    s_barrier
    s_add_u32 m0, s31, s26
    s_add_u32 s31, s31, 16384
    buffer_load_dwordx4 v188, s[16:19], s41 offen offset:0 lds
    buffer_load_dwordx4 v188, s[16:19], s41 offen offset:1024 lds
    buffer_load_dwordx4 v188, s[16:19], s41 offen offset:2048 lds
    buffer_load_dwordx4 v188, s[16:19], s41 offen offset:3072 lds
    s_add_u32 s41, s41, 16384
    s_add_u32 m0, s31, s26
    s_add_u32 s31, s31, 16384
    buffer_load_dwordx4 v188, s[16:19], s41 offen offset:0 lds
    buffer_load_dwordx4 v188, s[16:19], s41 offen offset:1024 lds
    buffer_load_dwordx4 v188, s[16:19], s41 offen offset:2048 lds
    buffer_load_dwordx4 v188, s[16:19], s41 offen offset:3072 lds
    s_add_u32 s41, s41, 16384
    s_cmp_eq_u32 s31, 131072
    s_cselect_b32 s31, 0, s31
    ds_read2st64_b32 v[160:161], v184 offset0:0 offset1:32
    ds_read2st64_b32 v[162:163], v184 offset0:2 offset1:34
    ds_read2st64_b32 v[164:165], v184 offset0:4 offset1:36
    ds_read2st64_b32 v[166:167], v184 offset0:6 offset1:38
    ds_read2st64_b32 v[168:169], v184 offset0:16 offset1:48
    ds_read2st64_b32 v[170:171], v184 offset0:18 offset1:50
    ds_read2st64_b32 v[172:173], v184 offset0:20 offset1:52
    ds_read2st64_b32 v[174:175], v184 offset0:22 offset1:54
    ds_read_b128 a[0:3], v185 offset:0
    ds_read_b128 a[4:7], v185 offset:1024
    ds_read_b128 a[8:11], v185 offset:2048
    ds_read_b128 a[12:15], v185 offset:3072
    ds_read_b128 v[112:115], v185 offset:8192
    ds_read_b128 v[116:119], v185 offset:9216
    ds_read_b128 v[120:123], v185 offset:10240
    ds_read_b128 v[124:127], v185 offset:11264
    ds_read_b128 v[128:131], v185 offset:12288
    ds_read_b128 v[132:135], v185 offset:13312
    ds_read_b128 v[136:139], v185 offset:14336
    ds_read_b128 v[140:143], v185 offset:15360
    ds_read_b128 a[16:19], v185 offset:4096
    ds_read_b128 a[20:23], v185 offset:5120
    ds_read_b128 a[24:27], v185 offset:6144
    ds_read_b128 a[28:31], v185 offset:7168
    s_waitcnt lgkmcnt(12)
    v_perm_b32 v144, v161, v160, s67
    v_perm_b32 v152, v161, v160, s68
    v_perm_b32 v145, v163, v162, s67
    v_perm_b32 v153, v163, v162, s68
    v_perm_b32 v146, v165, v164, s67
    v_perm_b32 v154, v165, v164, s68
    v_perm_b32 v147, v167, v166, s67
    v_perm_b32 v155, v167, v166, s68
    v_perm_b32 v148, v169, v168, s67
    v_perm_b32 v156, v169, v168, s68
    v_perm_b32 v149, v171, v170, s67
    v_perm_b32 v157, v171, v170, s68
    v_perm_b32 v150, v173, v172, s67
    v_perm_b32 v158, v173, v172, s68
    v_perm_b32 v151, v175, v174, s67
    v_perm_b32 v159, v175, v174, s68
    v_mfma_f32_32x32x16_bf16 v[0:15], v[144:147], a[0:3], 0
    v_mfma_f32_32x32x16_bf16 v[16:31], v[144:147], a[8:11], 0
    v_mfma_f32_32x32x16_bf16 v[32:47], v[152:155], a[0:3], 0
    v_mfma_f32_32x32x16_bf16 v[48:63], v[152:155], a[8:11], 0
    v_mfma_f32_32x32x16_bf16 v[0:15], v[148:151], a[4:7], v[0:15]
    v_mfma_f32_32x32x16_bf16 v[16:31], v[148:151], a[12:15], v[16:31]
    v_mfma_f32_32x32x16_bf16 v[32:47], v[156:159], a[4:7], v[32:47]
    v_mfma_f32_32x32x16_bf16 v[48:63], v[156:159], a[12:15], v[48:63]
    v_and_b32 v183, 31, v72
    v_lshlrev_b32 v183, 6, v183
    v_lshrrev_b32 v184, 5, v72
    v_lshlrev_b32 v184, 4, v184
    v_add_u32 v183, v183, v184
    s_lshl_b32 s60, s20, 3
    s_lshl_b32 s61, s25, 1
    s_add_u32 s60, s60, s61
    s_lshl_b32 s60, s60, 11
    s_add_u32 s61, s60, 2048
    v_lshlrev_b32 v180, 16, v182
    v_and_b32 v181, s69, v182
    v_mul_f32 v180, 0x35000000, v180
    v_mul_f32 v181, 0x35000000, v181
    s_waitcnt lgkmcnt(0)
    v_mul_f32 v176, v16, v128
    v_mul_f32 v177, v16, v112
    v_fma_f32 v16, v0, v128, v177
    v_fma_f32 v0, v0, v112, -v176
    v_mul_f32 v178, v17, v129
    v_mul_f32 v179, v17, v113
    v_fma_f32 v17, v1, v129, v179
    v_fma_f32 v1, v1, v113, -v178
    v_cvt_pk_bf16_f32 v160, v0, v1
    v_cvt_pk_bf16_f32 v168, v16, v17
    v_mul_f32 v176, v18, v130
    v_mul_f32 v177, v18, v114
    v_fma_f32 v18, v2, v130, v177
    v_fma_f32 v2, v2, v114, -v176
    v_mul_f32 v178, v19, v131
    v_mul_f32 v179, v19, v115
    v_fma_f32 v19, v3, v131, v179
    v_fma_f32 v3, v3, v115, -v178
    v_cvt_pk_bf16_f32 v161, v2, v3
    v_cvt_pk_bf16_f32 v169, v18, v19
    v_mul_f32 v176, v20, v132
    v_mul_f32 v177, v20, v116
    v_fma_f32 v20, v4, v132, v177
    v_fma_f32 v4, v4, v116, -v176
    v_mul_f32 v178, v21, v133
    v_mul_f32 v179, v21, v117
    v_fma_f32 v21, v5, v133, v179
    v_fma_f32 v5, v5, v117, -v178
    v_cvt_pk_bf16_f32 v162, v4, v5
    v_cvt_pk_bf16_f32 v170, v20, v21
    v_mul_f32 v176, v22, v134
    v_mul_f32 v177, v22, v118
    v_fma_f32 v22, v6, v134, v177
    v_fma_f32 v6, v6, v118, -v176
    v_mul_f32 v178, v23, v135
    v_mul_f32 v179, v23, v119
    v_fma_f32 v23, v7, v135, v179
    v_fma_f32 v7, v7, v119, -v178
    v_cvt_pk_bf16_f32 v163, v6, v7
    v_cvt_pk_bf16_f32 v171, v22, v23
    v_mul_f32 v176, v24, v136
    v_mul_f32 v177, v24, v120
    v_fma_f32 v24, v8, v136, v177
    v_fma_f32 v8, v8, v120, -v176
    v_mul_f32 v178, v25, v137
    v_mul_f32 v179, v25, v121
    v_fma_f32 v25, v9, v137, v179
    v_fma_f32 v9, v9, v121, -v178
    v_cvt_pk_bf16_f32 v164, v8, v9
    v_cvt_pk_bf16_f32 v172, v24, v25
    v_mul_f32 v176, v26, v138
    v_mul_f32 v177, v26, v122
    v_fma_f32 v26, v10, v138, v177
    v_fma_f32 v10, v10, v122, -v176
    v_mul_f32 v178, v27, v139
    v_mul_f32 v179, v27, v123
    v_fma_f32 v27, v11, v139, v179
    v_fma_f32 v11, v11, v123, -v178
    v_cvt_pk_bf16_f32 v165, v10, v11
    v_cvt_pk_bf16_f32 v173, v26, v27
    v_mul_f32 v176, v28, v140
    v_mul_f32 v177, v28, v124
    v_fma_f32 v28, v12, v140, v177
    v_fma_f32 v12, v12, v124, -v176
    v_mul_f32 v178, v29, v141
    v_mul_f32 v179, v29, v125
    v_fma_f32 v29, v13, v141, v179
    v_fma_f32 v13, v13, v125, -v178
    v_cvt_pk_bf16_f32 v166, v12, v13
    v_cvt_pk_bf16_f32 v174, v28, v29
    v_mul_f32 v176, v30, v142
    v_mul_f32 v177, v30, v126
    v_fma_f32 v30, v14, v142, v177
    v_fma_f32 v14, v14, v126, -v176
    v_mul_f32 v178, v31, v143
    v_mul_f32 v179, v31, v127
    v_fma_f32 v31, v15, v143, v179
    v_fma_f32 v15, v15, v127, -v178
    v_cvt_pk_bf16_f32 v167, v14, v15
    v_cvt_pk_bf16_f32 v175, v30, v31
    v_mfma_f32_32x32x16_bf16 v[0:15], v[160:163], a[16:19], 0
    v_mfma_f32_32x32x16_bf16 v[0:15], v[164:167], a[20:23], v[0:15]
    v_mfma_f32_32x32x16_bf16 v[0:15], v[168:171], a[24:27], v[0:15]
    v_mfma_f32_32x32x16_bf16 v[0:15], v[172:175], a[28:31], v[0:15]
    s_waitcnt vmcnt(8)
    s_barrier
    s_add_u32 m0, s31, s26
    s_add_u32 s31, s31, 16384
    buffer_load_dwordx4 v188, s[16:19], s41 offen offset:0 lds
    buffer_load_dwordx4 v188, s[16:19], s41 offen offset:1024 lds
    buffer_load_dwordx4 v188, s[16:19], s41 offen offset:2048 lds
    buffer_load_dwordx4 v188, s[16:19], s41 offen offset:3072 lds
    s_add_u32 s41, s41, 16384
    s_add_u32 m0, s31, s26
    s_add_u32 s31, s31, 16384
    buffer_load_dwordx4 v188, s[16:19], s41 offen offset:0 lds
    buffer_load_dwordx4 v188, s[16:19], s41 offen offset:1024 lds
    buffer_load_dwordx4 v188, s[16:19], s41 offen offset:2048 lds
    buffer_load_dwordx4 v188, s[16:19], s41 offen offset:3072 lds
    s_add_u32 s41, s41, 16384
    s_cmp_eq_u32 s31, 131072
    s_cselect_b32 s31, 0, s31
    v_mul_f32 v176, v48, v128
    v_mul_f32 v177, v48, v112
    v_fma_f32 v48, v32, v128, v177
    v_fma_f32 v32, v32, v112, -v176
    v_mul_f32 v178, v49, v129
    v_mul_f32 v179, v49, v113
    v_fma_f32 v49, v33, v129, v179
    v_fma_f32 v33, v33, v113, -v178
    v_cvt_pk_bf16_f32 v144, v32, v33
    v_cvt_pk_bf16_f32 v152, v48, v49
    v_mul_f32 v176, v50, v130
    v_mul_f32 v177, v50, v114
    v_fma_f32 v50, v34, v130, v177
    v_fma_f32 v34, v34, v114, -v176
    v_mul_f32 v178, v51, v131
    v_mul_f32 v179, v51, v115
    v_fma_f32 v51, v35, v131, v179
    v_fma_f32 v35, v35, v115, -v178
    v_cvt_pk_bf16_f32 v145, v34, v35
    v_cvt_pk_bf16_f32 v153, v50, v51
    v_mul_f32 v176, v52, v132
    v_mul_f32 v177, v52, v116
    v_fma_f32 v52, v36, v132, v177
    v_fma_f32 v36, v36, v116, -v176
    v_mul_f32 v178, v53, v133
    v_mul_f32 v179, v53, v117
    v_fma_f32 v53, v37, v133, v179
    v_fma_f32 v37, v37, v117, -v178
    v_cvt_pk_bf16_f32 v146, v36, v37
    v_cvt_pk_bf16_f32 v154, v52, v53
    v_mul_f32 v176, v54, v134
    v_mul_f32 v177, v54, v118
    v_fma_f32 v54, v38, v134, v177
    v_fma_f32 v38, v38, v118, -v176
    v_mul_f32 v178, v55, v135
    v_mul_f32 v179, v55, v119
    v_fma_f32 v55, v39, v135, v179
    v_fma_f32 v39, v39, v119, -v178
    v_cvt_pk_bf16_f32 v147, v38, v39
    v_cvt_pk_bf16_f32 v155, v54, v55
    v_mul_f32 v176, v56, v136
    v_mul_f32 v177, v56, v120
    v_fma_f32 v56, v40, v136, v177
    v_fma_f32 v40, v40, v120, -v176
    v_mul_f32 v178, v57, v137
    v_mul_f32 v179, v57, v121
    v_fma_f32 v57, v41, v137, v179
    v_fma_f32 v41, v41, v121, -v178
    v_cvt_pk_bf16_f32 v148, v40, v41
    v_cvt_pk_bf16_f32 v156, v56, v57
    v_mul_f32 v176, v58, v138
    v_mul_f32 v177, v58, v122
    v_fma_f32 v58, v42, v138, v177
    v_fma_f32 v42, v42, v122, -v176
    v_mul_f32 v178, v59, v139
    v_mul_f32 v179, v59, v123
    v_fma_f32 v59, v43, v139, v179
    v_fma_f32 v43, v43, v123, -v178
    v_cvt_pk_bf16_f32 v149, v42, v43
    v_cvt_pk_bf16_f32 v157, v58, v59
    v_mul_f32 v176, v60, v140
    v_mul_f32 v177, v60, v124
    v_fma_f32 v60, v44, v140, v177
    v_fma_f32 v44, v44, v124, -v176
    v_mul_f32 v178, v61, v141
    v_mul_f32 v179, v61, v125
    v_fma_f32 v61, v45, v141, v179
    v_fma_f32 v45, v45, v125, -v178
    v_cvt_pk_bf16_f32 v150, v44, v45
    v_cvt_pk_bf16_f32 v158, v60, v61
    v_mul_f32 v176, v62, v142
    v_mul_f32 v177, v62, v126
    v_fma_f32 v62, v46, v142, v177
    v_fma_f32 v46, v46, v126, -v176
    v_mul_f32 v178, v63, v143
    v_mul_f32 v179, v63, v127
    v_fma_f32 v63, v47, v143, v179
    v_fma_f32 v47, v47, v127, -v178
    v_cvt_pk_bf16_f32 v151, v46, v47
    v_cvt_pk_bf16_f32 v159, v62, v63
    v_mfma_f32_32x32x16_bf16 v[32:47], v[144:147], a[16:19], 0
    v_mfma_f32_32x32x16_bf16 v[32:47], v[148:151], a[20:23], v[32:47]
    v_mfma_f32_32x32x16_bf16 v[32:47], v[152:155], a[24:27], v[32:47]
    v_mfma_f32_32x32x16_bf16 v[32:47], v[156:159], a[28:31], v[32:47]
    s_lshl_b32 s62, s25, 12
    s_add_u32 s62, s62, 147456
    v_add_u32 v176, s62, v183
    v_lshlrev_b32 v177, 4, v72
    v_add_u32 v177, s62, v177
    v_add_f32 v0, v0, v180
    v_sub_f32 v1, v1, v180
    v_add_f32 v2, v2, v180
    v_sub_f32 v3, v3, v180
    v_add_f32 v4, v4, v180
    v_sub_f32 v5, v5, v180
    v_add_f32 v6, v6, v180
    v_sub_f32 v7, v7, v180
    v_add_f32 v8, v8, v180
    v_sub_f32 v9, v9, v180
    v_add_f32 v10, v10, v180
    v_sub_f32 v11, v11, v180
    v_add_f32 v12, v12, v180
    v_sub_f32 v13, v13, v180
    v_add_f32 v14, v14, v180
    v_sub_f32 v15, v15, v180
    v_cvt_pk_bf16_f32 v160, v0, v1
    v_cvt_pk_bf16_f32 v161, v2, v3
    v_cvt_pk_bf16_f32 v162, v4, v5
    v_cvt_pk_bf16_f32 v163, v6, v7
    s_nop 0
    v_permlane32_swap_b32 v160, v162
    v_permlane32_swap_b32 v161, v163
    ds_write_b128 v176, v[160:163] offset:0
    v_cvt_pk_bf16_f32 v164, v8, v9
    v_cvt_pk_bf16_f32 v165, v10, v11
    v_cvt_pk_bf16_f32 v166, v12, v13
    v_cvt_pk_bf16_f32 v167, v14, v15
    s_nop 0
    v_permlane32_swap_b32 v164, v166
    v_permlane32_swap_b32 v165, v167
    ds_write_b128 v176, v[164:167] offset:32
    v_add_f32 v32, v32, v181
    v_sub_f32 v33, v33, v181
    v_add_f32 v34, v34, v181
    v_sub_f32 v35, v35, v181
    v_add_f32 v36, v36, v181
    v_sub_f32 v37, v37, v181
    v_add_f32 v38, v38, v181
    v_sub_f32 v39, v39, v181
    v_add_f32 v40, v40, v181
    v_sub_f32 v41, v41, v181
    v_add_f32 v42, v42, v181
    v_sub_f32 v43, v43, v181
    v_add_f32 v44, v44, v181
    v_sub_f32 v45, v45, v181
    v_add_f32 v46, v46, v181
    v_sub_f32 v47, v47, v181
    v_cvt_pk_bf16_f32 v168, v32, v33
    v_cvt_pk_bf16_f32 v169, v34, v35
    v_cvt_pk_bf16_f32 v170, v36, v37
    v_cvt_pk_bf16_f32 v171, v38, v39
    s_nop 0
    v_permlane32_swap_b32 v168, v170
    v_permlane32_swap_b32 v169, v171
    ds_write_b128 v176, v[168:171] offset:2048
    v_cvt_pk_bf16_f32 v172, v40, v41
    v_cvt_pk_bf16_f32 v173, v42, v43
    v_cvt_pk_bf16_f32 v174, v44, v45
    v_cvt_pk_bf16_f32 v175, v46, v47
    s_nop 0
    v_permlane32_swap_b32 v172, v174
    v_permlane32_swap_b32 v173, v175
    ds_write_b128 v176, v[172:175] offset:2080
    s_waitcnt lgkmcnt(0)
    ds_read_b128 v[160:163], v177 offset:0
    ds_read_b128 v[164:167], v177 offset:1024
    ds_read_b128 v[168:171], v177 offset:2048
    ds_read_b128 v[172:175], v177 offset:3072
    s_waitcnt vmcnt(8)
    s_barrier
    s_add_u32 m0, s31, s26
    s_add_u32 s31, s31, 16384
    buffer_load_dwordx4 v188, s[16:19], s41 offen offset:0 lds
    buffer_load_dwordx4 v188, s[16:19], s41 offen offset:1024 lds
    buffer_load_dwordx4 v188, s[16:19], s41 offen offset:2048 lds
    buffer_load_dwordx4 v188, s[16:19], s41 offen offset:3072 lds
    s_add_u32 s41, s41, 16384
    s_add_u32 m0, s31, s26
    s_add_u32 s31, s31, 16384
    buffer_load_dwordx4 v188, s[16:19], s41 offen offset:0 lds
    buffer_load_dwordx4 v188, s[16:19], s41 offen offset:1024 lds
    buffer_load_dwordx4 v188, s[16:19], s41 offen offset:2048 lds
    buffer_load_dwordx4 v188, s[16:19], s41 offen offset:3072 lds
    s_add_u32 s41, s41, 16384
    s_cmp_eq_u32 s31, 131072
    s_cselect_b32 s31, 0, s31
    s_waitcnt lgkmcnt(3)
    buffer_store_dwordx4 v[160:163], v188, s[12:15], s60 offen offset:0 sc1
    s_waitcnt lgkmcnt(2)
    buffer_store_dwordx4 v[164:167], v188, s[12:15], s60 offen offset:1024 sc1
    s_waitcnt lgkmcnt(1)
    buffer_store_dwordx4 v[168:171], v188, s[12:15], s61 offen offset:0 sc1
    s_waitcnt lgkmcnt(0)
    buffer_store_dwordx4 v[172:175], v188, s[12:15], s61 offen offset:1024 sc1
    s_waitcnt vmcnt(12)
    s_barrier
    s_add_u32 m0, s31, s26
    s_add_u32 s31, s31, 16384
    buffer_load_dwordx4 v188, s[16:19], s41 offen offset:0 lds
    buffer_load_dwordx4 v188, s[16:19], s41 offen offset:1024 lds
    buffer_load_dwordx4 v188, s[16:19], s41 offen offset:2048 lds
    buffer_load_dwordx4 v188, s[16:19], s41 offen offset:3072 lds
    s_add_u32 s41, s41, 16384
    s_add_u32 m0, s31, s26
    s_add_u32 s31, s31, 16384
    buffer_load_dwordx4 v188, s[16:19], s41 offen offset:0 lds
    buffer_load_dwordx4 v188, s[16:19], s41 offen offset:1024 lds
    buffer_load_dwordx4 v188, s[16:19], s41 offen offset:2048 lds
    buffer_load_dwordx4 v188, s[16:19], s41 offen offset:3072 lds
    s_add_u32 s41, s41, 16384
    s_cmp_eq_u32 s31, 131072
    s_cselect_b32 s31, 0, s31
    s_waitcnt vmcnt(12)
    s_barrier
    s_add_u32 m0, s31, s26
    s_add_u32 s31, s31, 16384
    buffer_load_dwordx4 v188, s[16:19], s41 offen offset:0 lds
    buffer_load_dwordx4 v188, s[16:19], s41 offen offset:1024 lds
    buffer_load_dwordx4 v188, s[16:19], s41 offen offset:2048 lds
    buffer_load_dwordx4 v188, s[16:19], s41 offen offset:3072 lds
    s_add_u32 s41, s41, 16384
    s_add_u32 m0, s31, s26
    s_add_u32 s31, s31, 16384
    buffer_load_dwordx4 v188, s[16:19], s41 offen offset:0 lds
    buffer_load_dwordx4 v188, s[16:19], s41 offen offset:1024 lds
    buffer_load_dwordx4 v188, s[16:19], s41 offen offset:2048 lds
    buffer_load_dwordx4 v188, s[16:19], s41 offen offset:3072 lds
    s_add_u32 s41, s41, 16384
    s_cmp_eq_u32 s31, 131072
    s_cselect_b32 s31, 0, s31
    s_waitcnt vmcnt(8)
    s_barrier
    s_add_u32 m0, s31, s26
    s_add_u32 s31, s31, 16384
    buffer_load_dwordx4 v188, s[16:19], s41 offen offset:0 lds
    buffer_load_dwordx4 v188, s[16:19], s41 offen offset:1024 lds
    buffer_load_dwordx4 v188, s[16:19], s41 offen offset:2048 lds
    buffer_load_dwordx4 v188, s[16:19], s41 offen offset:3072 lds
    s_add_u32 s41, s41, 16384
    s_add_u32 m0, s31, s26
    s_add_u32 s31, s31, 16384
    buffer_load_dwordx4 v188, s[16:19], s41 offen offset:0 lds
    buffer_load_dwordx4 v188, s[16:19], s41 offen offset:1024 lds
    buffer_load_dwordx4 v188, s[16:19], s41 offen offset:2048 lds
    buffer_load_dwordx4 v188, s[16:19], s41 offen offset:3072 lds
    s_add_u32 s41, s41, 16384
    s_cmp_eq_u32 s31, 131072
    s_cselect_b32 s31, 0, s31
    s_cmp_lg_u32 s25, 0
    s_cbranch_scc1 g4_nosig
    s_lshr_b32 s60, s20, 2
    s_lshl_b32 s60, s60, 2
    v_mov_b32 v8, s60
    v_mov_b32 v9, 1
    s_mov_b64 exec, 1
    global_atomic_add v8, v9, s[54:55] sc1
    s_mov_b64 exec, -1
g4_nosig:
    s_mov_b32 s30, 6
g4_lloop:
    s_waitcnt vmcnt(8)
    s_barrier
    s_add_u32 m0, s31, s26
    s_add_u32 s31, s31, 16384
    buffer_load_dwordx4 v188, s[16:19], s41 offen offset:0 lds
    buffer_load_dwordx4 v188, s[16:19], s41 offen offset:1024 lds
    buffer_load_dwordx4 v188, s[16:19], s41 offen offset:2048 lds
    buffer_load_dwordx4 v188, s[16:19], s41 offen offset:3072 lds
    s_add_u32 s41, s41, 16384
    s_add_u32 m0, s31, s26
    s_add_u32 s31, s31, 16384
    buffer_load_dwordx4 v188, s[16:19], s41 offen offset:0 lds
    buffer_load_dwordx4 v188, s[16:19], s41 offen offset:1024 lds
    buffer_load_dwordx4 v188, s[16:19], s41 offen offset:2048 lds
    buffer_load_dwordx4 v188, s[16:19], s41 offen offset:3072 lds
    s_add_u32 s41, s41, 16384
    s_cmp_eq_u32 s31, 131072
    s_cselect_b32 s31, 0, s31
    s_add_u32 s30, s30, 1
    s_cmp_lt_u32 s30, 10
    s_cbranch_scc1 g4_lloop
    s_waitcnt vmcnt(8)
    s_barrier
    v_and_b32 v8, 3, v72
    v_lshlrev_b32 v8, 2, v8
    s_lshl_b32 s60, s22, 4
    v_add_u32 v8, s60, v8
    global_load_dword v9, v8, s[54:55] sc1
    s_add_u32 m0, s31, s26
    s_add_u32 s31, s31, 16384
    buffer_load_dwordx4 v188, s[16:19], s41 offen offset:0 lds
    buffer_load_dwordx4 v188, s[16:19], s41 offen offset:1024 lds
    buffer_load_dwordx4 v188, s[16:19], s41 offen offset:2048 lds
    buffer_load_dwordx4 v188, s[16:19], s41 offen offset:3072 lds
    s_add_u32 s41, s41, 16384
    s_add_u32 m0, s31, s26
    s_add_u32 s31, s31, 16384
    buffer_load_dwordx4 v188, s[16:19], s41 offen offset:0 lds
    buffer_load_dwordx4 v188, s[16:19], s41 offen offset:1024 lds
    buffer_load_dwordx4 v188, s[16:19], s41 offen offset:2048 lds
    buffer_load_dwordx4 v188, s[16:19], s41 offen offset:3072 lds
    s_add_u32 s41, s41, 16384
    s_cmp_eq_u32 s31, 131072
    s_cselect_b32 s31, 0, s31
    s_waitcnt vmcnt(8)
    v_cmp_gt_u32 vcc, 4, v9
    s_nop 3
    s_cmp_eq_u64 vcc, 0
    s_cbranch_scc1 g4_ready
    s_mov_b32 s70, 0
g4_poll:
    s_add_u32 s70, s70, 1
    s_cmp_ge_u32 s70, 400000
    s_cbranch_scc1 g4_ready
    s_sleep 1
    global_load_dword v9, v8, s[54:55] sc1
    s_waitcnt vmcnt(0)
    v_cmp_gt_u32 vcc, 4, v9
    s_nop 3
    s_cmp_eq_u64 vcc, 0
    s_cbranch_scc0 g4_poll
g4_ready:
    s_barrier
    s_waitcnt vmcnt(0)
    s_barrier
    s_endpgm
k3_done:
    s_endpgm
code_end:
.section .rodata,"a"
.p2align 6
.amdhsa_kernel ka_kernel
  .amdhsa_next_free_vgpr 256
  .amdhsa_next_free_sgpr 102
  .amdhsa_accum_offset 256
  .amdhsa_group_segment_fixed_size 0
  .amdhsa_kernarg_size 72
  .amdhsa_user_sgpr_count 2
  .amdhsa_user_sgpr_kernarg_segment_ptr 1
  .amdhsa_system_sgpr_workgroup_id_x 1
  .amdhsa_float_denorm_mode_32 3
.end_amdhsa_kernel
.section .rodata,"a"
.p2align 6
.amdhsa_kernel k3_kernel
  .amdhsa_next_free_vgpr 256
  .amdhsa_next_free_sgpr 102
  .amdhsa_accum_offset 192
  .amdhsa_group_segment_fixed_size 0
  .amdhsa_kernarg_size 72
  .amdhsa_user_sgpr_count 2
  .amdhsa_user_sgpr_kernarg_segment_ptr 1
  .amdhsa_system_sgpr_workgroup_id_x 1
  .amdhsa_float_denorm_mode_32 3
.end_amdhsa_kernel
.section .rodata,"a"
.p2align 8
.type tab_f1,@object
tab_f1:
.long 0x3f803f80,0x3f803f80,0x3f803f80,0x3f803f80,0x3f7b3f80,0x3f553f6d,0x3f0e3f35,0x3e483ec4
.long 0x3f6d3f80,0x3ec43f35,0xbec4248d,0xbf6dbf35,0x3f553f80,0xbe483ec4,0xbf7bbf35,0xbf0ebf6d
.long 0x3f353f80,0xbf35248d,0xbf35bf80,0x3f35a554,0x3f0e3f80,0xbf7bbec4,0x3e48bf35,0x3f553f6d
.long 0x3ec43f80,0xbf6dbf35,0x3f6da554,0xbec43f35,0x3e483f80,0xbf0ebf6d,0x3f553f35,0xbf7bbec4
.long 0x248d3f80,0xa554bf80,0x248d3f80,0xa554bf80,0xbe483f80,0x3f0ebf6d,0xbf553f35,0x3f7bbec4
.long 0xbec43f80,0x3f6dbf35,0xbf6d248d,0x3ec43f35,0xbf0e3f80,0x3f7bbec4,0xbe48bf35,0xbf553f6d
.long 0xbf353f80,0x3f35a554,0x3f35bf80,0xbf35248d,0xbf553f80,0x3e483ec4,0x3f7bbf35,0x3f0ebf6d
.long 0xbf6d3f80,0xbec43f35,0x3ec4a554,0x3f6dbf35,0xbf7b3f80,0xbf553f6d,0xbf0e3f35,0xbe483ec4
.long 0xbf803f80,0xbf803f80,0xbf803f80,0xbf803f80,0xbf7b3f80,0xbf553f6d,0xbf0e3f35,0xbe483ec4
.long 0xbf6d3f80,0xbec43f35,0x3ec4248d,0x3f6dbf35,0xbf553f80,0x3e483ec4,0x3f7bbf35,0x3f0ebf6d
.long 0xbf353f80,0x3f35248d,0x3f35bf80,0xbf35a554,0xbf0e3f80,0x3f7bbec4,0xbe48bf35,0xbf553f6d
.long 0xbec43f80,0x3f6dbf35,0xbf6da554,0x3ec43f35,0xbe483f80,0x3f0ebf6d,0xbf553f35,0x3f7bbec4
.long 0xa5543f80,0x248dbf80,0xa5543f80,0x248dbf80,0x3e483f80,0xbf0ebf6d,0x3f553f35,0xbf7bbec4
.long 0x3ec43f80,0xbf6dbf35,0x3f6d248d,0xbec43f35,0x3f0e3f80,0xbf7bbec4,0x3e48bf35,0x3f553f6d
.long 0x3f353f80,0xbf35a554,0xbf35bf80,0x3f35248d,0x3f553f80,0xbe483ec4,0xbf7bbf35,0xbf0ebf6d
.long 0x3f6d3f80,0x3ec43f35,0xbec4a554,0xbf6dbf35,0x3f7b3f80,0x3f553f6d,0x3f0e3f35,0x3e483ec4
.long 0x3f803f80,0x3f803f80,0x3f803f80,0x3f803f80,0xbe48248d,0xbf0ebec4,0xbf55bf35,0xbf7bbf6d
.long 0xbf6dbf80,0xbec4bf35,0x3ec4a554,0x3f6d3f35,0x3f0ea554,0x3f7b3f6d,0x3e483f35,0xbf55bec4
.long 0x3f353f80,0xbf35248d,0xbf35bf80,0x3f35a554,0xbf55248d,0xbe48bf6d,0x3f7b3f35,0xbf0e3ec4
.long 0xbec4bf80,0x3f6d3f35,0xbf6d248d,0x3ec4bf35,0x3f7ba554,0xbf553ec4,0x3f0ebf35,0xbe483f6d
.long 0x248d3f80,0xa554bf80,0x248d3f80,0xa554bf80,0xbf7b248d,0x3f553ec4,0xbf0ebf35,0x3e483f6d
.long 0x3ec4bf80,0xbf6d3f35,0x3f6da554,0xbec4bf35,0x3f55a554,0x3e48bf6d,0xbf7b3f35,0x3f0e3ec4
.long 0xbf353f80,0x3f35a554,0x3f35bf80,0xbf35248d,0xbf0e248d,0xbf7b3f6d,0xbe483f35,0x3f55bec4
.long 0x3f6dbf80,0x3ec4bf35,0xbec4248d,0xbf6d3f35,0x3e48a554,0x3f0ebec4,0x3f55bf35,0x3f7bbf6d
.long 0xbf803f80,0xbf803f80,0xbf803f80,0xbf803f80,0x3e48248d,0x3f0ebec4,0x3f55bf35,0x3f7bbf6d
.long 0x3f6dbf80,0x3ec4bf35,0xbec4a554,0xbf6d3f35,0xbf0ea554,0xbf7b3f6d,0xbe483f35,0x3f55bec4
.long 0xbf353f80,0x3f35248d,0x3f35bf80,0xbf35a554,0x3f55248d,0x3e48bf6d,0xbf7b3f35,0x3f0e3ec4
.long 0x3ec4bf80,0xbf6d3f35,0x3f6d248d,0xbec4bf35,0xbf7ba554,0x3f553ec4,0xbf0ebf35,0x3e483f6d
.long 0xa5543f80,0x248dbf80,0xa5543f80,0x248dbf80,0x3f7b248d,0xbf553ec4,0x3f0ebf35,0xbe483f6d
.long 0xbec4bf80,0x3f6d3f35,0xbf6da554,0x3ec4bf35,0xbf55a554,0xbe48bf6d,0x3f7b3f35,0xbf0e3ec4
.long 0x3f353f80,0xbf35a554,0xbf35bf80,0x3f35248d,0x3f0e248d,0x3f7b3f6d,0x3e483f35,0xbf55bec4
.long 0xbf6dbf80,0xbec4bf35,0x3ec4248d,0x3f6d3f35,0xbe48a554,0xbf0ebec4,0xbf55bf35,0xbf7bbf6d
.long 0x3f803f80,0x3f803f80,0x3f803f80,0x3f803f80,0xbf7bbf80,0xbf55bf6d,0xbf0ebf35,0xbe48bec4
.long 0x3f6d3f80,0x3ec43f35,0xbec4248d,0xbf6dbf35,0xbf55bf80,0x3e48bec4,0x3f7b3f35,0x3f0e3f6d
.long 0x3f353f80,0xbf35248d,0xbf35bf80,0x3f35a554,0xbf0ebf80,0x3f7b3ec4,0xbe483f35,0xbf55bf6d
.long 0x3ec43f80,0xbf6dbf35,0x3f6da554,0xbec43f35,0xbe48bf80,0x3f0e3f6d,0xbf55bf35,0x3f7b3ec4
.long 0x248d3f80,0xa554bf80,0x248d3f80,0xa554bf80,0x3e48bf80,0xbf0e3f6d,0x3f55bf35,0xbf7b3ec4
.long 0xbec43f80,0x3f6dbf35,0xbf6d248d,0x3ec43f35,0x3f0ebf80,0xbf7b3ec4,0x3e483f35,0x3f55bf6d
.long 0xbf353f80,0x3f35a554,0x3f35bf80,0xbf35248d,0x3f55bf80,0xbe48bec4,0xbf7b3f35,0xbf0e3f6d
.long 0xbf6d3f80,0xbec43f35,0x3ec4a554,0x3f6dbf35,0x3f7bbf80,0x3f55bf6d,0x3f0ebf35,0x3e48bec4
.long 0xbf803f80,0xbf803f80,0xbf803f80,0xbf803f80,0x3f7bbf80,0x3f55bf6d,0x3f0ebf35,0x3e48bec4
.long 0xbf6d3f80,0xbec43f35,0x3ec4248d,0x3f6dbf35,0x3f55bf80,0xbe48bec4,0xbf7b3f35,0xbf0e3f6d
.long 0xbf353f80,0x3f35248d,0x3f35bf80,0xbf35a554,0x3f0ebf80,0xbf7b3ec4,0x3e483f35,0x3f55bf6d
.long 0xbec43f80,0x3f6dbf35,0xbf6da554,0x3ec43f35,0x3e48bf80,0xbf0e3f6d,0x3f55bf35,0xbf7b3ec4
.long 0xa5543f80,0x248dbf80,0xa5543f80,0x248dbf80,0xbe48bf80,0x3f0e3f6d,0xbf55bf35,0x3f7b3ec4
.long 0x3ec43f80,0xbf6dbf35,0x3f6d248d,0xbec43f35,0xbf0ebf80,0x3f7b3ec4,0xbe483f35,0xbf55bf6d
.long 0x3f353f80,0xbf35a554,0xbf35bf80,0x3f35248d,0xbf55bf80,0x3e48bec4,0x3f7b3f35,0x3f0e3f6d
.long 0x3f6d3f80,0x3ec43f35,0xbec4a554,0xbf6dbf35,0xbf7bbf80,0xbf55bf6d,0xbf0ebf35,0xbe48bec4
.long 0x3f803f80,0x3f803f80,0x3f803f80,0x3f803f80,0x3e48a554,0x3f0e3ec4,0x3f553f35,0x3f7b3f6d
.long 0xbf6dbf80,0xbec4bf35,0x3ec4a554,0x3f6d3f35,0xbf0e248d,0xbf7bbf6d,0xbe48bf35,0x3f553ec4
.long 0x3f353f80,0xbf35248d,0xbf35bf80,0x3f35a554,0x3f55a554,0x3e483f6d,0xbf7bbf35,0x3f0ebec4
.long 0xbec4bf80,0x3f6d3f35,0xbf6d248d,0x3ec4bf35,0xbf7b248d,0x3f55bec4,0xbf0e3f35,0x3e48bf6d
.long 0x248d3f80,0xa554bf80,0x248d3f80,0xa554bf80,0x3f7ba554,0xbf55bec4,0x3f0e3f35,0xbe48bf6d
.long 0x3ec4bf80,0xbf6d3f35,0x3f6da554,0xbec4bf35,0xbf55248d,0xbe483f6d,0x3f7bbf35,0xbf0ebec4
.long 0xbf353f80,0x3f35a554,0x3f35bf80,0xbf35248d,0x3f0ea554,0x3f7bbf6d,0x3e48bf35,0xbf553ec4
.long 0x3f6dbf80,0x3ec4bf35,0xbec4248d,0xbf6d3f35,0xbe48248d,0xbf0e3ec4,0xbf553f35,0xbf7b3f6d
.long 0xbf803f80,0xbf803f80,0xbf803f80,0xbf803f80,0xbe48a554,0xbf0e3ec4,0xbf553f35,0xbf7b3f6d
.long 0x3f6dbf80,0x3ec4bf35,0xbec4a554,0xbf6d3f35,0x3f0e248d,0x3f7bbf6d,0x3e48bf35,0xbf553ec4
.long 0xbf353f80,0x3f35248d,0x3f35bf80,0xbf35a554,0xbf55a554,0xbe483f6d,0x3f7bbf35,0xbf0ebec4
.long 0x3ec4bf80,0xbf6d3f35,0x3f6d248d,0xbec4bf35,0x3f7b248d,0xbf55bec4,0x3f0e3f35,0xbe48bf6d
.long 0xa5543f80,0x248dbf80,0xa5543f80,0x248dbf80,0xbf7ba554,0x3f55bec4,0xbf0e3f35,0x3e48bf6d
.long 0xbec4bf80,0x3f6d3f35,0xbf6da554,0x3ec4bf35,0x3f55248d,0x3e483f6d,0xbf7bbf35,0x3f0ebec4
.long 0x3f353f80,0xbf35a554,0xbf35bf80,0x3f35248d,0xbf0ea554,0xbf7bbf6d,0xbe48bf35,0x3f553ec4
.long 0xbf6dbf80,0xbec4bf35,0x3ec4248d,0x3f6d3f35,0x3e48248d,0x3f0e3ec4,0x3f553f35,0x3f7b3f6d
.long 0x0,0x0,0x0,0x0,0xbe480000,0xbf0ebec4,0xbf55bf35,0xbf7bbf6d
.long 0xbec40000,0xbf6dbf35,0xbf6dbf80,0xbec4bf35,0xbf0e0000,0xbf7bbf6d,0xbe48bf35,0x3f553ec4
.long 0xbf350000,0xbf35bf80,0x3f35a50d,0x3f353f80,0xbf550000,0xbe48bf6d,0x3f7b3f35,0xbf0e3ec4
.long 0xbf6d0000,0x3ec4bf35,0x3ec43f80,0xbf6dbf35,0xbf7b0000,0x3f55bec4,0xbf0e3f35,0x3e48bf6d
.long 0xbf800000,0x3f80a50d,0xbf800000,0x3f80a50d,0xbf7b0000,0x3f553ec4,0xbf0ebf35,0x3e483f6d
.long 0xbf6d0000,0x3ec43f35,0x3ec4bf80,0xbf6d3f35,0xbf550000,0xbe483f6d,0x3f7bbf35,0xbf0ebec4
.long 0xbf350000,0xbf353f80,0x3f35a50d,0x3f35bf80,0xbf0e0000,0xbf7b3f6d,0xbe483f35,0x3f55bec4
.long 0xbec40000,0xbf6d3f35,0xbf6d3f80,0xbec43f35,0xbe480000,0xbf0e3ec4,0xbf553f35,0xbf7b3f6d
.long 0xa50d0000,0xa50d0000,0xa50d0000,0xa50d0000,0x3e480000,0x3f0ebec4,0x3f55bf35,0x3f7bbf6d
.long 0x3ec40000,0x3f6dbf35,0x3f6dbf80,0x3ec4bf35,0x3f0e0000,0x3f7bbf6d,0x3e48bf35,0xbf553ec4
.long 0x3f350000,0x3f35bf80,0xbf35a50d,0xbf353f80,0x3f550000,0x3e48bf6d,0xbf7b3f35,0x3f0e3ec4
.long 0x3f6d0000,0xbec4bf35,0xbec43f80,0x3f6dbf35,0x3f7b0000,0xbf55bec4,0x3f0e3f35,0xbe48bf6d
.long 0x3f800000,0xbf80a50d,0x3f800000,0xbf80a50d,0x3f7b0000,0xbf553ec4,0x3f0ebf35,0xbe483f6d
.long 0x3f6d0000,0xbec43f35,0xbec4bf80,0x3f6d3f35,0x3f550000,0x3e483f6d,0xbf7bbf35,0x3f0ebec4
.long 0x3f350000,0x3f353f80,0xbf35a50d,0xbf35bf80,0x3f0e0000,0x3f7b3f6d,0x3e483f35,0xbf55bec4
.long 0x3ec40000,0x3f6d3f35,0x3f6d3f80,0x3ec43f35,0x3e480000,0x3f0e3ec4,0x3f553f35,0x3f7b3f6d
.long 0x0,0x0,0x0,0x0,0xbf7bbf80,0xbf55bf6d,0xbf0ebf35,0xbe48bec4
.long 0x3ec4a50d,0x3f6d3f35,0x3f6d3f80,0x3ec43f35,0x3f553f80,0xbe483ec4,0xbf7bbf35,0xbf0ebf6d
.long 0xbf350000,0xbf35bf80,0x3f35a50d,0x3f353f80,0xbf0ebf80,0x3f7b3ec4,0xbe483f35,0xbf55bf6d
.long 0x3f6da50d,0xbec43f35,0xbec4bf80,0x3f6d3f35,0x3e483f80,0xbf0ebf6d,0x3f553f35,0xbf7bbec4
.long 0xbf800000,0x3f80a50d,0xbf800000,0x3f80a50d,0x3e48bf80,0xbf0e3f6d,0x3f55bf35,0xbf7b3ec4
.long 0x3f6da50d,0xbec4bf35,0xbec43f80,0x3f6dbf35,0xbf0e3f80,0x3f7bbec4,0xbe48bf35,0xbf553f6d
.long 0xbf350000,0xbf353f80,0x3f35a50d,0x3f35bf80,0x3f55bf80,0xbe48bec4,0xbf7b3f35,0xbf0e3f6d
.long 0x3ec4a50d,0x3f6dbf35,0x3f6dbf80,0x3ec4bf35,0xbf7b3f80,0xbf553f6d,0xbf0e3f35,0xbe483ec4
.long 0xa50d0000,0xa50d0000,0xa50d0000,0xa50d0000,0x3f7bbf80,0x3f55bf6d,0x3f0ebf35,0x3e48bec4
.long 0xbec4a50d,0xbf6d3f35,0xbf6d3f80,0xbec43f35,0xbf553f80,0x3e483ec4,0x3f7bbf35,0x3f0ebf6d
.long 0x3f350000,0x3f35bf80,0xbf35a50d,0xbf353f80,0x3f0ebf80,0xbf7b3ec4,0x3e483f35,0x3f55bf6d
.long 0xbf6da50d,0x3ec43f35,0x3ec4bf80,0xbf6d3f35,0xbe483f80,0x3f0ebf6d,0xbf553f35,0x3f7bbec4
.long 0x3f800000,0xbf80a50d,0x3f800000,0xbf80a50d,0xbe48bf80,0x3f0e3f6d,0xbf55bf35,0x3f7b3ec4
.long 0xbf6da50d,0x3ec4bf35,0x3ec43f80,0xbf6dbf35,0x3f0e3f80,0xbf7bbec4,0x3e48bf35,0x3f553f6d
.long 0x3f350000,0x3f353f80,0xbf35a50d,0xbf35bf80,0xbf55bf80,0x3e48bec4,0x3f7b3f35,0x3f0e3f6d
.long 0xbec4a50d,0xbf6dbf35,0xbf6dbf80,0xbec4bf35,0x3f7b3f80,0x3f553f6d,0x3f0e3f35,0x3e483ec4
.long 0x0,0x0,0x0,0x0,0x3e48a50d,0x3f0e3ec4,0x3f553f35,0x3f7b3f6d
.long 0xbec40000,0xbf6dbf35,0xbf6dbf80,0xbec4bf35,0x3f0ea50d,0x3f7b3f6d,0x3e483f35,0xbf55bec4
.long 0xbf350000,0xbf35bf80,0x3f35a50d,0x3f353f80,0x3f55a50d,0x3e483f6d,0xbf7bbf35,0x3f0ebec4
.long 0xbf6d0000,0x3ec4bf35,0x3ec43f80,0xbf6dbf35,0x3f7ba50d,0xbf553ec4,0x3f0ebf35,0xbe483f6d
.long 0xbf800000,0x3f80a50d,0xbf800000,0x3f80a50d,0x3f7ba50d,0xbf55bec4,0x3f0e3f35,0xbe48bf6d
.long 0xbf6d0000,0x3ec43f35,0x3ec4bf80,0xbf6d3f35,0x3f55a50d,0x3e48bf6d,0xbf7b3f35,0x3f0e3ec4
.long 0xbf350000,0xbf353f80,0x3f35a50d,0x3f35bf80,0x3f0ea50d,0x3f7bbf6d,0x3e48bf35,0xbf553ec4
.long 0xbec40000,0xbf6d3f35,0xbf6d3f80,0xbec43f35,0x3e48a50d,0x3f0ebec4,0x3f55bf35,0x3f7bbf6d
.long 0xa50d0000,0xa50d0000,0xa50d0000,0xa50d0000,0xbe48a50d,0xbf0e3ec4,0xbf553f35,0xbf7b3f6d
.long 0x3ec40000,0x3f6dbf35,0x3f6dbf80,0x3ec4bf35,0xbf0ea50d,0xbf7b3f6d,0xbe483f35,0x3f55bec4
.long 0x3f350000,0x3f35bf80,0xbf35a50d,0xbf353f80,0xbf55a50d,0xbe483f6d,0x3f7bbf35,0xbf0ebec4
.long 0x3f6d0000,0xbec4bf35,0xbec43f80,0x3f6dbf35,0xbf7ba50d,0x3f553ec4,0xbf0ebf35,0x3e483f6d
.long 0x3f800000,0xbf80a50d,0x3f800000,0xbf80a50d,0xbf7ba50d,0x3f55bec4,0xbf0e3f35,0x3e48bf6d
.long 0x3f6d0000,0xbec43f35,0xbec4bf80,0x3f6d3f35,0xbf55a50d,0xbe48bf6d,0x3f7b3f35,0xbf0e3ec4
.long 0x3f350000,0x3f353f80,0xbf35a50d,0xbf35bf80,0xbf0ea50d,0xbf7bbf6d,0xbe48bf35,0x3f553ec4
.long 0x3ec40000,0x3f6d3f35,0x3f6d3f80,0x3ec43f35,0xbe48a50d,0xbf0ebec4,0xbf55bf35,0xbf7bbf6d
.long 0x0,0x0,0x0,0x0,0x3f7b3f80,0x3f553f6d,0x3f0e3f35,0x3e483ec4
.long 0x3ec4a50d,0x3f6d3f35,0x3f6d3f80,0x3ec43f35,0xbf55bf80,0x3e48bec4,0x3f7b3f35,0x3f0e3f6d
.long 0xbf350000,0xbf35bf80,0x3f35a50d,0x3f353f80,0x3f0e3f80,0xbf7bbec4,0x3e48bf35,0x3f553f6d
.long 0x3f6da50d,0xbec43f35,0xbec4bf80,0x3f6d3f35,0xbe48bf80,0x3f0e3f6d,0xbf55bf35,0x3f7b3ec4
.long 0xbf800000,0x3f80a50d,0xbf800000,0x3f80a50d,0xbe483f80,0x3f0ebf6d,0xbf553f35,0x3f7bbec4
.long 0x3f6da50d,0xbec4bf35,0xbec43f80,0x3f6dbf35,0x3f0ebf80,0xbf7b3ec4,0x3e483f35,0x3f55bf6d
.long 0xbf350000,0xbf353f80,0x3f35a50d,0x3f35bf80,0xbf553f80,0x3e483ec4,0x3f7bbf35,0x3f0ebf6d
.long 0x3ec4a50d,0x3f6dbf35,0x3f6dbf80,0x3ec4bf35,0x3f7bbf80,0x3f55bf6d,0x3f0ebf35,0x3e48bec4
.long 0xa50d0000,0xa50d0000,0xa50d0000,0xa50d0000,0xbf7b3f80,0xbf553f6d,0xbf0e3f35,0xbe483ec4
.long 0xbec4a50d,0xbf6d3f35,0xbf6d3f80,0xbec43f35,0x3f55bf80,0xbe48bec4,0xbf7b3f35,0xbf0e3f6d
.long 0x3f350000,0x3f35bf80,0xbf35a50d,0xbf353f80,0xbf0e3f80,0x3f7bbec4,0xbe48bf35,0xbf553f6d
.long 0xbf6da50d,0x3ec43f35,0x3ec4bf80,0xbf6d3f35,0x3e48bf80,0xbf0e3f6d,0x3f55bf35,0xbf7b3ec4
.long 0x3f800000,0xbf80a50d,0x3f800000,0xbf80a50d,0x3e483f80,0xbf0ebf6d,0x3f553f35,0xbf7bbec4
.long 0xbf6da50d,0x3ec4bf35,0x3ec43f80,0xbf6dbf35,0xbf0ebf80,0x3f7b3ec4,0xbe483f35,0xbf55bf6d
.long 0x3f350000,0x3f353f80,0xbf35a50d,0xbf35bf80,0x3f553f80,0xbe483ec4,0xbf7bbf35,0xbf0ebf6d
.long 0xbec4a50d,0xbf6dbf35,0xbf6dbf80,0xbec4bf35,0xbf7bbf80,0xbf55bf6d,0xbf0ebf35,0xbe48bec4
.long 0x3f803f80,0x3f803f80,0x3f803f80,0x3f803f80,0x3f7b3f80,0x3f553f6d,0xbe48248d,0xbf0ebec4
.long 0x3f6d3f80,0x3ec43f35,0xbf6dbf80,0xbec4bf35,0x3f553f80,0xbe483ec4,0x3f0ea554,0x3f7b3f6d
.long 0x3f353f80,0xbf35248d,0x3f353f80,0xbf35248d,0x3f0e3f80,0xbf7bbec4,0xbf55248d,0xbe48bf6d
.long 0x3ec43f80,0xbf6dbf35,0xbec4bf80,0x3f6d3f35,0x3e483f80,0xbf0ebf6d,0x3f7ba554,0xbf553ec4
.long 0x248d3f80,0xa554bf80,0x248d3f80,0xa554bf80,0xbe483f80,0x3f0ebf6d,0xbf7b248d,0x3f553ec4
.long 0xbec43f80,0x3f6dbf35,0x3ec4bf80,0xbf6d3f35,0xbf0e3f80,0x3f7bbec4,0x3f55a554,0x3e48bf6d
.long 0xbf353f80,0x3f35a554,0xbf353f80,0x3f35a554,0xbf553f80,0x3e483ec4,0xbf0e248d,0xbf7b3f6d
.long 0xbf6d3f80,0xbec43f35,0x3f6dbf80,0x3ec4bf35,0xbf7b3f80,0xbf553f6d,0x3e48a554,0x3f0ebec4
.long 0x0,0x0,0x0,0x0,0xbe480000,0xbf0ebec4,0xbf7bbf80,0xbf55bf6d
.long 0xbec40000,0xbf6dbf35,0x3ec4a50d,0x3f6d3f35,0xbf0e0000,0xbf7bbf6d,0x3f553f80,0xbe483ec4
.long 0xbf350000,0xbf35bf80,0xbf350000,0xbf35bf80,0xbf550000,0xbe48bf6d,0xbf0ebf80,0x3f7b3ec4
.long 0xbf6d0000,0x3ec4bf35,0x3f6da50d,0xbec43f35,0xbf7b0000,0x3f55bec4,0x3e483f80,0xbf0ebf6d
.long 0xbf800000,0x3f80a50d,0xbf800000,0x3f80a50d,0xbf7b0000,0x3f553ec4,0x3e48bf80,0xbf0e3f6d
.long 0xbf6d0000,0x3ec43f35,0x3f6da50d,0xbec4bf35,0xbf550000,0xbe483f6d,0xbf0e3f80,0x3f7bbec4
.long 0xbf350000,0xbf353f80,0xbf350000,0xbf353f80,0xbf0e0000,0xbf7b3f6d,0x3f55bf80,0xbe48bec4
.long 0xbec40000,0xbf6d3f35,0x3ec4a50d,0x3f6dbf35,0xbe480000,0xbf0e3ec4,0xbf7b3f80,0xbf553f6d
.long 0x3f803f80,0x3f803f80,0x3f803f80,0x3f803f80,0x3f0e3f35,0x3e483ec4,0xbf55bf35,0xbf7bbf6d
.long 0xbec4248d,0xbf6dbf35,0x3ec4a554,0x3f6d3f35,0xbf7bbf35,0xbf0ebf6d,0x3e483f35,0xbf55bec4
.long 0xbf35bf80,0x3f35a554,0xbf35bf80,0x3f35a554,0x3e48bf35,0x3f553f6d,0x3f7b3f35,0xbf0e3ec4
.long 0x3f6da554,0xbec43f35,0xbf6d248d,0x3ec4bf35,0x3f553f35,0xbf7bbec4,0x3f0ebf35,0xbe483f6d
.long 0x248d3f80,0xa554bf80,0x248d3f80,0xa554bf80,0xbf553f35,0x3f7bbec4,0xbf0ebf35,0x3e483f6d
.long 0xbf6d248d,0x3ec43f35,0x3f6da554,0xbec4bf35,0xbe48bf35,0xbf553f6d,0xbf7b3f35,0x3f0e3ec4
.long 0x3f35bf80,0xbf35248d,0x3f35bf80,0xbf35248d,0x3f7bbf35,0x3f0ebf6d,0xbe483f35,0x3f55bec4
.long 0x3ec4a554,0x3f6dbf35,0xbec4248d,0xbf6d3f35,0xbf0e3f35,0xbe483ec4,0x3f55bf35,0x3f7bbf6d
.long 0x0,0x0,0x0,0x0,0xbf55bf35,0xbf7bbf6d,0xbf0ebf35,0xbe48bec4
.long 0xbf6dbf80,0xbec4bf35,0x3f6d3f80,0x3ec43f35,0xbe48bf35,0x3f553ec4,0xbf7bbf35,0xbf0ebf6d
.long 0x3f35a50d,0x3f353f80,0x3f35a50d,0x3f353f80,0x3f7b3f35,0xbf0e3ec4,0xbe483f35,0xbf55bf6d
.long 0x3ec43f80,0xbf6dbf35,0xbec4bf80,0x3f6d3f35,0xbf0e3f35,0x3e48bf6d,0x3f553f35,0xbf7bbec4
.long 0xbf800000,0x3f80a50d,0xbf800000,0x3f80a50d,0xbf0ebf35,0x3e483f6d,0x3f55bf35,0xbf7b3ec4
.long 0x3ec4bf80,0xbf6d3f35,0xbec43f80,0x3f6dbf35,0x3f7bbf35,0xbf0ebec4,0xbe48bf35,0xbf553f6d
.long 0x3f35a50d,0x3f35bf80,0x3f35a50d,0x3f35bf80,0xbe483f35,0x3f55bec4,0xbf7b3f35,0xbf0e3f6d
.long 0xbf6d3f80,0xbec43f35,0x3f6dbf80,0x3ec4bf35,0xbf553f35,0xbf7b3f6d,0xbf0e3f35,0xbe483ec4
.long 0x3f803f80,0x3f803f80,0x3f803f80,0x3f803f80,0xbf7bbf80,0xbf55bf6d,0x3e48a554,0x3f0e3ec4
.long 0x3f6d3f80,0x3ec43f35,0xbf6dbf80,0xbec4bf35,0xbf55bf80,0x3e48bec4,0xbf0e248d,0xbf7bbf6d
.long 0x3f353f80,0xbf35248d,0x3f353f80,0xbf35248d,0xbf0ebf80,0x3f7b3ec4,0x3f55a554,0x3e483f6d
.long 0x3ec43f80,0xbf6dbf35,0xbec4bf80,0x3f6d3f35,0xbe48bf80,0x3f0e3f6d,0xbf7b248d,0x3f55bec4
.long 0x248d3f80,0xa554bf80,0x248d3f80,0xa554bf80,0x3e48bf80,0xbf0e3f6d,0x3f7ba554,0xbf55bec4
.long 0xbec43f80,0x3f6dbf35,0x3ec4bf80,0xbf6d3f35,0x3f0ebf80,0xbf7b3ec4,0xbf55248d,0xbe483f6d
.long 0xbf353f80,0x3f35a554,0xbf353f80,0x3f35a554,0x3f55bf80,0xbe48bec4,0x3f0ea554,0x3f7bbf6d
.long 0xbf6d3f80,0xbec43f35,0x3f6dbf80,0x3ec4bf35,0x3f7bbf80,0x3f55bf6d,0xbe48248d,0xbf0e3ec4
.long 0x0,0x0,0x0,0x0,0x3e48a50d,0x3f0e3ec4,0x3f7b3f80,0x3f553f6d
.long 0xbec40000,0xbf6dbf35,0x3ec4a50d,0x3f6d3f35,0x3f0ea50d,0x3f7b3f6d,0xbf55bf80,0x3e48bec4
.long 0xbf350000,0xbf35bf80,0xbf350000,0xbf35bf80,0x3f55a50d,0x3e483f6d,0x3f0e3f80,0xbf7bbec4
.long 0xbf6d0000,0x3ec4bf35,0x3f6da50d,0xbec43f35,0x3f7ba50d,0xbf553ec4,0xbe48bf80,0x3f0e3f6d
.long 0xbf800000,0x3f80a50d,0xbf800000,0x3f80a50d,0x3f7ba50d,0xbf55bec4,0xbe483f80,0x3f0ebf6d
.long 0xbf6d0000,0x3ec43f35,0x3f6da50d,0xbec4bf35,0x3f55a50d,0x3e48bf6d,0x3f0ebf80,0xbf7b3ec4
.long 0xbf350000,0xbf353f80,0xbf350000,0xbf353f80,0x3f0ea50d,0x3f7bbf6d,0xbf553f80,0x3e483ec4
.long 0xbec40000,0xbf6d3f35,0x3ec4a50d,0x3f6dbf35,0x3e48a50d,0x3f0ebec4,0x3f7bbf80,0x3f55bf6d
.long 0x3f803f80,0x3f803f80,0x3f803f80,0x3f803f80,0xbf0ebf35,0xbe48bec4,0x3f553f35,0x3f7b3f6d
.long 0xbec4248d,0xbf6dbf35,0x3ec4a554,0x3f6d3f35,0x3f7b3f35,0x3f0e3f6d,0xbe48bf35,0x3f553ec4
.long 0xbf35bf80,0x3f35a554,0xbf35bf80,0x3f35a554,0xbe483f35,0xbf55bf6d,0xbf7bbf35,0x3f0ebec4
.long 0x3f6da554,0xbec43f35,0xbf6d248d,0x3ec4bf35,0xbf55bf35,0x3f7b3ec4,0xbf0e3f35,0x3e48bf6d
.long 0x248d3f80,0xa554bf80,0x248d3f80,0xa554bf80,0x3f55bf35,0xbf7b3ec4,0x3f0e3f35,0xbe48bf6d
.long 0xbf6d248d,0x3ec43f35,0x3f6da554,0xbec4bf35,0x3e483f35,0x3f55bf6d,0x3f7bbf35,0xbf0ebec4
.long 0x3f35bf80,0xbf35248d,0x3f35bf80,0xbf35248d,0xbf7b3f35,0xbf0e3f6d,0x3e48bf35,0xbf553ec4
.long 0x3ec4a554,0x3f6dbf35,0xbec4248d,0xbf6d3f35,0x3f0ebf35,0x3e48bec4,0xbf553f35,0xbf7b3f6d
.long 0x0,0x0,0x0,0x0,0x3f553f35,0x3f7b3f6d,0x3f0e3f35,0x3e483ec4
.long 0xbf6dbf80,0xbec4bf35,0x3f6d3f80,0x3ec43f35,0x3e483f35,0xbf55bec4,0x3f7b3f35,0x3f0e3f6d
.long 0x3f35a50d,0x3f353f80,0x3f35a50d,0x3f353f80,0xbf7bbf35,0x3f0ebec4,0x3e48bf35,0x3f553f6d
.long 0x3ec43f80,0xbf6dbf35,0xbec4bf80,0x3f6d3f35,0x3f0ebf35,0xbe483f6d,0xbf55bf35,0x3f7b3ec4
.long 0xbf800000,0x3f80a50d,0xbf800000,0x3f80a50d,0x3f0e3f35,0xbe48bf6d,0xbf553f35,0x3f7bbec4
.long 0x3ec4bf80,0xbf6d3f35,0xbec43f80,0x3f6dbf35,0xbf7b3f35,0x3f0e3ec4,0x3e483f35,0x3f55bf6d
.long 0x3f35a50d,0x3f35bf80,0x3f35a50d,0x3f35bf80,0x3e48bf35,0xbf553ec4,0x3f7bbf35,0x3f0ebf6d
.long 0xbf6d3f80,0xbec43f35,0x3f6dbf80,0x3ec4bf35,0x3f55bf35,0x3f7bbf6d,0x3f0ebf35,0x3e48bec4
.long 0x80008000,0x80008000,0x80008000,0x80008000,0x3e488000,0x3f0e3ec4,0x3f7b3f80,0x3f553f6d
.long 0x3ec48000,0x3f6d3f35,0xbec4250d,0xbf6dbf35,0x3f0e8000,0x3f7b3f6d,0xbf55bf80,0x3e48bec4
.long 0x3f358000,0x3f353f80,0x3f358000,0x3f353f80,0x3f558000,0x3e483f6d,0x3f0e3f80,0xbf7bbec4
.long 0x3f6d8000,0xbec43f35,0xbf6d250d,0x3ec4bf35,0x3f7b8000,0xbf553ec4,0xbe48bf80,0x3f0e3f6d
.long 0x3f808000,0xbf80250d,0x3f808000,0xbf80250d,0x3f7b8000,0xbf55bec4,0xbe483f80,0x3f0ebf6d
.long 0x3f6d8000,0xbec4bf35,0xbf6d250d,0x3ec43f35,0x3f558000,0x3e48bf6d,0x3f0ebf80,0xbf7b3ec4
.long 0x3f358000,0x3f35bf80,0x3f358000,0x3f35bf80,0x3f0e8000,0x3f7bbf6d,0xbf553f80,0x3e483ec4
.long 0x3ec48000,0x3f6dbf35,0xbec4250d,0xbf6d3f35,0x3e488000,0x3f0ebec4,0x3f7bbf80,0x3f55bf6d
.long 0x3f803f80,0x3f803f80,0x3f803f80,0x3f803f80,0x3f7b3f80,0x3f553f6d,0xbe48248d,0xbf0ebec4
.long 0x3f6d3f80,0x3ec43f35,0xbf6dbf80,0xbec4bf35,0x3f553f80,0xbe483ec4,0x3f0ea554,0x3f7b3f6d
.long 0x3f353f80,0xbf35248d,0x3f353f80,0xbf35248d,0x3f0e3f80,0xbf7bbec4,0xbf55248d,0xbe48bf6d
.long 0x3ec43f80,0xbf6dbf35,0xbec4bf80,0x3f6d3f35,0x3e483f80,0xbf0ebf6d,0x3f7ba554,0xbf553ec4
.long 0x248d3f80,0xa554bf80,0x248d3f80,0xa554bf80,0xbe483f80,0x3f0ebf6d,0xbf7b248d,0x3f553ec4
.long 0xbec43f80,0x3f6dbf35,0x3ec4bf80,0xbf6d3f35,0xbf0e3f80,0x3f7bbec4,0x3f55a554,0x3e48bf6d
.long 0xbf353f80,0x3f35a554,0xbf353f80,0x3f35a554,0xbf553f80,0x3e483ec4,0xbf0e248d,0xbf7b3f6d
.long 0xbf6d3f80,0xbec43f35,0x3f6dbf80,0x3ec4bf35,0xbf7b3f80,0xbf553f6d,0x3e48a554,0x3f0ebec4
.long 0x80008000,0x80008000,0x80008000,0x80008000,0x3f553f35,0x3f7b3f6d,0x3f0e3f35,0x3e483ec4
.long 0x3f6d3f80,0x3ec43f35,0xbf6dbf80,0xbec4bf35,0x3e483f35,0xbf55bec4,0x3f7b3f35,0x3f0e3f6d
.long 0xbf35250d,0xbf35bf80,0xbf35250d,0xbf35bf80,0xbf7bbf35,0x3f0ebec4,0x3e48bf35,0x3f553f6d
.long 0xbec4bf80,0x3f6d3f35,0x3ec43f80,0xbf6dbf35,0x3f0ebf35,0xbe483f6d,0xbf55bf35,0x3f7b3ec4
.long 0x3f808000,0xbf80250d,0x3f808000,0xbf80250d,0x3f0e3f35,0xbe48bf6d,0xbf553f35,0x3f7bbec4
.long 0xbec43f80,0x3f6dbf35,0x3ec4bf80,0xbf6d3f35,0xbf7b3f35,0x3f0e3ec4,0x3e483f35,0x3f55bf6d
.long 0xbf35250d,0xbf353f80,0xbf35250d,0xbf353f80,0x3e48bf35,0xbf553ec4,0x3f7bbf35,0x3f0ebf6d
.long 0x3f6dbf80,0x3ec4bf35,0xbf6d3f80,0xbec43f35,0x3f55bf35,0x3f7bbf6d,0x3f0ebf35,0x3e48bec4
.long 0x3f803f80,0x3f803f80,0x3f803f80,0x3f803f80,0x3f0e3f35,0x3e483ec4,0xbf55bf35,0xbf7bbf6d
.long 0xbec4248d,0xbf6dbf35,0x3ec4a554,0x3f6d3f35,0xbf7bbf35,0xbf0ebf6d,0x3e483f35,0xbf55bec4
.long 0xbf35bf80,0x3f35a554,0xbf35bf80,0x3f35a554,0x3e48bf35,0x3f553f6d,0x3f7b3f35,0xbf0e3ec4
.long 0x3f6da554,0xbec43f35,0xbf6d248d,0x3ec4bf35,0x3f553f35,0xbf7bbec4,0x3f0ebf35,0xbe483f6d
.long 0x248d3f80,0xa554bf80,0x248d3f80,0xa554bf80,0xbf553f35,0x3f7bbec4,0xbf0ebf35,0x3e483f6d
.long 0xbf6d248d,0x3ec43f35,0x3f6da554,0xbec4bf35,0xbe48bf35,0xbf553f6d,0xbf7b3f35,0x3f0e3ec4
.long 0x3f35bf80,0xbf35248d,0x3f35bf80,0xbf35248d,0x3f7bbf35,0x3f0ebf6d,0xbe483f35,0x3f55bec4
.long 0x3ec4a554,0x3f6dbf35,0xbec4248d,0xbf6d3f35,0xbf0e3f35,0xbe483ec4,0x3f55bf35,0x3f7bbf6d
.long 0x80008000,0x80008000,0x80008000,0x80008000,0xbe48250d,0xbf0ebec4,0xbf7bbf80,0xbf55bf6d
.long 0x3ec48000,0x3f6d3f35,0xbec4250d,0xbf6dbf35,0xbf0e250d,0xbf7bbf6d,0x3f553f80,0xbe483ec4
.long 0x3f358000,0x3f353f80,0x3f358000,0x3f353f80,0xbf55250d,0xbe48bf6d,0xbf0ebf80,0x3f7b3ec4
.long 0x3f6d8000,0xbec43f35,0xbf6d250d,0x3ec4bf35,0xbf7b250d,0x3f55bec4,0x3e483f80,0xbf0ebf6d
.long 0x3f808000,0xbf80250d,0x3f808000,0xbf80250d,0xbf7b250d,0x3f553ec4,0x3e48bf80,0xbf0e3f6d
.long 0x3f6d8000,0xbec4bf35,0xbf6d250d,0x3ec43f35,0xbf55250d,0xbe483f6d,0xbf0e3f80,0x3f7bbec4
.long 0x3f358000,0x3f35bf80,0x3f358000,0x3f35bf80,0xbf0e250d,0xbf7b3f6d,0x3f55bf80,0xbe48bec4
.long 0x3ec48000,0x3f6dbf35,0xbec4250d,0xbf6d3f35,0xbe48250d,0xbf0e3ec4,0xbf7b3f80,0xbf553f6d
.long 0x3f803f80,0x3f803f80,0x3f803f80,0x3f803f80,0xbf7bbf80,0xbf55bf6d,0x3e48a554,0x3f0e3ec4
.long 0x3f6d3f80,0x3ec43f35,0xbf6dbf80,0xbec4bf35,0xbf55bf80,0x3e48bec4,0xbf0e248d,0xbf7bbf6d
.long 0x3f353f80,0xbf35248d,0x3f353f80,0xbf35248d,0xbf0ebf80,0x3f7b3ec4,0x3f55a554,0x3e483f6d
.long 0x3ec43f80,0xbf6dbf35,0xbec4bf80,0x3f6d3f35,0xbe48bf80,0x3f0e3f6d,0xbf7b248d,0x3f55bec4
.long 0x248d3f80,0xa554bf80,0x248d3f80,0xa554bf80,0x3e48bf80,0xbf0e3f6d,0x3f7ba554,0xbf55bec4
.long 0xbec43f80,0x3f6dbf35,0x3ec4bf80,0xbf6d3f35,0x3f0ebf80,0xbf7b3ec4,0xbf55248d,0xbe483f6d
.long 0xbf353f80,0x3f35a554,0xbf353f80,0x3f35a554,0x3f55bf80,0xbe48bec4,0x3f0ea554,0x3f7bbf6d
.long 0xbf6d3f80,0xbec43f35,0x3f6dbf80,0x3ec4bf35,0x3f7bbf80,0x3f55bf6d,0xbe48248d,0xbf0e3ec4
.long 0x80008000,0x80008000,0x80008000,0x80008000,0xbf55bf35,0xbf7bbf6d,0xbf0ebf35,0xbe48bec4
.long 0x3f6d3f80,0x3ec43f35,0xbf6dbf80,0xbec4bf35,0xbe48bf35,0x3f553ec4,0xbf7bbf35,0xbf0ebf6d
.long 0xbf35250d,0xbf35bf80,0xbf35250d,0xbf35bf80,0x3f7b3f35,0xbf0e3ec4,0xbe483f35,0xbf55bf6d
.long 0xbec4bf80,0x3f6d3f35,0x3ec43f80,0xbf6dbf35,0xbf0e3f35,0x3e48bf6d,0x3f553f35,0xbf7bbec4
.long 0x3f808000,0xbf80250d,0x3f808000,0xbf80250d,0xbf0ebf35,0x3e483f6d,0x3f55bf35,0xbf7b3ec4
.long 0xbec43f80,0x3f6dbf35,0x3ec4bf80,0xbf6d3f35,0x3f7bbf35,0xbf0ebec4,0xbe48bf35,0xbf553f6d
.long 0xbf35250d,0xbf353f80,0xbf35250d,0xbf353f80,0xbe483f35,0x3f55bec4,0xbf7b3f35,0xbf0e3f6d
.long 0x3f6dbf80,0x3ec4bf35,0xbf6d3f80,0xbec43f35,0xbf553f35,0xbf7b3f6d,0xbf0e3f35,0xbe483ec4
.long 0x3f803f80,0x3f803f80,0x3f803f80,0x3f803f80,0xbf0ebf35,0xbe48bec4,0x3f553f35,0x3f7b3f6d
.long 0xbec4248d,0xbf6dbf35,0x3ec4a554,0x3f6d3f35,0x3f7b3f35,0x3f0e3f6d,0xbe48bf35,0x3f553ec4
.long 0xbf35bf80,0x3f35a554,0xbf35bf80,0x3f35a554,0xbe483f35,0xbf55bf6d,0xbf7bbf35,0x3f0ebec4
.long 0x3f6da554,0xbec43f35,0xbf6d248d,0x3ec4bf35,0xbf55bf35,0x3f7b3ec4,0xbf0e3f35,0x3e48bf6d
.long 0x248d3f80,0xa554bf80,0x248d3f80,0xa554bf80,0x3f55bf35,0xbf7b3ec4,0x3f0e3f35,0xbe48bf6d
.long 0xbf6d248d,0x3ec43f35,0x3f6da554,0xbec4bf35,0x3e483f35,0x3f55bf6d,0x3f7bbf35,0xbf0ebec4
.long 0x3f35bf80,0xbf35248d,0x3f35bf80,0xbf35248d,0xbf7b3f35,0xbf0e3f6d,0x3e48bf35,0xbf553ec4
.long 0x3ec4a554,0x3f6dbf35,0xbec4248d,0xbf6d3f35,0x3f0ebf35,0x3e48bec4,0xbf553f35,0xbf7b3f6d
.long 0x3f800000,0x3f800000,0x3f800000,0x3f800000,0x3f800000,0x3f7ffec4,0x3f7ffb11,0x3f7ff4e6
.long 0x3f800000,0x3f7ffb11,0x3f7fec43,0x3f7fd397,0x3f800000,0x3f7ff4e6,0x3f7fd397,0x3f7f9c18
.long 0x3f800000,0x3f7fec43,0x3f7fb10f,0x3f7f4e6d,0x3f800000,0x3f7fe129,0x3f7f84ab,0x3f7eea9d
.long 0x3f800000,0x3f7fd397,0x3f7f4e6d,0x3f7e70b0,0x3f800000,0x3f7fc38f,0x3f7f0e58,0x3f7de0b1
.long 0x3f800000,0x3f7fb10f,0x3f7ec46d,0x3f7d3aac,0x3f800000,0x3f7f9c18,0x3f7e70b0,0x3f7c7eb0
.long 0x3f800000,0x3f7f84ab,0x3f7e1324,0x3f7baccd,0x3f800000,0x3f7f6ac7,0x3f7dabcc,0x3f7ac516
.long 0x3f800000,0x3f7f4e6d,0x3f7d3aac,0x3f79c79d,0x3f800000,0x3f7f2f9d,0x3f7cbfc9,0x3f78b47b
.long 0x3f800000,0x3f7f0e58,0x3f7c3b28,0x3f778bc5,0x3f800000,0x3f7eea9d,0x3f7baccd,0x3f764d97
.long 0x3f800000,0x3f7ec46d,0x3f7b14be,0x3f74fa0b,0x3f800000,0x3f7e9bc9,0x3f7a7302,0x3f73913f
.long 0x3f800000,0x3f7e70b0,0x3f79c79d,0x3f721352,0x3f800000,0x3f7e4323,0x3f791298,0x3f708066
.long 0x3f800000,0x3f7e1324,0x3f7853f8,0x3f6ed89e,0x3f800000,0x3f7de0b1,0x3f778bc5,0x3f6d1c1d
.long 0x3f800000,0x3f7dabcc,0x3f76ba07,0x3f6b4b0c,0x3f800000,0x3f7d7474,0x3f75dec6,0x3f696591
.long 0x3f800000,0x3f7d3aac,0x3f74fa0b,0x3f676bd8,0x3f800000,0x3f7cfe73,0x3f740bdd,0x3f655e0b
.long 0x3f800000,0x3f7cbfc9,0x3f731447,0x3f633c5a,0x3f800000,0x3f7c7eb0,0x3f721352,0x3f6106f2
.long 0x3f800000,0x3f7c3b28,0x3f710908,0x3f5ebe05,0x3f800000,0x3f7bf531,0x3f6ff573,0x3f5c61c7
.long 0x3f800000,0x3f7baccd,0x3f6ed89e,0x3f59f26a,0x3f800000,0x3f7b61fc,0x3f6db293,0x3f577026
.long 0x3f800000,0x3f800000,0x3f800000,0x3f800000,0x3f7fec43,0x3f7fe129,0x3f7fd397,0x3f7fc38f
.long 0x3f7fb10f,0x3f7f84ab,0x3f7f4e6d,0x3f7f0e58,0x3f7f4e6d,0x3f7eea9d,0x3f7e70b0,0x3f7de0b1
.long 0x3f7ec46d,0x3f7e1324,0x3f7d3aac,0x3f7c3b28,0x3f7e1324,0x3f7cfe73,0x3f7baccd,0x3f7a1e84
.long 0x3f7d3aac,0x3f7baccd,0x3f79c79d,0x3f778bc5,0x3f7c3b28,0x3f7a1e84,0x3f778bc5,0x3f748422
.long 0x3f7b14be,0x3f7853f8,0x3f74fa0b,0x3f710908,0x3f79c79d,0x3f764d97,0x3f721352,0x3f6d1c1d
.long 0x3f7853f8,0x3f740bdd,0x3f6ed89e,0x3f68bf3c,0x3f76ba07,0x3f718f57,0x3f6b4b0c,0x3f63f473
.long 0x3f74fa0b,0x3f6ed89e,0x3f676bd8,0x3f5ebe05,0x3f731447,0x3f6be858,0x3f633c5a,0x3f591e6a
.long 0x3f710908,0x3f68bf3c,0x3f5ebe05,0x3f531849,0x3f6ed89e,0x3f655e0b,0x3f59f26a,0x3f4cae79
.long 0x3f6c835e,0x3f61c598,0x3f54db31,0x3f45e403,0x3f6a09a7,0x3f5df6be,0x3f4f7a1f,0x3f3ebc1b
.long 0x3f676bd8,0x3f59f26a,0x3f49d112,0x3f373a23,0x3f64aa59,0x3f55b993,0x3f43e200,0x3f2f61a5
.long 0x3f61c598,0x3f514d3d,0x3f3daef9,0x3f273656,0x3f5ebe05,0x3f4cae79,0x3f373a23,0x3f1ebc12
.long 0x3f5b941a,0x3f47de65,0x3f3085bb,0x3f15f6d9,0x3f584853,0x3f42de29,0x3f299415,0x3f0cead0
.long 0x3f54db31,0x3f3daef9,0x3f226799,0x3f039c3d,0x3f514d3d,0x3f385216,0x3f1b02c6,0x3ef41f07
.long 0x3f4d9f02,0x3f32c8c9,0x3f13682a,0x3ee0924f,0x3f49d112,0x3f2d1469,0x3f0b9a6b,0x3ecc9b8b
.long 0x3f45e403,0x3f273656,0x3f039c3d,0x3eb8442a,0x3f41d870,0x3f212ff9,0x3ef6e0cb,0x3ea395c5
.long 0x3f3daef9,0x3f1b02c6,0x3ee63375,0x3e8e9a22,0x3f396842,0x3f14b039,0x3ed53641,0x3e72b651
.long 0x3f800000,0x3f800000,0x3f800000,0x3f800000,0x3f7fb10f,0x3f7f9c18,0x3f7f84ab,0x3f7f6ac7
.long 0x3f7ec46d,0x3f7e70b0,0x3f7e1324,0x3f7dabcc,0x3f7d3aac,0x3f7c7eb0,0x3f7baccd,0x3f7ac516
.long 0x3f7b14be,0x3f79c79d,0x3f7853f8,0x3f76ba07,0x3f7853f8,0x3f764d97,0x3f740bdd,0x3f718f57
.long 0x3f74fa0b,0x3f721352,0x3f6ed89e,0x3f6b4b0c,0x3f710908,0x3f6d1c1d,0x3f68bf3c,0x3f63f473
.long 0x3f6c835e,0x3f676bd8,0x3f61c598,0x3f5b941a,0x3f676bd8,0x3f6106f2,0x3f59f26a,0x3f5233c6
.long 0x3f61c598,0x3f59f26a,0x3f514d3d,0x3f47de65,0x3f5b941a,0x3f5233c6,0x3f47de65,0x3f3ca003
.long 0x3f54db31,0x3f49d112,0x3f3daef9,0x3f3085bb,0x3f4d9f02,0x3f40d0da,0x3f32c8c9,0x3f239da9
.long 0x3f45e403,0x3f373a23,0x3f273656,0x3f15f6d9,0x3f3daef9,0x3f2d1469,0x3f1b02c6,0x3f07a136
.long 0x3f3504f3,0x3f226799,0x3f0e39da,0x3ef15aea,0x3f2beb4a,0x3f173c07,0x3f00e7e4,0x3ed25a09
.long 0x3f226799,0x3f0b9a6b,0x3ee63375,0x3eb263ef,0x3f187fc0,0x3eff17b2,0x3ec9b953,0x3e919ddd
.long 0x3f0e39da,0x3ee63375,0x3eac7cd4,0x3e605c13,0x3f039c3d,0x3ecc9b8b,0x3e8e9a22,0x3e1c76de
.long 0x3ef15aea,0x3eb263ef,0x3e605c13,0x3dafb680,0x3edae880,0x3e97a117,0x3e22abb6,0x3c96c9b6
.long 0x3ec3ef15,0x3e78cfcc,0x3dc8bd36,0xbd48fb30,0x3eac7cd4,0x3e419b37,0x3d16c32c,0xbdee3876
.long 0x3e94a031,0x3e09cf86,0xbcc90ab0,0xbe3b6ecf,0x3e78cfcc,0x3da3308c,0xbdafb680,0xbe7ee6e1
.long 0x3e47c5c2,0x3cc90ab0,0xbe164083,0xbea09ae5,0x3e164083,0xbcfb49ba,0xbe541501,0xbec1071e
.long 0x3dc8bd36,0xbdafb680,0xbe888e93,0xbee0924f,0x3d48fb30,0xbe1008b7,0xbea68f12,0xbeff17b2
.long 0x3f800000,0x3f800000,0x3f800000,0x3f800000,0x3f7f4e6d,0x3f7f2f9d,0x3f7f0e58,0x3f7eea9d
.long 0x3f7d3aac,0x3f7cbfc9,0x3f7c3b28,0x3f7baccd,0x3f79c79d,0x3f78b47b,0x3f778bc5,0x3f764d97
.long 0x3f74fa0b,0x3f731447,0x3f710908,0x3f6ed89e,0x3f6ed89e,0x3f6be858,0x3f68bf3c,0x3f655e0b
.long 0x3f676bd8,0x3f633c5a,0x3f5ebe05,0x3f59f26a,0x3f5ebe05,0x3f591e6a,0x3f531849,0x3f4cae79
.long 0x3f54db31,0x3f4d9f02,0x3f45e403,0x3f3daef9,0x3f49d112,0x3f40d0da,0x3f373a23,0x3f2d1469
.long 0x3f3daef9,0x3f32c8c9,0x3f273656,0x3f1b02c6,0x3f3085bb,0x3f239da9,0x3f15f6d9,0x3f07a136
.long 0x3f226799,0x3f13682a,0x3f039c3d,0x3ee63375,0x3f13682a,0x3f0242b1,0x3ee0924f,0x3ebb31a0
.long 0x3f039c3d,0x3ee0924f,0x3eb8442a,0x3e8e9a22,0x3ee63375,0x3ebb31a0,0x3e8e9a22,0x3e419b37
.long 0x3ec3ef15,0x3e94a031,0x3e47c5c2,0x3dc8bd36,0x3ea09ae5,0x3e5a3997,0x3de1bc2e,0x3bc90f88
.long 0x3e78cfcc,0x3e09cf86,0x3cc90ab0,0xbdafb680,0x3e2f10a2,0x3d621469,0xbd7b2b74,0xbe354098
.long 0x3dc8bd36,0xbcc90ab0,0xbe164083,0xbe888e93,0x3cc90ab0,0xbdd53db9,0xbe6c9a7f,0xbeb554ec
.long 0xbd48fb30,0xbe3b6ecf,0xbea09ae5,0xbee0924f,0xbdfab273,0xbe8586ce,0xbec9b953,0xbf04f484
.long 0xbe47c5c2,0xbeac7cd4,0xbef15aea,0xbf187fc0,0xbe888e93,0xbed25a09,0xbf0b9a6b,0xbf2ac082
.long 0xbeac7cd4,0xbef6e0cb,0xbf1d7fd1,0xbf3b8f3b,0xbecf7bca,0xbf0cead0,0xbf2e3bde,0xbf4ac77f
.long 0xbef15aea,0xbf1d7fd1,0xbf3daef9,0xbf584853,0xbf08f59b,0xbf2d1469,0xbf4bbbf8,0xbf63f473
.long 0xbf187fc0,0xbf3b8f3b,0xbf584853,0xbf6db293,0xbf273656,0xbf48d8b3,0xbf633c5a,0xbf756d97
.long 0x3f800000,0x3f800000,0x3f800000,0x3f800000,0x3f7ec46d,0x3f7e9bc9,0x3f7e70b0,0x3f7e4323
.long 0x3f7b14be,0x3f7a7302,0x3f79c79d,0x3f791298,0x3f74fa0b,0x3f73913f,0x3f721352,0x3f708066
.long 0x3f6c835e,0x3f6a09a7,0x3f676bd8,0x3f64aa59,0x3f61c598,0x3f5df6be,0x3f59f26a,0x3f55b993
.long 0x3f54db31,0x3f4f7a1f,0x3f49d112,0x3f43e200,0x3f45e403,0x3f3ebc1b,0x3f373a23,0x3f2f61a5
.long 0x3f3504f3,0x3f2beb4a,0x3f226799,0x3f187fc0,0x3f226799,0x3f173c07,0x3f0b9a6b,0x3eff17b2
.long 0x3f0e39da,0x3f00e7e4,0x3ee63375,0x3ec9b953,0x3ef15aea,0x3ed25a09,0x3eb263ef,0x3e919ddd
.long 0x3ec3ef15,0x3ea09ae5,0x3e78cfcc,0x3e2f10a2,0x3e94a031,0x3e5a3997,0x3e09cf86,0x3d621469
.long 0x3e47c5c2,0x3de1bc2e,0x3cc90ab0,0xbd7b2b74,0x3dc8bd36,0x3bc90f88,0xbdafb680,0xbe354098
.long 0x248d3132,0xbdc8bd36,0xbe47c5c2,0xbe94a031,0xbdc8bd36,0xbe4dee60,0xbe9aa086,0xbecc9b8b
.long 0xbe47c5c2,0xbe9aa086,0xbecf7bca,0xbf00e7e4,0xbe94a031,0xbecc9b8b,0xbf00e7e4,0xbf19c200
.long 0xbec3ef15,0xbefc5d27,0xbf187fc0,0xbf3085bb,0xbef15aea,0xbf14b039,0xbf2e3bde,0xbf44e3f5
.long 0xbf0e39da,0xbf299415,0xbf41d870,0xbf5695e5,0xbf226799,0xbf3ca003,0xbf531849,0xbf655e0b
.long 0xbf3504f3,0xbf4d9f02,0xbf61c598,0xbf710908,0xbf45e403,0xbf5c61c7,0xbf6db293,0xbf796e4e
.long 0xbf54db31,0xbf68bf3c,0xbf76ba07,0xbf7e70b0,0xbf61c598,0xbf7294f8,0xbf7cbfc9,0xbf7ffec4
.long 0xbf6c835e,0xbf79c79d,0xbf7fb10f,0xbf7e1324,0xbf74fa0b,0xbf7e4323,0xbf7f84ab,0xbf78b47b
.long 0xbf7b14be,0xbf7ffb11,0xbf7c3b28,0xbf6ff573,0xbf7ec46d,0xbf7eea9d,0xbf75dec6,0xbf63f473
.long 0x3f800000,0x3f800000,0x3f800000,0x3f800000,0x3f7e1324,0x3f7de0b1,0x3f7dabcc,0x3f7d7474
.long 0x3f7853f8,0x3f778bc5,0x3f76ba07,0x3f75dec6,0x3f6ed89e,0x3f6d1c1d,0x3f6b4b0c,0x3f696591
.long 0x3f61c598,0x3f5ebe05,0x3f5b941a,0x3f584853,0x3f514d3d,0x3f4cae79,0x3f47de65,0x3f42de29
.long 0x3f3daef9,0x3f373a23,0x3f3085bb,0x3f299415,0x3f273656,0x3f1ebc12,0x3f15f6d9,0x3f0cead0
.long 0x3f0e39da,0x3f039c3d,0x3ef15aea,0x3edae880,0x3ee63375,0x3ecc9b8b,0x3eb263ef,0x3e97a117
.long 0x3eac7cd4,0x3e8e9a22,0x3e605c13,0x3e22abb6,0x3e605c13,0x3e1c76de,0x3dafb680,0x3c96c9b6
.long 0x3dc8bd36,0x3cc90ab0,0xbd48fb30,0xbdfab273,0xbcc90ab0,0xbdd53db9,0xbe3b6ecf,0xbe8586ce
.long 0xbe164083,0xbe6c9a7f,0xbea09ae5,0xbec9b953,0xbe888e93,0xbeb554ec,0xbee0924f,0xbf04f484
.long 0xbec3ef15,0xbef15aea,0xbf0e39da,0xbf226799,0xbefc5d27,0xbf14b039,0xbf299415,0xbf3ca003
.long 0xbf187fc0,0xbf2e3bde,0xbf41d870,0xbf531849,0xbf3085bb,0xbf44e3f5,0xbf5695e5,0xbf655e0b
.long 0xbf45e403,0xbf584853,0xbf676bd8,0xbf731447,0xbf584853,0xbf6816a8,0xbf740bdd,0xbf7bf531
.long 0xbf676bd8,0xbf740bdd,0xbf7c3b28,0xbf7fd397,0xbf731447,0xbf7bf531,0xbf7fd397,0xbf7e9bc9
.long 0xbf7b14be,0xbf7fb10f,0xbf7ec46d,0xbf7853f8,0xbf7f4e6d,0xbf7f2f9d,0xbf791298,0xbf6d1c1d
.long 0xbf7fb10f,0xbf7a7302,0xbf6ed89e,0xbf5d2d53,0xbf7c3b28,0xbf718f57,0xbf604621,0xbf48d8b3
.long 0xbf74fa0b,0xbf64aa59,0xbf4d9f02,0xbf3085bb,0xbf6a09a7,0xbf53fac3,0xbf373a23,0xbf14b039
.long 0xbf5b941a,0xbf3fc767,0xbf1d7fd1,0xbeebcbbb,0xbf49d112,0xbf286605,0xbf00e7e4,0xbea986c4
.long 0x3f800000,0x3f800000,0x3f800000,0x3f800000,0x3f7d3aac,0x3f7cfe73,0x3f7cbfc9,0x3f7c7eb0
.long 0x3f74fa0b,0x3f740bdd,0x3f731447,0x3f721352,0x3f676bd8,0x3f655e0b,0x3f633c5a,0x3f6106f2
.long 0x3f54db31,0x3f514d3d,0x3f4d9f02,0x3f49d112,0x3f3daef9,0x3f385216,0x3f32c8c9,0x3f2d1469
.long 0x3f226799,0x3f1b02c6,0x3f13682a,0x3f0b9a6b,0x3f039c3d,0x3ef41f07,0x3ee0924f,0x3ecc9b8b
.long 0x3ec3ef15,0x3eac7cd4,0x3e94a031,0x3e78cfcc,0x3e78cfcc,0x3e419b37,0x3e09cf86,0x3da3308c
.long 0x3dc8bd36,0x3d16c32c,0xbcc90ab0,0xbdafb680,0xbd48fb30,0xbdee3876,0xbe3b6ecf,0xbe7ee6e1
.long 0xbe47c5c2,0xbe888e93,0xbeac7cd4,0xbecf7bca,0xbeac7cd4,0xbed25a09,0xbef6e0cb,0xbf0cead0
.long 0xbef15aea,0xbf0b9a6b,0xbf1d7fd1,0xbf2e3bde,0xbf187fc0,0xbf2ac082,0xbf3b8f3b,0xbf4ac77f
.long 0xbf3504f3,0xbf45e403,0xbf54db31,0xbf61c598,0xbf4d9f02,0xbf5c61c7,0xbf68bf3c,0xbf7294f8
.long 0xbf61c598,0xbf6db293,0xbf76ba07,0xbf7cbfc9,0xbf710908,0xbf796e4e,0xbf7e70b0,0xbf7ffec4
.long 0xbf7b14be,0xbf7f4e6d,0xbf7fb10f,0xbf7c3b28,0xbf7fb10f,0xbf7f2f9d,0xbf7a7302,0xbf718f57
.long 0xbf7ec46d,0xbf791298,0xbf6ed89e,0xbf604621,0xbf7853f8,0xbf6d1c1d,0xbf5d2d53,0xbf48d8b3
.long 0xbf6c835e,0xbf5b941a,0xbf45e403,0xbf2beb4a,0xbf5b941a,0xbf44e3f5,0xbf299415,0xbf0a48ad
.long 0xbf45e403,0xbf299415,0xbf08f59b,0xbec9b953,0xbf2beb4a,0xbf0a48ad,0xbec9b953,0xbe72b651
.long 0xbf0e39da,0xbecf7bca,0xbe78cfcc,0xbd96a905,0xbedae880,0xbe8586ce,0xbdafb680,0x3dbc3ac3
.long 0xbe94a031,0xbde1bc2e,0x3d96a905,0x3e827dc0,0xbe164083,0x3d2fe007,0x3e6c9a7f,0x3ed25a09
.long 0x3f800000,0x3f800000,0x3f800000,0x3f800000,0x3f7c3b28,0x3f7bf531,0x3f7baccd,0x3f7b61fc
.long 0x3f710908,0x3f6ff573,0x3f6ed89e,0x3f6db293,0x3f5ebe05,0x3f5c61c7,0x3f59f26a,0x3f577026
.long 0x3f45e403,0x3f41d870,0x3f3daef9,0x3f396842,0x3f273656,0x3f212ff9,0x3f1b02c6,0x3f14b039
.long 0x3f039c3d,0x3ef6e0cb,0x3ee63375,0x3ed53641,0x3eb8442a,0x3ea395c5,0x3e8e9a22,0x3e72b651
.long 0x3e47c5c2,0x3e164083,0x3dc8bd36,0x3d48fb30,0x3cc90ab0,0xbcfb49ba,0xbdafb680,0xbe1008b7
.long 0xbe164083,0xbe541501,0xbe888e93,0xbea68f12,0xbea09ae5,0xbec1071e,0xbee0924f,0xbeff17b2
.long 0xbef15aea,0xbf08f59b,0xbf187fc0,0xbf273656,0xbf1d7fd1,0xbf2d1469,0xbf3b8f3b,0xbf48d8b3
.long 0xbf3daef9,0xbf4bbbf8,0xbf584853,0xbf633c5a,0xbf584853,0xbf63f473,0xbf6db293,0xbf756d97
.long 0xbf6c835e,0xbf74fa0b,0xbf7b14be,0xbf7ec46d,0xbf79c79d,0xbf7e4323,0xbf7ffb11,0xbf7eea9d
.long 0xbf7fb10f,0xbf7f84ab,0xbf7c3b28,0xbf75dec6,0xbf7e1324,0xbf78b47b,0xbf6ff573,0xbf63f473
.long 0xbf74fa0b,0xbf6a09a7,0xbf5b941a,0xbf49d112,0xbf64aa59,0xbf53fac3,0xbf3fc767,0xbf286605
.long 0xbf4d9f02,0xbf373a23,0xbf1d7fd1,0xbf00e7e4,0xbf3085bb,0xbf14b039,0xbeebcbbb,0xbea986c4
.long 0xbf0e39da,0xbedae880,0xbe94a031,0xbe164083,0xbecf7bca,0xbe8586ce,0xbde1bc2e,0x3d2fe007
.long 0xbe78cfcc,0xbdafb680,0x3d96a905,0x3e6c9a7f,0xbd96a905,0x3dbc3ac3,0x3e827dc0,0x3ed25a09
.long 0x3dc8bd36,0x3e888e93,0x3edae880,0x3f13682a,0x3e888e93,0x3eddbe79,0x3f15f6d9,0x3f385216
.long 0x3edae880,0x3f15f6d9,0x3f396842,0x3f5695e5,0x3f13682a,0x3f385216,0x3f5695e5,0x3f6d1c1d
.long 0x0,0x0,0x0,0x0,0x0,0xbbc90f88,0xbc490e90,0xbc96c9b6
.long 0x0,0xbc490e90,0xbcc90ab0,0xbd16c32c,0x0,0xbc96c9b6,0xbd16c32c,0xbd621469
.long 0x0,0xbcc90ab0,0xbd48fb30,0xbd96a905,0x0,0xbcfb49ba,0xbd7b2b74,0xbdbc3ac3
.long 0x0,0xbd16c32c,0xbd96a905,0xbde1bc2e,0x0,0xbd2fe007,0xbdafb680,0xbe039502
.long 0x0,0xbd48fb30,0xbdc8bd36,0xbe164083,0x0,0xbd621469,0xbde1bc2e,0xbe28defc
.long 0x0,0xbd7b2b74,0xbdfab273,0xbe3b6ecf,0x0,0xbd8a200a,0xbe09cf86,0xbe4dee60
.long 0x0,0xbd96a905,0xbe164083,0xbe605c13,0x0,0xbda3308c,0xbe22abb6,0xbe72b651
.long 0x0,0xbdafb680,0xbe2f10a2,0xbe827dc0,0x0,0xbdbc3ac3,0xbe3b6ecf,0xbe8b9507
.long 0x0,0xbdc8bd36,0xbe47c5c2,0xbe94a031,0x0,0xbdd53db9,0xbe541501,0xbe9d9e78
.long 0x0,0xbde1bc2e,0xbe605c13,0xbea68f12,0x0,0xbdee3876,0xbe6c9a7f,0xbeaf713a
.long 0x0,0xbdfab273,0xbe78cfcc,0xbeb8442a,0x0,0xbe039502,0xbe827dc0,0xbec1071e
.long 0x0,0xbe09cf86,0xbe888e93,0xbec9b953,0x0,0xbe1008b7,0xbe8e9a22,0xbed25a09
.long 0x0,0xbe164083,0xbe94a031,0xbedae880,0x0,0xbe1c76de,0xbe9aa086,0xbee363fa
.long 0x0,0xbe22abb6,0xbea09ae5,0xbeebcbbb,0x0,0xbe28defc,0xbea68f12,0xbef41f07
.long 0x0,0xbe2f10a2,0xbeac7cd4,0xbefc5d27,0x0,0xbe354098,0xbeb263ef,0xbf0242b1
.long 0x0,0xbe3b6ecf,0xbeb8442a,0xbf064b82,0x0,0xbe419b37,0xbebe1d4a,0xbf0a48ad
.long 0x0,0x0,0x0,0x0,0xbcc90ab0,0xbcfb49ba,0xbd16c32c,0xbd2fe007
.long 0xbd48fb30,0xbd7b2b74,0xbd96a905,0xbdafb680,0xbd96a905,0xbdbc3ac3,0xbde1bc2e,0xbe039502
.long 0xbdc8bd36,0xbdfab273,0xbe164083,0xbe2f10a2,0xbdfab273,0xbe1c76de,0xbe3b6ecf,0xbe5a3997
.long 0xbe164083,0xbe3b6ecf,0xbe605c13,0xbe827dc0,0xbe2f10a2,0xbe5a3997,0xbe827dc0,0xbe97a117
.long 0xbe47c5c2,0xbe78cfcc,0xbe94a031,0xbeac7cd4,0xbe605c13,0xbe8b9507,0xbea68f12,0xbec1071e
.long 0xbe78cfcc,0xbe9aa086,0xbeb8442a,0xbed53641,0xbe888e93,0xbea986c4,0xbec9b953,0xbee900b7
.long 0xbe94a031,0xbeb8442a,0xbedae880,0xbefc5d27,0xbea09ae5,0xbec6d529,0xbeebcbbb,0xbf07a136
.long 0xbeac7cd4,0xbed53641,0xbefc5d27,0xbf10d3cd,0xbeb8442a,0xbee363fa,0xbf064b82,0xbf19c200
.long 0xbec3ef15,0xbef15aea,0xbf0e39da,0xbf226799,0xbecf7bca,0xbeff17b2,0xbf15f6d9,0xbf2ac082
.long 0xbedae880,0xbf064b82,0xbf1d7fd1,0xbf32c8c9,0xbee63375,0xbf0cead0,0xbf24d225,0xbf3a7ca4
.long 0xbef15aea,0xbf13682a,0xbf2beb4a,0xbf41d870,0xbefc5d27,0xbf19c200,0xbf32c8c9,0xbf48d8b3
.long 0xbf039c3d,0xbf1ff6cb,0xbf396842,0xbf4f7a1f,0xbf08f59b,0xbf26050a,0xbf3fc767,0xbf55b993
.long 0xbf0e39da,0xbf2beb4a,0xbf45e403,0xbf5b941a,0xbf13682a,0xbf31a81d,0xbf4bbbf8,0xbf6106f2
.long 0xbf187fc0,0xbf373a23,0xbf514d3d,0xbf660f88,0xbf1d7fd1,0xbf3ca003,0xbf5695e5,0xbf6aab7b
.long 0xbf226799,0xbf41d870,0xbf5b941a,0xbf6ed89e,0xbf273656,0xbf46e22a,0xbf604621,0xbf7294f8
.long 0xbf2beb4a,0xbf4bbbf8,0xbf64aa59,0xbf75dec6,0xbf3085bb,0xbf5064af,0xbf68bf3c,0xbf78b47b
.long 0x0,0x0,0x0,0x0,0xbd48fb30,0xbd621469,0xbd7b2b74,0xbd8a200a
.long 0xbdc8bd36,0xbde1bc2e,0xbdfab273,0xbe09cf86,0xbe164083,0xbe28defc,0xbe3b6ecf,0xbe4dee60
.long 0xbe47c5c2,0xbe605c13,0xbe78cfcc,0xbe888e93,0xbe78cfcc,0xbe8b9507,0xbe9aa086,0xbea986c4
.long 0xbe94a031,0xbea68f12,0xbeb8442a,0xbec9b953,0xbeac7cd4,0xbec1071e,0xbed53641,0xbee900b7
.long 0xbec3ef15,0xbedae880,0xbef15aea,0xbf039c3d,0xbedae880,0xbef41f07,0xbf064b82,0xbf121eb0
.long 0xbef15aea,0xbf064b82,0xbf13682a,0xbf1ff6cb,0xbf039c3d,0xbf121eb0,0xbf1ff6cb,0xbf2d1469
.long 0xbf0e39da,0xbf1d7fd1,0xbf2beb4a,0xbf396842,0xbf187fc0,0xbf286605,0xbf373a23,0xbf44e3f5
.long 0xbf226799,0xbf32c8c9,0xbf41d870,0xbf4f7a1f,0xbf2beb4a,0xbf3ca003,0xbf4bbbf8,0xbf591e6a
.long 0xbf3504f3,0xbf45e403,0xbf54db31,0xbf61c598,0xbf3daef9,0xbf4e8d90,0xbf5d2d53,0xbf696591
.long 0xbf45e403,0xbf5695e5,0xbf64aa59,0xbf6ff573,0xbf4d9f02,0xbf5df6be,0xbf6b4b0c,0xbf756d97
.long 0xbf54db31,0xbf64aa59,0xbf710908,0xbf79c79d,0xbf5b941a,0xbf6aab7b,0xbf75dec6,0xbf7cfe73
.long 0xbf61c598,0xbf6ff573,0xbf79c79d,0xbf7f0e58,0xbf676bd8,0xbf748422,0xbf7cbfc9,0xbf7ff4e6
.long 0xbf6c835e,0xbf7853f8,0xbf7ec46d,0xbf7fb10f,0xbf710908,0xbf7b61fc,0xbf7fd397,0xbf7e4323
.long 0xbf74fa0b,0xbf7dabcc,0xbf7fec43,0xbf7baccd,0xbf7853f8,0xbf7f2f9d,0xbf7f0e58,0xbf77f110
.long 0xbf7b14be,0xbf7fec43,0xbf7d3aac,0xbf731447,0xbf7d3aac,0xbf7fe129,0xbf7a7302,0xbf6d1c1d
.long 0xbf7ec46d,0xbf7f0e58,0xbf76ba07,0xbf660f88,0xbf7fb10f,0xbf7d7474,0xbf721352,0xbf5df6be
.long 0x0,0x0,0x0,0x0,0xbd96a905,0xbda3308c,0xbdafb680,0xbdbc3ac3
.long 0xbe164083,0xbe22abb6,0xbe2f10a2,0xbe3b6ecf,0xbe605c13,0xbe72b651,0xbe827dc0,0xbe8b9507
.long 0xbe94a031,0xbea09ae5,0xbeac7cd4,0xbeb8442a,0xbeb8442a,0xbec6d529,0xbed53641,0xbee363fa
.long 0xbedae880,0xbeebcbbb,0xbefc5d27,0xbf064b82,0xbefc5d27,0xbf07a136,0xbf10d3cd,0xbf19c200
.long 0xbf0e39da,0xbf187fc0,0xbf226799,0xbf2beb4a,0xbf1d7fd1,0xbf286605,0xbf32c8c9,0xbf3ca003
.long 0xbf2beb4a,0xbf373a23,0xbf41d870,0xbf4bbbf8,0xbf396842,0xbf44e3f5,0xbf4f7a1f,0xbf591e6a
.long 0xbf45e403,0xbf514d3d,0xbf5b941a,0xbf64aa59,0xbf514d3d,0xbf5c61c7,0xbf660f88,0xbf6e46be
.long 0xbf5b941a,0xbf660f88,0xbf6ed89e,0xbf75dec6,0xbf64aa59,0xbf6e46be,0xbf75dec6,0xbf7b61fc
.long 0xbf6c835e,0xbf74fa0b,0xbf7b14be,0xbf7ec46d,0xbf731447,0xbf7a1e84,0xbf7e70b0,0xbf7ffec4
.long 0xbf7853f8,0xbf7dabcc,0xbf7fec43,0xbf7f0e58,0xbf7c3b28,0xbf7f9c18,0xbf7f84ab,0xbf7bf531
.long 0xbf7ec46d,0xbf7fec43,0xbf7d3aac,0xbf76ba07,0xbf7fec43,0xbf7e9bc9,0xbf791298,0xbf6f6830
.long 0xbf7fb10f,0xbf7baccd,0xbf731447,0xbf660f88,0xbf7e1324,0xbf772417,0xbf6b4b0c,0xbf5ac450
.long 0xbf7b14be,0xbf710908,0xbf61c598,0xbf4d9f02,0xbf76ba07,0xbf696591,0xbf5695e5,0xbf3ebc1b
.long 0xbf710908,0xbf604621,0xbf49d112,0xbf2e3bde,0xbf6a09a7,0xbf55b993,0xbf3b8f3b,0xbf1c420c
.long 0xbf61c598,0xbf49d112,0xbf2beb4a,0xbf08f59b,0xbf584853,0xbf3ca003,0xbf1b02c6,0xbee900b7
.long 0xbf4d9f02,0xbf2e3bde,0xbf08f59b,0xbebe1d4a,0xbf41d870,0xbf1ebc12,0xbeebcbbb,0xbe919ddd
.long 0x0,0x0,0x0,0x0,0xbdc8bd36,0xbdd53db9,0xbde1bc2e,0xbdee3876
.long 0xbe47c5c2,0xbe541501,0xbe605c13,0xbe6c9a7f,0xbe94a031,0xbe9d9e78,0xbea68f12,0xbeaf713a
.long 0xbec3ef15,0xbecf7bca,0xbedae880,0xbee63375,0xbef15aea,0xbeff17b2,0xbf064b82,0xbf0cead0
.long 0xbf0e39da,0xbf15f6d9,0xbf1d7fd1,0xbf24d225,0xbf226799,0xbf2ac082,0xbf32c8c9,0xbf3a7ca4
.long 0xbf3504f3,0xbf3daef9,0xbf45e403,0xbf4d9f02,0xbf45e403,0xbf4e8d90,0xbf5695e5,0xbf5df6be
.long 0xbf54db31,0xbf5d2d53,0xbf64aa59,0xbf6b4b0c,0xbf61c598,0xbf696591,0xbf6ff573,0xbf756d97
.long 0xbf6c835e,0xbf731447,0xbf7853f8,0xbf7c3b28,0xbf74fa0b,0xbf7a1e84,0xbf7dabcc,0xbf7f9c18
.long 0xbf7b14be,0xbf7e70b0,0xbf7fec43,0xbf7f84ab,0xbf7ec46d,0xbf7ffec4,0xbf7f0e58,0xbf7bf531
.long 0xbf800000,0xbf7ec46d,0xbf7b14be,0xbf74fa0b,0xbf7ec46d,0xbf7ac516,0xbf740bdd,0xbf6aab7b
.long 0xbf7b14be,0xbf740bdd,0xbf6a09a7,0xbf5d2d53,0xbf74fa0b,0xbf6aab7b,0xbf5d2d53,0xbf4cae79
.long 0xbf6c835e,0xbf5ebe05,0xbf4d9f02,0xbf396842,0xbf61c598,0xbf5064af,0xbf3b8f3b,0xbf239da9
.long 0xbf54db31,0xbf3fc767,0xbf273656,0xbf0b9a6b,0xbf45e403,0xbf2d1469,0xbf10d3cd,0xbee363fa
.long 0xbf3504f3,0xbf187fc0,0xbef15aea,0xbeac7cd4,0xbf226799,0xbf0242b1,0xbebe1d4a,0xbe667c66
.long 0xbf0e39da,0xbed53641,0xbe888e93,0xbde1bc2e,0xbef15aea,0xbea395c5,0xbe22abb6,0x3bc90f88
.long 0xbec3ef15,0xbe605c13,0xbd48fb30,0x3dfab273,0xbe94a031,0xbdee3876,0x3d7b2b74,0x3e72b651
.long 0xbe47c5c2,0xbc490e90,0x3e2f10a2,0x3eb263ef,0xbdc8bd36,0x3dbc3ac3,0x3e8e9a22,0x3ee900b7
.long 0x0,0x0,0x0,0x0,0xbdfab273,0xbe039502,0xbe09cf86,0xbe1008b7
.long 0xbe78cfcc,0xbe827dc0,0xbe888e93,0xbe8e9a22,0xbeb8442a,0xbec1071e,0xbec9b953,0xbed25a09
.long 0xbef15aea,0xbefc5d27,0xbf039c3d,0xbf08f59b,0xbf13682a,0xbf19c200,0xbf1ff6cb,0xbf26050a
.long 0xbf2beb4a,0xbf32c8c9,0xbf396842,0xbf3fc767,0xbf41d870,0xbf48d8b3,0xbf4f7a1f,0xbf55b993
.long 0xbf54db31,0xbf5b941a,0xbf61c598,0xbf676bd8,0xbf64aa59,0xbf6aab7b,0xbf6ff573,0xbf748422
.long 0xbf710908,0xbf75dec6,0xbf79c79d,0xbf7cbfc9,0xbf79c79d,0xbf7cfe73,0xbf7f0e58,0xbf7ff4e6
.long 0xbf7ec46d,0xbf7fec43,0xbf7fb10f,0xbf7e1324,0xbf7fec43,0xbf7e9bc9,0xbf7baccd,0xbf772417
.long 0xbf7d3aac,0xbf791298,0xbf731447,0xbf6b4b0c,0xbf76ba07,0xbf6f6830,0xbf660f88,0xbf5ac450
.long 0xbf6c835e,0xbf61c598,0xbf54db31,0xbf45e403,0xbf5ebe05,0xbf5064af,0xbf3fc767,0xbf2d1469
.long 0xbf4d9f02,0xbf3b8f3b,0xbf273656,0xbf10d3cd,0xbf396842,0xbf239da9,0xbf0b9a6b,0xbee363fa
.long 0xbf226799,0xbf08f59b,0xbedae880,0xbea09ae5,0xbf08f59b,0xbed8106b,0xbe9aa086,0xbe354098
.long 0xbedae880,0xbe9aa086,0xbe2f10a2,0xbd16c32c,0xbea09ae5,0xbe354098,0xbd16c32c,0x3dd53db9
.long 0xbe47c5c2,0xbd48fb30,0x3dc8bd36,0x3e78cfcc,0xbd96a905,0x3da3308c,0x3e6c9a7f,0x3ec1071e
.long 0x3d48fb30,0x3e541501,0x3eb8442a,0x3f00e7e4,0x3e2f10a2,0x3ea986c4,0x3ef6e0cb,0x3f1ebc12
.long 0x3e94a031,0x3ee63375,0x3f187fc0,0x3f396842,0x3ecf7bca,0x3f0f8784,0x3f32c8c9,0x3f5064af
.long 0x3f039c3d,0x3f299415,0x3f49d112,0x3f633c5a,0x3f1d7fd1,0x3f40d0da,0x3f5d2d53,0x3f718f57
.long 0x0,0x0,0x0,0x0,0xbe164083,0xbe1c76de,0xbe22abb6,0xbe28defc
.long 0xbe94a031,0xbe9aa086,0xbea09ae5,0xbea68f12,0xbedae880,0xbee363fa,0xbeebcbbb,0xbef41f07
.long 0xbf0e39da,0xbf13682a,0xbf187fc0,0xbf1d7fd1,0xbf2beb4a,0xbf31a81d,0xbf373a23,0xbf3ca003
.long 0xbf45e403,0xbf4bbbf8,0xbf514d3d,0xbf5695e5,0xbf5b941a,0xbf6106f2,0xbf660f88,0xbf6aab7b
.long 0xbf6c835e,0xbf710908,0xbf74fa0b,0xbf7853f8,0xbf7853f8,0xbf7b61fc,0xbf7dabcc,0xbf7f2f9d
.long 0xbf7ec46d,0xbf7fd397,0xbf7fec43,0xbf7f0e58,0xbf7fb10f,0xbf7e4323,0xbf7baccd,0xbf77f110
.long 0xbf7b14be,0xbf76ba07,0xbf710908,0xbf6a09a7,0xbf710908,0xbf696591,0xbf604621,0xbf55b993
.long 0xbf61c598,0xbf5695e5,0xbf49d112,0xbf3b8f3b,0xbf4d9f02,0xbf3ebc1b,0xbf2e3bde,0xbf1c420c
.long 0xbf3504f3,0xbf226799,0xbf0e39da,0xbef15aea,0xbf187fc0,0xbf0242b1,0xbed53641,0xbea395c5
.long 0xbef15aea,0xbebe1d4a,0xbe888e93,0xbe22abb6,0xbeac7cd4,0xbe667c66,0xbde1bc2e,0x3bc90f88
.long 0xbe47c5c2,0xbd96a905,0x3d48fb30,0x3e2f10a2,0xbd48fb30,0x3da3308c,0x3e541501,0x3ea986c4
.long 0x3dc8bd36,0x3e6c9a7f,0x3eb8442a,0x3ef6e0cb,0x3e78cfcc,0x3ec1071e,0x3f00e7e4,0x3f1ebc12
.long 0x3ec3ef15,0x3f039c3d,0x3f226799,0x3f3daef9,0x3f039c3d,0x3f239da9,0x3f3fc767,0x3f577026
.long 0x3f226799,0x3f3fc767,0x3f584853,0x3f6b4b0c,0x3f3daef9,0x3f577026,0x3f6b4b0c,0x3f78b47b
.long 0x3f54db31,0x3f6a09a7,0x3f7853f8,0x3f7f4e6d,0x3f676bd8,0x3f772417,0x3f7f0e58,0x3f7eea9d
.long 0x3f74fa0b,0x3f7e70b0,0x3f7f4e6d,0x3f778bc5,0x3f7d3aac,0x3f7fc38f,0x3f791298,0x3f696591
.long 0x0,0x0,0x0,0x0,0xbe2f10a2,0xbe354098,0xbe3b6ecf,0xbe419b37
.long 0xbeac7cd4,0xbeb263ef,0xbeb8442a,0xbebe1d4a,0xbefc5d27,0xbf0242b1,0xbf064b82,0xbf0a48ad
.long 0xbf226799,0xbf273656,0xbf2beb4a,0xbf3085bb,0xbf41d870,0xbf46e22a,0xbf4bbbf8,0xbf5064af
.long 0xbf5b941a,0xbf604621,0xbf64aa59,0xbf68bf3c,0xbf6ed89e,0xbf7294f8,0xbf75dec6,0xbf78b47b
.long 0xbf7b14be,0xbf7d3aac,0xbf7ec46d,0xbf7fb10f,0xbf7fec43,0xbf7fe129,0xbf7f0e58,0xbf7d7474
.long 0xbf7d3aac,0xbf7a7302,0xbf76ba07,0xbf721352,0xbf731447,0xbf6d1c1d,0xbf660f88,0xbf5df6be
.long 0xbf61c598,0xbf584853,0xbf4d9f02,0xbf41d870,0xbf49d112,0xbf3ca003,0xbf2e3bde,0xbf1ebc12
.long 0xbf2beb4a,0xbf1b02c6,0xbf08f59b,0xbeebcbbb,0xbf08f59b,0xbee900b7,0xbebe1d4a,0xbe919ddd
.long 0xbec3ef15,0xbe94a031,0xbe47c5c2,0xbdc8bd36,0xbe605c13,0xbdee3876,0xbc490e90,0x3dbc3ac3
.long 0xbd48fb30,0x3d7b2b74,0x3e2f10a2,0x3e8e9a22,0x3dfab273,0x3e72b651,0x3eb263ef,0x3ee900b7
.long 0x3e94a031,0x3ecf7bca,0x3f039c3d,0x3f1d7fd1,0x3ee63375,0x3f0f8784,0x3f299415,0x3f40d0da
.long 0x3f187fc0,0x3f32c8c9,0x3f49d112,0x3f5d2d53,0x3f396842,0x3f5064af,0x3f633c5a,0x3f718f57
.long 0x3f54db31,0x3f676bd8,0x3f74fa0b,0x3f7d3aac,0x3f6a09a7,0x3f772417,0x3f7e70b0,0x3f7fc38f
.long 0x3f7853f8,0x3f7f0e58,0x3f7f4e6d,0x3f791298,0x3f7f4e6d,0x3f7eea9d,0x3f778bc5,0x3f696591
.long 0x3f7ec46d,0x3f76ba07,0x3f676bd8,0x3f514d3d,0x3f76ba07,0x3f66becc,0x3f4f7a1f,0x3f31a81d
.long 0x3f676bd8,0x3f4f7a1f,0x3f3085bb,0x3f0b9a6b,0x3f514d3d,0x3f31a81d,0x3f0b9a6b,0x3ec1071e
.size tab_f1, 16384
.section .rodata,"a"
.p2align 8
.type tab_f2,@object
tab_f2:
.long 0x3f803f80,0x3f803f80,0x3f803f80,0x3f803f80,0x3f7b3f80,0x3f553f6d,0xbe48248d,0xbf0ebec4
.long 0x3f6d3f80,0x3ec43f35,0xbf6dbf80,0xbec4bf35,0x3f553f80,0xbe483ec4,0x3f0ea554,0x3f7b3f6d
.long 0x3f353f80,0xbf35248d,0x3f353f80,0xbf35248d,0x3f0e3f80,0xbf7bbec4,0xbf55248d,0xbe48bf6d
.long 0x3ec43f80,0xbf6dbf35,0xbec4bf80,0x3f6d3f35,0x3e483f80,0xbf0ebf6d,0x3f7ba554,0xbf553ec4
.long 0x248d3f80,0xa554bf80,0x248d3f80,0xa554bf80,0xbe483f80,0x3f0ebf6d,0xbf7b248d,0x3f553ec4
.long 0xbec43f80,0x3f6dbf35,0x3ec4bf80,0xbf6d3f35,0xbf0e3f80,0x3f7bbec4,0x3f55a554,0x3e48bf6d
.long 0xbf353f80,0x3f35a554,0xbf353f80,0x3f35a554,0xbf553f80,0x3e483ec4,0xbf0e248d,0xbf7b3f6d
.long 0xbf6d3f80,0xbec43f35,0x3f6dbf80,0x3ec4bf35,0xbf7b3f80,0xbf553f6d,0x3e48a554,0x3f0ebec4
.long 0xbf803f80,0xbf803f80,0xbf803f80,0xbf803f80,0xbf7b3f80,0xbf553f6d,0x3e48248d,0x3f0ebec4
.long 0xbf6d3f80,0xbec43f35,0x3f6dbf80,0x3ec4bf35,0xbf553f80,0x3e483ec4,0xbf0ea554,0xbf7b3f6d
.long 0xbf353f80,0x3f35248d,0xbf353f80,0x3f35248d,0xbf0e3f80,0x3f7bbec4,0x3f55248d,0x3e48bf6d
.long 0xbec43f80,0x3f6dbf35,0x3ec4bf80,0xbf6d3f35,0xbe483f80,0x3f0ebf6d,0xbf7ba554,0x3f553ec4
.long 0xa5543f80,0x248dbf80,0xa5543f80,0x248dbf80,0x3e483f80,0xbf0ebf6d,0x3f7b248d,0xbf553ec4
.long 0x3ec43f80,0xbf6dbf35,0xbec4bf80,0x3f6d3f35,0x3f0e3f80,0xbf7bbec4,0xbf55a554,0xbe48bf6d
.long 0x3f353f80,0xbf35a554,0x3f353f80,0xbf35a554,0x3f553f80,0xbe483ec4,0x3f0e248d,0x3f7b3f6d
.long 0x3f6d3f80,0x3ec43f35,0xbf6dbf80,0xbec4bf35,0x3f7b3f80,0x3f553f6d,0xbe48a554,0xbf0ebec4
.long 0x3f803f80,0x3f803f80,0x3f803f80,0x3f803f80,0x3f0e3f35,0x3e483ec4,0xbf55bf35,0xbf7bbf6d
.long 0xbec4248d,0xbf6dbf35,0x3ec4a554,0x3f6d3f35,0xbf7bbf35,0xbf0ebf6d,0x3e483f35,0xbf55bec4
.long 0xbf35bf80,0x3f35a554,0xbf35bf80,0x3f35a554,0x3e48bf35,0x3f553f6d,0x3f7b3f35,0xbf0e3ec4
.long 0x3f6da554,0xbec43f35,0xbf6d248d,0x3ec4bf35,0x3f553f35,0xbf7bbec4,0x3f0ebf35,0xbe483f6d
.long 0x248d3f80,0xa554bf80,0x248d3f80,0xa554bf80,0xbf553f35,0x3f7bbec4,0xbf0ebf35,0x3e483f6d
.long 0xbf6d248d,0x3ec43f35,0x3f6da554,0xbec4bf35,0xbe48bf35,0xbf553f6d,0xbf7b3f35,0x3f0e3ec4
.long 0x3f35bf80,0xbf35248d,0x3f35bf80,0xbf35248d,0x3f7bbf35,0x3f0ebf6d,0xbe483f35,0x3f55bec4
.long 0x3ec4a554,0x3f6dbf35,0xbec4248d,0xbf6d3f35,0xbf0e3f35,0xbe483ec4,0x3f55bf35,0x3f7bbf6d
.long 0xbf803f80,0xbf803f80,0xbf803f80,0xbf803f80,0xbf0e3f35,0xbe483ec4,0x3f55bf35,0x3f7bbf6d
.long 0x3ec4248d,0x3f6dbf35,0xbec4a554,0xbf6d3f35,0x3f7bbf35,0x3f0ebf6d,0xbe483f35,0x3f55bec4
.long 0x3f35bf80,0xbf35a554,0x3f35bf80,0xbf35a554,0xbe48bf35,0xbf553f6d,0xbf7b3f35,0x3f0e3ec4
.long 0xbf6da554,0x3ec43f35,0x3f6d248d,0xbec4bf35,0xbf553f35,0x3f7bbec4,0xbf0ebf35,0x3e483f6d
.long 0xa5543f80,0x248dbf80,0xa5543f80,0x248dbf80,0x3f553f35,0xbf7bbec4,0x3f0ebf35,0xbe483f6d
.long 0x3f6d248d,0xbec43f35,0xbf6da554,0x3ec4bf35,0x3e48bf35,0x3f553f6d,0x3f7b3f35,0xbf0e3ec4
.long 0xbf35bf80,0x3f35248d,0xbf35bf80,0x3f35248d,0xbf7bbf35,0xbf0ebf6d,0x3e483f35,0xbf55bec4
.long 0xbec4a554,0xbf6dbf35,0x3ec4248d,0x3f6d3f35,0x3f0e3f35,0x3e483ec4,0xbf55bf35,0xbf7bbf6d
.long 0x0,0x0,0x0,0x0,0xbe480000,0xbf0ebec4,0xbf7bbf80,0xbf55bf6d
.long 0xbec40000,0xbf6dbf35,0x3ec4a50d,0x3f6d3f35,0xbf0e0000,0xbf7bbf6d,0x3f553f80,0xbe483ec4
.long 0xbf350000,0xbf35bf80,0xbf350000,0xbf35bf80,0xbf550000,0xbe48bf6d,0xbf0ebf80,0x3f7b3ec4
.long 0xbf6d0000,0x3ec4bf35,0x3f6da50d,0xbec43f35,0xbf7b0000,0x3f55bec4,0x3e483f80,0xbf0ebf6d
.long 0xbf800000,0x3f80a50d,0xbf800000,0x3f80a50d,0xbf7b0000,0x3f553ec4,0x3e48bf80,0xbf0e3f6d
.long 0xbf6d0000,0x3ec43f35,0x3f6da50d,0xbec4bf35,0xbf550000,0xbe483f6d,0xbf0e3f80,0x3f7bbec4
.long 0xbf350000,0xbf353f80,0xbf350000,0xbf353f80,0xbf0e0000,0xbf7b3f6d,0x3f55bf80,0xbe48bec4
.long 0xbec40000,0xbf6d3f35,0x3ec4a50d,0x3f6dbf35,0xbe480000,0xbf0e3ec4,0xbf7b3f80,0xbf553f6d
.long 0xa50d0000,0xa50d0000,0xa50d0000,0xa50d0000,0x3e480000,0x3f0ebec4,0x3f7bbf80,0x3f55bf6d
.long 0x3ec40000,0x3f6dbf35,0xbec4a50d,0xbf6d3f35,0x3f0e0000,0x3f7bbf6d,0xbf553f80,0x3e483ec4
.long 0x3f350000,0x3f35bf80,0x3f350000,0x3f35bf80,0x3f550000,0x3e48bf6d,0x3f0ebf80,0xbf7b3ec4
.long 0x3f6d0000,0xbec4bf35,0xbf6da50d,0x3ec43f35,0x3f7b0000,0xbf55bec4,0xbe483f80,0x3f0ebf6d
.long 0x3f800000,0xbf80a50d,0x3f800000,0xbf80a50d,0x3f7b0000,0xbf553ec4,0xbe48bf80,0x3f0e3f6d
.long 0x3f6d0000,0xbec43f35,0xbf6da50d,0x3ec4bf35,0x3f550000,0x3e483f6d,0x3f0e3f80,0xbf7bbec4
.long 0x3f350000,0x3f353f80,0x3f350000,0x3f353f80,0x3f0e0000,0x3f7b3f6d,0xbf55bf80,0x3e48bec4
.long 0x3ec40000,0x3f6d3f35,0xbec4a50d,0xbf6dbf35,0x3e480000,0x3f0e3ec4,0x3f7b3f80,0x3f553f6d
.long 0x0,0x0,0x0,0x0,0xbf55bf35,0xbf7bbf6d,0xbf0ebf35,0xbe48bec4
.long 0xbf6dbf80,0xbec4bf35,0x3f6d3f80,0x3ec43f35,0xbe48bf35,0x3f553ec4,0xbf7bbf35,0xbf0ebf6d
.long 0x3f35a50d,0x3f353f80,0x3f35a50d,0x3f353f80,0x3f7b3f35,0xbf0e3ec4,0xbe483f35,0xbf55bf6d
.long 0x3ec43f80,0xbf6dbf35,0xbec4bf80,0x3f6d3f35,0xbf0e3f35,0x3e48bf6d,0x3f553f35,0xbf7bbec4
.long 0xbf800000,0x3f80a50d,0xbf800000,0x3f80a50d,0xbf0ebf35,0x3e483f6d,0x3f55bf35,0xbf7b3ec4
.long 0x3ec4bf80,0xbf6d3f35,0xbec43f80,0x3f6dbf35,0x3f7bbf35,0xbf0ebec4,0xbe48bf35,0xbf553f6d
.long 0x3f35a50d,0x3f35bf80,0x3f35a50d,0x3f35bf80,0xbe483f35,0x3f55bec4,0xbf7b3f35,0xbf0e3f6d
.long 0xbf6d3f80,0xbec43f35,0x3f6dbf80,0x3ec4bf35,0xbf553f35,0xbf7b3f6d,0xbf0e3f35,0xbe483ec4
.long 0xa50d0000,0xa50d0000,0xa50d0000,0xa50d0000,0x3f55bf35,0x3f7bbf6d,0x3f0ebf35,0x3e48bec4
.long 0x3f6dbf80,0x3ec4bf35,0xbf6d3f80,0xbec43f35,0x3e48bf35,0xbf553ec4,0x3f7bbf35,0x3f0ebf6d
.long 0xbf35a50d,0xbf353f80,0xbf35a50d,0xbf353f80,0xbf7b3f35,0x3f0e3ec4,0x3e483f35,0x3f55bf6d
.long 0xbec43f80,0x3f6dbf35,0x3ec4bf80,0xbf6d3f35,0x3f0e3f35,0xbe48bf6d,0xbf553f35,0x3f7bbec4
.long 0x3f800000,0xbf80a50d,0x3f800000,0xbf80a50d,0x3f0ebf35,0xbe483f6d,0xbf55bf35,0x3f7b3ec4
.long 0xbec4bf80,0x3f6d3f35,0x3ec43f80,0xbf6dbf35,0xbf7bbf35,0x3f0ebec4,0x3e48bf35,0x3f553f6d
.long 0xbf35a50d,0xbf35bf80,0xbf35a50d,0xbf35bf80,0x3e483f35,0xbf55bec4,0x3f7b3f35,0x3f0e3f6d
.long 0x3f6d3f80,0x3ec43f35,0xbf6dbf80,0xbec4bf35,0x3f553f35,0x3f7b3f6d,0x3f0e3f35,0x3e483ec4
.long 0x80008000,0x80008000,0x80008000,0x80008000,0x3e488000,0x3f0e3ec4,0x3f7b3f80,0x3f553f6d
.long 0x3ec48000,0x3f6d3f35,0xbec4250d,0xbf6dbf35,0x3f0e8000,0x3f7b3f6d,0xbf55bf80,0x3e48bec4
.long 0x3f358000,0x3f353f80,0x3f358000,0x3f353f80,0x3f558000,0x3e483f6d,0x3f0e3f80,0xbf7bbec4
.long 0x3f6d8000,0xbec43f35,0xbf6d250d,0x3ec4bf35,0x3f7b8000,0xbf553ec4,0xbe48bf80,0x3f0e3f6d
.long 0x3f808000,0xbf80250d,0x3f808000,0xbf80250d,0x3f7b8000,0xbf55bec4,0xbe483f80,0x3f0ebf6d
.long 0x3f6d8000,0xbec4bf35,0xbf6d250d,0x3ec43f35,0x3f558000,0x3e48bf6d,0x3f0ebf80,0xbf7b3ec4
.long 0x3f358000,0x3f35bf80,0x3f358000,0x3f35bf80,0x3f0e8000,0x3f7bbf6d,0xbf553f80,0x3e483ec4
.long 0x3ec48000,0x3f6dbf35,0xbec4250d,0xbf6d3f35,0x3e488000,0x3f0ebec4,0x3f7bbf80,0x3f55bf6d
.long 0x250d8000,0x250d8000,0x250d8000,0x250d8000,0xbe488000,0xbf0e3ec4,0xbf7b3f80,0xbf553f6d
.long 0xbec48000,0xbf6d3f35,0x3ec4250d,0x3f6dbf35,0xbf0e8000,0xbf7b3f6d,0x3f55bf80,0xbe48bec4
.long 0xbf358000,0xbf353f80,0xbf358000,0xbf353f80,0xbf558000,0xbe483f6d,0xbf0e3f80,0x3f7bbec4
.long 0xbf6d8000,0x3ec43f35,0x3f6d250d,0xbec4bf35,0xbf7b8000,0x3f553ec4,0x3e48bf80,0xbf0e3f6d
.long 0xbf808000,0x3f80250d,0xbf808000,0x3f80250d,0xbf7b8000,0x3f55bec4,0x3e483f80,0xbf0ebf6d
.long 0xbf6d8000,0x3ec4bf35,0x3f6d250d,0xbec43f35,0xbf558000,0xbe48bf6d,0xbf0ebf80,0x3f7b3ec4
.long 0xbf358000,0xbf35bf80,0xbf358000,0xbf35bf80,0xbf0e8000,0xbf7bbf6d,0x3f553f80,0xbe483ec4
.long 0xbec48000,0xbf6dbf35,0x3ec4250d,0x3f6d3f35,0xbe488000,0xbf0ebec4,0xbf7bbf80,0xbf55bf6d
.long 0x80008000,0x80008000,0x80008000,0x80008000,0x3f553f35,0x3f7b3f6d,0x3f0e3f35,0x3e483ec4
.long 0x3f6d3f80,0x3ec43f35,0xbf6dbf80,0xbec4bf35,0x3e483f35,0xbf55bec4,0x3f7b3f35,0x3f0e3f6d
.long 0xbf35250d,0xbf35bf80,0xbf35250d,0xbf35bf80,0xbf7bbf35,0x3f0ebec4,0x3e48bf35,0x3f553f6d
.long 0xbec4bf80,0x3f6d3f35,0x3ec43f80,0xbf6dbf35,0x3f0ebf35,0xbe483f6d,0xbf55bf35,0x3f7b3ec4
.long 0x3f808000,0xbf80250d,0x3f808000,0xbf80250d,0x3f0e3f35,0xbe48bf6d,0xbf553f35,0x3f7bbec4
.long 0xbec43f80,0x3f6dbf35,0x3ec4bf80,0xbf6d3f35,0xbf7b3f35,0x3f0e3ec4,0x3e483f35,0x3f55bf6d
.long 0xbf35250d,0xbf353f80,0xbf35250d,0xbf353f80,0x3e48bf35,0xbf553ec4,0x3f7bbf35,0x3f0ebf6d
.long 0x3f6dbf80,0x3ec4bf35,0xbf6d3f80,0xbec43f35,0x3f55bf35,0x3f7bbf6d,0x3f0ebf35,0x3e48bec4
.long 0x250d8000,0x250d8000,0x250d8000,0x250d8000,0xbf553f35,0xbf7b3f6d,0xbf0e3f35,0xbe483ec4
.long 0xbf6d3f80,0xbec43f35,0x3f6dbf80,0x3ec4bf35,0xbe483f35,0x3f55bec4,0xbf7b3f35,0xbf0e3f6d
.long 0x3f35250d,0x3f35bf80,0x3f35250d,0x3f35bf80,0x3f7bbf35,0xbf0ebec4,0xbe48bf35,0xbf553f6d
.long 0x3ec4bf80,0xbf6d3f35,0xbec43f80,0x3f6dbf35,0xbf0ebf35,0x3e483f6d,0x3f55bf35,0xbf7b3ec4
.long 0xbf808000,0x3f80250d,0xbf808000,0x3f80250d,0xbf0e3f35,0x3e48bf6d,0x3f553f35,0xbf7bbec4
.long 0x3ec43f80,0xbf6dbf35,0xbec4bf80,0x3f6d3f35,0x3f7b3f35,0xbf0e3ec4,0xbe483f35,0xbf55bf6d
.long 0x3f35250d,0x3f353f80,0x3f35250d,0x3f353f80,0xbe48bf35,0x3f553ec4,0xbf7bbf35,0xbf0ebf6d
.long 0xbf6dbf80,0xbec4bf35,0x3f6d3f80,0x3ec43f35,0xbf55bf35,0xbf7bbf6d,0xbf0ebf35,0xbe48bec4
.long 0x3f803f80,0x3f803f80,0x3f803f80,0x3f803f80,0x3f753f7f,0x3f463f62,0xbe95bdc9,0xbf22bef1
.long 0x3f553f7b,0x3e483f0e,0xbf55bf7b,0xbe48bf0e,0x3f223f75,0xbef13dc9,0x3f463e95,0x3f623f7f
.long 0x3ec43f6d,0xbf6dbec4,0x3ec43f6d,0xbf6dbec4,0x3dc93f62,0xbf75bf46,0xbf7fbef1,0x3e95bf22
.long 0xbe483f55,0xbf0ebf7b,0x3e48bf55,0x3f0e3f7b,0xbef13f46,0x3dc9bf75,0x3f623f22,0xbf7fbe95
.long 0xbf353f35,0x3f35bf35,0xbf353f35,0x3f35bf35,0xbf623f22,0x3f7fbe95,0xbef1bf46,0x3dc93f75
.long 0xbf7b3f0e,0x3f553e48,0x3f7bbf0e,0xbf55be48,0xbf7f3ef1,0x3e953f22,0xbdc93f62,0x3f75bf46
.long 0xbf6d3ec4,0xbec43f6d,0xbf6d3ec4,0xbec43f6d,0xbf463e95,0xbf623f7f,0x3f22bf75,0xbef1bdc9
.long 0xbf0e3e48,0xbf7b3f55,0x3f0ebe48,0x3f7bbf55,0xbe953dc9,0xbf223ef1,0xbf753f7f,0xbf463f62
.long 0xa554248d,0xa554248d,0xa554248d,0xa554248d,0x3e95bdc9,0x3f22bef1,0x3f75bf7f,0x3f46bf62
.long 0x3f0ebe48,0x3f7bbf55,0xbf0e3e48,0xbf7b3f55,0x3f46be95,0x3f62bf7f,0xbf223f75,0x3ef13dc9
.long 0x3f6dbec4,0x3ec4bf6d,0x3f6dbec4,0x3ec4bf6d,0x3f7fbef1,0xbe95bf22,0x3dc9bf62,0xbf753f46
.long 0x3f7bbf0e,0xbf55be48,0xbf7b3f0e,0x3f553e48,0x3f62bf22,0xbf7f3e95,0x3ef13f46,0xbdc9bf75
.long 0x3f35bf35,0xbf353f35,0x3f35bf35,0xbf353f35,0x3ef1bf46,0xbdc93f75,0xbf62bf22,0x3f7f3e95
.long 0x3e48bf55,0x3f0e3f7b,0xbe483f55,0xbf0ebf7b,0xbdc9bf62,0x3f753f46,0x3f7f3ef1,0xbe953f22
.long 0xbec4bf6d,0x3f6d3ec4,0xbec4bf6d,0x3f6d3ec4,0xbf22bf75,0x3ef1bdc9,0xbf46be95,0xbf62bf7f
.long 0xbf55bf7b,0xbe48bf0e,0x3f553f7b,0x3e483f0e,0xbf75bf7f,0xbf46bf62,0x3e953dc9,0x3f223ef1
.long 0x3f803f80,0x3f803f80,0x3f803f80,0x3f803f80,0x3ef13f22,0x3dc93e95,0xbf62bf46,0xbf7fbf75
.long 0xbf0ebe48,0xbf7bbf55,0x3f0e3e48,0x3f7b3f55,0xbf7fbf62,0xbe95bf46,0xbdc93ef1,0xbf75bf22
.long 0xbec4bf6d,0x3f6d3ec4,0xbec4bf6d,0x3f6d3ec4,0x3f22be95,0x3ef13f7f,0x3f463f75,0xbf62bdc9
.long 0x3f7b3f0e,0xbf553e48,0xbf7bbf0e,0x3f55be48,0x3e953f7f,0xbf22bf62,0x3f75bdc9,0xbf463ef1
.long 0xbf353f35,0x3f35bf35,0xbf353f35,0x3f35bf35,0xbf75bdc9,0x3f463ef1,0x3e95bf7f,0xbf223f62
.long 0xbe48bf55,0xbf0e3f7b,0x3e483f55,0x3f0ebf7b,0x3f46bf75,0xbf623dc9,0xbf22be95,0xbef13f7f
.long 0x3f6dbec4,0x3ec4bf6d,0x3f6dbec4,0x3ec4bf6d,0x3dc93ef1,0x3f75bf22,0xbf7f3f62,0xbe953f46
.long 0xbf553f7b,0xbe483f0e,0x3f55bf7b,0x3e48bf0e,0xbf623f46,0xbf7f3f75,0xbef13f22,0xbdc93e95
.long 0xa554248d,0xa554248d,0xa554248d,0xa554248d,0x3f62bf46,0x3f7fbf75,0x3ef1bf22,0x3dc9be95
.long 0x3f55bf7b,0x3e48bf0e,0xbf553f7b,0xbe483f0e,0xbdc9bef1,0xbf753f22,0x3f7fbf62,0x3e95bf46
.long 0xbf6d3ec4,0xbec43f6d,0xbf6d3ec4,0xbec43f6d,0xbf463f75,0x3f62bdc9,0x3f223e95,0x3ef1bf7f
.long 0x3e483f55,0x3f0ebf7b,0xbe48bf55,0xbf0e3f7b,0x3f753dc9,0xbf46bef1,0xbe953f7f,0x3f22bf62
.long 0x3f35bf35,0xbf353f35,0x3f35bf35,0xbf353f35,0xbe95bf7f,0x3f223f62,0xbf753dc9,0x3f46bef1
.long 0xbf7bbf0e,0x3f55be48,0x3f7b3f0e,0xbf553e48,0xbf223e95,0xbef1bf7f,0xbf46bf75,0x3f623dc9
.long 0x3ec43f6d,0xbf6dbec4,0x3ec43f6d,0xbf6dbec4,0x3f7f3f62,0x3e953f46,0x3dc9bef1,0x3f753f22
.long 0x3f0e3e48,0x3f7b3f55,0xbf0ebe48,0xbf7bbf55,0xbef1bf22,0xbdc9be95,0x3f623f46,0x3f7f3f75
.long 0x0,0x0,0x0,0x0,0xbe95bdc9,0xbf22bef1,0xbf75bf7f,0xbf46bf62
.long 0xbf0ebe48,0xbf7bbf55,0x3f0e3e48,0x3f7b3f55,0xbf46be95,0xbf62bf7f,0x3f223f75,0xbef13dc9
.long 0xbf6dbec4,0xbec4bf6d,0xbf6dbec4,0xbec4bf6d,0xbf7fbef1,0x3e95bf22,0xbdc9bf62,0x3f753f46
.long 0xbf7bbf0e,0x3f55be48,0x3f7b3f0e,0xbf553e48,0xbf62bf22,0x3f7f3e95,0xbef13f46,0x3dc9bf75
.long 0xbf35bf35,0x3f353f35,0xbf35bf35,0x3f353f35,0xbef1bf46,0x3dc93f75,0x3f62bf22,0xbf7f3e95
.long 0xbe48bf55,0xbf0e3f7b,0x3e483f55,0x3f0ebf7b,0x3dc9bf62,0xbf753f46,0xbf7f3ef1,0x3e953f22
.long 0x3ec4bf6d,0xbf6d3ec4,0x3ec4bf6d,0xbf6d3ec4,0x3f22bf75,0xbef1bdc9,0x3f46be95,0x3f62bf7f
.long 0x3f55bf7b,0x3e48bf0e,0xbf553f7b,0xbe483f0e,0x3f75bf7f,0x3f46bf62,0xbe953dc9,0xbf223ef1
.long 0x3f80bf80,0x3f80bf80,0x3f80bf80,0x3f80bf80,0x3f75bf7f,0x3f46bf62,0xbe953dc9,0xbf223ef1
.long 0x3f55bf7b,0x3e48bf0e,0xbf553f7b,0xbe483f0e,0x3f22bf75,0xbef1bdc9,0x3f46be95,0x3f62bf7f
.long 0x3ec4bf6d,0xbf6d3ec4,0x3ec4bf6d,0xbf6d3ec4,0x3dc9bf62,0xbf753f46,0xbf7f3ef1,0x3e953f22
.long 0xbe48bf55,0xbf0e3f7b,0x3e483f55,0x3f0ebf7b,0xbef1bf46,0x3dc93f75,0x3f62bf22,0xbf7f3e95
.long 0xbf35bf35,0x3f353f35,0xbf35bf35,0x3f353f35,0xbf62bf22,0x3f7f3e95,0xbef13f46,0x3dc9bf75
.long 0xbf7bbf0e,0x3f55be48,0x3f7b3f0e,0xbf553e48,0xbf7fbef1,0x3e95bf22,0xbdc9bf62,0x3f753f46
.long 0xbf6dbec4,0xbec4bf6d,0xbf6dbec4,0xbec4bf6d,0xbf46be95,0xbf62bf7f,0x3f223f75,0xbef13dc9
.long 0xbf0ebe48,0xbf7bbf55,0x3f0e3e48,0x3f7b3f55,0xbe95bdc9,0xbf22bef1,0xbf75bf7f,0xbf46bf62
.long 0x0,0x0,0x0,0x0,0xbf62bf46,0xbf7fbf75,0xbef1bf22,0xbdc9be95
.long 0xbf55bf7b,0xbe48bf0e,0x3f553f7b,0x3e483f0e,0x3dc9bef1,0x3f753f22,0xbf7fbf62,0xbe95bf46
.long 0x3f6d3ec4,0x3ec43f6d,0x3f6d3ec4,0x3ec43f6d,0x3f463f75,0xbf62bdc9,0xbf223e95,0xbef1bf7f
.long 0xbe483f55,0xbf0ebf7b,0x3e48bf55,0x3f0e3f7b,0xbf753dc9,0x3f46bef1,0x3e953f7f,0xbf22bf62
.long 0xbf35bf35,0x3f353f35,0xbf35bf35,0x3f353f35,0x3e95bf7f,0xbf223f62,0x3f753dc9,0xbf46bef1
.long 0x3f7bbf0e,0xbf55be48,0xbf7b3f0e,0x3f553e48,0x3f223e95,0x3ef1bf7f,0x3f46bf75,0xbf623dc9
.long 0xbec43f6d,0x3f6dbec4,0xbec43f6d,0x3f6dbec4,0xbf7f3f62,0xbe953f46,0xbdc9bef1,0xbf753f22
.long 0xbf0e3e48,0xbf7b3f55,0x3f0ebe48,0x3f7bbf55,0x3ef1bf22,0x3dc9be95,0xbf623f46,0xbf7f3f75
.long 0x3f80bf80,0x3f80bf80,0x3f80bf80,0x3f80bf80,0x3ef1bf22,0x3dc9be95,0xbf623f46,0xbf7f3f75
.long 0xbf0e3e48,0xbf7b3f55,0x3f0ebe48,0x3f7bbf55,0xbf7f3f62,0xbe953f46,0xbdc9bef1,0xbf753f22
.long 0xbec43f6d,0x3f6dbec4,0xbec43f6d,0x3f6dbec4,0x3f223e95,0x3ef1bf7f,0x3f46bf75,0xbf623dc9
.long 0x3f7bbf0e,0xbf55be48,0xbf7b3f0e,0x3f553e48,0x3e95bf7f,0xbf223f62,0x3f753dc9,0xbf46bef1
.long 0xbf35bf35,0x3f353f35,0xbf35bf35,0x3f353f35,0xbf753dc9,0x3f46bef1,0x3e953f7f,0xbf22bf62
.long 0xbe483f55,0xbf0ebf7b,0x3e48bf55,0x3f0e3f7b,0x3f463f75,0xbf62bdc9,0xbf223e95,0xbef1bf7f
.long 0x3f6d3ec4,0x3ec43f6d,0x3f6d3ec4,0x3ec43f6d,0x3dc9bef1,0x3f753f22,0xbf7fbf62,0xbe95bf46
.long 0xbf55bf7b,0xbe48bf0e,0x3f553f7b,0x3e483f0e,0xbf62bf46,0xbf7fbf75,0xbef1bf22,0xbdc9be95
.long 0x80008000,0x80008000,0x80008000,0x80008000,0x3e953dc9,0x3f223ef1,0x3f753f7f,0x3f463f62
.long 0x3f0e3e48,0x3f7b3f55,0xbf0ebe48,0xbf7bbf55,0x3f463e95,0x3f623f7f,0xbf22bf75,0x3ef1bdc9
.long 0x3f6d3ec4,0x3ec43f6d,0x3f6d3ec4,0x3ec43f6d,0x3f7f3ef1,0xbe953f22,0x3dc93f62,0xbf75bf46
.long 0x3f7b3f0e,0xbf553e48,0xbf7bbf0e,0x3f55be48,0x3f623f22,0xbf7fbe95,0x3ef1bf46,0xbdc93f75
.long 0x3f353f35,0xbf35bf35,0x3f353f35,0xbf35bf35,0x3ef13f46,0xbdc9bf75,0xbf623f22,0x3f7fbe95
.long 0x3e483f55,0x3f0ebf7b,0xbe48bf55,0xbf0e3f7b,0xbdc93f62,0x3f75bf46,0x3f7fbef1,0xbe95bf22
.long 0xbec43f6d,0x3f6dbec4,0xbec43f6d,0x3f6dbec4,0xbf223f75,0x3ef13dc9,0xbf463e95,0xbf623f7f
.long 0xbf553f7b,0xbe483f0e,0x3f55bf7b,0x3e48bf0e,0xbf753f7f,0xbf463f62,0x3e95bdc9,0x3f22bef1
.long 0xbf803f80,0xbf803f80,0xbf803f80,0xbf803f80,0xbf753f7f,0xbf463f62,0x3e95bdc9,0x3f22bef1
.long 0xbf553f7b,0xbe483f0e,0x3f55bf7b,0x3e48bf0e,0xbf223f75,0x3ef13dc9,0xbf463e95,0xbf623f7f
.long 0xbec43f6d,0x3f6dbec4,0xbec43f6d,0x3f6dbec4,0xbdc93f62,0x3f75bf46,0x3f7fbef1,0xbe95bf22
.long 0x3e483f55,0x3f0ebf7b,0xbe48bf55,0xbf0e3f7b,0x3ef13f46,0xbdc9bf75,0xbf623f22,0x3f7fbe95
.long 0x3f353f35,0xbf35bf35,0x3f353f35,0xbf35bf35,0x3f623f22,0xbf7fbe95,0x3ef1bf46,0xbdc93f75
.long 0x3f7b3f0e,0xbf553e48,0xbf7bbf0e,0x3f55be48,0x3f7f3ef1,0xbe953f22,0x3dc93f62,0xbf75bf46
.long 0x3f6d3ec4,0x3ec43f6d,0x3f6d3ec4,0x3ec43f6d,0x3f463e95,0x3f623f7f,0xbf22bf75,0x3ef1bdc9
.long 0x3f0e3e48,0x3f7b3f55,0xbf0ebe48,0xbf7bbf55,0x3e953dc9,0x3f223ef1,0x3f753f7f,0x3f463f62
.long 0x80008000,0x80008000,0x80008000,0x80008000,0x3f623f46,0x3f7f3f75,0x3ef13f22,0x3dc93e95
.long 0x3f553f7b,0x3e483f0e,0xbf55bf7b,0xbe48bf0e,0xbdc93ef1,0xbf75bf22,0x3f7f3f62,0x3e953f46
.long 0xbf6dbec4,0xbec4bf6d,0xbf6dbec4,0xbec4bf6d,0xbf46bf75,0x3f623dc9,0x3f22be95,0x3ef13f7f
.long 0x3e48bf55,0x3f0e3f7b,0xbe483f55,0xbf0ebf7b,0x3f75bdc9,0xbf463ef1,0xbe95bf7f,0x3f223f62
.long 0x3f353f35,0xbf35bf35,0x3f353f35,0xbf35bf35,0xbe953f7f,0x3f22bf62,0xbf75bdc9,0x3f463ef1
.long 0xbf7b3f0e,0x3f553e48,0x3f7bbf0e,0xbf55be48,0xbf22be95,0xbef13f7f,0xbf463f75,0x3f62bdc9
.long 0x3ec4bf6d,0xbf6d3ec4,0x3ec4bf6d,0xbf6d3ec4,0x3f7fbf62,0x3e95bf46,0x3dc93ef1,0x3f75bf22
.long 0x3f0ebe48,0x3f7bbf55,0xbf0e3e48,0xbf7b3f55,0xbef13f22,0xbdc93e95,0x3f62bf46,0x3f7fbf75
.long 0xbf803f80,0xbf803f80,0xbf803f80,0xbf803f80,0xbef13f22,0xbdc93e95,0x3f62bf46,0x3f7fbf75
.long 0x3f0ebe48,0x3f7bbf55,0xbf0e3e48,0xbf7b3f55,0x3f7fbf62,0x3e95bf46,0x3dc93ef1,0x3f75bf22
.long 0x3ec4bf6d,0xbf6d3ec4,0x3ec4bf6d,0xbf6d3ec4,0xbf22be95,0xbef13f7f,0xbf463f75,0x3f62bdc9
.long 0xbf7b3f0e,0x3f553e48,0x3f7bbf0e,0xbf55be48,0xbe953f7f,0x3f22bf62,0xbf75bdc9,0x3f463ef1
.long 0x3f353f35,0xbf35bf35,0x3f353f35,0xbf35bf35,0x3f75bdc9,0xbf463ef1,0xbe95bf7f,0x3f223f62
.long 0x3e48bf55,0x3f0e3f7b,0xbe483f55,0xbf0ebf7b,0xbf46bf75,0x3f623dc9,0x3f22be95,0x3ef13f7f
.long 0xbf6dbec4,0xbec4bf6d,0xbf6dbec4,0xbec4bf6d,0xbdc93ef1,0xbf75bf22,0x3f7f3f62,0x3e953f46
.long 0x3f553f7b,0x3e483f0e,0xbf55bf7b,0xbe48bf0e,0x3f623f46,0x3f7f3f75,0x3ef13f22,0x3dc93e95
.long 0x3f803f80,0x3f803f80,0x3f803f80,0x3f803f80,0xbf7bbf80,0xbf55bf6d,0x3e48a554,0x3f0e3ec4
.long 0x3f6d3f80,0x3ec43f35,0xbf6dbf80,0xbec4bf35,0xbf55bf80,0x3e48bec4,0xbf0e248d,0xbf7bbf6d
.long 0x3f353f80,0xbf35248d,0x3f353f80,0xbf35248d,0xbf0ebf80,0x3f7b3ec4,0x3f55a554,0x3e483f6d
.long 0x3ec43f80,0xbf6dbf35,0xbec4bf80,0x3f6d3f35,0xbe48bf80,0x3f0e3f6d,0xbf7b248d,0x3f55bec4
.long 0x248d3f80,0xa554bf80,0x248d3f80,0xa554bf80,0x3e48bf80,0xbf0e3f6d,0x3f7ba554,0xbf55bec4
.long 0xbec43f80,0x3f6dbf35,0x3ec4bf80,0xbf6d3f35,0x3f0ebf80,0xbf7b3ec4,0xbf55248d,0xbe483f6d
.long 0xbf353f80,0x3f35a554,0xbf353f80,0x3f35a554,0x3f55bf80,0xbe48bec4,0x3f0ea554,0x3f7bbf6d
.long 0xbf6d3f80,0xbec43f35,0x3f6dbf80,0x3ec4bf35,0x3f7bbf80,0x3f55bf6d,0xbe48248d,0xbf0e3ec4
.long 0xbf803f80,0xbf803f80,0xbf803f80,0xbf803f80,0x3f7bbf80,0x3f55bf6d,0xbe48a554,0xbf0e3ec4
.long 0xbf6d3f80,0xbec43f35,0x3f6dbf80,0x3ec4bf35,0x3f55bf80,0xbe48bec4,0x3f0e248d,0x3f7bbf6d
.long 0xbf353f80,0x3f35248d,0xbf353f80,0x3f35248d,0x3f0ebf80,0xbf7b3ec4,0xbf55a554,0xbe483f6d
.long 0xbec43f80,0x3f6dbf35,0x3ec4bf80,0xbf6d3f35,0x3e48bf80,0xbf0e3f6d,0x3f7b248d,0xbf55bec4
.long 0xa5543f80,0x248dbf80,0xa5543f80,0x248dbf80,0xbe48bf80,0x3f0e3f6d,0xbf7ba554,0x3f55bec4
.long 0x3ec43f80,0xbf6dbf35,0xbec4bf80,0x3f6d3f35,0xbf0ebf80,0x3f7b3ec4,0x3f55248d,0x3e483f6d
.long 0x3f353f80,0xbf35a554,0x3f353f80,0xbf35a554,0xbf55bf80,0x3e48bec4,0xbf0ea554,0xbf7bbf6d
.long 0x3f6d3f80,0x3ec43f35,0xbf6dbf80,0xbec4bf35,0xbf7bbf80,0xbf55bf6d,0x3e48248d,0x3f0e3ec4
.long 0x3f803f80,0x3f803f80,0x3f803f80,0x3f803f80,0xbf0ebf35,0xbe48bec4,0x3f553f35,0x3f7b3f6d
.long 0xbec4248d,0xbf6dbf35,0x3ec4a554,0x3f6d3f35,0x3f7b3f35,0x3f0e3f6d,0xbe48bf35,0x3f553ec4
.long 0xbf35bf80,0x3f35a554,0xbf35bf80,0x3f35a554,0xbe483f35,0xbf55bf6d,0xbf7bbf35,0x3f0ebec4
.long 0x3f6da554,0xbec43f35,0xbf6d248d,0x3ec4bf35,0xbf55bf35,0x3f7b3ec4,0xbf0e3f35,0x3e48bf6d
.long 0x248d3f80,0xa554bf80,0x248d3f80,0xa554bf80,0x3f55bf35,0xbf7b3ec4,0x3f0e3f35,0xbe48bf6d
.long 0xbf6d248d,0x3ec43f35,0x3f6da554,0xbec4bf35,0x3e483f35,0x3f55bf6d,0x3f7bbf35,0xbf0ebec4
.long 0x3f35bf80,0xbf35248d,0x3f35bf80,0xbf35248d,0xbf7b3f35,0xbf0e3f6d,0x3e48bf35,0xbf553ec4
.long 0x3ec4a554,0x3f6dbf35,0xbec4248d,0xbf6d3f35,0x3f0ebf35,0x3e48bec4,0xbf553f35,0xbf7b3f6d
.long 0xbf803f80,0xbf803f80,0xbf803f80,0xbf803f80,0x3f0ebf35,0x3e48bec4,0xbf553f35,0xbf7b3f6d
.long 0x3ec4248d,0x3f6dbf35,0xbec4a554,0xbf6d3f35,0xbf7b3f35,0xbf0e3f6d,0x3e48bf35,0xbf553ec4
.long 0x3f35bf80,0xbf35a554,0x3f35bf80,0xbf35a554,0x3e483f35,0x3f55bf6d,0x3f7bbf35,0xbf0ebec4
.long 0xbf6da554,0x3ec43f35,0x3f6d248d,0xbec4bf35,0x3f55bf35,0xbf7b3ec4,0x3f0e3f35,0xbe48bf6d
.long 0xa5543f80,0x248dbf80,0xa5543f80,0x248dbf80,0xbf55bf35,0x3f7b3ec4,0xbf0e3f35,0x3e48bf6d
.long 0x3f6d248d,0xbec43f35,0xbf6da554,0x3ec4bf35,0xbe483f35,0xbf55bf6d,0xbf7bbf35,0x3f0ebec4
.long 0xbf35bf80,0x3f35248d,0xbf35bf80,0x3f35248d,0x3f7b3f35,0x3f0e3f6d,0xbe48bf35,0x3f553ec4
.long 0xbec4a554,0xbf6dbf35,0x3ec4248d,0x3f6d3f35,0xbf0ebf35,0xbe48bec4,0x3f553f35,0x3f7b3f6d
.long 0x0,0x0,0x0,0x0,0x3e48a50d,0x3f0e3ec4,0x3f7b3f80,0x3f553f6d
.long 0xbec40000,0xbf6dbf35,0x3ec4a50d,0x3f6d3f35,0x3f0ea50d,0x3f7b3f6d,0xbf55bf80,0x3e48bec4
.long 0xbf350000,0xbf35bf80,0xbf350000,0xbf35bf80,0x3f55a50d,0x3e483f6d,0x3f0e3f80,0xbf7bbec4
.long 0xbf6d0000,0x3ec4bf35,0x3f6da50d,0xbec43f35,0x3f7ba50d,0xbf553ec4,0xbe48bf80,0x3f0e3f6d
.long 0xbf800000,0x3f80a50d,0xbf800000,0x3f80a50d,0x3f7ba50d,0xbf55bec4,0xbe483f80,0x3f0ebf6d
.long 0xbf6d0000,0x3ec43f35,0x3f6da50d,0xbec4bf35,0x3f55a50d,0x3e48bf6d,0x3f0ebf80,0xbf7b3ec4
.long 0xbf350000,0xbf353f80,0xbf350000,0xbf353f80,0x3f0ea50d,0x3f7bbf6d,0xbf553f80,0x3e483ec4
.long 0xbec40000,0xbf6d3f35,0x3ec4a50d,0x3f6dbf35,0x3e48a50d,0x3f0ebec4,0x3f7bbf80,0x3f55bf6d
.long 0xa50d0000,0xa50d0000,0xa50d0000,0xa50d0000,0xbe48a50d,0xbf0e3ec4,0xbf7b3f80,0xbf553f6d
.long 0x3ec40000,0x3f6dbf35,0xbec4a50d,0xbf6d3f35,0xbf0ea50d,0xbf7b3f6d,0x3f55bf80,0xbe48bec4
.long 0x3f350000,0x3f35bf80,0x3f350000,0x3f35bf80,0xbf55a50d,0xbe483f6d,0xbf0e3f80,0x3f7bbec4
.long 0x3f6d0000,0xbec4bf35,0xbf6da50d,0x3ec43f35,0xbf7ba50d,0x3f553ec4,0x3e48bf80,0xbf0e3f6d
.long 0x3f800000,0xbf80a50d,0x3f800000,0xbf80a50d,0xbf7ba50d,0x3f55bec4,0x3e483f80,0xbf0ebf6d
.long 0x3f6d0000,0xbec43f35,0xbf6da50d,0x3ec4bf35,0xbf55a50d,0xbe48bf6d,0xbf0ebf80,0x3f7b3ec4
.long 0x3f350000,0x3f353f80,0x3f350000,0x3f353f80,0xbf0ea50d,0xbf7bbf6d,0x3f553f80,0xbe483ec4
.long 0x3ec40000,0x3f6d3f35,0xbec4a50d,0xbf6dbf35,0xbe48a50d,0xbf0ebec4,0xbf7bbf80,0xbf55bf6d
.long 0x0,0x0,0x0,0x0,0x3f553f35,0x3f7b3f6d,0x3f0e3f35,0x3e483ec4
.long 0xbf6dbf80,0xbec4bf35,0x3f6d3f80,0x3ec43f35,0x3e483f35,0xbf55bec4,0x3f7b3f35,0x3f0e3f6d
.long 0x3f35a50d,0x3f353f80,0x3f35a50d,0x3f353f80,0xbf7bbf35,0x3f0ebec4,0x3e48bf35,0x3f553f6d
.long 0x3ec43f80,0xbf6dbf35,0xbec4bf80,0x3f6d3f35,0x3f0ebf35,0xbe483f6d,0xbf55bf35,0x3f7b3ec4
.long 0xbf800000,0x3f80a50d,0xbf800000,0x3f80a50d,0x3f0e3f35,0xbe48bf6d,0xbf553f35,0x3f7bbec4
.long 0x3ec4bf80,0xbf6d3f35,0xbec43f80,0x3f6dbf35,0xbf7b3f35,0x3f0e3ec4,0x3e483f35,0x3f55bf6d
.long 0x3f35a50d,0x3f35bf80,0x3f35a50d,0x3f35bf80,0x3e48bf35,0xbf553ec4,0x3f7bbf35,0x3f0ebf6d
.long 0xbf6d3f80,0xbec43f35,0x3f6dbf80,0x3ec4bf35,0x3f55bf35,0x3f7bbf6d,0x3f0ebf35,0x3e48bec4
.long 0xa50d0000,0xa50d0000,0xa50d0000,0xa50d0000,0xbf553f35,0xbf7b3f6d,0xbf0e3f35,0xbe483ec4
.long 0x3f6dbf80,0x3ec4bf35,0xbf6d3f80,0xbec43f35,0xbe483f35,0x3f55bec4,0xbf7b3f35,0xbf0e3f6d
.long 0xbf35a50d,0xbf353f80,0xbf35a50d,0xbf353f80,0x3f7bbf35,0xbf0ebec4,0xbe48bf35,0xbf553f6d
.long 0xbec43f80,0x3f6dbf35,0x3ec4bf80,0xbf6d3f35,0xbf0ebf35,0x3e483f6d,0x3f55bf35,0xbf7b3ec4
.long 0x3f800000,0xbf80a50d,0x3f800000,0xbf80a50d,0xbf0e3f35,0x3e48bf6d,0x3f553f35,0xbf7bbec4
.long 0xbec4bf80,0x3f6d3f35,0x3ec43f80,0xbf6dbf35,0x3f7b3f35,0xbf0e3ec4,0xbe483f35,0xbf55bf6d
.long 0xbf35a50d,0xbf35bf80,0xbf35a50d,0xbf35bf80,0xbe48bf35,0x3f553ec4,0xbf7bbf35,0xbf0ebf6d
.long 0x3f6d3f80,0x3ec43f35,0xbf6dbf80,0xbec4bf35,0xbf55bf35,0xbf7bbf6d,0xbf0ebf35,0xbe48bec4
.long 0x80008000,0x80008000,0x80008000,0x80008000,0xbe48250d,0xbf0ebec4,0xbf7bbf80,0xbf55bf6d
.long 0x3ec48000,0x3f6d3f35,0xbec4250d,0xbf6dbf35,0xbf0e250d,0xbf7bbf6d,0x3f553f80,0xbe483ec4
.long 0x3f358000,0x3f353f80,0x3f358000,0x3f353f80,0xbf55250d,0xbe48bf6d,0xbf0ebf80,0x3f7b3ec4
.long 0x3f6d8000,0xbec43f35,0xbf6d250d,0x3ec4bf35,0xbf7b250d,0x3f55bec4,0x3e483f80,0xbf0ebf6d
.long 0x3f808000,0xbf80250d,0x3f808000,0xbf80250d,0xbf7b250d,0x3f553ec4,0x3e48bf80,0xbf0e3f6d
.long 0x3f6d8000,0xbec4bf35,0xbf6d250d,0x3ec43f35,0xbf55250d,0xbe483f6d,0xbf0e3f80,0x3f7bbec4
.long 0x3f358000,0x3f35bf80,0x3f358000,0x3f35bf80,0xbf0e250d,0xbf7b3f6d,0x3f55bf80,0xbe48bec4
.long 0x3ec48000,0x3f6dbf35,0xbec4250d,0xbf6d3f35,0xbe48250d,0xbf0e3ec4,0xbf7b3f80,0xbf553f6d
.long 0x250d8000,0x250d8000,0x250d8000,0x250d8000,0x3e48250d,0x3f0ebec4,0x3f7bbf80,0x3f55bf6d
.long 0xbec48000,0xbf6d3f35,0x3ec4250d,0x3f6dbf35,0x3f0e250d,0x3f7bbf6d,0xbf553f80,0x3e483ec4
.long 0xbf358000,0xbf353f80,0xbf358000,0xbf353f80,0x3f55250d,0x3e48bf6d,0x3f0ebf80,0xbf7b3ec4
.long 0xbf6d8000,0x3ec43f35,0x3f6d250d,0xbec4bf35,0x3f7b250d,0xbf55bec4,0xbe483f80,0x3f0ebf6d
.long 0xbf808000,0x3f80250d,0xbf808000,0x3f80250d,0x3f7b250d,0xbf553ec4,0xbe48bf80,0x3f0e3f6d
.long 0xbf6d8000,0x3ec4bf35,0x3f6d250d,0xbec43f35,0x3f55250d,0x3e483f6d,0x3f0e3f80,0xbf7bbec4
.long 0xbf358000,0xbf35bf80,0xbf358000,0xbf35bf80,0x3f0e250d,0x3f7b3f6d,0xbf55bf80,0x3e48bec4
.long 0xbec48000,0xbf6dbf35,0x3ec4250d,0x3f6d3f35,0x3e48250d,0x3f0e3ec4,0x3f7b3f80,0x3f553f6d
.long 0x80008000,0x80008000,0x80008000,0x80008000,0xbf55bf35,0xbf7bbf6d,0xbf0ebf35,0xbe48bec4
.long 0x3f6d3f80,0x3ec43f35,0xbf6dbf80,0xbec4bf35,0xbe48bf35,0x3f553ec4,0xbf7bbf35,0xbf0ebf6d
.long 0xbf35250d,0xbf35bf80,0xbf35250d,0xbf35bf80,0x3f7b3f35,0xbf0e3ec4,0xbe483f35,0xbf55bf6d
.long 0xbec4bf80,0x3f6d3f35,0x3ec43f80,0xbf6dbf35,0xbf0e3f35,0x3e48bf6d,0x3f553f35,0xbf7bbec4
.long 0x3f808000,0xbf80250d,0x3f808000,0xbf80250d,0xbf0ebf35,0x3e483f6d,0x3f55bf35,0xbf7b3ec4
.long 0xbec43f80,0x3f6dbf35,0x3ec4bf80,0xbf6d3f35,0x3f7bbf35,0xbf0ebec4,0xbe48bf35,0xbf553f6d
.long 0xbf35250d,0xbf353f80,0xbf35250d,0xbf353f80,0xbe483f35,0x3f55bec4,0xbf7b3f35,0xbf0e3f6d
.long 0x3f6dbf80,0x3ec4bf35,0xbf6d3f80,0xbec43f35,0xbf553f35,0xbf7b3f6d,0xbf0e3f35,0xbe483ec4
.long 0x250d8000,0x250d8000,0x250d8000,0x250d8000,0x3f55bf35,0x3f7bbf6d,0x3f0ebf35,0x3e48bec4
.long 0xbf6d3f80,0xbec43f35,0x3f6dbf80,0x3ec4bf35,0x3e48bf35,0xbf553ec4,0x3f7bbf35,0x3f0ebf6d
.long 0x3f35250d,0x3f35bf80,0x3f35250d,0x3f35bf80,0xbf7b3f35,0x3f0e3ec4,0x3e483f35,0x3f55bf6d
.long 0x3ec4bf80,0xbf6d3f35,0xbec43f80,0x3f6dbf35,0x3f0e3f35,0xbe48bf6d,0xbf553f35,0x3f7bbec4
.long 0xbf808000,0x3f80250d,0xbf808000,0x3f80250d,0x3f0ebf35,0xbe483f6d,0xbf55bf35,0x3f7b3ec4
.long 0x3ec43f80,0xbf6dbf35,0xbec4bf80,0x3f6d3f35,0xbf7bbf35,0x3f0ebec4,0x3e48bf35,0x3f553f6d
.long 0x3f35250d,0x3f353f80,0x3f35250d,0x3f353f80,0x3e483f35,0xbf55bec4,0x3f7b3f35,0x3f0e3f6d
.long 0xbf6dbf80,0xbec4bf35,0x3f6d3f80,0x3ec43f35,0x3f553f35,0x3f7b3f6d,0x3f0e3f35,0x3e483ec4
.long 0x3f803f80,0x3f803f80,0x3f803f80,0x3f803f80,0xbf75bf7f,0xbf46bf62,0x3e953dc9,0x3f223ef1
.long 0x3f553f7b,0x3e483f0e,0xbf55bf7b,0xbe48bf0e,0xbf22bf75,0x3ef1bdc9,0xbf46be95,0xbf62bf7f
.long 0x3ec43f6d,0xbf6dbec4,0x3ec43f6d,0xbf6dbec4,0xbdc9bf62,0x3f753f46,0x3f7f3ef1,0xbe953f22
.long 0xbe483f55,0xbf0ebf7b,0x3e48bf55,0x3f0e3f7b,0x3ef1bf46,0xbdc93f75,0xbf62bf22,0x3f7f3e95
.long 0xbf353f35,0x3f35bf35,0xbf353f35,0x3f35bf35,0x3f62bf22,0xbf7f3e95,0x3ef13f46,0xbdc9bf75
.long 0xbf7b3f0e,0x3f553e48,0x3f7bbf0e,0xbf55be48,0x3f7fbef1,0xbe95bf22,0x3dc9bf62,0xbf753f46
.long 0xbf6d3ec4,0xbec43f6d,0xbf6d3ec4,0xbec43f6d,0x3f46be95,0x3f62bf7f,0xbf223f75,0x3ef13dc9
.long 0xbf0e3e48,0xbf7b3f55,0x3f0ebe48,0x3f7bbf55,0x3e95bdc9,0x3f22bef1,0x3f75bf7f,0x3f46bf62
.long 0xa554248d,0xa554248d,0xa554248d,0xa554248d,0xbe953dc9,0xbf223ef1,0xbf753f7f,0xbf463f62
.long 0x3f0ebe48,0x3f7bbf55,0xbf0e3e48,0xbf7b3f55,0xbf463e95,0xbf623f7f,0x3f22bf75,0xbef1bdc9
.long 0x3f6dbec4,0x3ec4bf6d,0x3f6dbec4,0x3ec4bf6d,0xbf7f3ef1,0x3e953f22,0xbdc93f62,0x3f75bf46
.long 0x3f7bbf0e,0xbf55be48,0xbf7b3f0e,0x3f553e48,0xbf623f22,0x3f7fbe95,0xbef1bf46,0x3dc93f75
.long 0x3f35bf35,0xbf353f35,0x3f35bf35,0xbf353f35,0xbef13f46,0x3dc9bf75,0x3f623f22,0xbf7fbe95
.long 0x3e48bf55,0x3f0e3f7b,0xbe483f55,0xbf0ebf7b,0x3dc93f62,0xbf75bf46,0xbf7fbef1,0x3e95bf22
.long 0xbec4bf6d,0x3f6d3ec4,0xbec4bf6d,0x3f6d3ec4,0x3f223f75,0xbef13dc9,0x3f463e95,0x3f623f7f
.long 0xbf55bf7b,0xbe48bf0e,0x3f553f7b,0x3e483f0e,0x3f753f7f,0x3f463f62,0xbe95bdc9,0xbf22bef1
.long 0x3f803f80,0x3f803f80,0x3f803f80,0x3f803f80,0xbef1bf22,0xbdc9be95,0x3f623f46,0x3f7f3f75
.long 0xbf0ebe48,0xbf7bbf55,0x3f0e3e48,0x3f7b3f55,0x3f7f3f62,0x3e953f46,0x3dc9bef1,0x3f753f22
.long 0xbec4bf6d,0x3f6d3ec4,0xbec4bf6d,0x3f6d3ec4,0xbf223e95,0xbef1bf7f,0xbf46bf75,0x3f623dc9
.long 0x3f7b3f0e,0xbf553e48,0xbf7bbf0e,0x3f55be48,0xbe95bf7f,0x3f223f62,0xbf753dc9,0x3f46bef1
.long 0xbf353f35,0x3f35bf35,0xbf353f35,0x3f35bf35,0x3f753dc9,0xbf46bef1,0xbe953f7f,0x3f22bf62
.long 0xbe48bf55,0xbf0e3f7b,0x3e483f55,0x3f0ebf7b,0xbf463f75,0x3f62bdc9,0x3f223e95,0x3ef1bf7f
.long 0x3f6dbec4,0x3ec4bf6d,0x3f6dbec4,0x3ec4bf6d,0xbdc9bef1,0xbf753f22,0x3f7fbf62,0x3e95bf46
.long 0xbf553f7b,0xbe483f0e,0x3f55bf7b,0x3e48bf0e,0x3f62bf46,0x3f7fbf75,0x3ef1bf22,0x3dc9be95
.long 0xa554248d,0xa554248d,0xa554248d,0xa554248d,0xbf623f46,0xbf7f3f75,0xbef13f22,0xbdc93e95
.long 0x3f55bf7b,0x3e48bf0e,0xbf553f7b,0xbe483f0e,0x3dc93ef1,0x3f75bf22,0xbf7f3f62,0xbe953f46
.long 0xbf6d3ec4,0xbec43f6d,0xbf6d3ec4,0xbec43f6d,0x3f46bf75,0xbf623dc9,0xbf22be95,0xbef13f7f
.long 0x3e483f55,0x3f0ebf7b,0xbe48bf55,0xbf0e3f7b,0xbf75bdc9,0x3f463ef1,0x3e95bf7f,0xbf223f62
.long 0x3f35bf35,0xbf353f35,0x3f35bf35,0xbf353f35,0x3e953f7f,0xbf22bf62,0x3f75bdc9,0xbf463ef1
.long 0xbf7bbf0e,0x3f55be48,0x3f7b3f0e,0xbf553e48,0x3f22be95,0x3ef13f7f,0x3f463f75,0xbf62bdc9
.long 0x3ec43f6d,0xbf6dbec4,0x3ec43f6d,0xbf6dbec4,0xbf7fbf62,0xbe95bf46,0xbdc93ef1,0xbf75bf22
.long 0x3f0e3e48,0x3f7b3f55,0xbf0ebe48,0xbf7bbf55,0x3ef13f22,0x3dc93e95,0xbf62bf46,0xbf7fbf75
.long 0x0,0x0,0x0,0x0,0x3e953dc9,0x3f223ef1,0x3f753f7f,0x3f463f62
.long 0xbf0ebe48,0xbf7bbf55,0x3f0e3e48,0x3f7b3f55,0x3f463e95,0x3f623f7f,0xbf22bf75,0x3ef1bdc9
.long 0xbf6dbec4,0xbec4bf6d,0xbf6dbec4,0xbec4bf6d,0x3f7f3ef1,0xbe953f22,0x3dc93f62,0xbf75bf46
.long 0xbf7bbf0e,0x3f55be48,0x3f7b3f0e,0xbf553e48,0x3f623f22,0xbf7fbe95,0x3ef1bf46,0xbdc93f75
.long 0xbf35bf35,0x3f353f35,0xbf35bf35,0x3f353f35,0x3ef13f46,0xbdc9bf75,0xbf623f22,0x3f7fbe95
.long 0xbe48bf55,0xbf0e3f7b,0x3e483f55,0x3f0ebf7b,0xbdc93f62,0x3f75bf46,0x3f7fbef1,0xbe95bf22
.long 0x3ec4bf6d,0xbf6d3ec4,0x3ec4bf6d,0xbf6d3ec4,0xbf223f75,0x3ef13dc9,0xbf463e95,0xbf623f7f
.long 0x3f55bf7b,0x3e48bf0e,0xbf553f7b,0xbe483f0e,0xbf753f7f,0xbf463f62,0x3e95bdc9,0x3f22bef1
.long 0x3f80bf80,0x3f80bf80,0x3f80bf80,0x3f80bf80,0xbf753f7f,0xbf463f62,0x3e95bdc9,0x3f22bef1
.long 0x3f55bf7b,0x3e48bf0e,0xbf553f7b,0xbe483f0e,0xbf223f75,0x3ef13dc9,0xbf463e95,0xbf623f7f
.long 0x3ec4bf6d,0xbf6d3ec4,0x3ec4bf6d,0xbf6d3ec4,0xbdc93f62,0x3f75bf46,0x3f7fbef1,0xbe95bf22
.long 0xbe48bf55,0xbf0e3f7b,0x3e483f55,0x3f0ebf7b,0x3ef13f46,0xbdc9bf75,0xbf623f22,0x3f7fbe95
.long 0xbf35bf35,0x3f353f35,0xbf35bf35,0x3f353f35,0x3f623f22,0xbf7fbe95,0x3ef1bf46,0xbdc93f75
.long 0xbf7bbf0e,0x3f55be48,0x3f7b3f0e,0xbf553e48,0x3f7f3ef1,0xbe953f22,0x3dc93f62,0xbf75bf46
.long 0xbf6dbec4,0xbec4bf6d,0xbf6dbec4,0xbec4bf6d,0x3f463e95,0x3f623f7f,0xbf22bf75,0x3ef1bdc9
.long 0xbf0ebe48,0xbf7bbf55,0x3f0e3e48,0x3f7b3f55,0x3e953dc9,0x3f223ef1,0x3f753f7f,0x3f463f62
.long 0x0,0x0,0x0,0x0,0x3f623f46,0x3f7f3f75,0x3ef13f22,0x3dc93e95
.long 0xbf55bf7b,0xbe48bf0e,0x3f553f7b,0x3e483f0e,0xbdc93ef1,0xbf75bf22,0x3f7f3f62,0x3e953f46
.long 0x3f6d3ec4,0x3ec43f6d,0x3f6d3ec4,0x3ec43f6d,0xbf46bf75,0x3f623dc9,0x3f22be95,0x3ef13f7f
.long 0xbe483f55,0xbf0ebf7b,0x3e48bf55,0x3f0e3f7b,0x3f75bdc9,0xbf463ef1,0xbe95bf7f,0x3f223f62
.long 0xbf35bf35,0x3f353f35,0xbf35bf35,0x3f353f35,0xbe953f7f,0x3f22bf62,0xbf75bdc9,0x3f463ef1
.long 0x3f7bbf0e,0xbf55be48,0xbf7b3f0e,0x3f553e48,0xbf22be95,0xbef13f7f,0xbf463f75,0x3f62bdc9
.long 0xbec43f6d,0x3f6dbec4,0xbec43f6d,0x3f6dbec4,0x3f7fbf62,0x3e95bf46,0x3dc93ef1,0x3f75bf22
.long 0xbf0e3e48,0xbf7b3f55,0x3f0ebe48,0x3f7bbf55,0xbef13f22,0xbdc93e95,0x3f62bf46,0x3f7fbf75
.long 0x3f80bf80,0x3f80bf80,0x3f80bf80,0x3f80bf80,0xbef13f22,0xbdc93e95,0x3f62bf46,0x3f7fbf75
.long 0xbf0e3e48,0xbf7b3f55,0x3f0ebe48,0x3f7bbf55,0x3f7fbf62,0x3e95bf46,0x3dc93ef1,0x3f75bf22
.long 0xbec43f6d,0x3f6dbec4,0xbec43f6d,0x3f6dbec4,0xbf22be95,0xbef13f7f,0xbf463f75,0x3f62bdc9
.long 0x3f7bbf0e,0xbf55be48,0xbf7b3f0e,0x3f553e48,0xbe953f7f,0x3f22bf62,0xbf75bdc9,0x3f463ef1
.long 0xbf35bf35,0x3f353f35,0xbf35bf35,0x3f353f35,0x3f75bdc9,0xbf463ef1,0xbe95bf7f,0x3f223f62
.long 0xbe483f55,0xbf0ebf7b,0x3e48bf55,0x3f0e3f7b,0xbf46bf75,0x3f623dc9,0x3f22be95,0x3ef13f7f
.long 0x3f6d3ec4,0x3ec43f6d,0x3f6d3ec4,0x3ec43f6d,0xbdc93ef1,0xbf75bf22,0x3f7f3f62,0x3e953f46
.long 0xbf55bf7b,0xbe48bf0e,0x3f553f7b,0x3e483f0e,0x3f623f46,0x3f7f3f75,0x3ef13f22,0x3dc93e95
.long 0x80008000,0x80008000,0x80008000,0x80008000,0xbe95bdc9,0xbf22bef1,0xbf75bf7f,0xbf46bf62
.long 0x3f0e3e48,0x3f7b3f55,0xbf0ebe48,0xbf7bbf55,0xbf46be95,0xbf62bf7f,0x3f223f75,0xbef13dc9
.long 0x3f6d3ec4,0x3ec43f6d,0x3f6d3ec4,0x3ec43f6d,0xbf7fbef1,0x3e95bf22,0xbdc9bf62,0x3f753f46
.long 0x3f7b3f0e,0xbf553e48,0xbf7bbf0e,0x3f55be48,0xbf62bf22,0x3f7f3e95,0xbef13f46,0x3dc9bf75
.long 0x3f353f35,0xbf35bf35,0x3f353f35,0xbf35bf35,0xbef1bf46,0x3dc93f75,0x3f62bf22,0xbf7f3e95
.long 0x3e483f55,0x3f0ebf7b,0xbe48bf55,0xbf0e3f7b,0x3dc9bf62,0xbf753f46,0xbf7f3ef1,0x3e953f22
.long 0xbec43f6d,0x3f6dbec4,0xbec43f6d,0x3f6dbec4,0x3f22bf75,0xbef1bdc9,0x3f46be95,0x3f62bf7f
.long 0xbf553f7b,0xbe483f0e,0x3f55bf7b,0x3e48bf0e,0x3f75bf7f,0x3f46bf62,0xbe953dc9,0xbf223ef1
.long 0xbf803f80,0xbf803f80,0xbf803f80,0xbf803f80,0x3f75bf7f,0x3f46bf62,0xbe953dc9,0xbf223ef1
.long 0xbf553f7b,0xbe483f0e,0x3f55bf7b,0x3e48bf0e,0x3f22bf75,0xbef1bdc9,0x3f46be95,0x3f62bf7f
.long 0xbec43f6d,0x3f6dbec4,0xbec43f6d,0x3f6dbec4,0x3dc9bf62,0xbf753f46,0xbf7f3ef1,0x3e953f22
.long 0x3e483f55,0x3f0ebf7b,0xbe48bf55,0xbf0e3f7b,0xbef1bf46,0x3dc93f75,0x3f62bf22,0xbf7f3e95
.long 0x3f353f35,0xbf35bf35,0x3f353f35,0xbf35bf35,0xbf62bf22,0x3f7f3e95,0xbef13f46,0x3dc9bf75
.long 0x3f7b3f0e,0xbf553e48,0xbf7bbf0e,0x3f55be48,0xbf7fbef1,0x3e95bf22,0xbdc9bf62,0x3f753f46
.long 0x3f6d3ec4,0x3ec43f6d,0x3f6d3ec4,0x3ec43f6d,0xbf46be95,0xbf62bf7f,0x3f223f75,0xbef13dc9
.long 0x3f0e3e48,0x3f7b3f55,0xbf0ebe48,0xbf7bbf55,0xbe95bdc9,0xbf22bef1,0xbf75bf7f,0xbf46bf62
.long 0x80008000,0x80008000,0x80008000,0x80008000,0xbf62bf46,0xbf7fbf75,0xbef1bf22,0xbdc9be95
.long 0x3f553f7b,0x3e483f0e,0xbf55bf7b,0xbe48bf0e,0x3dc9bef1,0x3f753f22,0xbf7fbf62,0xbe95bf46
.long 0xbf6dbec4,0xbec4bf6d,0xbf6dbec4,0xbec4bf6d,0x3f463f75,0xbf62bdc9,0xbf223e95,0xbef1bf7f
.long 0x3e48bf55,0x3f0e3f7b,0xbe483f55,0xbf0ebf7b,0xbf753dc9,0x3f46bef1,0x3e953f7f,0xbf22bf62
.long 0x3f353f35,0xbf35bf35,0x3f353f35,0xbf35bf35,0x3e95bf7f,0xbf223f62,0x3f753dc9,0xbf46bef1
.long 0xbf7b3f0e,0x3f553e48,0x3f7bbf0e,0xbf55be48,0x3f223e95,0x3ef1bf7f,0x3f46bf75,0xbf623dc9
.long 0x3ec4bf6d,0xbf6d3ec4,0x3ec4bf6d,0xbf6d3ec4,0xbf7f3f62,0xbe953f46,0xbdc9bef1,0xbf753f22
.long 0x3f0ebe48,0x3f7bbf55,0xbf0e3e48,0xbf7b3f55,0x3ef1bf22,0x3dc9be95,0xbf623f46,0xbf7f3f75
.long 0xbf803f80,0xbf803f80,0xbf803f80,0xbf803f80,0x3ef1bf22,0x3dc9be95,0xbf623f46,0xbf7f3f75
.long 0x3f0ebe48,0x3f7bbf55,0xbf0e3e48,0xbf7b3f55,0xbf7f3f62,0xbe953f46,0xbdc9bef1,0xbf753f22
.long 0x3ec4bf6d,0xbf6d3ec4,0x3ec4bf6d,0xbf6d3ec4,0x3f223e95,0x3ef1bf7f,0x3f46bf75,0xbf623dc9
.long 0xbf7b3f0e,0x3f553e48,0x3f7bbf0e,0xbf55be48,0x3e95bf7f,0xbf223f62,0x3f753dc9,0xbf46bef1
.long 0x3f353f35,0xbf35bf35,0x3f353f35,0xbf35bf35,0xbf753dc9,0x3f46bef1,0x3e953f7f,0xbf22bf62
.long 0x3e48bf55,0x3f0e3f7b,0xbe483f55,0xbf0ebf7b,0x3f463f75,0xbf62bdc9,0xbf223e95,0xbef1bf7f
.long 0xbf6dbec4,0xbec4bf6d,0xbf6dbec4,0xbec4bf6d,0x3dc9bef1,0x3f753f22,0xbf7fbf62,0xbe95bf46
.long 0x3f553f7b,0x3e483f0e,0xbf55bf7b,0xbe48bf0e,0xbf62bf46,0xbf7fbf75,0xbef1bf22,0xbdc9be95
.long 0x3f803f80,0x3f803f80,0x3f803f80,0x3f803f80,0x3f7f3f80,0x3f753f7b,0x3f223f35,0x3ef13f0e
.long 0x3f7b3f80,0x3f553f6d,0xbe48248d,0xbf0ebec4,0x3f753f80,0x3f223f55,0xbf62bf35,0xbf7fbf7b
.long 0x3f6d3f80,0x3ec43f35,0xbf6dbf80,0xbec4bf35,0x3f623f80,0x3dc93f0e,0xbe95bf35,0x3f223e48
.long 0x3f553f80,0xbe483ec4,0x3f0ea554,0x3f7b3f6d,0x3f463f80,0xbef13e48,0x3f7f3f35,0x3e953f55
.long 0x3f353f80,0xbf35248d,0x3f353f80,0xbf35248d,0x3f223f80,0xbf62be48,0xbdc93f35,0xbf75bf55
.long 0x3f0e3f80,0xbf7bbec4,0xbf55248d,0xbe48bf6d,0x3ef13f80,0xbf7fbf0e,0xbf75bf35,0x3f46be48
.long 0x3ec43f80,0xbf6dbf35,0xbec4bf80,0x3f6d3f35,0x3e953f80,0xbf46bf55,0x3ef1bf35,0x3dc93f7b
.long 0x3e483f80,0xbf0ebf6d,0x3f7ba554,0xbf553ec4,0x3dc93f80,0xbe95bf7b,0x3f463f35,0xbf62bf0e
.long 0x248d3f80,0xa554bf80,0x248d3f80,0xa554bf80,0xbdc93f80,0x3e95bf7b,0xbf463f35,0x3f62bf0e
.long 0xbe483f80,0x3f0ebf6d,0xbf7b248d,0x3f553ec4,0xbe953f80,0x3f46bf55,0xbef1bf35,0xbdc93f7b
.long 0xbec43f80,0x3f6dbf35,0x3ec4bf80,0xbf6d3f35,0xbef13f80,0x3f7fbf0e,0x3f75bf35,0xbf46be48
.long 0xbf0e3f80,0x3f7bbec4,0x3f55a554,0x3e48bf6d,0xbf223f80,0x3f62be48,0x3dc93f35,0x3f75bf55
.long 0xbf353f80,0x3f35a554,0xbf353f80,0x3f35a554,0xbf463f80,0x3ef13e48,0xbf7f3f35,0xbe953f55
.long 0xbf553f80,0x3e483ec4,0xbf0e248d,0xbf7b3f6d,0xbf623f80,0xbdc93f0e,0x3e95bf35,0xbf223e48
.long 0xbf6d3f80,0xbec43f35,0x3f6dbf80,0x3ec4bf35,0xbf753f80,0xbf223f55,0x3f62bf35,0x3f7fbf7b
.long 0xbf7b3f80,0xbf553f6d,0x3e48a554,0x3f0ebec4,0xbf7f3f80,0xbf753f7b,0xbf223f35,0xbef13f0e
.long 0x3f803f80,0x3f803f80,0x3f803f80,0x3f803f80,0x3f623f6d,0x3f463f55,0x3e953ec4,0x3dc93e48
.long 0x3f0e3f35,0x3e483ec4,0xbf55bf35,0xbf7bbf6d,0x3dc93ec4,0xbef1be48,0xbf46bf6d,0xbe95bf0e
.long 0xbec4248d,0xbf6dbf35,0x3ec4a554,0x3f6d3f35,0xbf46bec4,0xbf75bf7b,0x3f7f3f6d,0x3ef13f55
.long 0xbf7bbf35,0xbf0ebf6d,0x3e483f35,0xbf55bec4,0xbf75bf6d,0x3dc9bf0e,0xbf62bec4,0xbf22bf7b
.long 0xbf35bf80,0x3f35a554,0xbf35bf80,0x3f35a554,0xbe95bf6d,0x3f7f3f0e,0x3ef1bec4,0x3f463f7b
.long 0x3e48bf35,0x3f553f6d,0x3f7b3f35,0xbf0e3ec4,0x3f22bec4,0x3e953f7b,0x3dc93f6d,0xbf62bf55
.long 0x3f6da554,0xbec43f35,0xbf6d248d,0x3ec4bf35,0x3f7f3ec4,0xbf623e48,0xbf22bf6d,0x3f753f0e
.long 0x3f553f35,0xbf7bbec4,0x3f0ebf35,0xbe483f6d,0x3ef13f6d,0xbf22bf55,0x3f753ec4,0xbf7fbe48
.long 0x248d3f80,0xa554bf80,0x248d3f80,0xa554bf80,0xbef13f6d,0x3f22bf55,0xbf753ec4,0x3f7fbe48
.long 0xbf553f35,0x3f7bbec4,0xbf0ebf35,0x3e483f6d,0xbf7f3ec4,0x3f623e48,0x3f22bf6d,0xbf753f0e
.long 0xbf6d248d,0x3ec43f35,0x3f6da554,0xbec4bf35,0xbf22bec4,0xbe953f7b,0xbdc93f6d,0x3f62bf55
.long 0xbe48bf35,0xbf553f6d,0xbf7b3f35,0x3f0e3ec4,0x3e95bf6d,0xbf7f3f0e,0xbef1bec4,0xbf463f7b
.long 0x3f35bf80,0xbf35248d,0x3f35bf80,0xbf35248d,0x3f75bf6d,0xbdc9bf0e,0x3f62bec4,0x3f22bf7b
.long 0x3f7bbf35,0x3f0ebf6d,0xbe483f35,0x3f55bec4,0x3f46bec4,0x3f75bf7b,0xbf7f3f6d,0xbef13f55
.long 0x3ec4a554,0x3f6dbf35,0xbec4248d,0xbf6d3f35,0xbdc93ec4,0x3ef1be48,0x3f46bf6d,0x3e95bf0e
.long 0xbf0e3f35,0xbe483ec4,0x3f55bf35,0x3f7bbf6d,0xbf623f6d,0xbf463f55,0xbe953ec4,0xbdc93e48
.long 0x0,0x0,0x0,0x0,0xbdc90000,0xbe95be48,0xbf46bf35,0xbf62bf55
.long 0xbe480000,0xbf0ebec4,0xbf7bbf80,0xbf55bf6d,0xbe950000,0xbf46bf0e,0xbef1bf35,0x3dc9be48
.long 0xbec40000,0xbf6dbf35,0x3ec4a50d,0x3f6d3f35,0xbef10000,0xbf7fbf55,0x3f753f35,0x3f463f7b
.long 0xbf0e0000,0xbf7bbf6d,0x3f553f80,0xbe483ec4,0xbf220000,0xbf62bf7b,0x3dc93f35,0xbf75bf0e
.long 0xbf350000,0xbf35bf80,0xbf350000,0xbf35bf80,0xbf460000,0xbef1bf7b,0xbf7fbf35,0x3e95bf0e
.long 0xbf550000,0xbe48bf6d,0xbf0ebf80,0x3f7b3ec4,0xbf620000,0x3dc9bf55,0x3e95bf35,0x3f223f7b
.long 0xbf6d0000,0x3ec4bf35,0x3f6da50d,0xbec43f35,0xbf750000,0x3f22bf0e,0x3f623f35,0xbf7fbe48
.long 0xbf7b0000,0x3f55bec4,0x3e483f80,0xbf0ebf6d,0xbf7f0000,0x3f75be48,0xbf223f35,0x3ef1bf55
.long 0xbf800000,0x3f80a50d,0xbf800000,0x3f80a50d,0xbf7f0000,0x3f753e48,0xbf22bf35,0x3ef13f55
.long 0xbf7b0000,0x3f553ec4,0x3e48bf80,0xbf0e3f6d,0xbf750000,0x3f223f0e,0x3f62bf35,0xbf7f3e48
.long 0xbf6d0000,0x3ec43f35,0x3f6da50d,0xbec4bf35,0xbf620000,0x3dc93f55,0x3e953f35,0x3f22bf7b
.long 0xbf550000,0xbe483f6d,0xbf0e3f80,0x3f7bbec4,0xbf460000,0xbef13f7b,0xbf7f3f35,0x3e953f0e
.long 0xbf350000,0xbf353f80,0xbf350000,0xbf353f80,0xbf220000,0xbf623f7b,0x3dc9bf35,0xbf753f0e
.long 0xbf0e0000,0xbf7b3f6d,0x3f55bf80,0xbe48bec4,0xbef10000,0xbf7f3f55,0x3f75bf35,0x3f46bf7b
.long 0xbec40000,0xbf6d3f35,0x3ec4a50d,0x3f6dbf35,0xbe950000,0xbf463f0e,0xbef13f35,0x3dc93e48
.long 0xbe480000,0xbf0e3ec4,0xbf7b3f80,0xbf553f6d,0xbdc90000,0xbe953e48,0xbf463f35,0xbf623f55
.long 0x0,0x0,0x0,0x0,0xbef1bec4,0xbf22bf0e,0xbf75bf6d,0xbf7fbf7b
.long 0xbf55bf35,0xbf7bbf6d,0xbf0ebf35,0xbe48bec4,0xbf7fbf6d,0xbf62bf7b,0x3f223ec4,0x3f753f55
.long 0xbf6dbf80,0xbec4bf35,0x3f6d3f80,0x3ec43f35,0xbf22bf6d,0x3e95be48,0xbdc93ec4,0xbf62bf0e
.long 0xbe48bf35,0x3f553ec4,0xbf7bbf35,0xbf0ebf6d,0x3e95bec4,0x3f7f3f55,0xbef1bf6d,0x3f463e48
.long 0x3f35a50d,0x3f353f80,0x3f35a50d,0x3f353f80,0x3f753ec4,0x3dc93f55,0x3f623f6d,0xbf223e48
.long 0x3f7b3f35,0xbf0e3ec4,0xbe483f35,0xbf55bf6d,0x3f463f6d,0xbf75be48,0xbf7fbec4,0x3ef1bf0e
.long 0x3ec43f80,0xbf6dbf35,0xbec4bf80,0x3f6d3f35,0xbdc93f6d,0xbef1bf7b,0x3f46bec4,0xbe953f55
.long 0xbf0e3f35,0x3e48bf6d,0x3f553f35,0xbf7bbec4,0xbf623ec4,0x3f46bf0e,0xbe953f6d,0x3dc9bf7b
.long 0xbf800000,0x3f80a50d,0xbf800000,0x3f80a50d,0xbf62bec4,0x3f463f0e,0xbe95bf6d,0x3dc93f7b
.long 0xbf0ebf35,0x3e483f6d,0x3f55bf35,0xbf7b3ec4,0xbdc9bf6d,0xbef13f7b,0x3f463ec4,0xbe95bf55
.long 0x3ec4bf80,0xbf6d3f35,0xbec43f80,0x3f6dbf35,0x3f46bf6d,0xbf753e48,0xbf7f3ec4,0x3ef13f0e
.long 0x3f7bbf35,0xbf0ebec4,0xbe48bf35,0xbf553f6d,0x3f75bec4,0x3dc9bf55,0x3f62bf6d,0xbf22be48
.long 0x3f35a50d,0x3f35bf80,0x3f35a50d,0x3f35bf80,0x3e953ec4,0x3f7fbf55,0xbef13f6d,0x3f46be48
.long 0xbe483f35,0x3f55bec4,0xbf7b3f35,0xbf0e3f6d,0xbf223f6d,0x3e953e48,0xbdc9bec4,0xbf623f0e
.long 0xbf6d3f80,0xbec43f35,0x3f6dbf80,0x3ec4bf35,0xbf7f3f6d,0xbf623f7b,0x3f22bec4,0x3f75bf55
.long 0xbf553f35,0xbf7b3f6d,0xbf0e3f35,0xbe483ec4,0xbef13ec4,0xbf223f0e,0xbf753f6d,0xbf7f3f7b
.long 0x80008000,0x80008000,0x80008000,0x80008000,0x3dc98000,0x3e953e48,0x3f463f35,0x3f623f55
.long 0x3e488000,0x3f0e3ec4,0x3f7b3f80,0x3f553f6d,0x3e958000,0x3f463f0e,0x3ef13f35,0xbdc93e48
.long 0x3ec48000,0x3f6d3f35,0xbec4250d,0xbf6dbf35,0x3ef18000,0x3f7f3f55,0xbf75bf35,0xbf46bf7b
.long 0x3f0e8000,0x3f7b3f6d,0xbf55bf80,0x3e48bec4,0x3f228000,0x3f623f7b,0xbdc9bf35,0x3f753f0e
.long 0x3f358000,0x3f353f80,0x3f358000,0x3f353f80,0x3f468000,0x3ef13f7b,0x3f7f3f35,0xbe953f0e
.long 0x3f558000,0x3e483f6d,0x3f0e3f80,0xbf7bbec4,0x3f628000,0xbdc93f55,0xbe953f35,0xbf22bf7b
.long 0x3f6d8000,0xbec43f35,0xbf6d250d,0x3ec4bf35,0x3f758000,0xbf223f0e,0xbf62bf35,0x3f7f3e48
.long 0x3f7b8000,0xbf553ec4,0xbe48bf80,0x3f0e3f6d,0x3f7f8000,0xbf753e48,0x3f22bf35,0xbef13f55
.long 0x3f808000,0xbf80250d,0x3f808000,0xbf80250d,0x3f7f8000,0xbf75be48,0x3f223f35,0xbef1bf55
.long 0x3f7b8000,0xbf55bec4,0xbe483f80,0x3f0ebf6d,0x3f758000,0xbf22bf0e,0xbf623f35,0x3f7fbe48
.long 0x3f6d8000,0xbec4bf35,0xbf6d250d,0x3ec43f35,0x3f628000,0xbdc9bf55,0xbe95bf35,0xbf223f7b
.long 0x3f558000,0x3e48bf6d,0x3f0ebf80,0xbf7b3ec4,0x3f468000,0x3ef1bf7b,0x3f7fbf35,0xbe95bf0e
.long 0x3f358000,0x3f35bf80,0x3f358000,0x3f35bf80,0x3f228000,0x3f62bf7b,0xbdc93f35,0x3f75bf0e
.long 0x3f0e8000,0x3f7bbf6d,0xbf553f80,0x3e483ec4,0x3ef18000,0x3f7fbf55,0xbf753f35,0xbf463f7b
.long 0x3ec48000,0x3f6dbf35,0xbec4250d,0xbf6d3f35,0x3e958000,0x3f46bf0e,0x3ef1bf35,0xbdc9be48
.long 0x3e488000,0x3f0ebec4,0x3f7bbf80,0x3f55bf6d,0x3dc98000,0x3e95be48,0x3f46bf35,0x3f62bf55
.long 0x80008000,0x80008000,0x80008000,0x80008000,0x3ef13ec4,0x3f223f0e,0x3f753f6d,0x3f7f3f7b
.long 0x3f553f35,0x3f7b3f6d,0x3f0e3f35,0x3e483ec4,0x3f7f3f6d,0x3f623f7b,0xbf22bec4,0xbf75bf55
.long 0x3f6d3f80,0x3ec43f35,0xbf6dbf80,0xbec4bf35,0x3f223f6d,0xbe953e48,0x3dc9bec4,0x3f623f0e
.long 0x3e483f35,0xbf55bec4,0x3f7b3f35,0x3f0e3f6d,0xbe953ec4,0xbf7fbf55,0x3ef13f6d,0xbf46be48
.long 0xbf35250d,0xbf35bf80,0xbf35250d,0xbf35bf80,0xbf75bec4,0xbdc9bf55,0xbf62bf6d,0x3f22be48
.long 0xbf7bbf35,0x3f0ebec4,0x3e48bf35,0x3f553f6d,0xbf46bf6d,0x3f753e48,0x3f7f3ec4,0xbef13f0e
.long 0xbec4bf80,0x3f6d3f35,0x3ec43f80,0xbf6dbf35,0x3dc9bf6d,0x3ef13f7b,0xbf463ec4,0x3e95bf55
.long 0x3f0ebf35,0xbe483f6d,0xbf55bf35,0x3f7b3ec4,0x3f62bec4,0xbf463f0e,0x3e95bf6d,0xbdc93f7b
.long 0x3f808000,0xbf80250d,0x3f808000,0xbf80250d,0x3f623ec4,0xbf46bf0e,0x3e953f6d,0xbdc9bf7b
.long 0x3f0e3f35,0xbe48bf6d,0xbf553f35,0x3f7bbec4,0x3dc93f6d,0x3ef1bf7b,0xbf46bec4,0x3e953f55
.long 0xbec43f80,0x3f6dbf35,0x3ec4bf80,0xbf6d3f35,0xbf463f6d,0x3f75be48,0x3f7fbec4,0xbef1bf0e
.long 0xbf7b3f35,0x3f0e3ec4,0x3e483f35,0x3f55bf6d,0xbf753ec4,0xbdc93f55,0xbf623f6d,0x3f223e48
.long 0xbf35250d,0xbf353f80,0xbf35250d,0xbf353f80,0xbe95bec4,0xbf7f3f55,0x3ef1bf6d,0xbf463e48
.long 0x3e48bf35,0xbf553ec4,0x3f7bbf35,0x3f0ebf6d,0x3f22bf6d,0xbe95be48,0x3dc93ec4,0x3f62bf0e
.long 0x3f6dbf80,0x3ec4bf35,0xbf6d3f80,0xbec43f35,0x3f7fbf6d,0x3f62bf7b,0xbf223ec4,0xbf753f55
.long 0x3f55bf35,0x3f7bbf6d,0x3f0ebf35,0x3e48bec4,0x3ef1bec4,0x3f22bf0e,0x3f75bf6d,0x3f7fbf7b
.long 0x3f803f80,0x3f803f80,0x3f803f80,0x3f803f80,0xbdc9248d,0xbe95be48,0xbf46bf35,0xbf62bf55
.long 0xbf7bbf80,0xbf55bf6d,0x3e48a554,0x3f0e3ec4,0x3e95a554,0x3f463f0e,0x3ef13f35,0xbdc93e48
.long 0x3f6d3f80,0x3ec43f35,0xbf6dbf80,0xbec4bf35,0xbef1248d,0xbf7fbf55,0x3f753f35,0x3f463f7b
.long 0xbf55bf80,0x3e48bec4,0xbf0e248d,0xbf7bbf6d,0x3f22a554,0x3f623f7b,0xbdc9bf35,0x3f753f0e
.long 0x3f353f80,0xbf35248d,0x3f353f80,0xbf35248d,0xbf46248d,0xbef1bf7b,0xbf7fbf35,0x3e95bf0e
.long 0xbf0ebf80,0x3f7b3ec4,0x3f55a554,0x3e483f6d,0x3f62a554,0xbdc93f55,0xbe953f35,0xbf22bf7b
.long 0x3ec43f80,0xbf6dbf35,0xbec4bf80,0x3f6d3f35,0xbf75248d,0x3f22bf0e,0x3f623f35,0xbf7fbe48
.long 0xbe48bf80,0x3f0e3f6d,0xbf7b248d,0x3f55bec4,0x3f7fa554,0xbf753e48,0x3f22bf35,0xbef13f55
.long 0x248d3f80,0xa554bf80,0x248d3f80,0xa554bf80,0xbf7f248d,0x3f753e48,0xbf22bf35,0x3ef13f55
.long 0x3e48bf80,0xbf0e3f6d,0x3f7ba554,0xbf55bec4,0x3f75a554,0xbf22bf0e,0xbf623f35,0x3f7fbe48
.long 0xbec43f80,0x3f6dbf35,0x3ec4bf80,0xbf6d3f35,0xbf62248d,0x3dc93f55,0x3e953f35,0x3f22bf7b
.long 0x3f0ebf80,0xbf7b3ec4,0xbf55248d,0xbe483f6d,0x3f46a554,0x3ef1bf7b,0x3f7fbf35,0xbe95bf0e
.long 0xbf353f80,0x3f35a554,0xbf353f80,0x3f35a554,0xbf22248d,0xbf623f7b,0x3dc9bf35,0xbf753f0e
.long 0x3f55bf80,0xbe48bec4,0x3f0ea554,0x3f7bbf6d,0x3ef1a554,0x3f7fbf55,0xbf753f35,0xbf463f7b
.long 0xbf6d3f80,0xbec43f35,0x3f6dbf80,0x3ec4bf35,0xbe95248d,0xbf463f0e,0xbef13f35,0x3dc93e48
.long 0x3f7bbf80,0x3f55bf6d,0xbe48248d,0xbf0e3ec4,0x3dc9a554,0x3e95be48,0x3f46bf35,0x3f62bf55
.long 0x3f803f80,0x3f803f80,0x3f803f80,0x3f803f80,0xbef1bec4,0xbf22bf0e,0xbf75bf6d,0xbf7fbf7b
.long 0xbf0ebf35,0xbe48bec4,0x3f553f35,0x3f7b3f6d,0x3f7f3f6d,0x3f623f7b,0xbf22bec4,0xbf75bf55
.long 0xbec4248d,0xbf6dbf35,0x3ec4a554,0x3f6d3f35,0xbf22bf6d,0x3e95be48,0xbdc93ec4,0xbf62bf0e
.long 0x3f7b3f35,0x3f0e3f6d,0xbe48bf35,0x3f553ec4,0xbe953ec4,0xbf7fbf55,0x3ef13f6d,0xbf46be48
.long 0xbf35bf80,0x3f35a554,0xbf35bf80,0x3f35a554,0x3f753ec4,0x3dc93f55,0x3f623f6d,0xbf223e48
.long 0xbe483f35,0xbf55bf6d,0xbf7bbf35,0x3f0ebec4,0xbf46bf6d,0x3f753e48,0x3f7f3ec4,0xbef13f0e
.long 0x3f6da554,0xbec43f35,0xbf6d248d,0x3ec4bf35,0xbdc93f6d,0xbef1bf7b,0x3f46bec4,0xbe953f55
.long 0xbf55bf35,0x3f7b3ec4,0xbf0e3f35,0x3e48bf6d,0x3f62bec4,0xbf463f0e,0x3e95bf6d,0xbdc93f7b
.long 0x248d3f80,0xa554bf80,0x248d3f80,0xa554bf80,0xbf62bec4,0x3f463f0e,0xbe95bf6d,0x3dc93f7b
.long 0x3f55bf35,0xbf7b3ec4,0x3f0e3f35,0xbe48bf6d,0x3dc93f6d,0x3ef1bf7b,0xbf46bec4,0x3e953f55
.long 0xbf6d248d,0x3ec43f35,0x3f6da554,0xbec4bf35,0x3f46bf6d,0xbf753e48,0xbf7f3ec4,0x3ef13f0e
.long 0x3e483f35,0x3f55bf6d,0x3f7bbf35,0xbf0ebec4,0xbf753ec4,0xbdc93f55,0xbf623f6d,0x3f223e48
.long 0x3f35bf80,0xbf35248d,0x3f35bf80,0xbf35248d,0x3e953ec4,0x3f7fbf55,0xbef13f6d,0x3f46be48
.long 0xbf7b3f35,0xbf0e3f6d,0x3e48bf35,0xbf553ec4,0x3f22bf6d,0xbe95be48,0x3dc93ec4,0x3f62bf0e
.long 0x3ec4a554,0x3f6dbf35,0xbec4248d,0xbf6d3f35,0xbf7f3f6d,0xbf623f7b,0x3f22bec4,0x3f75bf55
.long 0x3f0ebf35,0x3e48bec4,0xbf553f35,0xbf7b3f6d,0x3ef1bec4,0x3f22bf0e,0x3f75bf6d,0x3f7fbf7b
.long 0x0,0x0,0x0,0x0,0xbf7fbf80,0xbf75bf7b,0xbf22bf35,0xbef1bf0e
.long 0x3e48a50d,0x3f0e3ec4,0x3f7b3f80,0x3f553f6d,0x3f753f80,0x3f223f55,0xbf62bf35,0xbf7fbf7b
.long 0xbec40000,0xbf6dbf35,0x3ec4a50d,0x3f6d3f35,0xbf62bf80,0xbdc9bf0e,0x3e953f35,0xbf22be48
.long 0x3f0ea50d,0x3f7b3f6d,0xbf55bf80,0x3e48bec4,0x3f463f80,0xbef13e48,0x3f7f3f35,0x3e953f55
.long 0xbf350000,0xbf35bf80,0xbf350000,0xbf35bf80,0xbf22bf80,0x3f623e48,0x3dc9bf35,0x3f753f55
.long 0x3f55a50d,0x3e483f6d,0x3f0e3f80,0xbf7bbec4,0x3ef13f80,0xbf7fbf0e,0xbf75bf35,0x3f46be48
.long 0xbf6d0000,0x3ec4bf35,0x3f6da50d,0xbec43f35,0xbe95bf80,0x3f463f55,0xbef13f35,0xbdc9bf7b
.long 0x3f7ba50d,0xbf553ec4,0xbe48bf80,0x3f0e3f6d,0x3dc93f80,0xbe95bf7b,0x3f463f35,0xbf62bf0e
.long 0xbf800000,0x3f80a50d,0xbf800000,0x3f80a50d,0x3dc9bf80,0xbe953f7b,0x3f46bf35,0xbf623f0e
.long 0x3f7ba50d,0xbf55bec4,0xbe483f80,0x3f0ebf6d,0xbe953f80,0x3f46bf55,0xbef1bf35,0xbdc93f7b
.long 0xbf6d0000,0x3ec43f35,0x3f6da50d,0xbec4bf35,0x3ef1bf80,0xbf7f3f0e,0xbf753f35,0x3f463e48
.long 0x3f55a50d,0x3e48bf6d,0x3f0ebf80,0xbf7b3ec4,0xbf223f80,0x3f62be48,0x3dc93f35,0x3f75bf55
.long 0xbf350000,0xbf353f80,0xbf350000,0xbf353f80,0x3f46bf80,0xbef1be48,0x3f7fbf35,0x3e95bf55
.long 0x3f0ea50d,0x3f7bbf6d,0xbf553f80,0x3e483ec4,0xbf623f80,0xbdc93f0e,0x3e95bf35,0xbf223e48
.long 0xbec40000,0xbf6d3f35,0x3ec4a50d,0x3f6dbf35,0x3f75bf80,0x3f22bf55,0xbf623f35,0xbf7f3f7b
.long 0x3e48a50d,0x3f0ebec4,0x3f7bbf80,0x3f55bf6d,0xbf7f3f80,0xbf753f7b,0xbf223f35,0xbef13f0e
.long 0x0,0x0,0x0,0x0,0xbf62bf6d,0xbf46bf55,0xbe95bec4,0xbdc9be48
.long 0x3f553f35,0x3f7b3f6d,0x3f0e3f35,0x3e483ec4,0x3dc93ec4,0xbef1be48,0xbf46bf6d,0xbe95bf0e
.long 0xbf6dbf80,0xbec4bf35,0x3f6d3f80,0x3ec43f35,0x3f463ec4,0x3f753f7b,0xbf7fbf6d,0xbef1bf55
.long 0x3e483f35,0xbf55bec4,0x3f7b3f35,0x3f0e3f6d,0xbf75bf6d,0x3dc9bf0e,0xbf62bec4,0xbf22bf7b
.long 0x3f35a50d,0x3f353f80,0x3f35a50d,0x3f353f80,0x3e953f6d,0xbf7fbf0e,0xbef13ec4,0xbf46bf7b
.long 0xbf7bbf35,0x3f0ebec4,0x3e48bf35,0x3f553f6d,0x3f22bec4,0x3e953f7b,0x3dc93f6d,0xbf62bf55
.long 0x3ec43f80,0xbf6dbf35,0xbec4bf80,0x3f6d3f35,0xbf7fbec4,0x3f62be48,0x3f223f6d,0xbf75bf0e
.long 0x3f0ebf35,0xbe483f6d,0xbf55bf35,0x3f7b3ec4,0x3ef13f6d,0xbf22bf55,0x3f753ec4,0xbf7fbe48
.long 0xbf800000,0x3f80a50d,0xbf800000,0x3f80a50d,0x3ef1bf6d,0xbf223f55,0x3f75bec4,0xbf7f3e48
.long 0x3f0e3f35,0xbe48bf6d,0xbf553f35,0x3f7bbec4,0xbf7f3ec4,0x3f623e48,0x3f22bf6d,0xbf753f0e
.long 0x3ec4bf80,0xbf6d3f35,0xbec43f80,0x3f6dbf35,0x3f223ec4,0x3e95bf7b,0x3dc9bf6d,0xbf623f55
.long 0xbf7b3f35,0x3f0e3ec4,0x3e483f35,0x3f55bf6d,0x3e95bf6d,0xbf7f3f0e,0xbef1bec4,0xbf463f7b
.long 0x3f35a50d,0x3f35bf80,0x3f35a50d,0x3f35bf80,0xbf753f6d,0x3dc93f0e,0xbf623ec4,0xbf223f7b
.long 0x3e48bf35,0xbf553ec4,0x3f7bbf35,0x3f0ebf6d,0x3f46bec4,0x3f75bf7b,0xbf7f3f6d,0xbef13f55
.long 0xbf6d3f80,0xbec43f35,0x3f6dbf80,0x3ec4bf35,0x3dc9bec4,0xbef13e48,0xbf463f6d,0xbe953f0e
.long 0x3f55bf35,0x3f7bbf6d,0x3f0ebf35,0x3e48bec4,0xbf623f6d,0xbf463f55,0xbe953ec4,0xbdc93e48
.long 0x80008000,0x80008000,0x80008000,0x80008000,0x3f7f3f80,0x3f753f7b,0x3f223f35,0x3ef13f0e
.long 0xbe48250d,0xbf0ebec4,0xbf7bbf80,0xbf55bf6d,0xbf75bf80,0xbf22bf55,0x3f623f35,0x3f7f3f7b
.long 0x3ec48000,0x3f6d3f35,0xbec4250d,0xbf6dbf35,0x3f623f80,0x3dc93f0e,0xbe95bf35,0x3f223e48
.long 0xbf0e250d,0xbf7bbf6d,0x3f553f80,0xbe483ec4,0xbf46bf80,0x3ef1be48,0xbf7fbf35,0xbe95bf55
.long 0x3f358000,0x3f353f80,0x3f358000,0x3f353f80,0x3f223f80,0xbf62be48,0xbdc93f35,0xbf75bf55
.long 0xbf55250d,0xbe48bf6d,0xbf0ebf80,0x3f7b3ec4,0xbef1bf80,0x3f7f3f0e,0x3f753f35,0xbf463e48
.long 0x3f6d8000,0xbec43f35,0xbf6d250d,0x3ec4bf35,0x3e953f80,0xbf46bf55,0x3ef1bf35,0x3dc93f7b
.long 0xbf7b250d,0x3f55bec4,0x3e483f80,0xbf0ebf6d,0xbdc9bf80,0x3e953f7b,0xbf46bf35,0x3f623f0e
.long 0x3f808000,0xbf80250d,0x3f808000,0xbf80250d,0xbdc93f80,0x3e95bf7b,0xbf463f35,0x3f62bf0e
.long 0xbf7b250d,0x3f553ec4,0x3e48bf80,0xbf0e3f6d,0x3e95bf80,0xbf463f55,0x3ef13f35,0x3dc9bf7b
.long 0x3f6d8000,0xbec4bf35,0xbf6d250d,0x3ec43f35,0xbef13f80,0x3f7fbf0e,0x3f75bf35,0xbf46be48
.long 0xbf55250d,0xbe483f6d,0xbf0e3f80,0x3f7bbec4,0x3f22bf80,0xbf623e48,0xbdc9bf35,0xbf753f55
.long 0x3f358000,0x3f35bf80,0x3f358000,0x3f35bf80,0xbf463f80,0x3ef13e48,0xbf7f3f35,0xbe953f55
.long 0xbf0e250d,0xbf7b3f6d,0x3f55bf80,0xbe48bec4,0x3f62bf80,0x3dc9bf0e,0xbe953f35,0x3f22be48
.long 0x3ec48000,0x3f6dbf35,0xbec4250d,0xbf6d3f35,0xbf753f80,0xbf223f55,0x3f62bf35,0x3f7fbf7b
.long 0xbe48250d,0xbf0e3ec4,0xbf7b3f80,0xbf553f6d,0x3f7fbf80,0x3f75bf7b,0x3f22bf35,0x3ef1bf0e
.long 0x80008000,0x80008000,0x80008000,0x80008000,0x3f623f6d,0x3f463f55,0x3e953ec4,0x3dc93e48
.long 0xbf55bf35,0xbf7bbf6d,0xbf0ebf35,0xbe48bec4,0xbdc9bec4,0x3ef13e48,0x3f463f6d,0x3e953f0e
.long 0x3f6d3f80,0x3ec43f35,0xbf6dbf80,0xbec4bf35,0xbf46bec4,0xbf75bf7b,0x3f7f3f6d,0x3ef13f55
.long 0xbe48bf35,0x3f553ec4,0xbf7bbf35,0xbf0ebf6d,0x3f753f6d,0xbdc93f0e,0x3f623ec4,0x3f223f7b
.long 0xbf35250d,0xbf35bf80,0xbf35250d,0xbf35bf80,0xbe95bf6d,0x3f7f3f0e,0x3ef1bec4,0x3f463f7b
.long 0x3f7b3f35,0xbf0e3ec4,0xbe483f35,0xbf55bf6d,0xbf223ec4,0xbe95bf7b,0xbdc9bf6d,0x3f623f55
.long 0xbec4bf80,0x3f6d3f35,0x3ec43f80,0xbf6dbf35,0x3f7f3ec4,0xbf623e48,0xbf22bf6d,0x3f753f0e
.long 0xbf0e3f35,0x3e48bf6d,0x3f553f35,0xbf7bbec4,0xbef1bf6d,0x3f223f55,0xbf75bec4,0x3f7f3e48
.long 0x3f808000,0xbf80250d,0x3f808000,0xbf80250d,0xbef13f6d,0x3f22bf55,0xbf753ec4,0x3f7fbe48
.long 0xbf0ebf35,0x3e483f6d,0x3f55bf35,0xbf7b3ec4,0x3f7fbec4,0xbf62be48,0xbf223f6d,0x3f75bf0e
.long 0xbec43f80,0x3f6dbf35,0x3ec4bf80,0xbf6d3f35,0xbf22bec4,0xbe953f7b,0xbdc93f6d,0x3f62bf55
.long 0x3f7bbf35,0xbf0ebec4,0xbe48bf35,0xbf553f6d,0xbe953f6d,0x3f7fbf0e,0x3ef13ec4,0x3f46bf7b
.long 0xbf35250d,0xbf353f80,0xbf35250d,0xbf353f80,0x3f75bf6d,0xbdc9bf0e,0x3f62bec4,0x3f22bf7b
.long 0xbe483f35,0x3f55bec4,0xbf7b3f35,0xbf0e3f6d,0xbf463ec4,0xbf753f7b,0x3f7fbf6d,0x3ef1bf55
.long 0x3f6dbf80,0x3ec4bf35,0xbf6d3f80,0xbec43f35,0xbdc93ec4,0x3ef1be48,0x3f46bf6d,0x3e95bf0e
.long 0xbf553f35,0xbf7b3f6d,0xbf0e3f35,0xbe483ec4,0x3f62bf6d,0x3f46bf55,0x3e95bec4,0x3dc9be48
.long 0x3f803f80,0x3f803f80,0x3f803f80,0x3f803f80,0xbf7fbf80,0xbf75bf7b,0xbf22bf35,0xbef1bf0e
.long 0x3f7b3f80,0x3f553f6d,0xbe48248d,0xbf0ebec4,0xbf75bf80,0xbf22bf55,0x3f623f35,0x3f7f3f7b
.long 0x3f6d3f80,0x3ec43f35,0xbf6dbf80,0xbec4bf35,0xbf62bf80,0xbdc9bf0e,0x3e953f35,0xbf22be48
.long 0x3f553f80,0xbe483ec4,0x3f0ea554,0x3f7b3f6d,0xbf46bf80,0x3ef1be48,0xbf7fbf35,0xbe95bf55
.long 0x3f353f80,0xbf35248d,0x3f353f80,0xbf35248d,0xbf22bf80,0x3f623e48,0x3dc9bf35,0x3f753f55
.long 0x3f0e3f80,0xbf7bbec4,0xbf55248d,0xbe48bf6d,0xbef1bf80,0x3f7f3f0e,0x3f753f35,0xbf463e48
.long 0x3ec43f80,0xbf6dbf35,0xbec4bf80,0x3f6d3f35,0xbe95bf80,0x3f463f55,0xbef13f35,0xbdc9bf7b
.long 0x3e483f80,0xbf0ebf6d,0x3f7ba554,0xbf553ec4,0xbdc9bf80,0x3e953f7b,0xbf46bf35,0x3f623f0e
.long 0x248d3f80,0xa554bf80,0x248d3f80,0xa554bf80,0x3dc9bf80,0xbe953f7b,0x3f46bf35,0xbf623f0e
.long 0xbe483f80,0x3f0ebf6d,0xbf7b248d,0x3f553ec4,0x3e95bf80,0xbf463f55,0x3ef13f35,0x3dc9bf7b
.long 0xbec43f80,0x3f6dbf35,0x3ec4bf80,0xbf6d3f35,0x3ef1bf80,0xbf7f3f0e,0xbf753f35,0x3f463e48
.long 0xbf0e3f80,0x3f7bbec4,0x3f55a554,0x3e48bf6d,0x3f22bf80,0xbf623e48,0xbdc9bf35,0xbf753f55
.long 0xbf353f80,0x3f35a554,0xbf353f80,0x3f35a554,0x3f46bf80,0xbef1be48,0x3f7fbf35,0x3e95bf55
.long 0xbf553f80,0x3e483ec4,0xbf0e248d,0xbf7b3f6d,0x3f62bf80,0x3dc9bf0e,0xbe953f35,0x3f22be48
.long 0xbf6d3f80,0xbec43f35,0x3f6dbf80,0x3ec4bf35,0x3f75bf80,0x3f22bf55,0xbf623f35,0xbf7f3f7b
.long 0xbf7b3f80,0xbf553f6d,0x3e48a554,0x3f0ebec4,0x3f7fbf80,0x3f75bf7b,0x3f22bf35,0x3ef1bf0e
.long 0x3f803f80,0x3f803f80,0x3f803f80,0x3f803f80,0xbf62bf6d,0xbf46bf55,0xbe95bec4,0xbdc9be48
.long 0x3f0e3f35,0x3e483ec4,0xbf55bf35,0xbf7bbf6d,0xbdc9bec4,0x3ef13e48,0x3f463f6d,0x3e953f0e
.long 0xbec4248d,0xbf6dbf35,0x3ec4a554,0x3f6d3f35,0x3f463ec4,0x3f753f7b,0xbf7fbf6d,0xbef1bf55
.long 0xbf7bbf35,0xbf0ebf6d,0x3e483f35,0xbf55bec4,0x3f753f6d,0xbdc93f0e,0x3f623ec4,0x3f223f7b
.long 0xbf35bf80,0x3f35a554,0xbf35bf80,0x3f35a554,0x3e953f6d,0xbf7fbf0e,0xbef13ec4,0xbf46bf7b
.long 0x3e48bf35,0x3f553f6d,0x3f7b3f35,0xbf0e3ec4,0xbf223ec4,0xbe95bf7b,0xbdc9bf6d,0x3f623f55
.long 0x3f6da554,0xbec43f35,0xbf6d248d,0x3ec4bf35,0xbf7fbec4,0x3f62be48,0x3f223f6d,0xbf75bf0e
.long 0x3f553f35,0xbf7bbec4,0x3f0ebf35,0xbe483f6d,0xbef1bf6d,0x3f223f55,0xbf75bec4,0x3f7f3e48
.long 0x248d3f80,0xa554bf80,0x248d3f80,0xa554bf80,0x3ef1bf6d,0xbf223f55,0x3f75bec4,0xbf7f3e48
.long 0xbf553f35,0x3f7bbec4,0xbf0ebf35,0x3e483f6d,0x3f7fbec4,0xbf62be48,0xbf223f6d,0x3f75bf0e
.long 0xbf6d248d,0x3ec43f35,0x3f6da554,0xbec4bf35,0x3f223ec4,0x3e95bf7b,0x3dc9bf6d,0xbf623f55
.long 0xbe48bf35,0xbf553f6d,0xbf7b3f35,0x3f0e3ec4,0xbe953f6d,0x3f7fbf0e,0x3ef13ec4,0x3f46bf7b
.long 0x3f35bf80,0xbf35248d,0x3f35bf80,0xbf35248d,0xbf753f6d,0x3dc93f0e,0xbf623ec4,0xbf223f7b
.long 0x3f7bbf35,0x3f0ebf6d,0xbe483f35,0x3f55bec4,0xbf463ec4,0xbf753f7b,0x3f7fbf6d,0x3ef1bf55
.long 0x3ec4a554,0x3f6dbf35,0xbec4248d,0xbf6d3f35,0x3dc9bec4,0xbef13e48,0xbf463f6d,0xbe953f0e
.long 0xbf0e3f35,0xbe483ec4,0x3f55bf35,0x3f7bbf6d,0x3f62bf6d,0x3f46bf55,0x3e95bec4,0x3dc9be48
.long 0x0,0x0,0x0,0x0,0x3dc9a50d,0x3e953e48,0x3f463f35,0x3f623f55
.long 0xbe480000,0xbf0ebec4,0xbf7bbf80,0xbf55bf6d,0x3e95a50d,0x3f463f0e,0x3ef13f35,0xbdc93e48
.long 0xbec40000,0xbf6dbf35,0x3ec4a50d,0x3f6d3f35,0x3ef1a50d,0x3f7f3f55,0xbf75bf35,0xbf46bf7b
.long 0xbf0e0000,0xbf7bbf6d,0x3f553f80,0xbe483ec4,0x3f22a50d,0x3f623f7b,0xbdc9bf35,0x3f753f0e
.long 0xbf350000,0xbf35bf80,0xbf350000,0xbf35bf80,0x3f46a50d,0x3ef13f7b,0x3f7f3f35,0xbe953f0e
.long 0xbf550000,0xbe48bf6d,0xbf0ebf80,0x3f7b3ec4,0x3f62a50d,0xbdc93f55,0xbe953f35,0xbf22bf7b
.long 0xbf6d0000,0x3ec4bf35,0x3f6da50d,0xbec43f35,0x3f75a50d,0xbf223f0e,0xbf62bf35,0x3f7f3e48
.long 0xbf7b0000,0x3f55bec4,0x3e483f80,0xbf0ebf6d,0x3f7fa50d,0xbf753e48,0x3f22bf35,0xbef13f55
.long 0xbf800000,0x3f80a50d,0xbf800000,0x3f80a50d,0x3f7fa50d,0xbf75be48,0x3f223f35,0xbef1bf55
.long 0xbf7b0000,0x3f553ec4,0x3e48bf80,0xbf0e3f6d,0x3f75a50d,0xbf22bf0e,0xbf623f35,0x3f7fbe48
.long 0xbf6d0000,0x3ec43f35,0x3f6da50d,0xbec4bf35,0x3f62a50d,0xbdc9bf55,0xbe95bf35,0xbf223f7b
.long 0xbf550000,0xbe483f6d,0xbf0e3f80,0x3f7bbec4,0x3f46a50d,0x3ef1bf7b,0x3f7fbf35,0xbe95bf0e
.long 0xbf350000,0xbf353f80,0xbf350000,0xbf353f80,0x3f22a50d,0x3f62bf7b,0xbdc93f35,0x3f75bf0e
.long 0xbf0e0000,0xbf7b3f6d,0x3f55bf80,0xbe48bec4,0x3ef1a50d,0x3f7fbf55,0xbf753f35,0xbf463f7b
.long 0xbec40000,0xbf6d3f35,0x3ec4a50d,0x3f6dbf35,0x3e95a50d,0x3f46bf0e,0x3ef1bf35,0xbdc9be48
.long 0xbe480000,0xbf0e3ec4,0xbf7b3f80,0xbf553f6d,0x3dc9a50d,0x3e95be48,0x3f46bf35,0x3f62bf55
.long 0x0,0x0,0x0,0x0,0x3ef13ec4,0x3f223f0e,0x3f753f6d,0x3f7f3f7b
.long 0xbf55bf35,0xbf7bbf6d,0xbf0ebf35,0xbe48bec4,0x3f7f3f6d,0x3f623f7b,0xbf22bec4,0xbf75bf55
.long 0xbf6dbf80,0xbec4bf35,0x3f6d3f80,0x3ec43f35,0x3f223f6d,0xbe953e48,0x3dc9bec4,0x3f623f0e
.long 0xbe48bf35,0x3f553ec4,0xbf7bbf35,0xbf0ebf6d,0xbe953ec4,0xbf7fbf55,0x3ef13f6d,0xbf46be48
.long 0x3f35a50d,0x3f353f80,0x3f35a50d,0x3f353f80,0xbf75bec4,0xbdc9bf55,0xbf62bf6d,0x3f22be48
.long 0x3f7b3f35,0xbf0e3ec4,0xbe483f35,0xbf55bf6d,0xbf46bf6d,0x3f753e48,0x3f7f3ec4,0xbef13f0e
.long 0x3ec43f80,0xbf6dbf35,0xbec4bf80,0x3f6d3f35,0x3dc9bf6d,0x3ef13f7b,0xbf463ec4,0x3e95bf55
.long 0xbf0e3f35,0x3e48bf6d,0x3f553f35,0xbf7bbec4,0x3f62bec4,0xbf463f0e,0x3e95bf6d,0xbdc93f7b
.long 0xbf800000,0x3f80a50d,0xbf800000,0x3f80a50d,0x3f623ec4,0xbf46bf0e,0x3e953f6d,0xbdc9bf7b
.long 0xbf0ebf35,0x3e483f6d,0x3f55bf35,0xbf7b3ec4,0x3dc93f6d,0x3ef1bf7b,0xbf46bec4,0x3e953f55
.long 0x3ec4bf80,0xbf6d3f35,0xbec43f80,0x3f6dbf35,0xbf463f6d,0x3f75be48,0x3f7fbec4,0xbef1bf0e
.long 0x3f7bbf35,0xbf0ebec4,0xbe48bf35,0xbf553f6d,0xbf753ec4,0xbdc93f55,0xbf623f6d,0x3f223e48
.long 0x3f35a50d,0x3f35bf80,0x3f35a50d,0x3f35bf80,0xbe95bec4,0xbf7f3f55,0x3ef1bf6d,0xbf463e48
.long 0xbe483f35,0x3f55bec4,0xbf7b3f35,0xbf0e3f6d,0x3f22bf6d,0xbe95be48,0x3dc93ec4,0x3f62bf0e
.long 0xbf6d3f80,0xbec43f35,0x3f6dbf80,0x3ec4bf35,0x3f7fbf6d,0x3f62bf7b,0xbf223ec4,0xbf753f55
.long 0xbf553f35,0xbf7b3f6d,0xbf0e3f35,0xbe483ec4,0x3ef1bec4,0x3f22bf0e,0x3f75bf6d,0x3f7fbf7b
.long 0x80008000,0x80008000,0x80008000,0x80008000,0xbdc9250d,0xbe95be48,0xbf46bf35,0xbf62bf55
.long 0x3e488000,0x3f0e3ec4,0x3f7b3f80,0x3f553f6d,0xbe95250d,0xbf46bf0e,0xbef1bf35,0x3dc9be48
.long 0x3ec48000,0x3f6d3f35,0xbec4250d,0xbf6dbf35,0xbef1250d,0xbf7fbf55,0x3f753f35,0x3f463f7b
.long 0x3f0e8000,0x3f7b3f6d,0xbf55bf80,0x3e48bec4,0xbf22250d,0xbf62bf7b,0x3dc93f35,0xbf75bf0e
.long 0x3f358000,0x3f353f80,0x3f358000,0x3f353f80,0xbf46250d,0xbef1bf7b,0xbf7fbf35,0x3e95bf0e
.long 0x3f558000,0x3e483f6d,0x3f0e3f80,0xbf7bbec4,0xbf62250d,0x3dc9bf55,0x3e95bf35,0x3f223f7b
.long 0x3f6d8000,0xbec43f35,0xbf6d250d,0x3ec4bf35,0xbf75250d,0x3f22bf0e,0x3f623f35,0xbf7fbe48
.long 0x3f7b8000,0xbf553ec4,0xbe48bf80,0x3f0e3f6d,0xbf7f250d,0x3f75be48,0xbf223f35,0x3ef1bf55
.long 0x3f808000,0xbf80250d,0x3f808000,0xbf80250d,0xbf7f250d,0x3f753e48,0xbf22bf35,0x3ef13f55
.long 0x3f7b8000,0xbf55bec4,0xbe483f80,0x3f0ebf6d,0xbf75250d,0x3f223f0e,0x3f62bf35,0xbf7f3e48
.long 0x3f6d8000,0xbec4bf35,0xbf6d250d,0x3ec43f35,0xbf62250d,0x3dc93f55,0x3e953f35,0x3f22bf7b
.long 0x3f558000,0x3e48bf6d,0x3f0ebf80,0xbf7b3ec4,0xbf46250d,0xbef13f7b,0xbf7f3f35,0x3e953f0e
.long 0x3f358000,0x3f35bf80,0x3f358000,0x3f35bf80,0xbf22250d,0xbf623f7b,0x3dc9bf35,0xbf753f0e
.long 0x3f0e8000,0x3f7bbf6d,0xbf553f80,0x3e483ec4,0xbef1250d,0xbf7f3f55,0x3f75bf35,0x3f46bf7b
.long 0x3ec48000,0x3f6dbf35,0xbec4250d,0xbf6d3f35,0xbe95250d,0xbf463f0e,0xbef13f35,0x3dc93e48
.long 0x3e488000,0x3f0ebec4,0x3f7bbf80,0x3f55bf6d,0xbdc9250d,0xbe953e48,0xbf463f35,0xbf623f55
.long 0x80008000,0x80008000,0x80008000,0x80008000,0xbef1bec4,0xbf22bf0e,0xbf75bf6d,0xbf7fbf7b
.long 0x3f553f35,0x3f7b3f6d,0x3f0e3f35,0x3e483ec4,0xbf7fbf6d,0xbf62bf7b,0x3f223ec4,0x3f753f55
.long 0x3f6d3f80,0x3ec43f35,0xbf6dbf80,0xbec4bf35,0xbf22bf6d,0x3e95be48,0xbdc93ec4,0xbf62bf0e
.long 0x3e483f35,0xbf55bec4,0x3f7b3f35,0x3f0e3f6d,0x3e95bec4,0x3f7f3f55,0xbef1bf6d,0x3f463e48
.long 0xbf35250d,0xbf35bf80,0xbf35250d,0xbf35bf80,0x3f753ec4,0x3dc93f55,0x3f623f6d,0xbf223e48
.long 0xbf7bbf35,0x3f0ebec4,0x3e48bf35,0x3f553f6d,0x3f463f6d,0xbf75be48,0xbf7fbec4,0x3ef1bf0e
.long 0xbec4bf80,0x3f6d3f35,0x3ec43f80,0xbf6dbf35,0xbdc93f6d,0xbef1bf7b,0x3f46bec4,0xbe953f55
.long 0x3f0ebf35,0xbe483f6d,0xbf55bf35,0x3f7b3ec4,0xbf623ec4,0x3f46bf0e,0xbe953f6d,0x3dc9bf7b
.long 0x3f808000,0xbf80250d,0x3f808000,0xbf80250d,0xbf62bec4,0x3f463f0e,0xbe95bf6d,0x3dc93f7b
.long 0x3f0e3f35,0xbe48bf6d,0xbf553f35,0x3f7bbec4,0xbdc9bf6d,0xbef13f7b,0x3f463ec4,0xbe95bf55
.long 0xbec43f80,0x3f6dbf35,0x3ec4bf80,0xbf6d3f35,0x3f46bf6d,0xbf753e48,0xbf7f3ec4,0x3ef13f0e
.long 0xbf7b3f35,0x3f0e3ec4,0x3e483f35,0x3f55bf6d,0x3f75bec4,0x3dc9bf55,0x3f62bf6d,0xbf22be48
.long 0xbf35250d,0xbf353f80,0xbf35250d,0xbf353f80,0x3e953ec4,0x3f7fbf55,0xbef13f6d,0x3f46be48
.long 0x3e48bf35,0xbf553ec4,0x3f7bbf35,0x3f0ebf6d,0xbf223f6d,0x3e953e48,0xbdc9bec4,0xbf623f0e
.long 0x3f6dbf80,0x3ec4bf35,0xbf6d3f80,0xbec43f35,0xbf7f3f6d,0xbf623f7b,0x3f22bec4,0x3f75bf55
.long 0x3f55bf35,0x3f7bbf6d,0x3f0ebf35,0x3e48bec4,0xbef13ec4,0xbf223f0e,0xbf753f6d,0xbf7f3f7b
.long 0x3f803f80,0x3f803f80,0x3f803f80,0x3f803f80,0x3dc9a554,0x3e953e48,0x3f463f35,0x3f623f55
.long 0xbf7bbf80,0xbf55bf6d,0x3e48a554,0x3f0e3ec4,0xbe95248d,0xbf46bf0e,0xbef1bf35,0x3dc9be48
.long 0x3f6d3f80,0x3ec43f35,0xbf6dbf80,0xbec4bf35,0x3ef1a554,0x3f7f3f55,0xbf75bf35,0xbf46bf7b
.long 0xbf55bf80,0x3e48bec4,0xbf0e248d,0xbf7bbf6d,0xbf22248d,0xbf62bf7b,0x3dc93f35,0xbf75bf0e
.long 0x3f353f80,0xbf35248d,0x3f353f80,0xbf35248d,0x3f46a554,0x3ef13f7b,0x3f7f3f35,0xbe953f0e
.long 0xbf0ebf80,0x3f7b3ec4,0x3f55a554,0x3e483f6d,0xbf62248d,0x3dc9bf55,0x3e95bf35,0x3f223f7b
.long 0x3ec43f80,0xbf6dbf35,0xbec4bf80,0x3f6d3f35,0x3f75a554,0xbf223f0e,0xbf62bf35,0x3f7f3e48
.long 0xbe48bf80,0x3f0e3f6d,0xbf7b248d,0x3f55bec4,0xbf7f248d,0x3f75be48,0xbf223f35,0x3ef1bf55
.long 0x248d3f80,0xa554bf80,0x248d3f80,0xa554bf80,0x3f7fa554,0xbf75be48,0x3f223f35,0xbef1bf55
.long 0x3e48bf80,0xbf0e3f6d,0x3f7ba554,0xbf55bec4,0xbf75248d,0x3f223f0e,0x3f62bf35,0xbf7f3e48
.long 0xbec43f80,0x3f6dbf35,0x3ec4bf80,0xbf6d3f35,0x3f62a554,0xbdc9bf55,0xbe95bf35,0xbf223f7b
.long 0x3f0ebf80,0xbf7b3ec4,0xbf55248d,0xbe483f6d,0xbf46248d,0xbef13f7b,0xbf7f3f35,0x3e953f0e
.long 0xbf353f80,0x3f35a554,0xbf353f80,0x3f35a554,0x3f22a554,0x3f62bf7b,0xbdc93f35,0x3f75bf0e
.long 0x3f55bf80,0xbe48bec4,0x3f0ea554,0x3f7bbf6d,0xbef1248d,0xbf7f3f55,0x3f75bf35,0x3f46bf7b
.long 0xbf6d3f80,0xbec43f35,0x3f6dbf80,0x3ec4bf35,0x3e95a554,0x3f46bf0e,0x3ef1bf35,0xbdc9be48
.long 0x3f7bbf80,0x3f55bf6d,0xbe48248d,0xbf0e3ec4,0xbdc9248d,0xbe953e48,0xbf463f35,0xbf623f55
.long 0x3f803f80,0x3f803f80,0x3f803f80,0x3f803f80,0x3ef13ec4,0x3f223f0e,0x3f753f6d,0x3f7f3f7b
.long 0xbf0ebf35,0xbe48bec4,0x3f553f35,0x3f7b3f6d,0xbf7fbf6d,0xbf62bf7b,0x3f223ec4,0x3f753f55
.long 0xbec4248d,0xbf6dbf35,0x3ec4a554,0x3f6d3f35,0x3f223f6d,0xbe953e48,0x3dc9bec4,0x3f623f0e
.long 0x3f7b3f35,0x3f0e3f6d,0xbe48bf35,0x3f553ec4,0x3e95bec4,0x3f7f3f55,0xbef1bf6d,0x3f463e48
.long 0xbf35bf80,0x3f35a554,0xbf35bf80,0x3f35a554,0xbf75bec4,0xbdc9bf55,0xbf62bf6d,0x3f22be48
.long 0xbe483f35,0xbf55bf6d,0xbf7bbf35,0x3f0ebec4,0x3f463f6d,0xbf75be48,0xbf7fbec4,0x3ef1bf0e
.long 0x3f6da554,0xbec43f35,0xbf6d248d,0x3ec4bf35,0x3dc9bf6d,0x3ef13f7b,0xbf463ec4,0x3e95bf55
.long 0xbf55bf35,0x3f7b3ec4,0xbf0e3f35,0x3e48bf6d,0xbf623ec4,0x3f46bf0e,0xbe953f6d,0x3dc9bf7b
.long 0x248d3f80,0xa554bf80,0x248d3f80,0xa554bf80,0x3f623ec4,0xbf46bf0e,0x3e953f6d,0xbdc9bf7b
.long 0x3f55bf35,0xbf7b3ec4,0x3f0e3f35,0xbe48bf6d,0xbdc9bf6d,0xbef13f7b,0x3f463ec4,0xbe95bf55
.long 0xbf6d248d,0x3ec43f35,0x3f6da554,0xbec4bf35,0xbf463f6d,0x3f75be48,0x3f7fbec4,0xbef1bf0e
.long 0x3e483f35,0x3f55bf6d,0x3f7bbf35,0xbf0ebec4,0x3f75bec4,0x3dc9bf55,0x3f62bf6d,0xbf22be48
.long 0x3f35bf80,0xbf35248d,0x3f35bf80,0xbf35248d,0xbe95bec4,0xbf7f3f55,0x3ef1bf6d,0xbf463e48
.long 0xbf7b3f35,0xbf0e3f6d,0x3e48bf35,0xbf553ec4,0xbf223f6d,0x3e953e48,0xbdc9bec4,0xbf623f0e
.long 0x3ec4a554,0x3f6dbf35,0xbec4248d,0xbf6d3f35,0x3f7fbf6d,0x3f62bf7b,0xbf223ec4,0xbf753f55
.long 0x3f0ebf35,0x3e48bec4,0xbf553f35,0xbf7b3f6d,0xbef13ec4,0xbf223f0e,0xbf753f6d,0xbf7f3f7b
.long 0x0,0x0,0x0,0x0,0x3f7f3f80,0x3f753f7b,0x3f223f35,0x3ef13f0e
.long 0x3e48a50d,0x3f0e3ec4,0x3f7b3f80,0x3f553f6d,0xbf75bf80,0xbf22bf55,0x3f623f35,0x3f7f3f7b
.long 0xbec40000,0xbf6dbf35,0x3ec4a50d,0x3f6d3f35,0x3f623f80,0x3dc93f0e,0xbe95bf35,0x3f223e48
.long 0x3f0ea50d,0x3f7b3f6d,0xbf55bf80,0x3e48bec4,0xbf46bf80,0x3ef1be48,0xbf7fbf35,0xbe95bf55
.long 0xbf350000,0xbf35bf80,0xbf350000,0xbf35bf80,0x3f223f80,0xbf62be48,0xbdc93f35,0xbf75bf55
.long 0x3f55a50d,0x3e483f6d,0x3f0e3f80,0xbf7bbec4,0xbef1bf80,0x3f7f3f0e,0x3f753f35,0xbf463e48
.long 0xbf6d0000,0x3ec4bf35,0x3f6da50d,0xbec43f35,0x3e953f80,0xbf46bf55,0x3ef1bf35,0x3dc93f7b
.long 0x3f7ba50d,0xbf553ec4,0xbe48bf80,0x3f0e3f6d,0xbdc9bf80,0x3e953f7b,0xbf46bf35,0x3f623f0e
.long 0xbf800000,0x3f80a50d,0xbf800000,0x3f80a50d,0xbdc93f80,0x3e95bf7b,0xbf463f35,0x3f62bf0e
.long 0x3f7ba50d,0xbf55bec4,0xbe483f80,0x3f0ebf6d,0x3e95bf80,0xbf463f55,0x3ef13f35,0x3dc9bf7b
.long 0xbf6d0000,0x3ec43f35,0x3f6da50d,0xbec4bf35,0xbef13f80,0x3f7fbf0e,0x3f75bf35,0xbf46be48
.long 0x3f55a50d,0x3e48bf6d,0x3f0ebf80,0xbf7b3ec4,0x3f22bf80,0xbf623e48,0xbdc9bf35,0xbf753f55
.long 0xbf350000,0xbf353f80,0xbf350000,0xbf353f80,0xbf463f80,0x3ef13e48,0xbf7f3f35,0xbe953f55
.long 0x3f0ea50d,0x3f7bbf6d,0xbf553f80,0x3e483ec4,0x3f62bf80,0x3dc9bf0e,0xbe953f35,0x3f22be48
.long 0xbec40000,0xbf6d3f35,0x3ec4a50d,0x3f6dbf35,0xbf753f80,0xbf223f55,0x3f62bf35,0x3f7fbf7b
.long 0x3e48a50d,0x3f0ebec4,0x3f7bbf80,0x3f55bf6d,0x3f7fbf80,0x3f75bf7b,0x3f22bf35,0x3ef1bf0e
.long 0x0,0x0,0x0,0x0,0x3f623f6d,0x3f463f55,0x3e953ec4,0x3dc93e48
.long 0x3f553f35,0x3f7b3f6d,0x3f0e3f35,0x3e483ec4,0xbdc9bec4,0x3ef13e48,0x3f463f6d,0x3e953f0e
.long 0xbf6dbf80,0xbec4bf35,0x3f6d3f80,0x3ec43f35,0xbf46bec4,0xbf75bf7b,0x3f7f3f6d,0x3ef13f55
.long 0x3e483f35,0xbf55bec4,0x3f7b3f35,0x3f0e3f6d,0x3f753f6d,0xbdc93f0e,0x3f623ec4,0x3f223f7b
.long 0x3f35a50d,0x3f353f80,0x3f35a50d,0x3f353f80,0xbe95bf6d,0x3f7f3f0e,0x3ef1bec4,0x3f463f7b
.long 0xbf7bbf35,0x3f0ebec4,0x3e48bf35,0x3f553f6d,0xbf223ec4,0xbe95bf7b,0xbdc9bf6d,0x3f623f55
.long 0x3ec43f80,0xbf6dbf35,0xbec4bf80,0x3f6d3f35,0x3f7f3ec4,0xbf623e48,0xbf22bf6d,0x3f753f0e
.long 0x3f0ebf35,0xbe483f6d,0xbf55bf35,0x3f7b3ec4,0xbef1bf6d,0x3f223f55,0xbf75bec4,0x3f7f3e48
.long 0xbf800000,0x3f80a50d,0xbf800000,0x3f80a50d,0xbef13f6d,0x3f22bf55,0xbf753ec4,0x3f7fbe48
.long 0x3f0e3f35,0xbe48bf6d,0xbf553f35,0x3f7bbec4,0x3f7fbec4,0xbf62be48,0xbf223f6d,0x3f75bf0e
.long 0x3ec4bf80,0xbf6d3f35,0xbec43f80,0x3f6dbf35,0xbf22bec4,0xbe953f7b,0xbdc93f6d,0x3f62bf55
.long 0xbf7b3f35,0x3f0e3ec4,0x3e483f35,0x3f55bf6d,0xbe953f6d,0x3f7fbf0e,0x3ef13ec4,0x3f46bf7b
.long 0x3f35a50d,0x3f35bf80,0x3f35a50d,0x3f35bf80,0x3f75bf6d,0xbdc9bf0e,0x3f62bec4,0x3f22bf7b
.long 0x3e48bf35,0xbf553ec4,0x3f7bbf35,0x3f0ebf6d,0xbf463ec4,0xbf753f7b,0x3f7fbf6d,0x3ef1bf55
.long 0xbf6d3f80,0xbec43f35,0x3f6dbf80,0x3ec4bf35,0xbdc93ec4,0x3ef1be48,0x3f46bf6d,0x3e95bf0e
.long 0x3f55bf35,0x3f7bbf6d,0x3f0ebf35,0x3e48bec4,0x3f62bf6d,0x3f46bf55,0x3e95bec4,0x3dc9be48
.long 0x80008000,0x80008000,0x80008000,0x80008000,0xbf7fbf80,0xbf75bf7b,0xbf22bf35,0xbef1bf0e
.long 0xbe48250d,0xbf0ebec4,0xbf7bbf80,0xbf55bf6d,0x3f753f80,0x3f223f55,0xbf62bf35,0xbf7fbf7b
.long 0x3ec48000,0x3f6d3f35,0xbec4250d,0xbf6dbf35,0xbf62bf80,0xbdc9bf0e,0x3e953f35,0xbf22be48
.long 0xbf0e250d,0xbf7bbf6d,0x3f553f80,0xbe483ec4,0x3f463f80,0xbef13e48,0x3f7f3f35,0x3e953f55
.long 0x3f358000,0x3f353f80,0x3f358000,0x3f353f80,0xbf22bf80,0x3f623e48,0x3dc9bf35,0x3f753f55
.long 0xbf55250d,0xbe48bf6d,0xbf0ebf80,0x3f7b3ec4,0x3ef13f80,0xbf7fbf0e,0xbf75bf35,0x3f46be48
.long 0x3f6d8000,0xbec43f35,0xbf6d250d,0x3ec4bf35,0xbe95bf80,0x3f463f55,0xbef13f35,0xbdc9bf7b
.long 0xbf7b250d,0x3f55bec4,0x3e483f80,0xbf0ebf6d,0x3dc93f80,0xbe95bf7b,0x3f463f35,0xbf62bf0e
.long 0x3f808000,0xbf80250d,0x3f808000,0xbf80250d,0x3dc9bf80,0xbe953f7b,0x3f46bf35,0xbf623f0e
.long 0xbf7b250d,0x3f553ec4,0x3e48bf80,0xbf0e3f6d,0xbe953f80,0x3f46bf55,0xbef1bf35,0xbdc93f7b
.long 0x3f6d8000,0xbec4bf35,0xbf6d250d,0x3ec43f35,0x3ef1bf80,0xbf7f3f0e,0xbf753f35,0x3f463e48
.long 0xbf55250d,0xbe483f6d,0xbf0e3f80,0x3f7bbec4,0xbf223f80,0x3f62be48,0x3dc93f35,0x3f75bf55
.long 0x3f358000,0x3f35bf80,0x3f358000,0x3f35bf80,0x3f46bf80,0xbef1be48,0x3f7fbf35,0x3e95bf55
.long 0xbf0e250d,0xbf7b3f6d,0x3f55bf80,0xbe48bec4,0xbf623f80,0xbdc93f0e,0x3e95bf35,0xbf223e48
.long 0x3ec48000,0x3f6dbf35,0xbec4250d,0xbf6d3f35,0x3f75bf80,0x3f22bf55,0xbf623f35,0xbf7f3f7b
.long 0xbe48250d,0xbf0e3ec4,0xbf7b3f80,0xbf553f6d,0xbf7f3f80,0xbf753f7b,0xbf223f35,0xbef13f0e
.long 0x80008000,0x80008000,0x80008000,0x80008000,0xbf62bf6d,0xbf46bf55,0xbe95bec4,0xbdc9be48
.long 0xbf55bf35,0xbf7bbf6d,0xbf0ebf35,0xbe48bec4,0x3dc93ec4,0xbef1be48,0xbf46bf6d,0xbe95bf0e
.long 0x3f6d3f80,0x3ec43f35,0xbf6dbf80,0xbec4bf35,0x3f463ec4,0x3f753f7b,0xbf7fbf6d,0xbef1bf55
.long 0xbe48bf35,0x3f553ec4,0xbf7bbf35,0xbf0ebf6d,0xbf75bf6d,0x3dc9bf0e,0xbf62bec4,0xbf22bf7b
.long 0xbf35250d,0xbf35bf80,0xbf35250d,0xbf35bf80,0x3e953f6d,0xbf7fbf0e,0xbef13ec4,0xbf46bf7b
.long 0x3f7b3f35,0xbf0e3ec4,0xbe483f35,0xbf55bf6d,0x3f22bec4,0x3e953f7b,0x3dc93f6d,0xbf62bf55
.long 0xbec4bf80,0x3f6d3f35,0x3ec43f80,0xbf6dbf35,0xbf7fbec4,0x3f62be48,0x3f223f6d,0xbf75bf0e
.long 0xbf0e3f35,0x3e48bf6d,0x3f553f35,0xbf7bbec4,0x3ef13f6d,0xbf22bf55,0x3f753ec4,0xbf7fbe48
.long 0x3f808000,0xbf80250d,0x3f808000,0xbf80250d,0x3ef1bf6d,0xbf223f55,0x3f75bec4,0xbf7f3e48
.long 0xbf0ebf35,0x3e483f6d,0x3f55bf35,0xbf7b3ec4,0xbf7f3ec4,0x3f623e48,0x3f22bf6d,0xbf753f0e
.long 0xbec43f80,0x3f6dbf35,0x3ec4bf80,0xbf6d3f35,0x3f223ec4,0x3e95bf7b,0x3dc9bf6d,0xbf623f55
.long 0x3f7bbf35,0xbf0ebec4,0xbe48bf35,0xbf553f6d,0x3e95bf6d,0xbf7f3f0e,0xbef1bec4,0xbf463f7b
.long 0xbf35250d,0xbf353f80,0xbf35250d,0xbf353f80,0xbf753f6d,0x3dc93f0e,0xbf623ec4,0xbf223f7b
.long 0xbe483f35,0x3f55bec4,0xbf7b3f35,0xbf0e3f6d,0x3f46bec4,0x3f75bf7b,0xbf7f3f6d,0xbef13f55
.long 0x3f6dbf80,0x3ec4bf35,0xbf6d3f80,0xbec43f35,0x3dc9bec4,0xbef13e48,0xbf463f6d,0xbe953f0e
.long 0xbf553f35,0xbf7b3f6d,0xbf0e3f35,0xbe483ec4,0xbf623f6d,0xbf463f55,0xbe953ec4,0xbdc93e48
.long 0xbf803f80,0xbf803f80,0xbf803f80,0xbf803f80,0xbf7f3f80,0xbf753f7b,0xbf223f35,0xbef13f0e
.long 0xbf7b3f80,0xbf553f6d,0x3e48248d,0x3f0ebec4,0xbf753f80,0xbf223f55,0x3f62bf35,0x3f7fbf7b
.long 0xbf6d3f80,0xbec43f35,0x3f6dbf80,0x3ec4bf35,0xbf623f80,0xbdc93f0e,0x3e95bf35,0xbf223e48
.long 0xbf553f80,0x3e483ec4,0xbf0ea554,0xbf7b3f6d,0xbf463f80,0x3ef13e48,0xbf7f3f35,0xbe953f55
.long 0xbf353f80,0x3f35248d,0xbf353f80,0x3f35248d,0xbf223f80,0x3f62be48,0x3dc93f35,0x3f75bf55
.long 0xbf0e3f80,0x3f7bbec4,0x3f55248d,0x3e48bf6d,0xbef13f80,0x3f7fbf0e,0x3f75bf35,0xbf46be48
.long 0xbec43f80,0x3f6dbf35,0x3ec4bf80,0xbf6d3f35,0xbe953f80,0x3f46bf55,0xbef1bf35,0xbdc93f7b
.long 0xbe483f80,0x3f0ebf6d,0xbf7ba554,0x3f553ec4,0xbdc93f80,0x3e95bf7b,0xbf463f35,0x3f62bf0e
.long 0xa5543f80,0x248dbf80,0xa5543f80,0x248dbf80,0x3dc93f80,0xbe95bf7b,0x3f463f35,0xbf62bf0e
.long 0x3e483f80,0xbf0ebf6d,0x3f7b248d,0xbf553ec4,0x3e953f80,0xbf46bf55,0x3ef1bf35,0x3dc93f7b
.long 0x3ec43f80,0xbf6dbf35,0xbec4bf80,0x3f6d3f35,0x3ef13f80,0xbf7fbf0e,0xbf75bf35,0x3f46be48
.long 0x3f0e3f80,0xbf7bbec4,0xbf55a554,0xbe48bf6d,0x3f223f80,0xbf62be48,0xbdc93f35,0xbf75bf55
.long 0x3f353f80,0xbf35a554,0x3f353f80,0xbf35a554,0x3f463f80,0xbef13e48,0x3f7f3f35,0x3e953f55
.long 0x3f553f80,0xbe483ec4,0x3f0e248d,0x3f7b3f6d,0x3f623f80,0x3dc93f0e,0xbe95bf35,0x3f223e48
.long 0x3f6d3f80,0x3ec43f35,0xbf6dbf80,0xbec4bf35,0x3f753f80,0x3f223f55,0xbf62bf35,0xbf7fbf7b
.long 0x3f7b3f80,0x3f553f6d,0xbe48a554,0xbf0ebec4,0x3f7f3f80,0x3f753f7b,0x3f223f35,0x3ef13f0e
.long 0xbf803f80,0xbf803f80,0xbf803f80,0xbf803f80,0xbf623f6d,0xbf463f55,0xbe953ec4,0xbdc93e48
.long 0xbf0e3f35,0xbe483ec4,0x3f55bf35,0x3f7bbf6d,0xbdc93ec4,0x3ef1be48,0x3f46bf6d,0x3e95bf0e
.long 0x3ec4248d,0x3f6dbf35,0xbec4a554,0xbf6d3f35,0x3f46bec4,0x3f75bf7b,0xbf7f3f6d,0xbef13f55
.long 0x3f7bbf35,0x3f0ebf6d,0xbe483f35,0x3f55bec4,0x3f75bf6d,0xbdc9bf0e,0x3f62bec4,0x3f22bf7b
.long 0x3f35bf80,0xbf35a554,0x3f35bf80,0xbf35a554,0x3e95bf6d,0xbf7f3f0e,0xbef1bec4,0xbf463f7b
.long 0xbe48bf35,0xbf553f6d,0xbf7b3f35,0x3f0e3ec4,0xbf22bec4,0xbe953f7b,0xbdc93f6d,0x3f62bf55
.long 0xbf6da554,0x3ec43f35,0x3f6d248d,0xbec4bf35,0xbf7f3ec4,0x3f623e48,0x3f22bf6d,0xbf753f0e
.long 0xbf553f35,0x3f7bbec4,0xbf0ebf35,0x3e483f6d,0xbef13f6d,0x3f22bf55,0xbf753ec4,0x3f7fbe48
.long 0xa5543f80,0x248dbf80,0xa5543f80,0x248dbf80,0x3ef13f6d,0xbf22bf55,0x3f753ec4,0xbf7fbe48
.long 0x3f553f35,0xbf7bbec4,0x3f0ebf35,0xbe483f6d,0x3f7f3ec4,0xbf623e48,0xbf22bf6d,0x3f753f0e
.long 0x3f6d248d,0xbec43f35,0xbf6da554,0x3ec4bf35,0x3f22bec4,0x3e953f7b,0x3dc93f6d,0xbf62bf55
.long 0x3e48bf35,0x3f553f6d,0x3f7b3f35,0xbf0e3ec4,0xbe95bf6d,0x3f7f3f0e,0x3ef1bec4,0x3f463f7b
.long 0xbf35bf80,0x3f35248d,0xbf35bf80,0x3f35248d,0xbf75bf6d,0x3dc9bf0e,0xbf62bec4,0xbf22bf7b
.long 0xbf7bbf35,0xbf0ebf6d,0x3e483f35,0xbf55bec4,0xbf46bec4,0xbf75bf7b,0x3f7f3f6d,0x3ef13f55
.long 0xbec4a554,0xbf6dbf35,0x3ec4248d,0x3f6d3f35,0x3dc93ec4,0xbef1be48,0xbf46bf6d,0xbe95bf0e
.long 0x3f0e3f35,0x3e483ec4,0xbf55bf35,0xbf7bbf6d,0x3f623f6d,0x3f463f55,0x3e953ec4,0x3dc93e48
.long 0xa50d0000,0xa50d0000,0xa50d0000,0xa50d0000,0x3dc90000,0x3e95be48,0x3f46bf35,0x3f62bf55
.long 0x3e480000,0x3f0ebec4,0x3f7bbf80,0x3f55bf6d,0x3e950000,0x3f46bf0e,0x3ef1bf35,0xbdc9be48
.long 0x3ec40000,0x3f6dbf35,0xbec4a50d,0xbf6d3f35,0x3ef10000,0x3f7fbf55,0xbf753f35,0xbf463f7b
.long 0x3f0e0000,0x3f7bbf6d,0xbf553f80,0x3e483ec4,0x3f220000,0x3f62bf7b,0xbdc93f35,0x3f75bf0e
.long 0x3f350000,0x3f35bf80,0x3f350000,0x3f35bf80,0x3f460000,0x3ef1bf7b,0x3f7fbf35,0xbe95bf0e
.long 0x3f550000,0x3e48bf6d,0x3f0ebf80,0xbf7b3ec4,0x3f620000,0xbdc9bf55,0xbe95bf35,0xbf223f7b
.long 0x3f6d0000,0xbec4bf35,0xbf6da50d,0x3ec43f35,0x3f750000,0xbf22bf0e,0xbf623f35,0x3f7fbe48
.long 0x3f7b0000,0xbf55bec4,0xbe483f80,0x3f0ebf6d,0x3f7f0000,0xbf75be48,0x3f223f35,0xbef1bf55
.long 0x3f800000,0xbf80a50d,0x3f800000,0xbf80a50d,0x3f7f0000,0xbf753e48,0x3f22bf35,0xbef13f55
.long 0x3f7b0000,0xbf553ec4,0xbe48bf80,0x3f0e3f6d,0x3f750000,0xbf223f0e,0xbf62bf35,0x3f7f3e48
.long 0x3f6d0000,0xbec43f35,0xbf6da50d,0x3ec4bf35,0x3f620000,0xbdc93f55,0xbe953f35,0xbf22bf7b
.long 0x3f550000,0x3e483f6d,0x3f0e3f80,0xbf7bbec4,0x3f460000,0x3ef13f7b,0x3f7f3f35,0xbe953f0e
.long 0x3f350000,0x3f353f80,0x3f350000,0x3f353f80,0x3f220000,0x3f623f7b,0xbdc9bf35,0x3f753f0e
.long 0x3f0e0000,0x3f7b3f6d,0xbf55bf80,0x3e48bec4,0x3ef10000,0x3f7f3f55,0xbf75bf35,0xbf46bf7b
.long 0x3ec40000,0x3f6d3f35,0xbec4a50d,0xbf6dbf35,0x3e950000,0x3f463f0e,0x3ef13f35,0xbdc93e48
.long 0x3e480000,0x3f0e3ec4,0x3f7b3f80,0x3f553f6d,0x3dc90000,0x3e953e48,0x3f463f35,0x3f623f55
.long 0xa50d0000,0xa50d0000,0xa50d0000,0xa50d0000,0x3ef1bec4,0x3f22bf0e,0x3f75bf6d,0x3f7fbf7b
.long 0x3f55bf35,0x3f7bbf6d,0x3f0ebf35,0x3e48bec4,0x3f7fbf6d,0x3f62bf7b,0xbf223ec4,0xbf753f55
.long 0x3f6dbf80,0x3ec4bf35,0xbf6d3f80,0xbec43f35,0x3f22bf6d,0xbe95be48,0x3dc93ec4,0x3f62bf0e
.long 0x3e48bf35,0xbf553ec4,0x3f7bbf35,0x3f0ebf6d,0xbe95bec4,0xbf7f3f55,0x3ef1bf6d,0xbf463e48
.long 0xbf35a50d,0xbf353f80,0xbf35a50d,0xbf353f80,0xbf753ec4,0xbdc93f55,0xbf623f6d,0x3f223e48
.long 0xbf7b3f35,0x3f0e3ec4,0x3e483f35,0x3f55bf6d,0xbf463f6d,0x3f75be48,0x3f7fbec4,0xbef1bf0e
.long 0xbec43f80,0x3f6dbf35,0x3ec4bf80,0xbf6d3f35,0x3dc93f6d,0x3ef1bf7b,0xbf46bec4,0x3e953f55
.long 0x3f0e3f35,0xbe48bf6d,0xbf553f35,0x3f7bbec4,0x3f623ec4,0xbf46bf0e,0x3e953f6d,0xbdc9bf7b
.long 0x3f800000,0xbf80a50d,0x3f800000,0xbf80a50d,0x3f62bec4,0xbf463f0e,0x3e95bf6d,0xbdc93f7b
.long 0x3f0ebf35,0xbe483f6d,0xbf55bf35,0x3f7b3ec4,0x3dc9bf6d,0x3ef13f7b,0xbf463ec4,0x3e95bf55
.long 0xbec4bf80,0x3f6d3f35,0x3ec43f80,0xbf6dbf35,0xbf46bf6d,0x3f753e48,0x3f7f3ec4,0xbef13f0e
.long 0xbf7bbf35,0x3f0ebec4,0x3e48bf35,0x3f553f6d,0xbf75bec4,0xbdc9bf55,0xbf62bf6d,0x3f22be48
.long 0xbf35a50d,0xbf35bf80,0xbf35a50d,0xbf35bf80,0xbe953ec4,0xbf7fbf55,0x3ef13f6d,0xbf46be48
.long 0x3e483f35,0xbf55bec4,0x3f7b3f35,0x3f0e3f6d,0x3f223f6d,0xbe953e48,0x3dc9bec4,0x3f623f0e
.long 0x3f6d3f80,0x3ec43f35,0xbf6dbf80,0xbec4bf35,0x3f7f3f6d,0x3f623f7b,0xbf22bec4,0xbf75bf55
.long 0x3f553f35,0x3f7b3f6d,0x3f0e3f35,0x3e483ec4,0x3ef13ec4,0x3f223f0e,0x3f753f6d,0x3f7f3f7b
.long 0x250d8000,0x250d8000,0x250d8000,0x250d8000,0xbdc98000,0xbe953e48,0xbf463f35,0xbf623f55
.long 0xbe488000,0xbf0e3ec4,0xbf7b3f80,0xbf553f6d,0xbe958000,0xbf463f0e,0xbef13f35,0x3dc93e48
.long 0xbec48000,0xbf6d3f35,0x3ec4250d,0x3f6dbf35,0xbef18000,0xbf7f3f55,0x3f75bf35,0x3f46bf7b
.long 0xbf0e8000,0xbf7b3f6d,0x3f55bf80,0xbe48bec4,0xbf228000,0xbf623f7b,0x3dc9bf35,0xbf753f0e
.long 0xbf358000,0xbf353f80,0xbf358000,0xbf353f80,0xbf468000,0xbef13f7b,0xbf7f3f35,0x3e953f0e
.long 0xbf558000,0xbe483f6d,0xbf0e3f80,0x3f7bbec4,0xbf628000,0x3dc93f55,0x3e953f35,0x3f22bf7b
.long 0xbf6d8000,0x3ec43f35,0x3f6d250d,0xbec4bf35,0xbf758000,0x3f223f0e,0x3f62bf35,0xbf7f3e48
.long 0xbf7b8000,0x3f553ec4,0x3e48bf80,0xbf0e3f6d,0xbf7f8000,0x3f753e48,0xbf22bf35,0x3ef13f55
.long 0xbf808000,0x3f80250d,0xbf808000,0x3f80250d,0xbf7f8000,0x3f75be48,0xbf223f35,0x3ef1bf55
.long 0xbf7b8000,0x3f55bec4,0x3e483f80,0xbf0ebf6d,0xbf758000,0x3f22bf0e,0x3f623f35,0xbf7fbe48
.long 0xbf6d8000,0x3ec4bf35,0x3f6d250d,0xbec43f35,0xbf628000,0x3dc9bf55,0x3e95bf35,0x3f223f7b
.long 0xbf558000,0xbe48bf6d,0xbf0ebf80,0x3f7b3ec4,0xbf468000,0xbef1bf7b,0xbf7fbf35,0x3e95bf0e
.long 0xbf358000,0xbf35bf80,0xbf358000,0xbf35bf80,0xbf228000,0xbf62bf7b,0x3dc93f35,0xbf75bf0e
.long 0xbf0e8000,0xbf7bbf6d,0x3f553f80,0xbe483ec4,0xbef18000,0xbf7fbf55,0x3f753f35,0x3f463f7b
.long 0xbec48000,0xbf6dbf35,0x3ec4250d,0x3f6d3f35,0xbe958000,0xbf46bf0e,0xbef1bf35,0x3dc9be48
.long 0xbe488000,0xbf0ebec4,0xbf7bbf80,0xbf55bf6d,0xbdc98000,0xbe95be48,0xbf46bf35,0xbf62bf55
.long 0x250d8000,0x250d8000,0x250d8000,0x250d8000,0xbef13ec4,0xbf223f0e,0xbf753f6d,0xbf7f3f7b
.long 0xbf553f35,0xbf7b3f6d,0xbf0e3f35,0xbe483ec4,0xbf7f3f6d,0xbf623f7b,0x3f22bec4,0x3f75bf55
.long 0xbf6d3f80,0xbec43f35,0x3f6dbf80,0x3ec4bf35,0xbf223f6d,0x3e953e48,0xbdc9bec4,0xbf623f0e
.long 0xbe483f35,0x3f55bec4,0xbf7b3f35,0xbf0e3f6d,0x3e953ec4,0x3f7fbf55,0xbef13f6d,0x3f46be48
.long 0x3f35250d,0x3f35bf80,0x3f35250d,0x3f35bf80,0x3f75bec4,0x3dc9bf55,0x3f62bf6d,0xbf22be48
.long 0x3f7bbf35,0xbf0ebec4,0xbe48bf35,0xbf553f6d,0x3f46bf6d,0xbf753e48,0xbf7f3ec4,0x3ef13f0e
.long 0x3ec4bf80,0xbf6d3f35,0xbec43f80,0x3f6dbf35,0xbdc9bf6d,0xbef13f7b,0x3f463ec4,0xbe95bf55
.long 0xbf0ebf35,0x3e483f6d,0x3f55bf35,0xbf7b3ec4,0xbf62bec4,0x3f463f0e,0xbe95bf6d,0x3dc93f7b
.long 0xbf808000,0x3f80250d,0xbf808000,0x3f80250d,0xbf623ec4,0x3f46bf0e,0xbe953f6d,0x3dc9bf7b
.long 0xbf0e3f35,0x3e48bf6d,0x3f553f35,0xbf7bbec4,0xbdc93f6d,0xbef1bf7b,0x3f46bec4,0xbe953f55
.long 0x3ec43f80,0xbf6dbf35,0xbec4bf80,0x3f6d3f35,0x3f463f6d,0xbf75be48,0xbf7fbec4,0x3ef1bf0e
.long 0x3f7b3f35,0xbf0e3ec4,0xbe483f35,0xbf55bf6d,0x3f753ec4,0x3dc93f55,0x3f623f6d,0xbf223e48
.long 0x3f35250d,0x3f353f80,0x3f35250d,0x3f353f80,0x3e95bec4,0x3f7f3f55,0xbef1bf6d,0x3f463e48
.long 0xbe48bf35,0x3f553ec4,0xbf7bbf35,0xbf0ebf6d,0xbf22bf6d,0x3e95be48,0xbdc93ec4,0xbf62bf0e
.long 0xbf6dbf80,0xbec4bf35,0x3f6d3f80,0x3ec43f35,0xbf7fbf6d,0xbf62bf7b,0x3f223ec4,0x3f753f55
.long 0xbf55bf35,0xbf7bbf6d,0xbf0ebf35,0xbe48bec4,0xbef1bec4,0xbf22bf0e,0xbf75bf6d,0xbf7fbf7b
.long 0xbf803f80,0xbf803f80,0xbf803f80,0xbf803f80,0x3dc9248d,0x3e95be48,0x3f46bf35,0x3f62bf55
.long 0x3f7bbf80,0x3f55bf6d,0xbe48a554,0xbf0e3ec4,0xbe95a554,0xbf463f0e,0xbef13f35,0x3dc93e48
.long 0xbf6d3f80,0xbec43f35,0x3f6dbf80,0x3ec4bf35,0x3ef1248d,0x3f7fbf55,0xbf753f35,0xbf463f7b
.long 0x3f55bf80,0xbe48bec4,0x3f0e248d,0x3f7bbf6d,0xbf22a554,0xbf623f7b,0x3dc9bf35,0xbf753f0e
.long 0xbf353f80,0x3f35248d,0xbf353f80,0x3f35248d,0x3f46248d,0x3ef1bf7b,0x3f7fbf35,0xbe95bf0e
.long 0x3f0ebf80,0xbf7b3ec4,0xbf55a554,0xbe483f6d,0xbf62a554,0x3dc93f55,0x3e953f35,0x3f22bf7b
.long 0xbec43f80,0x3f6dbf35,0x3ec4bf80,0xbf6d3f35,0x3f75248d,0xbf22bf0e,0xbf623f35,0x3f7fbe48
.long 0x3e48bf80,0xbf0e3f6d,0x3f7b248d,0xbf55bec4,0xbf7fa554,0x3f753e48,0xbf22bf35,0x3ef13f55
.long 0xa5543f80,0x248dbf80,0xa5543f80,0x248dbf80,0x3f7f248d,0xbf753e48,0x3f22bf35,0xbef13f55
.long 0xbe48bf80,0x3f0e3f6d,0xbf7ba554,0x3f55bec4,0xbf75a554,0x3f22bf0e,0x3f623f35,0xbf7fbe48
.long 0x3ec43f80,0xbf6dbf35,0xbec4bf80,0x3f6d3f35,0x3f62248d,0xbdc93f55,0xbe953f35,0xbf22bf7b
.long 0xbf0ebf80,0x3f7b3ec4,0x3f55248d,0x3e483f6d,0xbf46a554,0xbef1bf7b,0xbf7fbf35,0x3e95bf0e
.long 0x3f353f80,0xbf35a554,0x3f353f80,0xbf35a554,0x3f22248d,0x3f623f7b,0xbdc9bf35,0x3f753f0e
.long 0xbf55bf80,0x3e48bec4,0xbf0ea554,0xbf7bbf6d,0xbef1a554,0xbf7fbf55,0x3f753f35,0x3f463f7b
.long 0x3f6d3f80,0x3ec43f35,0xbf6dbf80,0xbec4bf35,0x3e95248d,0x3f463f0e,0x3ef13f35,0xbdc93e48
.long 0xbf7bbf80,0xbf55bf6d,0x3e48248d,0x3f0e3ec4,0xbdc9a554,0xbe95be48,0xbf46bf35,0xbf62bf55
.long 0xbf803f80,0xbf803f80,0xbf803f80,0xbf803f80,0x3ef1bec4,0x3f22bf0e,0x3f75bf6d,0x3f7fbf7b
.long 0x3f0ebf35,0x3e48bec4,0xbf553f35,0xbf7b3f6d,0xbf7f3f6d,0xbf623f7b,0x3f22bec4,0x3f75bf55
.long 0x3ec4248d,0x3f6dbf35,0xbec4a554,0xbf6d3f35,0x3f22bf6d,0xbe95be48,0x3dc93ec4,0x3f62bf0e
.long 0xbf7b3f35,0xbf0e3f6d,0x3e48bf35,0xbf553ec4,0x3e953ec4,0x3f7fbf55,0xbef13f6d,0x3f46be48
.long 0x3f35bf80,0xbf35a554,0x3f35bf80,0xbf35a554,0xbf753ec4,0xbdc93f55,0xbf623f6d,0x3f223e48
.long 0x3e483f35,0x3f55bf6d,0x3f7bbf35,0xbf0ebec4,0x3f46bf6d,0xbf753e48,0xbf7f3ec4,0x3ef13f0e
.long 0xbf6da554,0x3ec43f35,0x3f6d248d,0xbec4bf35,0x3dc93f6d,0x3ef1bf7b,0xbf46bec4,0x3e953f55
.long 0x3f55bf35,0xbf7b3ec4,0x3f0e3f35,0xbe48bf6d,0xbf62bec4,0x3f463f0e,0xbe95bf6d,0x3dc93f7b
.long 0xa5543f80,0x248dbf80,0xa5543f80,0x248dbf80,0x3f62bec4,0xbf463f0e,0x3e95bf6d,0xbdc93f7b
.long 0xbf55bf35,0x3f7b3ec4,0xbf0e3f35,0x3e48bf6d,0xbdc93f6d,0xbef1bf7b,0x3f46bec4,0xbe953f55
.long 0x3f6d248d,0xbec43f35,0xbf6da554,0x3ec4bf35,0xbf46bf6d,0x3f753e48,0x3f7f3ec4,0xbef13f0e
.long 0xbe483f35,0xbf55bf6d,0xbf7bbf35,0x3f0ebec4,0x3f753ec4,0x3dc93f55,0x3f623f6d,0xbf223e48
.long 0xbf35bf80,0x3f35248d,0xbf35bf80,0x3f35248d,0xbe953ec4,0xbf7fbf55,0x3ef13f6d,0xbf46be48
.long 0x3f7b3f35,0x3f0e3f6d,0xbe48bf35,0x3f553ec4,0xbf22bf6d,0x3e95be48,0xbdc93ec4,0xbf62bf0e
.long 0xbec4a554,0xbf6dbf35,0x3ec4248d,0x3f6d3f35,0x3f7f3f6d,0x3f623f7b,0xbf22bec4,0xbf75bf55
.long 0xbf0ebf35,0xbe48bec4,0x3f553f35,0x3f7b3f6d,0xbef1bec4,0xbf22bf0e,0xbf75bf6d,0xbf7fbf7b
.long 0xa50d0000,0xa50d0000,0xa50d0000,0xa50d0000,0x3f7fbf80,0x3f75bf7b,0x3f22bf35,0x3ef1bf0e
.long 0xbe48a50d,0xbf0e3ec4,0xbf7b3f80,0xbf553f6d,0xbf753f80,0xbf223f55,0x3f62bf35,0x3f7fbf7b
.long 0x3ec40000,0x3f6dbf35,0xbec4a50d,0xbf6d3f35,0x3f62bf80,0x3dc9bf0e,0xbe953f35,0x3f22be48
.long 0xbf0ea50d,0xbf7b3f6d,0x3f55bf80,0xbe48bec4,0xbf463f80,0x3ef13e48,0xbf7f3f35,0xbe953f55
.long 0x3f350000,0x3f35bf80,0x3f350000,0x3f35bf80,0x3f22bf80,0xbf623e48,0xbdc9bf35,0xbf753f55
.long 0xbf55a50d,0xbe483f6d,0xbf0e3f80,0x3f7bbec4,0xbef13f80,0x3f7fbf0e,0x3f75bf35,0xbf46be48
.long 0x3f6d0000,0xbec4bf35,0xbf6da50d,0x3ec43f35,0x3e95bf80,0xbf463f55,0x3ef13f35,0x3dc9bf7b
.long 0xbf7ba50d,0x3f553ec4,0x3e48bf80,0xbf0e3f6d,0xbdc93f80,0x3e95bf7b,0xbf463f35,0x3f62bf0e
.long 0x3f800000,0xbf80a50d,0x3f800000,0xbf80a50d,0xbdc9bf80,0x3e953f7b,0xbf46bf35,0x3f623f0e
.long 0xbf7ba50d,0x3f55bec4,0x3e483f80,0xbf0ebf6d,0x3e953f80,0xbf46bf55,0x3ef1bf35,0x3dc93f7b
.long 0x3f6d0000,0xbec43f35,0xbf6da50d,0x3ec4bf35,0xbef1bf80,0x3f7f3f0e,0x3f753f35,0xbf463e48
.long 0xbf55a50d,0xbe48bf6d,0xbf0ebf80,0x3f7b3ec4,0x3f223f80,0xbf62be48,0xbdc93f35,0xbf75bf55
.long 0x3f350000,0x3f353f80,0x3f350000,0x3f353f80,0xbf46bf80,0x3ef1be48,0xbf7fbf35,0xbe95bf55
.long 0xbf0ea50d,0xbf7bbf6d,0x3f553f80,0xbe483ec4,0x3f623f80,0x3dc93f0e,0xbe95bf35,0x3f223e48
.long 0x3ec40000,0x3f6d3f35,0xbec4a50d,0xbf6dbf35,0xbf75bf80,0xbf22bf55,0x3f623f35,0x3f7f3f7b
.long 0xbe48a50d,0xbf0ebec4,0xbf7bbf80,0xbf55bf6d,0x3f7f3f80,0x3f753f7b,0x3f223f35,0x3ef13f0e
.long 0xa50d0000,0xa50d0000,0xa50d0000,0xa50d0000,0x3f62bf6d,0x3f46bf55,0x3e95bec4,0x3dc9be48
.long 0xbf553f35,0xbf7b3f6d,0xbf0e3f35,0xbe483ec4,0xbdc93ec4,0x3ef1be48,0x3f46bf6d,0x3e95bf0e
.long 0x3f6dbf80,0x3ec4bf35,0xbf6d3f80,0xbec43f35,0xbf463ec4,0xbf753f7b,0x3f7fbf6d,0x3ef1bf55
.long 0xbe483f35,0x3f55bec4,0xbf7b3f35,0xbf0e3f6d,0x3f75bf6d,0xbdc9bf0e,0x3f62bec4,0x3f22bf7b
.long 0xbf35a50d,0xbf353f80,0xbf35a50d,0xbf353f80,0xbe953f6d,0x3f7fbf0e,0x3ef13ec4,0x3f46bf7b
.long 0x3f7bbf35,0xbf0ebec4,0xbe48bf35,0xbf553f6d,0xbf22bec4,0xbe953f7b,0xbdc93f6d,0x3f62bf55
.long 0xbec43f80,0x3f6dbf35,0x3ec4bf80,0xbf6d3f35,0x3f7fbec4,0xbf62be48,0xbf223f6d,0x3f75bf0e
.long 0xbf0ebf35,0x3e483f6d,0x3f55bf35,0xbf7b3ec4,0xbef13f6d,0x3f22bf55,0xbf753ec4,0x3f7fbe48
.long 0x3f800000,0xbf80a50d,0x3f800000,0xbf80a50d,0xbef1bf6d,0x3f223f55,0xbf75bec4,0x3f7f3e48
.long 0xbf0e3f35,0x3e48bf6d,0x3f553f35,0xbf7bbec4,0x3f7f3ec4,0xbf623e48,0xbf22bf6d,0x3f753f0e
.long 0xbec4bf80,0x3f6d3f35,0x3ec43f80,0xbf6dbf35,0xbf223ec4,0xbe95bf7b,0xbdc9bf6d,0x3f623f55
.long 0x3f7b3f35,0xbf0e3ec4,0xbe483f35,0xbf55bf6d,0xbe95bf6d,0x3f7f3f0e,0x3ef1bec4,0x3f463f7b
.long 0xbf35a50d,0xbf35bf80,0xbf35a50d,0xbf35bf80,0x3f753f6d,0xbdc93f0e,0x3f623ec4,0x3f223f7b
.long 0xbe48bf35,0x3f553ec4,0xbf7bbf35,0xbf0ebf6d,0xbf46bec4,0xbf75bf7b,0x3f7f3f6d,0x3ef13f55
.long 0x3f6d3f80,0x3ec43f35,0xbf6dbf80,0xbec4bf35,0xbdc9bec4,0x3ef13e48,0x3f463f6d,0x3e953f0e
.long 0xbf55bf35,0xbf7bbf6d,0xbf0ebf35,0xbe48bec4,0x3f623f6d,0x3f463f55,0x3e953ec4,0x3dc93e48
.long 0x250d8000,0x250d8000,0x250d8000,0x250d8000,0xbf7f3f80,0xbf753f7b,0xbf223f35,0xbef13f0e
.long 0x3e48250d,0x3f0ebec4,0x3f7bbf80,0x3f55bf6d,0x3f75bf80,0x3f22bf55,0xbf623f35,0xbf7f3f7b
.long 0xbec48000,0xbf6d3f35,0x3ec4250d,0x3f6dbf35,0xbf623f80,0xbdc93f0e,0x3e95bf35,0xbf223e48
.long 0x3f0e250d,0x3f7bbf6d,0xbf553f80,0x3e483ec4,0x3f46bf80,0xbef1be48,0x3f7fbf35,0x3e95bf55
.long 0xbf358000,0xbf353f80,0xbf358000,0xbf353f80,0xbf223f80,0x3f62be48,0x3dc93f35,0x3f75bf55
.long 0x3f55250d,0x3e48bf6d,0x3f0ebf80,0xbf7b3ec4,0x3ef1bf80,0xbf7f3f0e,0xbf753f35,0x3f463e48
.long 0xbf6d8000,0x3ec43f35,0x3f6d250d,0xbec4bf35,0xbe953f80,0x3f46bf55,0xbef1bf35,0xbdc93f7b
.long 0x3f7b250d,0xbf55bec4,0xbe483f80,0x3f0ebf6d,0x3dc9bf80,0xbe953f7b,0x3f46bf35,0xbf623f0e
.long 0xbf808000,0x3f80250d,0xbf808000,0x3f80250d,0x3dc93f80,0xbe95bf7b,0x3f463f35,0xbf62bf0e
.long 0x3f7b250d,0xbf553ec4,0xbe48bf80,0x3f0e3f6d,0xbe95bf80,0x3f463f55,0xbef13f35,0xbdc9bf7b
.long 0xbf6d8000,0x3ec4bf35,0x3f6d250d,0xbec43f35,0x3ef13f80,0xbf7fbf0e,0xbf75bf35,0x3f46be48
.long 0x3f55250d,0x3e483f6d,0x3f0e3f80,0xbf7bbec4,0xbf22bf80,0x3f623e48,0x3dc9bf35,0x3f753f55
.long 0xbf358000,0xbf35bf80,0xbf358000,0xbf35bf80,0x3f463f80,0xbef13e48,0x3f7f3f35,0x3e953f55
.long 0x3f0e250d,0x3f7b3f6d,0xbf55bf80,0x3e48bec4,0xbf62bf80,0xbdc9bf0e,0x3e953f35,0xbf22be48
.long 0xbec48000,0xbf6dbf35,0x3ec4250d,0x3f6d3f35,0x3f753f80,0x3f223f55,0xbf62bf35,0xbf7fbf7b
.long 0x3e48250d,0x3f0e3ec4,0x3f7b3f80,0x3f553f6d,0xbf7fbf80,0xbf75bf7b,0xbf22bf35,0xbef1bf0e
.long 0x250d8000,0x250d8000,0x250d8000,0x250d8000,0xbf623f6d,0xbf463f55,0xbe953ec4,0xbdc93e48
.long 0x3f55bf35,0x3f7bbf6d,0x3f0ebf35,0x3e48bec4,0x3dc9bec4,0xbef13e48,0xbf463f6d,0xbe953f0e
.long 0xbf6d3f80,0xbec43f35,0x3f6dbf80,0x3ec4bf35,0x3f46bec4,0x3f75bf7b,0xbf7f3f6d,0xbef13f55
.long 0x3e48bf35,0xbf553ec4,0x3f7bbf35,0x3f0ebf6d,0xbf753f6d,0x3dc93f0e,0xbf623ec4,0xbf223f7b
.long 0x3f35250d,0x3f35bf80,0x3f35250d,0x3f35bf80,0x3e95bf6d,0xbf7f3f0e,0xbef1bec4,0xbf463f7b
.long 0xbf7b3f35,0x3f0e3ec4,0x3e483f35,0x3f55bf6d,0x3f223ec4,0x3e95bf7b,0x3dc9bf6d,0xbf623f55
.long 0x3ec4bf80,0xbf6d3f35,0xbec43f80,0x3f6dbf35,0xbf7f3ec4,0x3f623e48,0x3f22bf6d,0xbf753f0e
.long 0x3f0e3f35,0xbe48bf6d,0xbf553f35,0x3f7bbec4,0x3ef1bf6d,0xbf223f55,0x3f75bec4,0xbf7f3e48
.long 0xbf808000,0x3f80250d,0xbf808000,0x3f80250d,0x3ef13f6d,0xbf22bf55,0x3f753ec4,0xbf7fbe48
.long 0x3f0ebf35,0xbe483f6d,0xbf55bf35,0x3f7b3ec4,0xbf7fbec4,0x3f62be48,0x3f223f6d,0xbf75bf0e
.long 0x3ec43f80,0xbf6dbf35,0xbec4bf80,0x3f6d3f35,0x3f22bec4,0x3e953f7b,0x3dc93f6d,0xbf62bf55
.long 0xbf7bbf35,0x3f0ebec4,0x3e48bf35,0x3f553f6d,0x3e953f6d,0xbf7fbf0e,0xbef13ec4,0xbf46bf7b
.long 0x3f35250d,0x3f353f80,0x3f35250d,0x3f353f80,0xbf75bf6d,0x3dc9bf0e,0xbf62bec4,0xbf22bf7b
.long 0x3e483f35,0xbf55bec4,0x3f7b3f35,0x3f0e3f6d,0x3f463ec4,0x3f753f7b,0xbf7fbf6d,0xbef1bf55
.long 0xbf6dbf80,0xbec4bf35,0x3f6d3f80,0x3ec43f35,0x3dc93ec4,0xbef1be48,0xbf46bf6d,0xbe95bf0e
.long 0x3f553f35,0x3f7b3f6d,0x3f0e3f35,0x3e483ec4,0xbf62bf6d,0xbf46bf55,0xbe95bec4,0xbdc9be48
.long 0xbf803f80,0xbf803f80,0xbf803f80,0xbf803f80,0x3f7fbf80,0x3f75bf7b,0x3f22bf35,0x3ef1bf0e
.long 0xbf7b3f80,0xbf553f6d,0x3e48248d,0x3f0ebec4,0x3f75bf80,0x3f22bf55,0xbf623f35,0xbf7f3f7b
.long 0xbf6d3f80,0xbec43f35,0x3f6dbf80,0x3ec4bf35,0x3f62bf80,0x3dc9bf0e,0xbe953f35,0x3f22be48
.long 0xbf553f80,0x3e483ec4,0xbf0ea554,0xbf7b3f6d,0x3f46bf80,0xbef1be48,0x3f7fbf35,0x3e95bf55
.long 0xbf353f80,0x3f35248d,0xbf353f80,0x3f35248d,0x3f22bf80,0xbf623e48,0xbdc9bf35,0xbf753f55
.long 0xbf0e3f80,0x3f7bbec4,0x3f55248d,0x3e48bf6d,0x3ef1bf80,0xbf7f3f0e,0xbf753f35,0x3f463e48
.long 0xbec43f80,0x3f6dbf35,0x3ec4bf80,0xbf6d3f35,0x3e95bf80,0xbf463f55,0x3ef13f35,0x3dc9bf7b
.long 0xbe483f80,0x3f0ebf6d,0xbf7ba554,0x3f553ec4,0x3dc9bf80,0xbe953f7b,0x3f46bf35,0xbf623f0e
.long 0xa5543f80,0x248dbf80,0xa5543f80,0x248dbf80,0xbdc9bf80,0x3e953f7b,0xbf46bf35,0x3f623f0e
.long 0x3e483f80,0xbf0ebf6d,0x3f7b248d,0xbf553ec4,0xbe95bf80,0x3f463f55,0xbef13f35,0xbdc9bf7b
.long 0x3ec43f80,0xbf6dbf35,0xbec4bf80,0x3f6d3f35,0xbef1bf80,0x3f7f3f0e,0x3f753f35,0xbf463e48
.long 0x3f0e3f80,0xbf7bbec4,0xbf55a554,0xbe48bf6d,0xbf22bf80,0x3f623e48,0x3dc9bf35,0x3f753f55
.long 0x3f353f80,0xbf35a554,0x3f353f80,0xbf35a554,0xbf46bf80,0x3ef1be48,0xbf7fbf35,0xbe95bf55
.long 0x3f553f80,0xbe483ec4,0x3f0e248d,0x3f7b3f6d,0xbf62bf80,0xbdc9bf0e,0x3e953f35,0xbf22be48
.long 0x3f6d3f80,0x3ec43f35,0xbf6dbf80,0xbec4bf35,0xbf75bf80,0xbf22bf55,0x3f623f35,0x3f7f3f7b
.long 0x3f7b3f80,0x3f553f6d,0xbe48a554,0xbf0ebec4,0xbf7fbf80,0xbf75bf7b,0xbf22bf35,0xbef1bf0e
.long 0xbf803f80,0xbf803f80,0xbf803f80,0xbf803f80,0x3f62bf6d,0x3f46bf55,0x3e95bec4,0x3dc9be48
.long 0xbf0e3f35,0xbe483ec4,0x3f55bf35,0x3f7bbf6d,0x3dc9bec4,0xbef13e48,0xbf463f6d,0xbe953f0e
.long 0x3ec4248d,0x3f6dbf35,0xbec4a554,0xbf6d3f35,0xbf463ec4,0xbf753f7b,0x3f7fbf6d,0x3ef1bf55
.long 0x3f7bbf35,0x3f0ebf6d,0xbe483f35,0x3f55bec4,0xbf753f6d,0x3dc93f0e,0xbf623ec4,0xbf223f7b
.long 0x3f35bf80,0xbf35a554,0x3f35bf80,0xbf35a554,0xbe953f6d,0x3f7fbf0e,0x3ef13ec4,0x3f46bf7b
.long 0xbe48bf35,0xbf553f6d,0xbf7b3f35,0x3f0e3ec4,0x3f223ec4,0x3e95bf7b,0x3dc9bf6d,0xbf623f55
.long 0xbf6da554,0x3ec43f35,0x3f6d248d,0xbec4bf35,0x3f7fbec4,0xbf62be48,0xbf223f6d,0x3f75bf0e
.long 0xbf553f35,0x3f7bbec4,0xbf0ebf35,0x3e483f6d,0x3ef1bf6d,0xbf223f55,0x3f75bec4,0xbf7f3e48
.long 0xa5543f80,0x248dbf80,0xa5543f80,0x248dbf80,0xbef1bf6d,0x3f223f55,0xbf75bec4,0x3f7f3e48
.long 0x3f553f35,0xbf7bbec4,0x3f0ebf35,0xbe483f6d,0xbf7fbec4,0x3f62be48,0x3f223f6d,0xbf75bf0e
.long 0x3f6d248d,0xbec43f35,0xbf6da554,0x3ec4bf35,0xbf223ec4,0xbe95bf7b,0xbdc9bf6d,0x3f623f55
.long 0x3e48bf35,0x3f553f6d,0x3f7b3f35,0xbf0e3ec4,0x3e953f6d,0xbf7fbf0e,0xbef13ec4,0xbf46bf7b
.long 0xbf35bf80,0x3f35248d,0xbf35bf80,0x3f35248d,0x3f753f6d,0xbdc93f0e,0x3f623ec4,0x3f223f7b
.long 0xbf7bbf35,0xbf0ebf6d,0x3e483f35,0xbf55bec4,0x3f463ec4,0x3f753f7b,0xbf7fbf6d,0xbef1bf55
.long 0xbec4a554,0xbf6dbf35,0x3ec4248d,0x3f6d3f35,0xbdc9bec4,0x3ef13e48,0x3f463f6d,0x3e953f0e
.long 0x3f0e3f35,0x3e483ec4,0xbf55bf35,0xbf7bbf6d,0xbf62bf6d,0xbf46bf55,0xbe95bec4,0xbdc9be48
.long 0xa50d0000,0xa50d0000,0xa50d0000,0xa50d0000,0xbdc9a50d,0xbe953e48,0xbf463f35,0xbf623f55
.long 0x3e480000,0x3f0ebec4,0x3f7bbf80,0x3f55bf6d,0xbe95a50d,0xbf463f0e,0xbef13f35,0x3dc93e48
.long 0x3ec40000,0x3f6dbf35,0xbec4a50d,0xbf6d3f35,0xbef1a50d,0xbf7f3f55,0x3f75bf35,0x3f46bf7b
.long 0x3f0e0000,0x3f7bbf6d,0xbf553f80,0x3e483ec4,0xbf22a50d,0xbf623f7b,0x3dc9bf35,0xbf753f0e
.long 0x3f350000,0x3f35bf80,0x3f350000,0x3f35bf80,0xbf46a50d,0xbef13f7b,0xbf7f3f35,0x3e953f0e
.long 0x3f550000,0x3e48bf6d,0x3f0ebf80,0xbf7b3ec4,0xbf62a50d,0x3dc93f55,0x3e953f35,0x3f22bf7b
.long 0x3f6d0000,0xbec4bf35,0xbf6da50d,0x3ec43f35,0xbf75a50d,0x3f223f0e,0x3f62bf35,0xbf7f3e48
.long 0x3f7b0000,0xbf55bec4,0xbe483f80,0x3f0ebf6d,0xbf7fa50d,0x3f753e48,0xbf22bf35,0x3ef13f55
.long 0x3f800000,0xbf80a50d,0x3f800000,0xbf80a50d,0xbf7fa50d,0x3f75be48,0xbf223f35,0x3ef1bf55
.long 0x3f7b0000,0xbf553ec4,0xbe48bf80,0x3f0e3f6d,0xbf75a50d,0x3f22bf0e,0x3f623f35,0xbf7fbe48
.long 0x3f6d0000,0xbec43f35,0xbf6da50d,0x3ec4bf35,0xbf62a50d,0x3dc9bf55,0x3e95bf35,0x3f223f7b
.long 0x3f550000,0x3e483f6d,0x3f0e3f80,0xbf7bbec4,0xbf46a50d,0xbef1bf7b,0xbf7fbf35,0x3e95bf0e
.long 0x3f350000,0x3f353f80,0x3f350000,0x3f353f80,0xbf22a50d,0xbf62bf7b,0x3dc93f35,0xbf75bf0e
.long 0x3f0e0000,0x3f7b3f6d,0xbf55bf80,0x3e48bec4,0xbef1a50d,0xbf7fbf55,0x3f753f35,0x3f463f7b
.long 0x3ec40000,0x3f6d3f35,0xbec4a50d,0xbf6dbf35,0xbe95a50d,0xbf46bf0e,0xbef1bf35,0x3dc9be48
.long 0x3e480000,0x3f0e3ec4,0x3f7b3f80,0x3f553f6d,0xbdc9a50d,0xbe95be48,0xbf46bf35,0xbf62bf55
.long 0xa50d0000,0xa50d0000,0xa50d0000,0xa50d0000,0xbef13ec4,0xbf223f0e,0xbf753f6d,0xbf7f3f7b
.long 0x3f55bf35,0x3f7bbf6d,0x3f0ebf35,0x3e48bec4,0xbf7f3f6d,0xbf623f7b,0x3f22bec4,0x3f75bf55
.long 0x3f6dbf80,0x3ec4bf35,0xbf6d3f80,0xbec43f35,0xbf223f6d,0x3e953e48,0xbdc9bec4,0xbf623f0e
.long 0x3e48bf35,0xbf553ec4,0x3f7bbf35,0x3f0ebf6d,0x3e953ec4,0x3f7fbf55,0xbef13f6d,0x3f46be48
.long 0xbf35a50d,0xbf353f80,0xbf35a50d,0xbf353f80,0x3f75bec4,0x3dc9bf55,0x3f62bf6d,0xbf22be48
.long 0xbf7b3f35,0x3f0e3ec4,0x3e483f35,0x3f55bf6d,0x3f46bf6d,0xbf753e48,0xbf7f3ec4,0x3ef13f0e
.long 0xbec43f80,0x3f6dbf35,0x3ec4bf80,0xbf6d3f35,0xbdc9bf6d,0xbef13f7b,0x3f463ec4,0xbe95bf55
.long 0x3f0e3f35,0xbe48bf6d,0xbf553f35,0x3f7bbec4,0xbf62bec4,0x3f463f0e,0xbe95bf6d,0x3dc93f7b
.long 0x3f800000,0xbf80a50d,0x3f800000,0xbf80a50d,0xbf623ec4,0x3f46bf0e,0xbe953f6d,0x3dc9bf7b
.long 0x3f0ebf35,0xbe483f6d,0xbf55bf35,0x3f7b3ec4,0xbdc93f6d,0xbef1bf7b,0x3f46bec4,0xbe953f55
.long 0xbec4bf80,0x3f6d3f35,0x3ec43f80,0xbf6dbf35,0x3f463f6d,0xbf75be48,0xbf7fbec4,0x3ef1bf0e
.long 0xbf7bbf35,0x3f0ebec4,0x3e48bf35,0x3f553f6d,0x3f753ec4,0x3dc93f55,0x3f623f6d,0xbf223e48
.long 0xbf35a50d,0xbf35bf80,0xbf35a50d,0xbf35bf80,0x3e95bec4,0x3f7f3f55,0xbef1bf6d,0x3f463e48
.long 0x3e483f35,0xbf55bec4,0x3f7b3f35,0x3f0e3f6d,0xbf22bf6d,0x3e95be48,0xbdc93ec4,0xbf62bf0e
.long 0x3f6d3f80,0x3ec43f35,0xbf6dbf80,0xbec4bf35,0xbf7fbf6d,0xbf62bf7b,0x3f223ec4,0x3f753f55
.long 0x3f553f35,0x3f7b3f6d,0x3f0e3f35,0x3e483ec4,0xbef1bec4,0xbf22bf0e,0xbf75bf6d,0xbf7fbf7b
.long 0x250d8000,0x250d8000,0x250d8000,0x250d8000,0x3dc9250d,0x3e95be48,0x3f46bf35,0x3f62bf55
.long 0xbe488000,0xbf0e3ec4,0xbf7b3f80,0xbf553f6d,0x3e95250d,0x3f46bf0e,0x3ef1bf35,0xbdc9be48
.long 0xbec48000,0xbf6d3f35,0x3ec4250d,0x3f6dbf35,0x3ef1250d,0x3f7fbf55,0xbf753f35,0xbf463f7b
.long 0xbf0e8000,0xbf7b3f6d,0x3f55bf80,0xbe48bec4,0x3f22250d,0x3f62bf7b,0xbdc93f35,0x3f75bf0e
.long 0xbf358000,0xbf353f80,0xbf358000,0xbf353f80,0x3f46250d,0x3ef1bf7b,0x3f7fbf35,0xbe95bf0e
.long 0xbf558000,0xbe483f6d,0xbf0e3f80,0x3f7bbec4,0x3f62250d,0xbdc9bf55,0xbe95bf35,0xbf223f7b
.long 0xbf6d8000,0x3ec43f35,0x3f6d250d,0xbec4bf35,0x3f75250d,0xbf22bf0e,0xbf623f35,0x3f7fbe48
.long 0xbf7b8000,0x3f553ec4,0x3e48bf80,0xbf0e3f6d,0x3f7f250d,0xbf75be48,0x3f223f35,0xbef1bf55
.long 0xbf808000,0x3f80250d,0xbf808000,0x3f80250d,0x3f7f250d,0xbf753e48,0x3f22bf35,0xbef13f55
.long 0xbf7b8000,0x3f55bec4,0x3e483f80,0xbf0ebf6d,0x3f75250d,0xbf223f0e,0xbf62bf35,0x3f7f3e48
.long 0xbf6d8000,0x3ec4bf35,0x3f6d250d,0xbec43f35,0x3f62250d,0xbdc93f55,0xbe953f35,0xbf22bf7b
.long 0xbf558000,0xbe48bf6d,0xbf0ebf80,0x3f7b3ec4,0x3f46250d,0x3ef13f7b,0x3f7f3f35,0xbe953f0e
.long 0xbf358000,0xbf35bf80,0xbf358000,0xbf35bf80,0x3f22250d,0x3f623f7b,0xbdc9bf35,0x3f753f0e
.long 0xbf0e8000,0xbf7bbf6d,0x3f553f80,0xbe483ec4,0x3ef1250d,0x3f7f3f55,0xbf75bf35,0xbf46bf7b
.long 0xbec48000,0xbf6dbf35,0x3ec4250d,0x3f6d3f35,0x3e95250d,0x3f463f0e,0x3ef13f35,0xbdc93e48
.long 0xbe488000,0xbf0ebec4,0xbf7bbf80,0xbf55bf6d,0x3dc9250d,0x3e953e48,0x3f463f35,0x3f623f55
.long 0x250d8000,0x250d8000,0x250d8000,0x250d8000,0x3ef1bec4,0x3f22bf0e,0x3f75bf6d,0x3f7fbf7b
.long 0xbf553f35,0xbf7b3f6d,0xbf0e3f35,0xbe483ec4,0x3f7fbf6d,0x3f62bf7b,0xbf223ec4,0xbf753f55
.long 0xbf6d3f80,0xbec43f35,0x3f6dbf80,0x3ec4bf35,0x3f22bf6d,0xbe95be48,0x3dc93ec4,0x3f62bf0e
.long 0xbe483f35,0x3f55bec4,0xbf7b3f35,0xbf0e3f6d,0xbe95bec4,0xbf7f3f55,0x3ef1bf6d,0xbf463e48
.long 0x3f35250d,0x3f35bf80,0x3f35250d,0x3f35bf80,0xbf753ec4,0xbdc93f55,0xbf623f6d,0x3f223e48
.long 0x3f7bbf35,0xbf0ebec4,0xbe48bf35,0xbf553f6d,0xbf463f6d,0x3f75be48,0x3f7fbec4,0xbef1bf0e
.long 0x3ec4bf80,0xbf6d3f35,0xbec43f80,0x3f6dbf35,0x3dc93f6d,0x3ef1bf7b,0xbf46bec4,0x3e953f55
.long 0xbf0ebf35,0x3e483f6d,0x3f55bf35,0xbf7b3ec4,0x3f623ec4,0xbf46bf0e,0x3e953f6d,0xbdc9bf7b
.long 0xbf808000,0x3f80250d,0xbf808000,0x3f80250d,0x3f62bec4,0xbf463f0e,0x3e95bf6d,0xbdc93f7b
.long 0xbf0e3f35,0x3e48bf6d,0x3f553f35,0xbf7bbec4,0x3dc9bf6d,0x3ef13f7b,0xbf463ec4,0x3e95bf55
.long 0x3ec43f80,0xbf6dbf35,0xbec4bf80,0x3f6d3f35,0xbf46bf6d,0x3f753e48,0x3f7f3ec4,0xbef13f0e
.long 0x3f7b3f35,0xbf0e3ec4,0xbe483f35,0xbf55bf6d,0xbf75bec4,0xbdc9bf55,0xbf62bf6d,0x3f22be48
.long 0x3f35250d,0x3f353f80,0x3f35250d,0x3f353f80,0xbe953ec4,0xbf7fbf55,0x3ef13f6d,0xbf46be48
.long 0xbe48bf35,0x3f553ec4,0xbf7bbf35,0xbf0ebf6d,0x3f223f6d,0xbe953e48,0x3dc9bec4,0x3f623f0e
.long 0xbf6dbf80,0xbec4bf35,0x3f6d3f80,0x3ec43f35,0x3f7f3f6d,0x3f623f7b,0xbf22bec4,0xbf75bf55
.long 0xbf55bf35,0xbf7bbf6d,0xbf0ebf35,0xbe48bec4,0x3ef13ec4,0x3f223f0e,0x3f753f6d,0x3f7f3f7b
.long 0xbf803f80,0xbf803f80,0xbf803f80,0xbf803f80,0xbdc9a554,0xbe953e48,0xbf463f35,0xbf623f55
.long 0x3f7bbf80,0x3f55bf6d,0xbe48a554,0xbf0e3ec4,0x3e95248d,0x3f46bf0e,0x3ef1bf35,0xbdc9be48
.long 0xbf6d3f80,0xbec43f35,0x3f6dbf80,0x3ec4bf35,0xbef1a554,0xbf7f3f55,0x3f75bf35,0x3f46bf7b
.long 0x3f55bf80,0xbe48bec4,0x3f0e248d,0x3f7bbf6d,0x3f22248d,0x3f62bf7b,0xbdc93f35,0x3f75bf0e
.long 0xbf353f80,0x3f35248d,0xbf353f80,0x3f35248d,0xbf46a554,0xbef13f7b,0xbf7f3f35,0x3e953f0e
.long 0x3f0ebf80,0xbf7b3ec4,0xbf55a554,0xbe483f6d,0x3f62248d,0xbdc9bf55,0xbe95bf35,0xbf223f7b
.long 0xbec43f80,0x3f6dbf35,0x3ec4bf80,0xbf6d3f35,0xbf75a554,0x3f223f0e,0x3f62bf35,0xbf7f3e48
.long 0x3e48bf80,0xbf0e3f6d,0x3f7b248d,0xbf55bec4,0x3f7f248d,0xbf75be48,0x3f223f35,0xbef1bf55
.long 0xa5543f80,0x248dbf80,0xa5543f80,0x248dbf80,0xbf7fa554,0x3f75be48,0xbf223f35,0x3ef1bf55
.long 0xbe48bf80,0x3f0e3f6d,0xbf7ba554,0x3f55bec4,0x3f75248d,0xbf223f0e,0xbf62bf35,0x3f7f3e48
.long 0x3ec43f80,0xbf6dbf35,0xbec4bf80,0x3f6d3f35,0xbf62a554,0x3dc9bf55,0x3e95bf35,0x3f223f7b
.long 0xbf0ebf80,0x3f7b3ec4,0x3f55248d,0x3e483f6d,0x3f46248d,0x3ef13f7b,0x3f7f3f35,0xbe953f0e
.long 0x3f353f80,0xbf35a554,0x3f353f80,0xbf35a554,0xbf22a554,0xbf62bf7b,0x3dc93f35,0xbf75bf0e
.long 0xbf55bf80,0x3e48bec4,0xbf0ea554,0xbf7bbf6d,0x3ef1248d,0x3f7f3f55,0xbf75bf35,0xbf46bf7b
.long 0x3f6d3f80,0x3ec43f35,0xbf6dbf80,0xbec4bf35,0xbe95a554,0xbf46bf0e,0xbef1bf35,0x3dc9be48
.long 0xbf7bbf80,0xbf55bf6d,0x3e48248d,0x3f0e3ec4,0x3dc9248d,0x3e953e48,0x3f463f35,0x3f623f55
.long 0xbf803f80,0xbf803f80,0xbf803f80,0xbf803f80,0xbef13ec4,0xbf223f0e,0xbf753f6d,0xbf7f3f7b
.long 0x3f0ebf35,0x3e48bec4,0xbf553f35,0xbf7b3f6d,0x3f7fbf6d,0x3f62bf7b,0xbf223ec4,0xbf753f55
.long 0x3ec4248d,0x3f6dbf35,0xbec4a554,0xbf6d3f35,0xbf223f6d,0x3e953e48,0xbdc9bec4,0xbf623f0e
.long 0xbf7b3f35,0xbf0e3f6d,0x3e48bf35,0xbf553ec4,0xbe95bec4,0xbf7f3f55,0x3ef1bf6d,0xbf463e48
.long 0x3f35bf80,0xbf35a554,0x3f35bf80,0xbf35a554,0x3f75bec4,0x3dc9bf55,0x3f62bf6d,0xbf22be48
.long 0x3e483f35,0x3f55bf6d,0x3f7bbf35,0xbf0ebec4,0xbf463f6d,0x3f75be48,0x3f7fbec4,0xbef1bf0e
.long 0xbf6da554,0x3ec43f35,0x3f6d248d,0xbec4bf35,0xbdc9bf6d,0xbef13f7b,0x3f463ec4,0xbe95bf55
.long 0x3f55bf35,0xbf7b3ec4,0x3f0e3f35,0xbe48bf6d,0x3f623ec4,0xbf46bf0e,0x3e953f6d,0xbdc9bf7b
.long 0xa5543f80,0x248dbf80,0xa5543f80,0x248dbf80,0xbf623ec4,0x3f46bf0e,0xbe953f6d,0x3dc9bf7b
.long 0xbf55bf35,0x3f7b3ec4,0xbf0e3f35,0x3e48bf6d,0x3dc9bf6d,0x3ef13f7b,0xbf463ec4,0x3e95bf55
.long 0x3f6d248d,0xbec43f35,0xbf6da554,0x3ec4bf35,0x3f463f6d,0xbf75be48,0xbf7fbec4,0x3ef1bf0e
.long 0xbe483f35,0xbf55bf6d,0xbf7bbf35,0x3f0ebec4,0xbf75bec4,0xbdc9bf55,0xbf62bf6d,0x3f22be48
.long 0xbf35bf80,0x3f35248d,0xbf35bf80,0x3f35248d,0x3e95bec4,0x3f7f3f55,0xbef1bf6d,0x3f463e48
.long 0x3f7b3f35,0x3f0e3f6d,0xbe48bf35,0x3f553ec4,0x3f223f6d,0xbe953e48,0x3dc9bec4,0x3f623f0e
.long 0xbec4a554,0xbf6dbf35,0x3ec4248d,0x3f6d3f35,0xbf7fbf6d,0xbf62bf7b,0x3f223ec4,0x3f753f55
.long 0xbf0ebf35,0xbe48bec4,0x3f553f35,0x3f7b3f6d,0x3ef13ec4,0x3f223f0e,0x3f753f6d,0x3f7f3f7b
.long 0xa50d0000,0xa50d0000,0xa50d0000,0xa50d0000,0xbf7f3f80,0xbf753f7b,0xbf223f35,0xbef13f0e
.long 0xbe48a50d,0xbf0e3ec4,0xbf7b3f80,0xbf553f6d,0x3f75bf80,0x3f22bf55,0xbf623f35,0xbf7f3f7b
.long 0x3ec40000,0x3f6dbf35,0xbec4a50d,0xbf6d3f35,0xbf623f80,0xbdc93f0e,0x3e95bf35,0xbf223e48
.long 0xbf0ea50d,0xbf7b3f6d,0x3f55bf80,0xbe48bec4,0x3f46bf80,0xbef1be48,0x3f7fbf35,0x3e95bf55
.long 0x3f350000,0x3f35bf80,0x3f350000,0x3f35bf80,0xbf223f80,0x3f62be48,0x3dc93f35,0x3f75bf55
.long 0xbf55a50d,0xbe483f6d,0xbf0e3f80,0x3f7bbec4,0x3ef1bf80,0xbf7f3f0e,0xbf753f35,0x3f463e48
.long 0x3f6d0000,0xbec4bf35,0xbf6da50d,0x3ec43f35,0xbe953f80,0x3f46bf55,0xbef1bf35,0xbdc93f7b
.long 0xbf7ba50d,0x3f553ec4,0x3e48bf80,0xbf0e3f6d,0x3dc9bf80,0xbe953f7b,0x3f46bf35,0xbf623f0e
.long 0x3f800000,0xbf80a50d,0x3f800000,0xbf80a50d,0x3dc93f80,0xbe95bf7b,0x3f463f35,0xbf62bf0e
.long 0xbf7ba50d,0x3f55bec4,0x3e483f80,0xbf0ebf6d,0xbe95bf80,0x3f463f55,0xbef13f35,0xbdc9bf7b
.long 0x3f6d0000,0xbec43f35,0xbf6da50d,0x3ec4bf35,0x3ef13f80,0xbf7fbf0e,0xbf75bf35,0x3f46be48
.long 0xbf55a50d,0xbe48bf6d,0xbf0ebf80,0x3f7b3ec4,0xbf22bf80,0x3f623e48,0x3dc9bf35,0x3f753f55
.long 0x3f350000,0x3f353f80,0x3f350000,0x3f353f80,0x3f463f80,0xbef13e48,0x3f7f3f35,0x3e953f55
.long 0xbf0ea50d,0xbf7bbf6d,0x3f553f80,0xbe483ec4,0xbf62bf80,0xbdc9bf0e,0x3e953f35,0xbf22be48
.long 0x3ec40000,0x3f6d3f35,0xbec4a50d,0xbf6dbf35,0x3f753f80,0x3f223f55,0xbf62bf35,0xbf7fbf7b
.long 0xbe48a50d,0xbf0ebec4,0xbf7bbf80,0xbf55bf6d,0xbf7fbf80,0xbf75bf7b,0xbf22bf35,0xbef1bf0e
.long 0xa50d0000,0xa50d0000,0xa50d0000,0xa50d0000,0xbf623f6d,0xbf463f55,0xbe953ec4,0xbdc93e48
.long 0xbf553f35,0xbf7b3f6d,0xbf0e3f35,0xbe483ec4,0x3dc9bec4,0xbef13e48,0xbf463f6d,0xbe953f0e
.long 0x3f6dbf80,0x3ec4bf35,0xbf6d3f80,0xbec43f35,0x3f46bec4,0x3f75bf7b,0xbf7f3f6d,0xbef13f55
.long 0xbe483f35,0x3f55bec4,0xbf7b3f35,0xbf0e3f6d,0xbf753f6d,0x3dc93f0e,0xbf623ec4,0xbf223f7b
.long 0xbf35a50d,0xbf353f80,0xbf35a50d,0xbf353f80,0x3e95bf6d,0xbf7f3f0e,0xbef1bec4,0xbf463f7b
.long 0x3f7bbf35,0xbf0ebec4,0xbe48bf35,0xbf553f6d,0x3f223ec4,0x3e95bf7b,0x3dc9bf6d,0xbf623f55
.long 0xbec43f80,0x3f6dbf35,0x3ec4bf80,0xbf6d3f35,0xbf7f3ec4,0x3f623e48,0x3f22bf6d,0xbf753f0e
.long 0xbf0ebf35,0x3e483f6d,0x3f55bf35,0xbf7b3ec4,0x3ef1bf6d,0xbf223f55,0x3f75bec4,0xbf7f3e48
.long 0x3f800000,0xbf80a50d,0x3f800000,0xbf80a50d,0x3ef13f6d,0xbf22bf55,0x3f753ec4,0xbf7fbe48
.long 0xbf0e3f35,0x3e48bf6d,0x3f553f35,0xbf7bbec4,0xbf7fbec4,0x3f62be48,0x3f223f6d,0xbf75bf0e
.long 0xbec4bf80,0x3f6d3f35,0x3ec43f80,0xbf6dbf35,0x3f22bec4,0x3e953f7b,0x3dc93f6d,0xbf62bf55
.long 0x3f7b3f35,0xbf0e3ec4,0xbe483f35,0xbf55bf6d,0x3e953f6d,0xbf7fbf0e,0xbef13ec4,0xbf46bf7b
.long 0xbf35a50d,0xbf35bf80,0xbf35a50d,0xbf35bf80,0xbf75bf6d,0x3dc9bf0e,0xbf62bec4,0xbf22bf7b
.long 0xbe48bf35,0x3f553ec4,0xbf7bbf35,0xbf0ebf6d,0x3f463ec4,0x3f753f7b,0xbf7fbf6d,0xbef1bf55
.long 0x3f6d3f80,0x3ec43f35,0xbf6dbf80,0xbec4bf35,0x3dc93ec4,0xbef1be48,0xbf46bf6d,0xbe95bf0e
.long 0xbf55bf35,0xbf7bbf6d,0xbf0ebf35,0xbe48bec4,0xbf62bf6d,0xbf46bf55,0xbe95bec4,0xbdc9be48
.long 0x250d8000,0x250d8000,0x250d8000,0x250d8000,0x3f7fbf80,0x3f75bf7b,0x3f22bf35,0x3ef1bf0e
.long 0x3e48250d,0x3f0ebec4,0x3f7bbf80,0x3f55bf6d,0xbf753f80,0xbf223f55,0x3f62bf35,0x3f7fbf7b
.long 0xbec48000,0xbf6d3f35,0x3ec4250d,0x3f6dbf35,0x3f62bf80,0x3dc9bf0e,0xbe953f35,0x3f22be48
.long 0x3f0e250d,0x3f7bbf6d,0xbf553f80,0x3e483ec4,0xbf463f80,0x3ef13e48,0xbf7f3f35,0xbe953f55
.long 0xbf358000,0xbf353f80,0xbf358000,0xbf353f80,0x3f22bf80,0xbf623e48,0xbdc9bf35,0xbf753f55
.long 0x3f55250d,0x3e48bf6d,0x3f0ebf80,0xbf7b3ec4,0xbef13f80,0x3f7fbf0e,0x3f75bf35,0xbf46be48
.long 0xbf6d8000,0x3ec43f35,0x3f6d250d,0xbec4bf35,0x3e95bf80,0xbf463f55,0x3ef13f35,0x3dc9bf7b
.long 0x3f7b250d,0xbf55bec4,0xbe483f80,0x3f0ebf6d,0xbdc93f80,0x3e95bf7b,0xbf463f35,0x3f62bf0e
.long 0xbf808000,0x3f80250d,0xbf808000,0x3f80250d,0xbdc9bf80,0x3e953f7b,0xbf46bf35,0x3f623f0e
.long 0x3f7b250d,0xbf553ec4,0xbe48bf80,0x3f0e3f6d,0x3e953f80,0xbf46bf55,0x3ef1bf35,0x3dc93f7b
.long 0xbf6d8000,0x3ec4bf35,0x3f6d250d,0xbec43f35,0xbef1bf80,0x3f7f3f0e,0x3f753f35,0xbf463e48
.long 0x3f55250d,0x3e483f6d,0x3f0e3f80,0xbf7bbec4,0x3f223f80,0xbf62be48,0xbdc93f35,0xbf75bf55
.long 0xbf358000,0xbf35bf80,0xbf358000,0xbf35bf80,0xbf46bf80,0x3ef1be48,0xbf7fbf35,0xbe95bf55
.long 0x3f0e250d,0x3f7b3f6d,0xbf55bf80,0x3e48bec4,0x3f623f80,0x3dc93f0e,0xbe95bf35,0x3f223e48
.long 0xbec48000,0xbf6dbf35,0x3ec4250d,0x3f6d3f35,0xbf75bf80,0xbf22bf55,0x3f623f35,0x3f7f3f7b
.long 0x3e48250d,0x3f0e3ec4,0x3f7b3f80,0x3f553f6d,0x3f7f3f80,0x3f753f7b,0x3f223f35,0x3ef13f0e
.long 0x250d8000,0x250d8000,0x250d8000,0x250d8000,0x3f62bf6d,0x3f46bf55,0x3e95bec4,0x3dc9be48
.long 0x3f55bf35,0x3f7bbf6d,0x3f0ebf35,0x3e48bec4,0xbdc93ec4,0x3ef1be48,0x3f46bf6d,0x3e95bf0e
.long 0xbf6d3f80,0xbec43f35,0x3f6dbf80,0x3ec4bf35,0xbf463ec4,0xbf753f7b,0x3f7fbf6d,0x3ef1bf55
.long 0x3e48bf35,0xbf553ec4,0x3f7bbf35,0x3f0ebf6d,0x3f75bf6d,0xbdc9bf0e,0x3f62bec4,0x3f22bf7b
.long 0x3f35250d,0x3f35bf80,0x3f35250d,0x3f35bf80,0xbe953f6d,0x3f7fbf0e,0x3ef13ec4,0x3f46bf7b
.long 0xbf7b3f35,0x3f0e3ec4,0x3e483f35,0x3f55bf6d,0xbf22bec4,0xbe953f7b,0xbdc93f6d,0x3f62bf55
.long 0x3ec4bf80,0xbf6d3f35,0xbec43f80,0x3f6dbf35,0x3f7fbec4,0xbf62be48,0xbf223f6d,0x3f75bf0e
.long 0x3f0e3f35,0xbe48bf6d,0xbf553f35,0x3f7bbec4,0xbef13f6d,0x3f22bf55,0xbf753ec4,0x3f7fbe48
.long 0xbf808000,0x3f80250d,0xbf808000,0x3f80250d,0xbef1bf6d,0x3f223f55,0xbf75bec4,0x3f7f3e48
.long 0x3f0ebf35,0xbe483f6d,0xbf55bf35,0x3f7b3ec4,0x3f7f3ec4,0xbf623e48,0xbf22bf6d,0x3f753f0e
.long 0x3ec43f80,0xbf6dbf35,0xbec4bf80,0x3f6d3f35,0xbf223ec4,0xbe95bf7b,0xbdc9bf6d,0x3f623f55
.long 0xbf7bbf35,0x3f0ebec4,0x3e48bf35,0x3f553f6d,0xbe95bf6d,0x3f7f3f0e,0x3ef1bec4,0x3f463f7b
.long 0x3f35250d,0x3f353f80,0x3f35250d,0x3f353f80,0x3f753f6d,0xbdc93f0e,0x3f623ec4,0x3f223f7b
.long 0x3e483f35,0xbf55bec4,0x3f7b3f35,0x3f0e3f6d,0xbf46bec4,0xbf75bf7b,0x3f7f3f6d,0x3ef13f55
.long 0xbf6dbf80,0xbec4bf35,0x3f6d3f80,0x3ec43f35,0xbdc9bec4,0x3ef13e48,0x3f463f6d,0x3e953f0e
.long 0x3f553f35,0x3f7b3f6d,0x3f0e3f35,0x3e483ec4,0x3f623f6d,0x3f463f55,0x3e953ec4,0x3dc93e48
.long 0x3f7f3f80,0x3f753f7b,0x3f223f35,0x3ef13f0e,0x3f753f80,0x3f223f55,0xbf62bf35,0xbf7fbf7b
.long 0x3f623f80,0x3dc93f0e,0xbe95bf35,0x3f223e48,0x3f463f80,0xbef13e48,0x3f7f3f35,0x3e953f55
.long 0x3f223f80,0xbf62be48,0xbdc93f35,0xbf75bf55,0x3ef13f80,0xbf7fbf0e,0xbf75bf35,0x3f46be48
.long 0x3e953f80,0xbf46bf55,0x3ef1bf35,0x3dc93f7b,0x3dc93f80,0xbe95bf7b,0x3f463f35,0xbf62bf0e
.long 0xbdc93f80,0x3e95bf7b,0xbf463f35,0x3f62bf0e,0xbe953f80,0x3f46bf55,0xbef1bf35,0xbdc93f7b
.long 0xbef13f80,0x3f7fbf0e,0x3f75bf35,0xbf46be48,0xbf223f80,0x3f62be48,0x3dc93f35,0x3f75bf55
.long 0xbf463f80,0x3ef13e48,0xbf7f3f35,0xbe953f55,0xbf623f80,0xbdc93f0e,0x3e95bf35,0xbf223e48
.long 0xbf753f80,0xbf223f55,0x3f62bf35,0x3f7fbf7b,0xbf7f3f80,0xbf753f7b,0xbf223f35,0xbef13f0e
.long 0xbf7f3f80,0xbf753f7b,0xbf223f35,0xbef13f0e,0xbf753f80,0xbf223f55,0x3f62bf35,0x3f7fbf7b
.long 0xbf623f80,0xbdc93f0e,0x3e95bf35,0xbf223e48,0xbf463f80,0x3ef13e48,0xbf7f3f35,0xbe953f55
.long 0xbf223f80,0x3f62be48,0x3dc93f35,0x3f75bf55,0xbef13f80,0x3f7fbf0e,0x3f75bf35,0xbf46be48
.long 0xbe953f80,0x3f46bf55,0xbef1bf35,0xbdc93f7b,0xbdc93f80,0x3e95bf7b,0xbf463f35,0x3f62bf0e
.long 0x3dc93f80,0xbe95bf7b,0x3f463f35,0xbf62bf0e,0x3e953f80,0xbf46bf55,0x3ef1bf35,0x3dc93f7b
.long 0x3ef13f80,0xbf7fbf0e,0xbf75bf35,0x3f46be48,0x3f223f80,0xbf62be48,0xbdc93f35,0xbf75bf55
.long 0x3f463f80,0xbef13e48,0x3f7f3f35,0x3e953f55,0x3f623f80,0x3dc93f0e,0xbe95bf35,0x3f223e48
.long 0x3f753f80,0x3f223f55,0xbf62bf35,0xbf7fbf7b,0x3f7f3f80,0x3f753f7b,0x3f223f35,0x3ef13f0e
.long 0x3f623f6d,0x3f463f55,0x3e953ec4,0x3dc93e48,0x3dc93ec4,0xbef1be48,0xbf46bf6d,0xbe95bf0e
.long 0xbf46bec4,0xbf75bf7b,0x3f7f3f6d,0x3ef13f55,0xbf75bf6d,0x3dc9bf0e,0xbf62bec4,0xbf22bf7b
.long 0xbe95bf6d,0x3f7f3f0e,0x3ef1bec4,0x3f463f7b,0x3f22bec4,0x3e953f7b,0x3dc93f6d,0xbf62bf55
.long 0x3f7f3ec4,0xbf623e48,0xbf22bf6d,0x3f753f0e,0x3ef13f6d,0xbf22bf55,0x3f753ec4,0xbf7fbe48
.long 0xbef13f6d,0x3f22bf55,0xbf753ec4,0x3f7fbe48,0xbf7f3ec4,0x3f623e48,0x3f22bf6d,0xbf753f0e
.long 0xbf22bec4,0xbe953f7b,0xbdc93f6d,0x3f62bf55,0x3e95bf6d,0xbf7f3f0e,0xbef1bec4,0xbf463f7b
.long 0x3f75bf6d,0xbdc9bf0e,0x3f62bec4,0x3f22bf7b,0x3f46bec4,0x3f75bf7b,0xbf7f3f6d,0xbef13f55
.long 0xbdc93ec4,0x3ef1be48,0x3f46bf6d,0x3e95bf0e,0xbf623f6d,0xbf463f55,0xbe953ec4,0xbdc93e48
.long 0xbf623f6d,0xbf463f55,0xbe953ec4,0xbdc93e48,0xbdc93ec4,0x3ef1be48,0x3f46bf6d,0x3e95bf0e
.long 0x3f46bec4,0x3f75bf7b,0xbf7f3f6d,0xbef13f55,0x3f75bf6d,0xbdc9bf0e,0x3f62bec4,0x3f22bf7b
.long 0x3e95bf6d,0xbf7f3f0e,0xbef1bec4,0xbf463f7b,0xbf22bec4,0xbe953f7b,0xbdc93f6d,0x3f62bf55
.long 0xbf7f3ec4,0x3f623e48,0x3f22bf6d,0xbf753f0e,0xbef13f6d,0x3f22bf55,0xbf753ec4,0x3f7fbe48
.long 0x3ef13f6d,0xbf22bf55,0x3f753ec4,0xbf7fbe48,0x3f7f3ec4,0xbf623e48,0xbf22bf6d,0x3f753f0e
.long 0x3f22bec4,0x3e953f7b,0x3dc93f6d,0xbf62bf55,0xbe95bf6d,0x3f7f3f0e,0x3ef1bec4,0x3f463f7b
.long 0xbf75bf6d,0x3dc9bf0e,0xbf62bec4,0xbf22bf7b,0xbf46bec4,0xbf75bf7b,0x3f7f3f6d,0x3ef13f55
.long 0x3dc93ec4,0xbef1be48,0xbf46bf6d,0xbe95bf0e,0x3f623f6d,0x3f463f55,0x3e953ec4,0x3dc93e48
.long 0x3dc98000,0x3e953e48,0x3f463f35,0x3f623f55,0x3e958000,0x3f463f0e,0x3ef13f35,0xbdc93e48
.long 0x3ef18000,0x3f7f3f55,0xbf75bf35,0xbf46bf7b,0x3f228000,0x3f623f7b,0xbdc9bf35,0x3f753f0e
.long 0x3f468000,0x3ef13f7b,0x3f7f3f35,0xbe953f0e,0x3f628000,0xbdc93f55,0xbe953f35,0xbf22bf7b
.long 0x3f758000,0xbf223f0e,0xbf62bf35,0x3f7f3e48,0x3f7f8000,0xbf753e48,0x3f22bf35,0xbef13f55
.long 0x3f7f8000,0xbf75be48,0x3f223f35,0xbef1bf55,0x3f758000,0xbf22bf0e,0xbf623f35,0x3f7fbe48
.long 0x3f628000,0xbdc9bf55,0xbe95bf35,0xbf223f7b,0x3f468000,0x3ef1bf7b,0x3f7fbf35,0xbe95bf0e
.long 0x3f228000,0x3f62bf7b,0xbdc93f35,0x3f75bf0e,0x3ef18000,0x3f7fbf55,0xbf753f35,0xbf463f7b
.long 0x3e958000,0x3f46bf0e,0x3ef1bf35,0xbdc9be48,0x3dc98000,0x3e95be48,0x3f46bf35,0x3f62bf55
.long 0xbdc98000,0xbe953e48,0xbf463f35,0xbf623f55,0xbe958000,0xbf463f0e,0xbef13f35,0x3dc93e48
.long 0xbef18000,0xbf7f3f55,0x3f75bf35,0x3f46bf7b,0xbf228000,0xbf623f7b,0x3dc9bf35,0xbf753f0e
.long 0xbf468000,0xbef13f7b,0xbf7f3f35,0x3e953f0e,0xbf628000,0x3dc93f55,0x3e953f35,0x3f22bf7b
.long 0xbf758000,0x3f223f0e,0x3f62bf35,0xbf7f3e48,0xbf7f8000,0x3f753e48,0xbf22bf35,0x3ef13f55
.long 0xbf7f8000,0x3f75be48,0xbf223f35,0x3ef1bf55,0xbf758000,0x3f22bf0e,0x3f623f35,0xbf7fbe48
.long 0xbf628000,0x3dc9bf55,0x3e95bf35,0x3f223f7b,0xbf468000,0xbef1bf7b,0xbf7fbf35,0x3e95bf0e
.long 0xbf228000,0xbf62bf7b,0x3dc93f35,0xbf75bf0e,0xbef18000,0xbf7fbf55,0x3f753f35,0x3f463f7b
.long 0xbe958000,0xbf46bf0e,0xbef1bf35,0x3dc9be48,0xbdc98000,0xbe95be48,0xbf46bf35,0xbf62bf55
.long 0x3ef13ec4,0x3f223f0e,0x3f753f6d,0x3f7f3f7b,0x3f7f3f6d,0x3f623f7b,0xbf22bec4,0xbf75bf55
.long 0x3f223f6d,0xbe953e48,0x3dc9bec4,0x3f623f0e,0xbe953ec4,0xbf7fbf55,0x3ef13f6d,0xbf46be48
.long 0xbf75bec4,0xbdc9bf55,0xbf62bf6d,0x3f22be48,0xbf46bf6d,0x3f753e48,0x3f7f3ec4,0xbef13f0e
.long 0x3dc9bf6d,0x3ef13f7b,0xbf463ec4,0x3e95bf55,0x3f62bec4,0xbf463f0e,0x3e95bf6d,0xbdc93f7b
.long 0x3f623ec4,0xbf46bf0e,0x3e953f6d,0xbdc9bf7b,0x3dc93f6d,0x3ef1bf7b,0xbf46bec4,0x3e953f55
.long 0xbf463f6d,0x3f75be48,0x3f7fbec4,0xbef1bf0e,0xbf753ec4,0xbdc93f55,0xbf623f6d,0x3f223e48
.long 0xbe95bec4,0xbf7f3f55,0x3ef1bf6d,0xbf463e48,0x3f22bf6d,0xbe95be48,0x3dc93ec4,0x3f62bf0e
.long 0x3f7fbf6d,0x3f62bf7b,0xbf223ec4,0xbf753f55,0x3ef1bec4,0x3f22bf0e,0x3f75bf6d,0x3f7fbf7b
.long 0xbef13ec4,0xbf223f0e,0xbf753f6d,0xbf7f3f7b,0xbf7f3f6d,0xbf623f7b,0x3f22bec4,0x3f75bf55
.long 0xbf223f6d,0x3e953e48,0xbdc9bec4,0xbf623f0e,0x3e953ec4,0x3f7fbf55,0xbef13f6d,0x3f46be48
.long 0x3f75bec4,0x3dc9bf55,0x3f62bf6d,0xbf22be48,0x3f46bf6d,0xbf753e48,0xbf7f3ec4,0x3ef13f0e
.long 0xbdc9bf6d,0xbef13f7b,0x3f463ec4,0xbe95bf55,0xbf62bec4,0x3f463f0e,0xbe95bf6d,0x3dc93f7b
.long 0xbf623ec4,0x3f46bf0e,0xbe953f6d,0x3dc9bf7b,0xbdc93f6d,0xbef1bf7b,0x3f46bec4,0xbe953f55
.long 0x3f463f6d,0xbf75be48,0xbf7fbec4,0x3ef1bf0e,0x3f753ec4,0x3dc93f55,0x3f623f6d,0xbf223e48
.long 0x3e95bec4,0x3f7f3f55,0xbef1bf6d,0x3f463e48,0xbf22bf6d,0x3e95be48,0xbdc93ec4,0xbf62bf0e
.long 0xbf7fbf6d,0xbf62bf7b,0x3f223ec4,0x3f753f55,0xbef1bec4,0xbf22bf0e,0xbf75bf6d,0xbf7fbf7b
.long 0xbdc90000,0xbe95be48,0xbf46bf35,0xbf62bf55,0xbe950000,0xbf46bf0e,0xbef1bf35,0x3dc9be48
.long 0xbef10000,0xbf7fbf55,0x3f753f35,0x3f463f7b,0xbf220000,0xbf62bf7b,0x3dc93f35,0xbf75bf0e
.long 0xbf460000,0xbef1bf7b,0xbf7fbf35,0x3e95bf0e,0xbf620000,0x3dc9bf55,0x3e95bf35,0x3f223f7b
.long 0xbf750000,0x3f22bf0e,0x3f623f35,0xbf7fbe48,0xbf7f0000,0x3f75be48,0xbf223f35,0x3ef1bf55
.long 0xbf7f0000,0x3f753e48,0xbf22bf35,0x3ef13f55,0xbf750000,0x3f223f0e,0x3f62bf35,0xbf7f3e48
.long 0xbf620000,0x3dc93f55,0x3e953f35,0x3f22bf7b,0xbf460000,0xbef13f7b,0xbf7f3f35,0x3e953f0e
.long 0xbf220000,0xbf623f7b,0x3dc9bf35,0xbf753f0e,0xbef10000,0xbf7f3f55,0x3f75bf35,0x3f46bf7b
.long 0xbe950000,0xbf463f0e,0xbef13f35,0x3dc93e48,0xbdc90000,0xbe953e48,0xbf463f35,0xbf623f55
.long 0x3dc90000,0x3e95be48,0x3f46bf35,0x3f62bf55,0x3e950000,0x3f46bf0e,0x3ef1bf35,0xbdc9be48
.long 0x3ef10000,0x3f7fbf55,0xbf753f35,0xbf463f7b,0x3f220000,0x3f62bf7b,0xbdc93f35,0x3f75bf0e
.long 0x3f460000,0x3ef1bf7b,0x3f7fbf35,0xbe95bf0e,0x3f620000,0xbdc9bf55,0xbe95bf35,0xbf223f7b
.long 0x3f750000,0xbf22bf0e,0xbf623f35,0x3f7fbe48,0x3f7f0000,0xbf75be48,0x3f223f35,0xbef1bf55
.long 0x3f7f0000,0xbf753e48,0x3f22bf35,0xbef13f55,0x3f750000,0xbf223f0e,0xbf62bf35,0x3f7f3e48
.long 0x3f620000,0xbdc93f55,0xbe953f35,0xbf22bf7b,0x3f460000,0x3ef13f7b,0x3f7f3f35,0xbe953f0e
.long 0x3f220000,0x3f623f7b,0xbdc9bf35,0x3f753f0e,0x3ef10000,0x3f7f3f55,0xbf75bf35,0xbf46bf7b
.long 0x3e950000,0x3f463f0e,0x3ef13f35,0xbdc93e48,0x3dc90000,0x3e953e48,0x3f463f35,0x3f623f55
.long 0xbef1bec4,0xbf22bf0e,0xbf75bf6d,0xbf7fbf7b,0xbf7fbf6d,0xbf62bf7b,0x3f223ec4,0x3f753f55
.long 0xbf22bf6d,0x3e95be48,0xbdc93ec4,0xbf62bf0e,0x3e95bec4,0x3f7f3f55,0xbef1bf6d,0x3f463e48
.long 0x3f753ec4,0x3dc93f55,0x3f623f6d,0xbf223e48,0x3f463f6d,0xbf75be48,0xbf7fbec4,0x3ef1bf0e
.long 0xbdc93f6d,0xbef1bf7b,0x3f46bec4,0xbe953f55,0xbf623ec4,0x3f46bf0e,0xbe953f6d,0x3dc9bf7b
.long 0xbf62bec4,0x3f463f0e,0xbe95bf6d,0x3dc93f7b,0xbdc9bf6d,0xbef13f7b,0x3f463ec4,0xbe95bf55
.long 0x3f46bf6d,0xbf753e48,0xbf7f3ec4,0x3ef13f0e,0x3f75bec4,0x3dc9bf55,0x3f62bf6d,0xbf22be48
.long 0x3e953ec4,0x3f7fbf55,0xbef13f6d,0x3f46be48,0xbf223f6d,0x3e953e48,0xbdc9bec4,0xbf623f0e
.long 0xbf7f3f6d,0xbf623f7b,0x3f22bec4,0x3f75bf55,0xbef13ec4,0xbf223f0e,0xbf753f6d,0xbf7f3f7b
.long 0x3ef1bec4,0x3f22bf0e,0x3f75bf6d,0x3f7fbf7b,0x3f7fbf6d,0x3f62bf7b,0xbf223ec4,0xbf753f55
.long 0x3f22bf6d,0xbe95be48,0x3dc93ec4,0x3f62bf0e,0xbe95bec4,0xbf7f3f55,0x3ef1bf6d,0xbf463e48
.long 0xbf753ec4,0xbdc93f55,0xbf623f6d,0x3f223e48,0xbf463f6d,0x3f75be48,0x3f7fbec4,0xbef1bf0e
.long 0x3dc93f6d,0x3ef1bf7b,0xbf46bec4,0x3e953f55,0x3f623ec4,0xbf46bf0e,0x3e953f6d,0xbdc9bf7b
.long 0x3f62bec4,0xbf463f0e,0x3e95bf6d,0xbdc93f7b,0x3dc9bf6d,0x3ef13f7b,0xbf463ec4,0x3e95bf55
.long 0xbf46bf6d,0x3f753e48,0x3f7f3ec4,0xbef13f0e,0xbf75bec4,0xbdc9bf55,0xbf62bf6d,0x3f22be48
.long 0xbe953ec4,0xbf7fbf55,0x3ef13f6d,0xbf46be48,0x3f223f6d,0xbe953e48,0x3dc9bec4,0x3f623f0e
.long 0x3f7f3f6d,0x3f623f7b,0xbf22bec4,0xbf75bf55,0x3ef13ec4,0x3f223f0e,0x3f753f6d,0x3f7f3f7b
.long 0xbdc9248d,0xbe95be48,0xbf46bf35,0xbf62bf55,0x3e95a554,0x3f463f0e,0x3ef13f35,0xbdc93e48
.long 0xbef1248d,0xbf7fbf55,0x3f753f35,0x3f463f7b,0x3f22a554,0x3f623f7b,0xbdc9bf35,0x3f753f0e
.long 0xbf46248d,0xbef1bf7b,0xbf7fbf35,0x3e95bf0e,0x3f62a554,0xbdc93f55,0xbe953f35,0xbf22bf7b
.long 0xbf75248d,0x3f22bf0e,0x3f623f35,0xbf7fbe48,0x3f7fa554,0xbf753e48,0x3f22bf35,0xbef13f55
.long 0xbf7f248d,0x3f753e48,0xbf22bf35,0x3ef13f55,0x3f75a554,0xbf22bf0e,0xbf623f35,0x3f7fbe48
.long 0xbf62248d,0x3dc93f55,0x3e953f35,0x3f22bf7b,0x3f46a554,0x3ef1bf7b,0x3f7fbf35,0xbe95bf0e
.long 0xbf22248d,0xbf623f7b,0x3dc9bf35,0xbf753f0e,0x3ef1a554,0x3f7fbf55,0xbf753f35,0xbf463f7b
.long 0xbe95248d,0xbf463f0e,0xbef13f35,0x3dc93e48,0x3dc9a554,0x3e95be48,0x3f46bf35,0x3f62bf55
.long 0x3dc9248d,0x3e95be48,0x3f46bf35,0x3f62bf55,0xbe95a554,0xbf463f0e,0xbef13f35,0x3dc93e48
.long 0x3ef1248d,0x3f7fbf55,0xbf753f35,0xbf463f7b,0xbf22a554,0xbf623f7b,0x3dc9bf35,0xbf753f0e
.long 0x3f46248d,0x3ef1bf7b,0x3f7fbf35,0xbe95bf0e,0xbf62a554,0x3dc93f55,0x3e953f35,0x3f22bf7b
.long 0x3f75248d,0xbf22bf0e,0xbf623f35,0x3f7fbe48,0xbf7fa554,0x3f753e48,0xbf22bf35,0x3ef13f55
.long 0x3f7f248d,0xbf753e48,0x3f22bf35,0xbef13f55,0xbf75a554,0x3f22bf0e,0x3f623f35,0xbf7fbe48
.long 0x3f62248d,0xbdc93f55,0xbe953f35,0xbf22bf7b,0xbf46a554,0xbef1bf7b,0xbf7fbf35,0x3e95bf0e
.long 0x3f22248d,0x3f623f7b,0xbdc9bf35,0x3f753f0e,0xbef1a554,0xbf7fbf55,0x3f753f35,0x3f463f7b
.long 0x3e95248d,0x3f463f0e,0x3ef13f35,0xbdc93e48,0xbdc9a554,0xbe95be48,0xbf46bf35,0xbf62bf55
.long 0xbef1bec4,0xbf22bf0e,0xbf75bf6d,0xbf7fbf7b,0x3f7f3f6d,0x3f623f7b,0xbf22bec4,0xbf75bf55
.long 0xbf22bf6d,0x3e95be48,0xbdc93ec4,0xbf62bf0e,0xbe953ec4,0xbf7fbf55,0x3ef13f6d,0xbf46be48
.long 0x3f753ec4,0x3dc93f55,0x3f623f6d,0xbf223e48,0xbf46bf6d,0x3f753e48,0x3f7f3ec4,0xbef13f0e
.long 0xbdc93f6d,0xbef1bf7b,0x3f46bec4,0xbe953f55,0x3f62bec4,0xbf463f0e,0x3e95bf6d,0xbdc93f7b
.long 0xbf62bec4,0x3f463f0e,0xbe95bf6d,0x3dc93f7b,0x3dc93f6d,0x3ef1bf7b,0xbf46bec4,0x3e953f55
.long 0x3f46bf6d,0xbf753e48,0xbf7f3ec4,0x3ef13f0e,0xbf753ec4,0xbdc93f55,0xbf623f6d,0x3f223e48
.long 0x3e953ec4,0x3f7fbf55,0xbef13f6d,0x3f46be48,0x3f22bf6d,0xbe95be48,0x3dc93ec4,0x3f62bf0e
.long 0xbf7f3f6d,0xbf623f7b,0x3f22bec4,0x3f75bf55,0x3ef1bec4,0x3f22bf0e,0x3f75bf6d,0x3f7fbf7b
.long 0x3ef1bec4,0x3f22bf0e,0x3f75bf6d,0x3f7fbf7b,0xbf7f3f6d,0xbf623f7b,0x3f22bec4,0x3f75bf55
.long 0x3f22bf6d,0xbe95be48,0x3dc93ec4,0x3f62bf0e,0x3e953ec4,0x3f7fbf55,0xbef13f6d,0x3f46be48
.long 0xbf753ec4,0xbdc93f55,0xbf623f6d,0x3f223e48,0x3f46bf6d,0xbf753e48,0xbf7f3ec4,0x3ef13f0e
.long 0x3dc93f6d,0x3ef1bf7b,0xbf46bec4,0x3e953f55,0xbf62bec4,0x3f463f0e,0xbe95bf6d,0x3dc93f7b
.long 0x3f62bec4,0xbf463f0e,0x3e95bf6d,0xbdc93f7b,0xbdc93f6d,0xbef1bf7b,0x3f46bec4,0xbe953f55
.long 0xbf46bf6d,0x3f753e48,0x3f7f3ec4,0xbef13f0e,0x3f753ec4,0x3dc93f55,0x3f623f6d,0xbf223e48
.long 0xbe953ec4,0xbf7fbf55,0x3ef13f6d,0xbf46be48,0xbf22bf6d,0x3e95be48,0xbdc93ec4,0xbf62bf0e
.long 0x3f7f3f6d,0x3f623f7b,0xbf22bec4,0xbf75bf55,0xbef1bec4,0xbf22bf0e,0xbf75bf6d,0xbf7fbf7b
.long 0x3f7f3f80,0x3f753f7b,0x3f223f35,0x3ef13f0e,0xbf75bf80,0xbf22bf55,0x3f623f35,0x3f7f3f7b
.long 0x3f623f80,0x3dc93f0e,0xbe95bf35,0x3f223e48,0xbf46bf80,0x3ef1be48,0xbf7fbf35,0xbe95bf55
.long 0x3f223f80,0xbf62be48,0xbdc93f35,0xbf75bf55,0xbef1bf80,0x3f7f3f0e,0x3f753f35,0xbf463e48
.long 0x3e953f80,0xbf46bf55,0x3ef1bf35,0x3dc93f7b,0xbdc9bf80,0x3e953f7b,0xbf46bf35,0x3f623f0e
.long 0xbdc93f80,0x3e95bf7b,0xbf463f35,0x3f62bf0e,0x3e95bf80,0xbf463f55,0x3ef13f35,0x3dc9bf7b
.long 0xbef13f80,0x3f7fbf0e,0x3f75bf35,0xbf46be48,0x3f22bf80,0xbf623e48,0xbdc9bf35,0xbf753f55
.long 0xbf463f80,0x3ef13e48,0xbf7f3f35,0xbe953f55,0x3f62bf80,0x3dc9bf0e,0xbe953f35,0x3f22be48
.long 0xbf753f80,0xbf223f55,0x3f62bf35,0x3f7fbf7b,0x3f7fbf80,0x3f75bf7b,0x3f22bf35,0x3ef1bf0e
.long 0xbf7f3f80,0xbf753f7b,0xbf223f35,0xbef13f0e,0x3f75bf80,0x3f22bf55,0xbf623f35,0xbf7f3f7b
.long 0xbf623f80,0xbdc93f0e,0x3e95bf35,0xbf223e48,0x3f46bf80,0xbef1be48,0x3f7fbf35,0x3e95bf55
.long 0xbf223f80,0x3f62be48,0x3dc93f35,0x3f75bf55,0x3ef1bf80,0xbf7f3f0e,0xbf753f35,0x3f463e48
.long 0xbe953f80,0x3f46bf55,0xbef1bf35,0xbdc93f7b,0x3dc9bf80,0xbe953f7b,0x3f46bf35,0xbf623f0e
.long 0x3dc93f80,0xbe95bf7b,0x3f463f35,0xbf62bf0e,0xbe95bf80,0x3f463f55,0xbef13f35,0xbdc9bf7b
.long 0x3ef13f80,0xbf7fbf0e,0xbf75bf35,0x3f46be48,0xbf22bf80,0x3f623e48,0x3dc9bf35,0x3f753f55
.long 0x3f463f80,0xbef13e48,0x3f7f3f35,0x3e953f55,0xbf62bf80,0xbdc9bf0e,0x3e953f35,0xbf22be48
.long 0x3f753f80,0x3f223f55,0xbf62bf35,0xbf7fbf7b,0xbf7fbf80,0xbf75bf7b,0xbf22bf35,0xbef1bf0e
.long 0x3f623f6d,0x3f463f55,0x3e953ec4,0x3dc93e48,0xbdc9bec4,0x3ef13e48,0x3f463f6d,0x3e953f0e
.long 0xbf46bec4,0xbf75bf7b,0x3f7f3f6d,0x3ef13f55,0x3f753f6d,0xbdc93f0e,0x3f623ec4,0x3f223f7b
.long 0xbe95bf6d,0x3f7f3f0e,0x3ef1bec4,0x3f463f7b,0xbf223ec4,0xbe95bf7b,0xbdc9bf6d,0x3f623f55
.long 0x3f7f3ec4,0xbf623e48,0xbf22bf6d,0x3f753f0e,0xbef1bf6d,0x3f223f55,0xbf75bec4,0x3f7f3e48
.long 0xbef13f6d,0x3f22bf55,0xbf753ec4,0x3f7fbe48,0x3f7fbec4,0xbf62be48,0xbf223f6d,0x3f75bf0e
.long 0xbf22bec4,0xbe953f7b,0xbdc93f6d,0x3f62bf55,0xbe953f6d,0x3f7fbf0e,0x3ef13ec4,0x3f46bf7b
.long 0x3f75bf6d,0xbdc9bf0e,0x3f62bec4,0x3f22bf7b,0xbf463ec4,0xbf753f7b,0x3f7fbf6d,0x3ef1bf55
.long 0xbdc93ec4,0x3ef1be48,0x3f46bf6d,0x3e95bf0e,0x3f62bf6d,0x3f46bf55,0x3e95bec4,0x3dc9be48
.long 0xbf623f6d,0xbf463f55,0xbe953ec4,0xbdc93e48,0x3dc9bec4,0xbef13e48,0xbf463f6d,0xbe953f0e
.long 0x3f46bec4,0x3f75bf7b,0xbf7f3f6d,0xbef13f55,0xbf753f6d,0x3dc93f0e,0xbf623ec4,0xbf223f7b
.long 0x3e95bf6d,0xbf7f3f0e,0xbef1bec4,0xbf463f7b,0x3f223ec4,0x3e95bf7b,0x3dc9bf6d,0xbf623f55
.long 0xbf7f3ec4,0x3f623e48,0x3f22bf6d,0xbf753f0e,0x3ef1bf6d,0xbf223f55,0x3f75bec4,0xbf7f3e48
.long 0x3ef13f6d,0xbf22bf55,0x3f753ec4,0xbf7fbe48,0xbf7fbec4,0x3f62be48,0x3f223f6d,0xbf75bf0e
.long 0x3f22bec4,0x3e953f7b,0x3dc93f6d,0xbf62bf55,0x3e953f6d,0xbf7fbf0e,0xbef13ec4,0xbf46bf7b
.long 0xbf75bf6d,0x3dc9bf0e,0xbf62bec4,0xbf22bf7b,0x3f463ec4,0x3f753f7b,0xbf7fbf6d,0xbef1bf55
.long 0x3dc93ec4,0xbef1be48,0xbf46bf6d,0xbe95bf0e,0xbf62bf6d,0xbf46bf55,0xbe95bec4,0xbdc9be48
.long 0xbf7fbf80,0xbf75bf7b,0xbf22bf35,0xbef1bf0e,0x3f753f80,0x3f223f55,0xbf62bf35,0xbf7fbf7b
.long 0xbf62bf80,0xbdc9bf0e,0x3e953f35,0xbf22be48,0x3f463f80,0xbef13e48,0x3f7f3f35,0x3e953f55
.long 0xbf22bf80,0x3f623e48,0x3dc9bf35,0x3f753f55,0x3ef13f80,0xbf7fbf0e,0xbf75bf35,0x3f46be48
.long 0xbe95bf80,0x3f463f55,0xbef13f35,0xbdc9bf7b,0x3dc93f80,0xbe95bf7b,0x3f463f35,0xbf62bf0e
.long 0x3dc9bf80,0xbe953f7b,0x3f46bf35,0xbf623f0e,0xbe953f80,0x3f46bf55,0xbef1bf35,0xbdc93f7b
.long 0x3ef1bf80,0xbf7f3f0e,0xbf753f35,0x3f463e48,0xbf223f80,0x3f62be48,0x3dc93f35,0x3f75bf55
.long 0x3f46bf80,0xbef1be48,0x3f7fbf35,0x3e95bf55,0xbf623f80,0xbdc93f0e,0x3e95bf35,0xbf223e48
.long 0x3f75bf80,0x3f22bf55,0xbf623f35,0xbf7f3f7b,0xbf7f3f80,0xbf753f7b,0xbf223f35,0xbef13f0e
.long 0x3f7fbf80,0x3f75bf7b,0x3f22bf35,0x3ef1bf0e,0xbf753f80,0xbf223f55,0x3f62bf35,0x3f7fbf7b
.long 0x3f62bf80,0x3dc9bf0e,0xbe953f35,0x3f22be48,0xbf463f80,0x3ef13e48,0xbf7f3f35,0xbe953f55
.long 0x3f22bf80,0xbf623e48,0xbdc9bf35,0xbf753f55,0xbef13f80,0x3f7fbf0e,0x3f75bf35,0xbf46be48
.long 0x3e95bf80,0xbf463f55,0x3ef13f35,0x3dc9bf7b,0xbdc93f80,0x3e95bf7b,0xbf463f35,0x3f62bf0e
.long 0xbdc9bf80,0x3e953f7b,0xbf46bf35,0x3f623f0e,0x3e953f80,0xbf46bf55,0x3ef1bf35,0x3dc93f7b
.long 0xbef1bf80,0x3f7f3f0e,0x3f753f35,0xbf463e48,0x3f223f80,0xbf62be48,0xbdc93f35,0xbf75bf55
.long 0xbf46bf80,0x3ef1be48,0xbf7fbf35,0xbe95bf55,0x3f623f80,0x3dc93f0e,0xbe95bf35,0x3f223e48
.long 0xbf75bf80,0xbf22bf55,0x3f623f35,0x3f7f3f7b,0x3f7f3f80,0x3f753f7b,0x3f223f35,0x3ef13f0e
.long 0xbf62bf6d,0xbf46bf55,0xbe95bec4,0xbdc9be48,0x3dc93ec4,0xbef1be48,0xbf46bf6d,0xbe95bf0e
.long 0x3f463ec4,0x3f753f7b,0xbf7fbf6d,0xbef1bf55,0xbf75bf6d,0x3dc9bf0e,0xbf62bec4,0xbf22bf7b
.long 0x3e953f6d,0xbf7fbf0e,0xbef13ec4,0xbf46bf7b,0x3f22bec4,0x3e953f7b,0x3dc93f6d,0xbf62bf55
.long 0xbf7fbec4,0x3f62be48,0x3f223f6d,0xbf75bf0e,0x3ef13f6d,0xbf22bf55,0x3f753ec4,0xbf7fbe48
.long 0x3ef1bf6d,0xbf223f55,0x3f75bec4,0xbf7f3e48,0xbf7f3ec4,0x3f623e48,0x3f22bf6d,0xbf753f0e
.long 0x3f223ec4,0x3e95bf7b,0x3dc9bf6d,0xbf623f55,0x3e95bf6d,0xbf7f3f0e,0xbef1bec4,0xbf463f7b
.long 0xbf753f6d,0x3dc93f0e,0xbf623ec4,0xbf223f7b,0x3f46bec4,0x3f75bf7b,0xbf7f3f6d,0xbef13f55
.long 0x3dc9bec4,0xbef13e48,0xbf463f6d,0xbe953f0e,0xbf623f6d,0xbf463f55,0xbe953ec4,0xbdc93e48
.long 0x3f62bf6d,0x3f46bf55,0x3e95bec4,0x3dc9be48,0xbdc93ec4,0x3ef1be48,0x3f46bf6d,0x3e95bf0e
.long 0xbf463ec4,0xbf753f7b,0x3f7fbf6d,0x3ef1bf55,0x3f75bf6d,0xbdc9bf0e,0x3f62bec4,0x3f22bf7b
.long 0xbe953f6d,0x3f7fbf0e,0x3ef13ec4,0x3f46bf7b,0xbf22bec4,0xbe953f7b,0xbdc93f6d,0x3f62bf55
.long 0x3f7fbec4,0xbf62be48,0xbf223f6d,0x3f75bf0e,0xbef13f6d,0x3f22bf55,0xbf753ec4,0x3f7fbe48
.long 0xbef1bf6d,0x3f223f55,0xbf75bec4,0x3f7f3e48,0x3f7f3ec4,0xbf623e48,0xbf22bf6d,0x3f753f0e
.long 0xbf223ec4,0xbe95bf7b,0xbdc9bf6d,0x3f623f55,0xbe95bf6d,0x3f7f3f0e,0x3ef1bec4,0x3f463f7b
.long 0x3f753f6d,0xbdc93f0e,0x3f623ec4,0x3f223f7b,0xbf46bec4,0xbf75bf7b,0x3f7f3f6d,0x3ef13f55
.long 0xbdc9bec4,0x3ef13e48,0x3f463f6d,0x3e953f0e,0x3f623f6d,0x3f463f55,0x3e953ec4,0x3dc93e48
.long 0x3f800000,0x3f800000,0x3f800000,0x3f800000,0x3f800000,0x3f7fffb1,0x3f7ffec4,0x3f7ffd39
.long 0x3f800000,0x3f7ffec4,0x3f7ffb11,0x3f7ff4e6,0x3f800000,0x3f7ffd39,0x3f7ff4e6,0x3f7fe705
.long 0x3f800000,0x3f7ffb11,0x3f7fec43,0x3f7fd397,0x3f800000,0x3f7ff84a,0x3f7fe129,0x3f7fba9e
.long 0x3f800000,0x3f7ff4e6,0x3f7fd397,0x3f7f9c18,0x3f800000,0x3f7ff0e3,0x3f7fc38f,0x3f7f7808
.long 0x3f800000,0x3f7fec43,0x3f7fb10f,0x3f7f4e6d,0x3f800000,0x3f7fe705,0x3f7f9c18,0x3f7f1f49
.long 0x3f800000,0x3f7fe129,0x3f7f84ab,0x3f7eea9d,0x3f800000,0x3f7fdaaf,0x3f7f6ac7,0x3f7eb069
.long 0x3f800000,0x3f7fd397,0x3f7f4e6d,0x3f7e70b0,0x3f800000,0x3f7fcbe2,0x3f7f2f9d,0x3f7e2b72
.long 0x3f800000,0x3f7fc38f,0x3f7f0e58,0x3f7de0b1,0x3f800000,0x3f7fba9e,0x3f7eea9d,0x3f7d906e
.long 0x3f800000,0x3f7fb10f,0x3f7ec46d,0x3f7d3aac,0x3f800000,0x3f7fa6e3,0x3f7e9bc9,0x3f7cdf6c
.long 0x3f800000,0x3f7f9c18,0x3f7e70b0,0x3f7c7eb0,0x3f800000,0x3f7f90b1,0x3f7e4323,0x3f7c187a
.long 0x3f800000,0x3f7f84ab,0x3f7e1324,0x3f7baccd,0x3f800000,0x3f7f7808,0x3f7de0b1,0x3f7b3bab
.long 0x3f800000,0x3f7f6ac7,0x3f7dabcc,0x3f7ac516,0x3f800000,0x3f7f5ce9,0x3f7d7474,0x3f7a4910
.long 0x3f800000,0x3f7f4e6d,0x3f7d3aac,0x3f79c79d,0x3f800000,0x3f7f3f54,0x3f7cfe73,0x3f7940c0
.long 0x3f800000,0x3f7f2f9d,0x3f7cbfc9,0x3f78b47b,0x3f800000,0x3f7f1f49,0x3f7c7eb0,0x3f7822d1
.long 0x3f800000,0x3f7f0e58,0x3f7c3b28,0x3f778bc5,0x3f800000,0x3f7efcc9,0x3f7bf531,0x3f76ef5b
.long 0x3f800000,0x3f7eea9d,0x3f7baccd,0x3f764d97,0x3f800000,0x3f7ed7d4,0x3f7b61fc,0x3f75a67b
.long 0x3f800000,0x3f800000,0x3f800000,0x3f800000,0x3f7ffb11,0x3f7ff84a,0x3f7ff4e6,0x3f7ff0e3
.long 0x3f7fec43,0x3f7fe129,0x3f7fd397,0x3f7fc38f,0x3f7fd397,0x3f7fba9e,0x3f7f9c18,0x3f7f7808
.long 0x3f7fb10f,0x3f7f84ab,0x3f7f4e6d,0x3f7f0e58,0x3f7f84ab,0x3f7f3f54,0x3f7eea9d,0x3f7e868b
.long 0x3f7f4e6d,0x3f7eea9d,0x3f7e70b0,0x3f7de0b1,0x3f7f0e58,0x3f7e868b,0x3f7de0b1,0x3f7d1cdd
.long 0x3f7ec46d,0x3f7e1324,0x3f7d3aac,0x3f7c3b28,0x3f7e70b0,0x3f7d906e,0x3f7c7eb0,0x3f7b3bab
.long 0x3f7e1324,0x3f7cfe73,0x3f7baccd,0x3f7a1e84,0x3f7dabcc,0x3f7c5d3a,0x3f7ac516,0x3f78e3d6
.long 0x3f7d3aac,0x3f7baccd,0x3f79c79d,0x3f778bc5,0x3f7cbfc9,0x3f7aed37,0x3f78b47b,0x3f76167a
.long 0x3f7c3b28,0x3f7a1e84,0x3f778bc5,0x3f748422,0x3f7baccd,0x3f7940c0,0x3f764d97,0x3f72d4eb
.long 0x3f7b14be,0x3f7853f8,0x3f74fa0b,0x3f710908,0x3f7a7302,0x3f77583a,0x3f73913f,0x3f6f20b0
.long 0x3f79c79d,0x3f764d97,0x3f721352,0x3f6d1c1d,0x3f791298,0x3f75341d,0x3f708066,0x3f6afb8c
.long 0x3f7853f8,0x3f740bdd,0x3f6ed89e,0x3f68bf3c,0x3f778bc5,0x3f72d4eb,0x3f6d1c1d,0x3f666771
.long 0x3f76ba07,0x3f718f57,0x3f6b4b0c,0x3f63f473,0x3f75dec6,0x3f703b37,0x3f696591,0x3f61668a
.long 0x3f74fa0b,0x3f6ed89e,0x3f676bd8,0x3f5ebe05,0x3f740bdd,0x3f6d67a1,0x3f655e0b,0x3f5bfb34
.long 0x3f731447,0x3f6be858,0x3f633c5a,0x3f591e6a,0x3f721352,0x3f6a5ad9,0x3f6106f2,0x3f5627fe
.long 0x3f710908,0x3f68bf3c,0x3f5ebe05,0x3f531849,0x3f6ff573,0x3f671599,0x3f5c61c7,0x3f4fefa8
.long 0x3f6ed89e,0x3f655e0b,0x3f59f26a,0x3f4cae79,0x3f6db293,0x3f6398ac,0x3f577026,0x3f495521
.long 0x3f800000,0x3f800000,0x3f800000,0x3f800000,0x3f7fec43,0x3f7fe705,0x3f7fe129,0x3f7fdaaf
.long 0x3f7fb10f,0x3f7f9c18,0x3f7f84ab,0x3f7f6ac7,0x3f7f4e6d,0x3f7f1f49,0x3f7eea9d,0x3f7eb069
.long 0x3f7ec46d,0x3f7e70b0,0x3f7e1324,0x3f7dabcc,0x3f7e1324,0x3f7d906e,0x3f7cfe73,0x3f7c5d3a
.long 0x3f7d3aac,0x3f7c7eb0,0x3f7baccd,0x3f7ac516,0x3f7c3b28,0x3f7b3bab,0x3f7a1e84,0x3f78e3d6
.long 0x3f7b14be,0x3f79c79d,0x3f7853f8,0x3f76ba07,0x3f79c79d,0x3f7822d1,0x3f764d97,0x3f74484b
.long 0x3f7853f8,0x3f764d97,0x3f740bdd,0x3f718f57,0x3f76ba07,0x3f74484b,0x3f718f57,0x3f6e8ff8
.long 0x3f74fa0b,0x3f721352,0x3f6ed89e,0x3f6b4b0c,0x3f731447,0x3f6faf1b,0x3f6be858,0x3f67c187
.long 0x3f710908,0x3f6d1c1d,0x3f68bf3c,0x3f63f473,0x3f6ed89e,0x3f6a5ad9,0x3f655e0b,0x3f5fe4e9
.long 0x3f6c835e,0x3f676bd8,0x3f61c598,0x3f5b941a,0x3f6a09a7,0x3f644fac,0x3f5df6be,0x3f570348
.long 0x3f676bd8,0x3f6106f2,0x3f59f26a,0x3f5233c6,0x3f64aa59,0x3f5d924d,0x3f55b993,0x3f4d26fd
.long 0x3f61c598,0x3f59f26a,0x3f514d3d,0x3f47de65,0x3f5ebe05,0x3f5627fe,0x3f4cae79,0x3f425b89
.long 0x3f5b941a,0x3f5233c6,0x3f47de65,0x3f3ca003,0x3f584853,0x3f4e1689,0x3f42de29,0x3f36ad7f
.long 0x3f54db31,0x3f49d112,0x3f3daef9,0x3f3085bb,0x3f514d3d,0x3f456439,0x3f385216,0x3f2a2a80
.long 0x3f4d9f02,0x3f40d0da,0x3f32c8c9,0x3f239da9,0x3f49d112,0x3f3c17d9,0x3f2d1469,0x3f1ce11f
.long 0x3f45e403,0x3f373a23,0x3f273656,0x3f15f6d9,0x3f41d870,0x3f3238aa,0x3f212ff9,0x3f0ee0db
.long 0x3f3daef9,0x3f2d1469,0x3f1b02c6,0x3f07a136,0x3f396842,0x3f27ce61,0x3f14b039,0x3f003a06
.long 0x3f800000,0x3f800000,0x3f800000,0x3f800000,0x3f7fd397,0x3f7fcbe2,0x3f7fc38f,0x3f7fba9e
.long 0x3f7f4e6d,0x3f7f2f9d,0x3f7f0e58,0x3f7eea9d,0x3f7e70b0,0x3f7e2b72,0x3f7de0b1,0x3f7d906e
.long 0x3f7d3aac,0x3f7cbfc9,0x3f7c3b28,0x3f7baccd,0x3f7baccd,0x3f7aed37,0x3f7a1e84,0x3f7940c0
.long 0x3f79c79d,0x3f78b47b,0x3f778bc5,0x3f764d97,0x3f778bc5,0x3f76167a,0x3f748422,0x3f72d4eb
.long 0x3f74fa0b,0x3f731447,0x3f710908,0x3f6ed89e,0x3f721352,0x3f6faf1b,0x3f6d1c1d,0x3f6a5ad9
.long 0x3f6ed89e,0x3f6be858,0x3f68bf3c,0x3f655e0b,0x3f6b4b0c,0x3f67c187,0x3f63f473,0x3f5fe4e9
.long 0x3f676bd8,0x3f633c5a,0x3f5ebe05,0x3f59f26a,0x3f633c5a,0x3f5e5aa6,0x3f591e6a,0x3f5389c7
.long 0x3f5ebe05,0x3f591e6a,0x3f531849,0x3f4cae79,0x3f59f26a,0x3f5389c7,0x3f4cae79,0x3f456439
.long 0x3f54db31,0x3f4d9f02,0x3f45e403,0x3f3daef9,0x3f4f7a1f,0x3f476085,0x3f3ebc1b,0x3f3592e7
.long 0x3f49d112,0x3f40d0da,0x3f373a23,0x3f2d1469,0x3f43e200,0x3f39f2ac,0x3f2f61a5,0x3f24381a
.long 0x3f3daef9,0x3f32c8c9,0x3f273656,0x3f1b02c6,0x3f373a23,0x3f2b561b,0x3f1ebc12,0x3f11796b
.long 0x3f3085bb,0x3f239da9,0x3f15f6d9,0x3f07a136,0x3f299415,0x3f1ba299,0x3f0cead0,0x3efafef7
.long 0x3f226799,0x3f13682a,0x3f039c3d,0x3ee63375,0x3f1b02c6,0x3f0af1b7,0x3ef41f07,0x3ed0eb2a
.long 0x3f13682a,0x3f0242b1,0x3ee0924f,0x3ebb31a0,0x3f0b9a6b,0x3ef2bd43,0x3ecc9b8b,0x3ea5129f
.long 0x3f039c3d,0x3ee0924f,0x3eb8442a,0x3e8e9a22,0x3ef6e0cb,0x3ece0bea,0x3ea395c5,0x3e6fa8b2
.long 0x3ee63375,0x3ebb31a0,0x3e8e9a22,0x3e419b37,0x3ed53641,0x3ea80b1f,0x3e72b651,0x3e1324ca
.long 0x3f800000,0x3f800000,0x3f800000,0x3f800000,0x3f7fb10f,0x3f7fa6e3,0x3f7f9c18,0x3f7f90b1
.long 0x3f7ec46d,0x3f7e9bc9,0x3f7e70b0,0x3f7e4323,0x3f7d3aac,0x3f7cdf6c,0x3f7c7eb0,0x3f7c187a
.long 0x3f7b14be,0x3f7a7302,0x3f79c79d,0x3f791298,0x3f7853f8,0x3f77583a,0x3f764d97,0x3f75341d
.long 0x3f74fa0b,0x3f73913f,0x3f721352,0x3f708066,0x3f710908,0x3f6f20b0,0x3f6d1c1d,0x3f6afb8c
.long 0x3f6c835e,0x3f6a09a7,0x3f676bd8,0x3f64aa59,0x3f676bd8,0x3f644fac,0x3f6106f2,0x3f5d924d
.long 0x3f61c598,0x3f5df6be,0x3f59f26a,0x3f55b993,0x3f5b941a,0x3f570348,0x3f5233c6,0x3f4d26fd
.long 0x3f54db31,0x3f4f7a1f,0x3f49d112,0x3f43e200,0x3f4d9f02,0x3f476085,0x3f40d0da,0x3f39f2ac
.long 0x3f45e403,0x3f3ebc1b,0x3f373a23,0x3f2f61a5,0x3f3daef9,0x3f3592e7,0x3f2d1469,0x3f24381a
.long 0x3f3504f3,0x3f2beb4a,0x3f226799,0x3f187fc0,0x3f2beb4a,0x3f21cbfb,0x3f173c07,0x3f0c42c9
.long 0x3f226799,0x3f173c07,0x3f0b9a6b,0x3eff17b2,0x3f187fc0,0x3f0c42c9,0x3eff17b2,0x3ee4cbfe
.long 0x3f0e39da,0x3f00e7e4,0x3ee63375,0x3ec9b953,0x3f039c3d,0x3eea6681,0x3ecc9b8b,0x3eadf73c
.long 0x3ef15aea,0x3ed25a09,0x3eb263ef,0x3e919ddd,0x3edae880,0x3eb9bb1e,0x3e97a117,0x3e698bba
.long 0x3ec3ef15,0x3ea09ae5,0x3e78cfcc,0x3e2f10a2,0x3eac7cd4,0x3e870ada,0x3e419b37,0x3de7fa9a
.long 0x3e94a031,0x3e5a3997,0x3e09cf86,0x3d621469,0x3e78cfcc,0x3e25c58c,0x3da3308c,0xbb490fc6
.long 0x3e47c5c2,0x3de1bc2e,0x3cc90ab0,0xbd7b2b74,0x3e164083,0x3d6ea038,0xbcfb49ba,0xbdf475c0
.long 0x3dc8bd36,0x3bc90f88,0xbdafb680,0xbe354098,0x3d48fb30,0xbd3c6dd5,0xbe1008b7,0xbe6fa8b2
.long 0x3f800000,0x3f800000,0x3f800000,0x3f800000,0x3f7f84ab,0x3f7f7808,0x3f7f6ac7,0x3f7f5ce9
.long 0x3f7e1324,0x3f7de0b1,0x3f7dabcc,0x3f7d7474,0x3f7baccd,0x3f7b3bab,0x3f7ac516,0x3f7a4910
.long 0x3f7853f8,0x3f778bc5,0x3f76ba07,0x3f75dec6,0x3f740bdd,0x3f72d4eb,0x3f718f57,0x3f703b37
.long 0x3f6ed89e,0x3f6d1c1d,0x3f6b4b0c,0x3f696591,0x3f68bf3c,0x3f666771,0x3f63f473,0x3f61668a
.long 0x3f61c598,0x3f5ebe05,0x3f5b941a,0x3f584853,0x3f59f26a,0x3f5627fe,0x3f5233c6,0x3f4e1689
.long 0x3f514d3d,0x3f4cae79,0x3f47de65,0x3f42de29,0x3f47de65,0x3f425b89,0x3f3ca003,0x3f36ad7f
.long 0x3f3daef9,0x3f373a23,0x3f3085bb,0x3f299415,0x3f32c8c9,0x3f2b561b,0x3f239da9,0x3f1ba299
.long 0x3f273656,0x3f1ebc12,0x3f15f6d9,0x3f0cead0,0x3f1b02c6,0x3f11796b,0x3f07a136,0x3efafef7
.long 0x3f0e39da,0x3f039c3d,0x3ef15aea,0x3edae880,0x3f00e7e4,0x3eea6681,0x3ed25a09,0x3eb9bb1e
.long 0x3ee63375,0x3ecc9b8b,0x3eb263ef,0x3e97a117,0x3ec9b953,0x3eadf73c,0x3e919ddd,0x3e698bba
.long 0x3eac7cd4,0x3e8e9a22,0x3e605c13,0x3e22abb6,0x3e8e9a22,0x3e5d4b1a,0x3e1c76de,0x3db5f8da
.long 0x3e605c13,0x3e1c76de,0x3dafb680,0x3c96c9b6,0x3e22abb6,0x3db5f8da,0x3c96c9b6,0xbd55880e
.long 0x3dc8bd36,0x3cc90ab0,0xbd48fb30,0xbdfab273,0x3d16c32c,0xbd2351cb,0xbdee3876,0xbe44b0b9
.long 0xbcc90ab0,0xbdd53db9,0xbe3b6ecf,0xbe8586ce,0xbdafb680,0xbe2bf804,0xbe7ee6e1,0xbea80b1f
.long 0xbe164083,0xbe6c9a7f,0xbea09ae5,0xbec9b953,0xbe541501,0xbe9620d2,0xbec1071e,0xbeea6681
.long 0xbe888e93,0xbeb554ec,0xbee0924f,0xbf04f484,0xbea68f12,0xbed3c867,0xbeff17b2,0xbf140c5f
.long 0x3f800000,0x3f800000,0x3f800000,0x3f800000,0x3f7f4e6d,0x3f7f3f54,0x3f7f2f9d,0x3f7f1f49
.long 0x3f7d3aac,0x3f7cfe73,0x3f7cbfc9,0x3f7c7eb0,0x3f79c79d,0x3f7940c0,0x3f78b47b,0x3f7822d1
.long 0x3f74fa0b,0x3f740bdd,0x3f731447,0x3f721352,0x3f6ed89e,0x3f6d67a1,0x3f6be858,0x3f6a5ad9
.long 0x3f676bd8,0x3f655e0b,0x3f633c5a,0x3f6106f2,0x3f5ebe05,0x3f5bfb34,0x3f591e6a,0x3f5627fe
.long 0x3f54db31,0x3f514d3d,0x3f4d9f02,0x3f49d112,0x3f49d112,0x3f456439,0x3f40d0da,0x3f3c17d9
.long 0x3f3daef9,0x3f385216,0x3f32c8c9,0x3f2d1469,0x3f3085bb,0x3f2a2a80,0x3f239da9,0x3f1ce11f
.long 0x3f226799,0x3f1b02c6,0x3f13682a,0x3f0b9a6b,0x3f13682a,0x3f0af1b7,0x3f0242b1,0x3ef2bd43
.long 0x3f039c3d,0x3ef41f07,0x3ee0924f,0x3ecc9b8b,0x3ee63375,0x3ed0eb2a,0x3ebb31a0,0x3ea5129f
.long 0x3ec3ef15,0x3eac7cd4,0x3e94a031,0x3e78cfcc,0x3ea09ae5,0x3e870ada,0x3e5a3997,0x3e25c58c
.long 0x3e78cfcc,0x3e419b37,0x3e09cf86,0x3da3308c,0x3e2f10a2,0x3de7fa9a,0x3d621469,0xbb490fc6
.long 0x3dc8bd36,0x3d16c32c,0xbcc90ab0,0xbdafb680,0x3cc90ab0,0xbd2351cb,0xbdd53db9,0xbe2bf804
.long 0xbd48fb30,0xbdee3876,0xbe3b6ecf,0xbe7ee6e1,0xbdfab273,0xbe44b0b9,0xbe8586ce,0xbea80b1f
.long 0xbe47c5c2,0xbe888e93,0xbeac7cd4,0xbecf7bca,0xbe888e93,0xbeadf73c,0xbed25a09,0xbef58035
.long 0xbeac7cd4,0xbed25a09,0xbef6e0cb,0xbf0cead0,0xbecf7bca,0xbef58035,0xbf0cead0,0xbf1e1e22
.long 0xbef15aea,0xbf0b9a6b,0xbf1d7fd1,0xbf2e3bde,0xbf08f59b,0xbf1ba299,0xbf2d1469,0xbf3d27b8
.long 0xbf187fc0,0xbf2ac082,0xbf3b8f3b,0xbf4ac77f,0xbf273656,0xbf38dd65,0xbf48d8b3,0xbf570348
.long 0x3f800000,0x3f800000,0x3f800000,0x3f800000,0x3f7f0e58,0x3f7efcc9,0x3f7eea9d,0x3f7ed7d4
.long 0x3f7c3b28,0x3f7bf531,0x3f7baccd,0x3f7b61fc,0x3f778bc5,0x3f76ef5b,0x3f764d97,0x3f75a67b
.long 0x3f710908,0x3f6ff573,0x3f6ed89e,0x3f6db293,0x3f68bf3c,0x3f671599,0x3f655e0b,0x3f6398ac
.long 0x3f5ebe05,0x3f5c61c7,0x3f59f26a,0x3f577026,0x3f531849,0x3f4fefa8,0x3f4cae79,0x3f495521
.long 0x3f45e403,0x3f41d870,0x3f3daef9,0x3f396842,0x3f373a23,0x3f3238aa,0x3f2d1469,0x3f27ce61
.long 0x3f273656,0x3f212ff9,0x3f1b02c6,0x3f14b039,0x3f15f6d9,0x3f0ee0db,0x3f07a136,0x3f003a06
.long 0x3f039c3d,0x3ef6e0cb,0x3ee63375,0x3ed53641,0x3ee0924f,0x3ece0bea,0x3ebb31a0,0x3ea80b1f
.long 0x3eb8442a,0x3ea395c5,0x3e8e9a22,0x3e72b651,0x3e8e9a22,0x3e6fa8b2,0x3e419b37,0x3e1324ca
.long 0x3e47c5c2,0x3e164083,0x3dc8bd36,0x3d48fb30,0x3de1bc2e,0x3d6ea038,0x3bc90f88,0xbd3c6dd5
.long 0x3cc90ab0,0xbcfb49ba,0xbdafb680,0xbe1008b7,0xbd7b2b74,0xbdf475c0,0xbe354098,0xbe6fa8b2
.long 0xbe164083,0xbe541501,0xbe888e93,0xbea68f12,0xbe6c9a7f,0xbe9620d2,0xbeb554ec,0xbed3c867
.long 0xbea09ae5,0xbec1071e,0xbee0924f,0xbeff17b2,0xbec9b953,0xbeea6681,0xbf04f484,0xbf140c5f
.long 0xbef15aea,0xbf08f59b,0xbf187fc0,0xbf273656,0xbf0b9a6b,0xbf1ba299,0xbf2ac082,0xbf38dd65
.long 0xbf1d7fd1,0xbf2d1469,0xbf3b8f3b,0xbf48d8b3,0xbf2e3bde,0xbf3d27b8,0xbf4ac77f,0xbf570348
.long 0xbf3daef9,0xbf4bbbf8,0xbf584853,0xbf633c5a,0xbf4bbbf8,0xbf58b3a1,0xbf63f473,0xbf6d67a1
.long 0xbf584853,0xbf63f473,0xbf6db293,0xbf756d97,0xbf633c5a,0xbf6d67a1,0xbf756d97,0xbf7b3bab
.long 0x0,0x0,0x0,0x0,0x0,0xbb490fc6,0xbbc90f88,0xbc16cb58
.long 0x0,0xbbc90f88,0xbc490e90,0xbc96c9b6,0x0,0xbc16cb58,0xbc96c9b6,0xbce22a7a
.long 0x0,0xbc490e90,0xbcc90ab0,0xbd16c32c,0x0,0xbc7b514b,0xbcfb49ba,0xbd3c6dd5
.long 0x0,0xbc96c9b6,0xbd16c32c,0xbd621469,0x0,0xbcafea69,0xbd2fe007,0xbd83db0a
.long 0x0,0xbcc90ab0,0xbd48fb30,0xbd96a905,0x0,0xbce22a7a,0xbd621469,0xbda973ba
.long 0x0,0xbcfb49ba,0xbd7b2b74,0xbdbc3ac3,0x0,0xbd0a342f,0xbd8a200a,0xbdcefdb7
.long 0x0,0xbd16c32c,0xbd96a905,0xbde1bc2e,0x0,0xbd2351cb,0xbda3308c,0xbdf475c0
.long 0x0,0xbd2fe007,0xbdafb680,0xbe039502,0x0,0xbd3c6dd5,0xbdbc3ac3,0xbe0cec4a
.long 0x0,0xbd48fb30,0xbdc8bd36,0xbe164083,0x0,0xbd55880e,0xbdd53db9,0xbe1f917b
.long 0x0,0xbd621469,0xbde1bc2e,0xbe28defc,0x0,0xbd6ea038,0xbdee3876,0xbe3228d4
.long 0x0,0xbd7b2b74,0xbdfab273,0xbe3b6ecf,0x0,0xbd83db0a,0xbe039502,0xbe44b0b9
.long 0x0,0xbd8a200a,0xbe09cf86,0xbe4dee60,0x0,0xbd9064b4,0xbe1008b7,0xbe57278f
.long 0x0,0xbd96a905,0xbe164083,0xbe605c13,0x0,0xbd9cecf9,0xbe1c76de,0xbe698bba
.long 0x0,0xbda3308c,0xbe22abb6,0xbe72b651,0x0,0xbda973ba,0xbe28defc,0xbe7bdba4
.long 0x0,0xbdafb680,0xbe2f10a2,0xbe827dc0,0x0,0xbdb5f8da,0xbe354098,0xbe870ada
.long 0x0,0xbdbc3ac3,0xbe3b6ecf,0xbe8b9507,0x0,0xbdc27c39,0xbe419b37,0xbe901c2c
.long 0x0,0x0,0x0,0x0,0xbc490e90,0xbc7b514b,0xbc96c9b6,0xbcafea69
.long 0xbcc90ab0,0xbcfb49ba,0xbd16c32c,0xbd2fe007,0xbd16c32c,0xbd3c6dd5,0xbd621469,0xbd83db0a
.long 0xbd48fb30,0xbd7b2b74,0xbd96a905,0xbdafb680,0xbd7b2b74,0xbd9cecf9,0xbdbc3ac3,0xbddb7d37
.long 0xbd96a905,0xbdbc3ac3,0xbde1bc2e,0xbe039502,0xbdafb680,0xbddb7d37,0xbe039502,0xbe195be0
.long 0xbdc8bd36,0xbdfab273,0xbe164083,0xbe2f10a2,0xbde1bc2e,0xbe0cec4a,0xbe28defc,0xbe44b0b9
.long 0xbdfab273,0xbe1c76de,0xbe3b6ecf,0xbe5a3997,0xbe09cf86,0xbe2bf804,0xbe4dee60,0xbe6fa8b2
.long 0xbe164083,0xbe3b6ecf,0xbe605c13,0xbe827dc0,0xbe22abb6,0xbe4ada4f,0xbe72b651,0xbe8d17c0
.long 0xbe2f10a2,0xbe5a3997,0xbe827dc0,0xbe97a117,0xbe3b6ecf,0xbe698bba,0xbe8b9507,0xbea21887
.long 0xbe47c5c2,0xbe78cfcc,0xbe94a031,0xbeac7cd4,0xbe541501,0xbe840270,0xbe9d9e78,0xbeb6ccc3
.long 0xbe605c13,0xbe8b9507,0xbea68f12,0xbec1071e,0xbe6c9a7f,0xbe931f35,0xbeaf713a,0xbecb2aae
.long 0xbe78cfcc,0xbe9aa086,0xbeb8442a,0xbed53641,0xbe827dc0,0xbea21887,0xbec1071e,0xbedf28a9
.long 0xbe888e93,0xbea986c4,0xbec9b953,0xbee900b7,0xbe8e9a22,0xbeb0eacb,0xbed25a09,0xbef2bd43
.long 0xbe94a031,0xbeb8442a,0xbedae880,0xbefc5d27,0xbe9aa086,0xbebf926f,0xbee363fa,0xbf02ef9f
.long 0xbea09ae5,0xbec6d529,0xbeebcbbb,0xbf07a136,0xbea68f12,0xbece0bea,0xbef41f07,0xbf0c42c9
.long 0xbeac7cd4,0xbed53641,0xbefc5d27,0xbf10d3cd,0xbeb263ef,0xbedc53c1,0xbf0242b1,0xbf1553b7
.long 0xbeb8442a,0xbee363fa,0xbf064b82,0xbf19c200,0xbebe1d4a,0xbeea6681,0xbf0a48ad,0xbf1e1e22
.long 0x0,0x0,0x0,0x0,0xbcc90ab0,0xbce22a7a,0xbcfb49ba,0xbd0a342f
.long 0xbd48fb30,0xbd621469,0xbd7b2b74,0xbd8a200a,0xbd96a905,0xbda973ba,0xbdbc3ac3,0xbdcefdb7
.long 0xbdc8bd36,0xbde1bc2e,0xbdfab273,0xbe09cf86,0xbdfab273,0xbe0cec4a,0xbe1c76de,0xbe2bf804
.long 0xbe164083,0xbe28defc,0xbe3b6ecf,0xbe4dee60,0xbe2f10a2,0xbe44b0b9,0xbe5a3997,0xbe6fa8b2
.long 0xbe47c5c2,0xbe605c13,0xbe78cfcc,0xbe888e93,0xbe605c13,0xbe7bdba4,0xbe8b9507,0xbe9920fe
.long 0xbe78cfcc,0xbe8b9507,0xbe9aa086,0xbea986c4,0xbe888e93,0xbe9920fe,0xbea986c4,0xbeb9bb1e
.long 0xbe94a031,0xbea68f12,0xbeb8442a,0xbec9b953,0xbea09ae5,0xbeb3dca5,0xbec6d529,0xbed97cb9
.long 0xbeac7cd4,0xbec1071e,0xbed53641,0xbee900b7,0xbeb8442a,0xbece0bea,0xbee363fa,0xbef840c8
.long 0xbec3ef15,0xbedae880,0xbef15aea,0xbf039c3d,0xbecf7bca,0xbee79a5d,0xbeff17b2,0xbf0af1b7
.long 0xbedae880,0xbef41f07,0xbf064b82,0xbf121eb0,0xbee63375,0xbf003a06,0xbf0cead0,0xbf19210f
.long 0xbef15aea,0xbf064b82,0xbf13682a,0xbf1ff6cb,0xbefc5d27,0xbf0c42c9,0xbf19c200,0xbf269de3
.long 0xbf039c3d,0xbf121eb0,0xbf1ff6cb,0xbf2d1469,0xbf08f59b,0xbf17de12,0xbf26050a,0xbf33587a
.long 0xbf0e39da,0xbf1d7fd1,0xbf2beb4a,0xbf396842,0xbf13682a,0xbf2302d3,0xbf31a81d,0xbf3f41fc
.long 0xbf187fc0,0xbf286605,0xbf373a23,0xbf44e3f5,0xbf1d7fd1,0xbf2da859,0xbf3ca003,0xbf4a4c87
.long 0xbf226799,0xbf32c8c9,0xbf41d870,0xbf4f7a1f,0xbf273656,0xbf37c655,0xbf46e22a,0xbf546b3b
.long 0xbf2beb4a,0xbf3ca003,0xbf4bbbf8,0xbf591e6a,0xbf3085bb,0xbf4154e1,0xbf5064af,0xbf5d924d
.long 0x0,0x0,0x0,0x0,0xbd16c32c,0xbd2351cb,0xbd2fe007,0xbd3c6dd5
.long 0xbd96a905,0xbda3308c,0xbdafb680,0xbdbc3ac3,0xbde1bc2e,0xbdf475c0,0xbe039502,0xbe0cec4a
.long 0xbe164083,0xbe22abb6,0xbe2f10a2,0xbe3b6ecf,0xbe3b6ecf,0xbe4ada4f,0xbe5a3997,0xbe698bba
.long 0xbe605c13,0xbe72b651,0xbe827dc0,0xbe8b9507,0xbe827dc0,0xbe8d17c0,0xbe97a117,0xbea21887
.long 0xbe94a031,0xbea09ae5,0xbeac7cd4,0xbeb8442a,0xbea68f12,0xbeb3dca5,0xbec1071e,0xbece0bea
.long 0xbeb8442a,0xbec6d529,0xbed53641,0xbee363fa,0xbec9b953,0xbed97cb9,0xbee900b7,0xbef840c8
.long 0xbedae880,0xbeebcbbb,0xbefc5d27,0xbf064b82,0xbeebcbbb,0xbefdbabb,0xbf07a136,0xbf102dd5
.long 0xbefc5d27,0xbf07a136,0xbf10d3cd,0xbf19c200,0xbf064b82,0xbf102dd5,0xbf19c200,0xbf2302d3
.long 0xbf0e39da,0xbf187fc0,0xbf226799,0xbf2beb4a,0xbf15f6d9,0xbf209393,0xbf2ac082,0xbf34768f
.long 0xbf1d7fd1,0xbf286605,0xbf32c8c9,0xbf3ca003,0xbf24d225,0xbf2ff3e6,0xbf3a7ca4,0xbf446337
.long 0xbf2beb4a,0xbf373a23,0xbf41d870,0xbf4bbbf8,0xbf32c8c9,0xbf3e35c5,0xbf48d8b3,0xbf52a649
.long 0xbf396842,0xbf44e3f5,0xbf4f7a1f,0xbf591e6a,0xbf3fc767,0xbf4b41fa,0xbf55b993,0xbf5f20db
.long 0xbf45e403,0xbf514d3d,0xbf5b941a,0xbf64aa59,0xbf4bbbf8,0xbf570348,0xbf6106f2,0xbf69b7e4
.long 0xbf514d3d,0xbf5c61c7,0xbf660f88,0xbf6e46be,0xbf5695e5,0xbf61668a,0xbf6aab7b,0xbf725470
.long 0xbf5b941a,0xbf660f88,0xbf6ed89e,0xbf75dec6,0xbf604621,0xbf6a5ad9,0xbf7294f8,0xbf78e3d6
.long 0xbf64aa59,0xbf6e46be,0xbf75dec6,0xbf7b61fc,0xbf68bf3c,0xbf71d19f,0xbf78b47b,0xbf7d57de
.long 0x0,0x0,0x0,0x0,0xbd48fb30,0xbd55880e,0xbd621469,0xbd6ea038
.long 0xbdc8bd36,0xbdd53db9,0xbde1bc2e,0xbdee3876,0xbe164083,0xbe1f917b,0xbe28defc,0xbe3228d4
.long 0xbe47c5c2,0xbe541501,0xbe605c13,0xbe6c9a7f,0xbe78cfcc,0xbe840270,0xbe8b9507,0xbe931f35
.long 0xbe94a031,0xbe9d9e78,0xbea68f12,0xbeaf713a,0xbeac7cd4,0xbeb6ccc3,0xbec1071e,0xbecb2aae
.long 0xbec3ef15,0xbecf7bca,0xbedae880,0xbee63375,0xbedae880,0xbee79a5d,0xbef41f07,0xbf003a06
.long 0xbef15aea,0xbeff17b2,0xbf064b82,0xbf0cead0,0xbf039c3d,0xbf0af1b7,0xbf121eb0,0xbf19210f
.long 0xbf0e39da,0xbf15f6d9,0xbf1d7fd1,0xbf24d225,0xbf187fc0,0xbf209393,0xbf286605,0xbf2ff3e6
.long 0xbf226799,0xbf2ac082,0xbf32c8c9,0xbf3a7ca4,0xbf2beb4a,0xbf34768f,0xbf3ca003,0xbf446337
.long 0xbf3504f3,0xbf3daef9,0xbf45e403,0xbf4d9f02,0xbf3daef9,0xbf466354,0xbf4e8d90,0xbf5627fe
.long 0xbf45e403,0xbf4e8d90,0xbf5695e5,0xbf5df6be,0xbf4d9f02,0xbf5627fe,0xbf5df6be,0xbf650479
.long 0xbf54db31,0xbf5d2d53,0xbf64aa59,0xbf6b4b0c,0xbf5b941a,0xbf6398ac,0xbf6aab7b,0xbf70c501
.long 0xbf61c598,0xbf696591,0xbf6ff573,0xbf756d97,0xbf676bd8,0xbf6e8ff8,0xbf748422,0xbf7940c0
.long 0xbf6c835e,0xbf731447,0xbf7853f8,0xbf7c3b28,0xbf710908,0xbf76ef5b,0xbf7b61fc,0xbf7e5a38
.long 0xbf74fa0b,0xbf7a1e84,0xbf7dabcc,0xbf7f9c18,0xbf7853f8,0xbf7c9f8a,0xbf7f2f9d,0xbf7fffb1
.long 0xbf7b14be,0xbf7e70b0,0xbf7fec43,0xbf7f84ab,0xbf7d3aac,0xbf7f90b1,0xbf7fe129,0xbf7e2b72
.long 0xbf7ec46d,0xbf7ffec4,0xbf7f0e58,0xbf7bf531,0xbf7fb10f,0xbf7fba9e,0xbf7d7474,0xbf78e3d6
.long 0x0,0x0,0x0,0x0,0xbd7b2b74,0xbd83db0a,0xbd8a200a,0xbd9064b4
.long 0xbdfab273,0xbe039502,0xbe09cf86,0xbe1008b7,0xbe3b6ecf,0xbe44b0b9,0xbe4dee60,0xbe57278f
.long 0xbe78cfcc,0xbe827dc0,0xbe888e93,0xbe8e9a22,0xbe9aa086,0xbea21887,0xbea986c4,0xbeb0eacb
.long 0xbeb8442a,0xbec1071e,0xbec9b953,0xbed25a09,0xbed53641,0xbedf28a9,0xbee900b7,0xbef2bd43
.long 0xbef15aea,0xbefc5d27,0xbf039c3d,0xbf08f59b,0xbf064b82,0xbf0c42c9,0xbf121eb0,0xbf17de12
.long 0xbf13682a,0xbf19c200,0xbf1ff6cb,0xbf26050a,0xbf1ff6cb,0xbf269de3,0xbf2d1469,0xbf33587a
.long 0xbf2beb4a,0xbf32c8c9,0xbf396842,0xbf3fc767,0xbf373a23,0xbf3e35c5,0xbf44e3f5,0xbf4b41fa
.long 0xbf41d870,0xbf48d8b3,0xbf4f7a1f,0xbf55b993,0xbf4bbbf8,0xbf52a649,0xbf591e6a,0xbf5f20db
.long 0xbf54db31,0xbf5b941a,0xbf61c598,0xbf676bd8,0xbf5d2d53,0xbf6398ac,0xbf696591,0xbf6e8ff8
.long 0xbf64aa59,0xbf6aab7b,0xbf6ff573,0xbf748422,0xbf6b4b0c,0xbf70c501,0xbf756d97,0xbf7940c0
.long 0xbf710908,0xbf75dec6,0xbf79c79d,0xbf7cbfc9,0xbf75dec6,0xbf79f35e,0xbf7cfe73,0xbf7efcc9
.long 0xbf79c79d,0xbf7cfe73,0xbf7f0e58,0xbf7ff4e6,0xbf7cbfc9,0xbf7efcc9,0xbf7ff4e6,0xbf7fa6e3
.long 0xbf7ec46d,0xbf7fec43,0xbf7fb10f,0xbf7e1324,0xbf7fd397,0xbf7fcbe2,0xbf7e4323,0xbf7b3bab
.long 0xbf7fec43,0xbf7e9bc9,0xbf7baccd,0xbf772417,0xbf7f0e58,0xbf7c5d3a,0xbf77f110,0xbf71d19f
.long 0xbf7d3aac,0xbf791298,0xbf731447,0xbf6b4b0c,0xbf7a7302,0xbf74bf62,0xbf6d1c1d,0xbf6398ac
.long 0xbf76ba07,0xbf6f6830,0xbf660f88,0xbf5ac450,0xbf721352,0xbf6912ae,0xbf5df6be,0xbf50d937
.long 0x0,0x0,0x0,0x0,0xbd96a905,0xbd9cecf9,0xbda3308c,0xbda973ba
.long 0xbe164083,0xbe1c76de,0xbe22abb6,0xbe28defc,0xbe605c13,0xbe698bba,0xbe72b651,0xbe7bdba4
.long 0xbe94a031,0xbe9aa086,0xbea09ae5,0xbea68f12,0xbeb8442a,0xbebf926f,0xbec6d529,0xbece0bea
.long 0xbedae880,0xbee363fa,0xbeebcbbb,0xbef41f07,0xbefc5d27,0xbf02ef9f,0xbf07a136,0xbf0c42c9
.long 0xbf0e39da,0xbf13682a,0xbf187fc0,0xbf1d7fd1,0xbf1d7fd1,0xbf2302d3,0xbf286605,0xbf2da859
.long 0xbf2beb4a,0xbf31a81d,0xbf373a23,0xbf3ca003,0xbf396842,0xbf3f41fc,0xbf44e3f5,0xbf4a4c87
.long 0xbf45e403,0xbf4bbbf8,0xbf514d3d,0xbf5695e5,0xbf514d3d,0xbf570348,0xbf5c61c7,0xbf61668a
.long 0xbf5b941a,0xbf6106f2,0xbf660f88,0xbf6aab7b,0xbf64aa59,0xbf69b7e4,0xbf6e46be,0xbf725470
.long 0xbf6c835e,0xbf710908,0xbf74fa0b,0xbf7853f8,0xbf731447,0xbf76ef5b,0xbf7a1e84,0xbf7c9f8a
.long 0xbf7853f8,0xbf7b61fc,0xbf7dabcc,0xbf7f2f9d,0xbf7c3b28,0xbf7e5a38,0xbf7f9c18,0xbf7fffb1
.long 0xbf7ec46d,0xbf7fd397,0xbf7fec43,0xbf7f0e58,0xbf7fec43,0xbf7fcbe2,0xbf7e9bc9,0xbf7c5d3a
.long 0xbf7fb10f,0xbf7e4323,0xbf7baccd,0xbf77f110,0xbf7e1324,0xbf7b3bab,0xbf772417,0xbf71d19f
.long 0xbf7b14be,0xbf76ba07,0xbf710908,0xbf6a09a7,0xbf76ba07,0xbf70c501,0xbf696591,0xbf60a6cf
.long 0xbf710908,0xbf696591,0xbf604621,0xbf55b993,0xbf6a09a7,0xbf60a6cf,0xbf55b993,0xbf495521
.long 0xbf61c598,0xbf5695e5,0xbf49d112,0xbf3b8f3b,0xbf584853,0xbf4b41fa,0xbf3ca003,0xbf2c800f
.long 0xbf4d9f02,0xbf3ebc1b,0xbf2e3bde,0xbf1c420c,0xbf41d870,0xbf311722,0xbf1ebc12,0xbf0af1b7
.long 0x0,0x0,0x0,0x0,0xbdafb680,0xbdb5f8da,0xbdbc3ac3,0xbdc27c39
.long 0xbe2f10a2,0xbe354098,0xbe3b6ecf,0xbe419b37,0xbe827dc0,0xbe870ada,0xbe8b9507,0xbe901c2c
.long 0xbeac7cd4,0xbeb263ef,0xbeb8442a,0xbebe1d4a,0xbed53641,0xbedc53c1,0xbee363fa,0xbeea6681
.long 0xbefc5d27,0xbf0242b1,0xbf064b82,0xbf0a48ad,0xbf10d3cd,0xbf1553b7,0xbf19c200,0xbf1e1e22
.long 0xbf226799,0xbf273656,0xbf2beb4a,0xbf3085bb,0xbf32c8c9,0xbf37c655,0xbf3ca003,0xbf4154e1
.long 0xbf41d870,0xbf46e22a,0xbf4bbbf8,0xbf5064af,0xbf4f7a1f,0xbf546b3b,0xbf591e6a,0xbf5d924d
.long 0xbf5b941a,0xbf604621,0xbf64aa59,0xbf68bf3c,0xbf660f88,0xbf6a5ad9,0xbf6e46be,0xbf71d19f
.long 0xbf6ed89e,0xbf7294f8,0xbf75dec6,0xbf78b47b,0xbf75dec6,0xbf78e3d6,0xbf7b61fc,0xbf7d57de
.long 0xbf7b14be,0xbf7d3aac,0xbf7ec46d,0xbf7fb10f,0xbf7e70b0,0xbf7f90b1,0xbf7ffec4,0xbf7fba9e
.long 0xbf7fec43,0xbf7fe129,0xbf7f0e58,0xbf7d7474,0xbf7f84ab,0xbf7e2b72,0xbf7bf531,0xbf78e3d6
.long 0xbf7d3aac,0xbf7a7302,0xbf76ba07,0xbf721352,0xbf791298,0xbf74bf62,0xbf6f6830,0xbf6912ae
.long 0xbf731447,0xbf6d1c1d,0xbf660f88,0xbf5df6be,0xbf6b4b0c,0xbf6398ac,0xbf5ac450,0xbf50d937
.long 0xbf61c598,0xbf584853,0xbf4d9f02,0xbf41d870,0xbf5695e5,0xbf4b41fa,0xbf3ebc1b,0xbf311722
.long 0xbf49d112,0xbf3ca003,0xbf2e3bde,0xbf1ebc12,0xbf3b8f3b,0xbf2c800f,0xbf1c420c,0xbf0af1b7
.long 0xbf2beb4a,0xbf1b02c6,0xbf08f59b,0xbeebcbbb,0xbf1b02c6,0xbf084b92,0xbee900b7,0xbebf926f
.long 0xbf08f59b,0xbee900b7,0xbebe1d4a,0xbe919ddd,0xbeebcbbb,0xbebf926f,0xbe919ddd,0xbe44b0b9
.size tab_f2, 51200
.section .rodata,"a"
.p2align 8
.type tab_f3,@object
tab_f3:
.long 0x3f80,0x3f80,0x3f80,0x3f80,0x3f80,0xbe483f7b,0xbec43f6d,0xbf0e3f55
.long 0x3f80,0xbec43f6d,0xbf353f35,0xbf6d3ec4,0x3f80,0xbf0e3f55,0xbf6d3ec4,0xbf7bbe48
.long 0x3f80,0xbf353f35,0xbf80248d,0xbf35bf35,0x3f80,0xbf553f0e,0xbf6dbec4,0xbe48bf7b
.long 0x3f80,0xbf6d3ec4,0xbf35bf35,0x3ec4bf6d,0x3f80,0xbf7b3e48,0xbec4bf6d,0x3f55bf0e
.long 0x3f80,0xbf80248d,0xa50dbf80,0x3f80a554,0x3f80,0xbf7bbe48,0x3ec4bf6d,0x3f553f0e
.long 0x3f80,0xbf6dbec4,0x3f35bf35,0x3ec43f6d,0x3f80,0xbf55bf0e,0x3f6dbec4,0xbe483f7b
.long 0x3f80,0xbf35bf35,0x3f80a554,0xbf353f35,0x3f80,0xbf0ebf55,0x3f6d3ec4,0xbf7b3e48
.long 0x3f80,0xbec4bf6d,0x3f353f35,0xbf6dbec4,0x3f80,0xbe48bf7b,0x3ec43f6d,0xbf0ebf55
.long 0x3f80,0xa50dbf80,0x3f80,0xa50dbf80,0x3f80,0x3e48bf7b,0xbec43f6d,0x3f0ebf55
.long 0x3f80,0x3ec4bf6d,0xbf353f35,0x3f6dbec4,0x3f80,0x3f0ebf55,0xbf6d3ec4,0x3f7b3e48
.long 0x3f80,0x3f35bf35,0xbf80248d,0x3f353f35,0x3f80,0x3f55bf0e,0xbf6dbec4,0x3e483f7b
.long 0x3f80,0x3f6dbec4,0xbf35bf35,0xbec43f6d,0x3f80,0x3f7bbe48,0xbec4bf6d,0xbf553f0e
.long 0x3f80,0x3f80a554,0xa50dbf80,0xbf80248d,0x3f80,0x3f7b3e48,0x3ec4bf6d,0xbf55bf0e
.long 0x3f80,0x3f6d3ec4,0x3f35bf35,0xbec4bf6d,0x3f80,0x3f553f0e,0x3f6dbec4,0x3e48bf7b
.long 0x3f80,0x3f353f35,0x3f80a554,0x3f35bf35,0x3f80,0x3f0e3f55,0x3f6d3ec4,0x3f7bbe48
.long 0x3f80,0x3ec43f6d,0x3f353f35,0x3f6d3ec4,0x3f80,0x3e483f7b,0x3ec43f6d,0x3f0e3f55
.long 0x3f80,0x3f80,0x3f80,0x3f80,0xbf353f35,0xbf553f0e,0xbf6d3ec4,0xbf7b3e48
.long 0xbf80248d,0xbf6dbec4,0xbf35bf35,0xbec4bf6d,0xbf35bf35,0xbe48bf7b,0x3ec4bf6d,0x3f55bf0e
.long 0xa50dbf80,0x3f35bf35,0x3f80a554,0x3f353f35,0x3f35bf35,0x3f7b3e48,0x3ec43f6d,0xbf0e3f55
.long 0x3f80a554,0x3ec43f6d,0xbf353f35,0xbf6dbec4,0x3f353f35,0xbf0e3f55,0xbf6dbec4,0x3e48bf7b
.long 0x3f80,0xbf80248d,0xa50dbf80,0x3f80a554,0xbf353f35,0xbf0ebf55,0x3f6dbec4,0x3e483f7b
.long 0xbf80248d,0x3ec4bf6d,0x3f353f35,0xbf6d3ec4,0xbf35bf35,0x3f7bbe48,0xbec43f6d,0xbf0ebf55
.long 0xa50dbf80,0x3f353f35,0xbf80248d,0x3f35bf35,0x3f35bf35,0xbe483f7b,0xbec4bf6d,0x3f553f0e
.long 0x3f80a554,0xbf6d3ec4,0x3f35bf35,0xbec43f6d,0x3f353f35,0xbf55bf0e,0x3f6d3ec4,0xbf7bbe48
.long 0x3f80,0xa50dbf80,0x3f80,0xa50dbf80,0xbf353f35,0x3f55bf0e,0xbf6d3ec4,0x3f7bbe48
.long 0xbf80248d,0x3f6d3ec4,0xbf35bf35,0x3ec43f6d,0xbf35bf35,0x3e483f7b,0x3ec4bf6d,0xbf553f0e
.long 0xa50dbf80,0xbf353f35,0x3f80a554,0xbf35bf35,0x3f35bf35,0xbf7bbe48,0x3ec43f6d,0x3f0ebf55
.long 0x3f80a554,0xbec4bf6d,0xbf353f35,0x3f6d3ec4,0x3f353f35,0x3f0ebf55,0xbf6dbec4,0xbe483f7b
.long 0x3f80,0x3f80a554,0xa50dbf80,0xbf80248d,0xbf353f35,0x3f0e3f55,0x3f6dbec4,0xbe48bf7b
.long 0xbf80248d,0xbec43f6d,0x3f353f35,0x3f6dbec4,0xbf35bf35,0xbf7b3e48,0xbec43f6d,0x3f0e3f55
.long 0xa50dbf80,0xbf35bf35,0xbf80248d,0xbf353f35,0x3f35bf35,0x3e48bf7b,0xbec4bf6d,0xbf55bf0e
.long 0x3f80a554,0x3f6dbec4,0x3f35bf35,0x3ec4bf6d,0x3f353f35,0x3f553f0e,0x3f6d3ec4,0x3f7b3e48
.long 0x3f80,0x3f80,0x3f80,0x3f80,0xbf80248d,0xbf7bbe48,0xbf6dbec4,0xbf55bf0e
.long 0xa50dbf80,0x3ec4bf6d,0x3f35bf35,0x3f6dbec4,0x3f80a554,0x3f553f0e,0x3ec43f6d,0xbe483f7b
.long 0x3f80,0xbf353f35,0xbf80248d,0xbf35bf35,0xbf80248d,0xbf0ebf55,0x3ec4bf6d,0x3f7bbe48
.long 0xa50dbf80,0x3f6dbec4,0x3f353f35,0xbec43f6d,0x3f80a554,0x3e483f7b,0xbf6d3ec4,0xbf0ebf55
.long 0x3f80,0xbf80248d,0xa50dbf80,0x3f80a554,0xbf80248d,0x3e48bf7b,0x3f6d3ec4,0xbf0e3f55
.long 0xa50dbf80,0x3f6d3ec4,0xbf353f35,0xbec4bf6d,0x3f80a554,0xbf0e3f55,0xbec4bf6d,0x3f7b3e48
.long 0x3f80,0xbf35bf35,0x3f80a554,0xbf353f35,0xbf80248d,0x3f55bf0e,0xbec43f6d,0xbe48bf7b
.long 0xa50dbf80,0x3ec43f6d,0xbf35bf35,0x3f6d3ec4,0x3f80a554,0xbf7b3e48,0x3f6dbec4,0xbf553f0e
.long 0x3f80,0xa50dbf80,0x3f80,0xa50dbf80,0xbf80248d,0x3f7b3e48,0xbf6dbec4,0x3f553f0e
.long 0xa50dbf80,0xbec43f6d,0x3f35bf35,0xbf6d3ec4,0x3f80a554,0xbf55bf0e,0x3ec43f6d,0x3e48bf7b
.long 0x3f80,0x3f35bf35,0xbf80248d,0x3f353f35,0xbf80248d,0x3f0e3f55,0x3ec4bf6d,0xbf7b3e48
.long 0xa50dbf80,0xbf6d3ec4,0x3f353f35,0x3ec4bf6d,0x3f80a554,0xbe48bf7b,0xbf6d3ec4,0x3f0e3f55
.long 0x3f80,0x3f80a554,0xa50dbf80,0xbf80248d,0xbf80248d,0xbe483f7b,0x3f6d3ec4,0x3f0ebf55
.long 0xa50dbf80,0xbf6dbec4,0xbf353f35,0x3ec43f6d,0x3f80a554,0x3f0ebf55,0xbec4bf6d,0xbf7bbe48
.long 0x3f80,0x3f353f35,0x3f80a554,0x3f35bf35,0xbf80248d,0xbf553f0e,0xbec43f6d,0x3e483f7b
.long 0xa50dbf80,0xbec4bf6d,0xbf35bf35,0xbf6dbec4,0x3f80a554,0x3f7bbe48,0x3f6dbec4,0x3f55bf0e
.long 0x3f80,0x3f80,0x3f80,0x3f80,0xbf35bf35,0xbf0ebf55,0xbec4bf6d,0xbe48bf7b
.long 0x3f80a554,0x3f6d3ec4,0x3f353f35,0x3ec43f6d,0xbf353f35,0xbf7b3e48,0xbf6dbec4,0xbf0ebf55
.long 0xa50dbf80,0x3f35bf35,0x3f80a554,0x3f353f35,0x3f353f35,0xbe483f7b,0xbf6d3ec4,0xbf55bf0e
.long 0xbf80248d,0xbec4bf6d,0x3f35bf35,0x3f6d3ec4,0x3f35bf35,0x3f553f0e,0xbec43f6d,0xbf7bbe48
.long 0x3f80,0xbf80248d,0xa50dbf80,0x3f80a554,0xbf35bf35,0x3f55bf0e,0x3ec43f6d,0xbf7b3e48
.long 0x3f80a554,0xbec43f6d,0xbf35bf35,0x3f6dbec4,0xbf353f35,0xbe48bf7b,0x3f6d3ec4,0xbf553f0e
.long 0xa50dbf80,0x3f353f35,0xbf80248d,0x3f35bf35,0x3f353f35,0xbf7bbe48,0x3f6dbec4,0xbf0e3f55
.long 0xbf80248d,0x3f6dbec4,0xbf353f35,0x3ec4bf6d,0x3f35bf35,0xbf0e3f55,0x3ec4bf6d,0xbe483f7b
.long 0x3f80,0xa50dbf80,0x3f80,0xa50dbf80,0xbf35bf35,0x3f0e3f55,0xbec4bf6d,0x3e483f7b
.long 0x3f80a554,0xbf6dbec4,0x3f353f35,0xbec4bf6d,0xbf353f35,0x3f7bbe48,0xbf6dbec4,0x3f0e3f55
.long 0xa50dbf80,0xbf353f35,0x3f80a554,0xbf35bf35,0x3f353f35,0x3e48bf7b,0xbf6d3ec4,0x3f553f0e
.long 0xbf80248d,0x3ec43f6d,0x3f35bf35,0xbf6dbec4,0x3f35bf35,0xbf55bf0e,0xbec43f6d,0x3f7b3e48
.long 0x3f80,0x3f80a554,0xa50dbf80,0xbf80248d,0xbf35bf35,0xbf553f0e,0x3ec43f6d,0x3f7bbe48
.long 0x3f80a554,0x3ec4bf6d,0xbf35bf35,0xbf6d3ec4,0xbf353f35,0x3e483f7b,0x3f6d3ec4,0x3f55bf0e
.long 0xa50dbf80,0xbf35bf35,0xbf80248d,0xbf353f35,0x3f353f35,0x3f7b3e48,0x3f6dbec4,0x3f0ebf55
.long 0xbf80248d,0xbf6d3ec4,0xbf353f35,0xbec43f6d,0x3f35bf35,0x3f0ebf55,0x3ec4bf6d,0x3e48bf7b
.long 0x3f808000,0x3f808000,0x3f808000,0x3f808000,0x3f808000,0x3f7b3e48,0x3f6d3ec4,0x3f553f0e
.long 0x3f808000,0x3f6d3ec4,0x3f353f35,0x3ec43f6d,0x3f808000,0x3f553f0e,0x3ec43f6d,0xbe483f7b
.long 0x3f808000,0x3f353f35,0x248d3f80,0xbf353f35,0x3f808000,0x3f0e3f55,0xbec43f6d,0xbf7b3e48
.long 0x3f808000,0x3ec43f6d,0xbf353f35,0xbf6dbec4,0x3f808000,0x3e483f7b,0xbf6d3ec4,0xbf0ebf55
.long 0x3f808000,0x248d3f80,0xbf80250d,0xa554bf80,0x3f808000,0xbe483f7b,0xbf6dbec4,0x3f0ebf55
.long 0x3f808000,0xbec43f6d,0xbf35bf35,0x3f6dbec4,0x3f808000,0xbf0e3f55,0xbec4bf6d,0x3f7b3e48
.long 0x3f808000,0xbf353f35,0xa554bf80,0x3f353f35,0x3f808000,0xbf553f0e,0x3ec4bf6d,0x3e483f7b
.long 0x3f808000,0xbf6d3ec4,0x3f35bf35,0xbec43f6d,0x3f808000,0xbf7b3e48,0x3f6dbec4,0xbf553f0e
.long 0x3f808000,0xbf80250d,0x3f808000,0xbf80250d,0x3f808000,0xbf7bbe48,0x3f6d3ec4,0xbf55bf0e
.long 0x3f808000,0xbf6dbec4,0x3f353f35,0xbec4bf6d,0x3f808000,0xbf55bf0e,0x3ec43f6d,0x3e48bf7b
.long 0x3f808000,0xbf35bf35,0x248d3f80,0x3f35bf35,0x3f808000,0xbf0ebf55,0xbec43f6d,0x3f7bbe48
.long 0x3f808000,0xbec4bf6d,0xbf353f35,0x3f6d3ec4,0x3f808000,0xbe48bf7b,0xbf6d3ec4,0x3f0e3f55
.long 0x3f808000,0xa554bf80,0xbf80250d,0x248d3f80,0x3f808000,0x3e48bf7b,0xbf6dbec4,0xbf0e3f55
.long 0x3f808000,0x3ec4bf6d,0xbf35bf35,0xbf6d3ec4,0x3f808000,0x3f0ebf55,0xbec4bf6d,0xbf7bbe48
.long 0x3f808000,0x3f35bf35,0xa554bf80,0xbf35bf35,0x3f808000,0x3f55bf0e,0x3ec4bf6d,0xbe48bf7b
.long 0x3f808000,0x3f6dbec4,0x3f35bf35,0x3ec4bf6d,0x3f808000,0x3f7bbe48,0x3f6dbec4,0x3f55bf0e
.long 0x3f808000,0x3f808000,0x3f808000,0x3f808000,0x3f353f35,0x3f0e3f55,0x3ec43f6d,0x3e483f7b
.long 0x248d3f80,0xbec43f6d,0xbf353f35,0xbf6d3ec4,0xbf353f35,0xbf7b3e48,0xbf6dbec4,0xbf0ebf55
.long 0xbf80250d,0xbf35bf35,0xa554bf80,0x3f35bf35,0xbf35bf35,0x3e48bf7b,0x3f6dbec4,0x3f553f0e
.long 0xa554bf80,0x3f6dbec4,0x3f353f35,0xbec43f6d,0x3f35bf35,0x3f553f0e,0xbec43f6d,0xbf7bbe48
.long 0x3f808000,0x248d3f80,0xbf80250d,0xa554bf80,0x3f353f35,0xbf553f0e,0xbec4bf6d,0x3f7bbe48
.long 0x248d3f80,0xbf6dbec4,0x3f35bf35,0x3ec43f6d,0xbf353f35,0xbe48bf7b,0x3f6d3ec4,0xbf553f0e
.long 0xbf80250d,0x3f35bf35,0x248d3f80,0xbf35bf35,0xbf35bf35,0x3f7b3e48,0xbf6d3ec4,0x3f0ebf55
.long 0xa554bf80,0x3ec43f6d,0xbf35bf35,0x3f6d3ec4,0x3f35bf35,0xbf0e3f55,0x3ec4bf6d,0xbe483f7b
.long 0x3f808000,0xbf80250d,0x3f808000,0xbf80250d,0x3f353f35,0xbf0ebf55,0x3ec43f6d,0xbe48bf7b
.long 0x248d3f80,0x3ec4bf6d,0xbf353f35,0x3f6dbec4,0xbf353f35,0x3f7bbe48,0xbf6dbec4,0x3f0e3f55
.long 0xbf80250d,0x3f353f35,0xa554bf80,0xbf353f35,0xbf35bf35,0xbe483f7b,0x3f6dbec4,0xbf55bf0e
.long 0xa554bf80,0xbf6d3ec4,0x3f353f35,0x3ec4bf6d,0x3f35bf35,0xbf55bf0e,0xbec43f6d,0x3f7b3e48
.long 0x3f808000,0xa554bf80,0xbf80250d,0x248d3f80,0x3f353f35,0x3f55bf0e,0xbec4bf6d,0xbf7b3e48
.long 0x248d3f80,0x3f6d3ec4,0x3f35bf35,0xbec4bf6d,0xbf353f35,0x3e483f7b,0x3f6d3ec4,0x3f55bf0e
.long 0xbf80250d,0xbf353f35,0x248d3f80,0x3f353f35,0xbf35bf35,0xbf7bbe48,0xbf6d3ec4,0xbf0e3f55
.long 0xa554bf80,0xbec4bf6d,0xbf35bf35,0xbf6dbec4,0x3f35bf35,0x3f0ebf55,0x3ec4bf6d,0x3e48bf7b
.long 0x3f808000,0x3f808000,0x3f808000,0x3f808000,0x248d3f80,0xbe483f7b,0xbec43f6d,0xbf0e3f55
.long 0xbf80250d,0xbf6dbec4,0xbf35bf35,0xbec4bf6d,0xa554bf80,0x3f0ebf55,0x3f6dbec4,0x3f7b3e48
.long 0x3f808000,0x3f353f35,0x248d3f80,0xbf353f35,0x248d3f80,0xbf553f0e,0xbf6dbec4,0xbe48bf7b
.long 0xbf80250d,0xbec4bf6d,0x3f35bf35,0x3f6d3ec4,0xa554bf80,0x3f7bbe48,0x3ec43f6d,0xbf553f0e
.long 0x3f808000,0x248d3f80,0xbf80250d,0xa554bf80,0x248d3f80,0xbf7bbe48,0x3ec4bf6d,0x3f553f0e
.long 0xbf80250d,0x3ec4bf6d,0x3f353f35,0xbf6d3ec4,0xa554bf80,0x3f553f0e,0xbf6d3ec4,0x3e48bf7b
.long 0x3f808000,0xbf353f35,0xa554bf80,0x3f353f35,0x248d3f80,0xbf0ebf55,0x3f6d3ec4,0xbf7b3e48
.long 0xbf80250d,0x3f6dbec4,0xbf353f35,0x3ec4bf6d,0xa554bf80,0x3e483f7b,0xbec4bf6d,0x3f0e3f55
.long 0x3f808000,0xbf80250d,0x3f808000,0xbf80250d,0x248d3f80,0x3e48bf7b,0xbec43f6d,0x3f0ebf55
.long 0xbf80250d,0x3f6d3ec4,0xbf35bf35,0x3ec43f6d,0xa554bf80,0xbf0e3f55,0x3f6dbec4,0xbf7bbe48
.long 0x3f808000,0xbf35bf35,0x248d3f80,0x3f35bf35,0x248d3f80,0x3f55bf0e,0xbf6dbec4,0x3e483f7b
.long 0xbf80250d,0x3ec43f6d,0x3f35bf35,0xbf6dbec4,0xa554bf80,0xbf7b3e48,0x3ec43f6d,0x3f55bf0e
.long 0x3f808000,0xa554bf80,0xbf80250d,0x248d3f80,0x248d3f80,0x3f7b3e48,0x3ec4bf6d,0xbf55bf0e
.long 0xbf80250d,0xbec43f6d,0x3f353f35,0x3f6dbec4,0xa554bf80,0xbf55bf0e,0xbf6d3ec4,0xbe483f7b
.long 0x3f808000,0x3f35bf35,0xa554bf80,0xbf35bf35,0x248d3f80,0x3f0e3f55,0x3f6d3ec4,0x3f7bbe48
.long 0xbf80250d,0xbf6d3ec4,0xbf353f35,0xbec43f6d,0xa554bf80,0xbe48bf7b,0xbec4bf6d,0xbf0ebf55
.long 0x3f808000,0x3f808000,0x3f808000,0x3f808000,0xbf353f35,0xbf553f0e,0xbf6d3ec4,0xbf7b3e48
.long 0xa554bf80,0x3ec4bf6d,0x3f35bf35,0x3f6dbec4,0x3f353f35,0x3e483f7b,0xbec43f6d,0xbf553f0e
.long 0xbf80250d,0xbf35bf35,0xa554bf80,0x3f35bf35,0x3f35bf35,0x3f7b3e48,0x3ec43f6d,0xbf0e3f55
.long 0x248d3f80,0xbf6d3ec4,0xbf35bf35,0x3ec4bf6d,0xbf35bf35,0x3f0ebf55,0x3f6d3ec4,0xbe483f7b
.long 0x3f808000,0x248d3f80,0xbf80250d,0xa554bf80,0xbf353f35,0xbf0ebf55,0x3f6dbec4,0x3e483f7b
.long 0xa554bf80,0x3f6d3ec4,0xbf353f35,0xbec4bf6d,0x3f353f35,0xbf7b3e48,0x3ec4bf6d,0x3f0e3f55
.long 0xbf80250d,0x3f35bf35,0x248d3f80,0xbf35bf35,0x3f35bf35,0xbe483f7b,0xbec4bf6d,0x3f553f0e
.long 0x248d3f80,0xbec4bf6d,0x3f353f35,0xbf6dbec4,0xbf35bf35,0x3f553f0e,0xbf6dbec4,0x3f7b3e48
.long 0x3f808000,0xbf80250d,0x3f808000,0xbf80250d,0xbf353f35,0x3f55bf0e,0xbf6d3ec4,0x3f7bbe48
.long 0xa554bf80,0xbec43f6d,0x3f35bf35,0xbf6d3ec4,0x3f353f35,0xbe48bf7b,0xbec43f6d,0x3f55bf0e
.long 0xbf80250d,0x3f353f35,0xa554bf80,0xbf353f35,0x3f35bf35,0xbf7bbe48,0x3ec43f6d,0x3f0ebf55
.long 0x248d3f80,0x3f6dbec4,0xbf35bf35,0xbec43f6d,0xbf35bf35,0xbf0e3f55,0x3f6d3ec4,0x3e48bf7b
.long 0x3f808000,0xa554bf80,0xbf80250d,0x248d3f80,0xbf353f35,0x3f0e3f55,0x3f6dbec4,0xbe48bf7b
.long 0xa554bf80,0xbf6dbec4,0xbf353f35,0x3ec43f6d,0x3f353f35,0x3f7bbe48,0x3ec4bf6d,0xbf0ebf55
.long 0xbf80250d,0xbf353f35,0x248d3f80,0x3f353f35,0x3f35bf35,0x3e48bf7b,0xbec4bf6d,0xbf55bf0e
.long 0x248d3f80,0x3ec43f6d,0x3f353f35,0x3f6d3ec4,0xbf35bf35,0xbf55bf0e,0xbf6dbec4,0xbf7bbe48
.long 0x35803580,0x35803580,0x35803580,0x35803580,0x357b3580,0x3555356d,0xb4481a8d,0xb50eb4c4
.long 0x356d3580,0x34c43535,0xb56db580,0xb4c4b535,0x35553580,0xb44834c4,0x350e9b54,0x357b356d
.long 0x35353580,0xb5351a8d,0x35353580,0xb5351a8d,0x350e3580,0xb57bb4c4,0xb5551a8d,0xb448b56d
.long 0x34c43580,0xb56db535,0xb4c4b580,0x356d3535,0x34483580,0xb50eb56d,0x357b9b54,0xb55534c4
.long 0x1a8d3580,0x9b54b580,0x1a8d3580,0x9b54b580,0xb4483580,0x350eb56d,0xb57b1a8d,0x355534c4
.long 0xb4c43580,0x356db535,0x34c4b580,0xb56d3535,0xb50e3580,0x357bb4c4,0x35559b54,0x3448b56d
.long 0xb5353580,0x35359b54,0xb5353580,0x35359b54,0xb5553580,0x344834c4,0xb50e1a8d,0xb57b356d
.long 0xb56d3580,0xb4c43535,0x356db580,0x34c4b535,0xb57b3580,0xb555356d,0x34489b54,0x350eb4c4
.long 0xb5803580,0xb5803580,0xb5803580,0xb5803580,0xb57b3580,0xb555356d,0x34481a8d,0x350eb4c4
.long 0xb56d3580,0xb4c43535,0x356db580,0x34c4b535,0xb5553580,0x344834c4,0xb50e9b54,0xb57b356d
.long 0xb5353580,0x35351a8d,0xb5353580,0x35351a8d,0xb50e3580,0x357bb4c4,0x35551a8d,0x3448b56d
.long 0xb4c43580,0x356db535,0x34c4b580,0xb56d3535,0xb4483580,0x350eb56d,0xb57b9b54,0x355534c4
.long 0x9b543580,0x1a8db580,0x9b543580,0x1a8db580,0x34483580,0xb50eb56d,0x357b1a8d,0xb55534c4
.long 0x34c43580,0xb56db535,0xb4c4b580,0x356d3535,0x350e3580,0xb57bb4c4,0xb5559b54,0xb448b56d
.long 0x35353580,0xb5359b54,0x35353580,0xb5359b54,0x35553580,0xb44834c4,0x350e1a8d,0x357b356d
.long 0x356d3580,0x34c43535,0xb56db580,0xb4c4b535,0x357b3580,0x3555356d,0xb4489b54,0xb50eb4c4
.long 0x35803580,0x35803580,0x35803580,0x35803580,0x350e3535,0x344834c4,0xb555b535,0xb57bb56d
.long 0xb4c41a8d,0xb56db535,0x34c49b54,0x356d3535,0xb57bb535,0xb50eb56d,0x34483535,0xb555b4c4
.long 0xb535b580,0x35359b54,0xb535b580,0x35359b54,0x3448b535,0x3555356d,0x357b3535,0xb50e34c4
.long 0x356d9b54,0xb4c43535,0xb56d1a8d,0x34c4b535,0x35553535,0xb57bb4c4,0x350eb535,0xb448356d
.long 0x1a8d3580,0x9b54b580,0x1a8d3580,0x9b54b580,0xb5553535,0x357bb4c4,0xb50eb535,0x3448356d
.long 0xb56d1a8d,0x34c43535,0x356d9b54,0xb4c4b535,0xb448b535,0xb555356d,0xb57b3535,0x350e34c4
.long 0x3535b580,0xb5351a8d,0x3535b580,0xb5351a8d,0x357bb535,0x350eb56d,0xb4483535,0x3555b4c4
.long 0x34c49b54,0x356db535,0xb4c41a8d,0xb56d3535,0xb50e3535,0xb44834c4,0x3555b535,0x357bb56d
.long 0xb5803580,0xb5803580,0xb5803580,0xb5803580,0xb50e3535,0xb44834c4,0x3555b535,0x357bb56d
.long 0x34c41a8d,0x356db535,0xb4c49b54,0xb56d3535,0x357bb535,0x350eb56d,0xb4483535,0x3555b4c4
.long 0x3535b580,0xb5359b54,0x3535b580,0xb5359b54,0xb448b535,0xb555356d,0xb57b3535,0x350e34c4
.long 0xb56d9b54,0x34c43535,0x356d1a8d,0xb4c4b535,0xb5553535,0x357bb4c4,0xb50eb535,0x3448356d
.long 0x9b543580,0x1a8db580,0x9b543580,0x1a8db580,0x35553535,0xb57bb4c4,0x350eb535,0xb448356d
.long 0x356d1a8d,0xb4c43535,0xb56d9b54,0x34c4b535,0x3448b535,0x3555356d,0x357b3535,0xb50e34c4
.long 0xb535b580,0x35351a8d,0xb535b580,0x35351a8d,0xb57bb535,0xb50eb56d,0x34483535,0xb555b4c4
.long 0xb4c49b54,0xb56db535,0x34c41a8d,0x356d3535,0x350e3535,0x344834c4,0xb555b535,0xb57bb56d
.long 0x35803580,0x35803580,0x35803580,0x35803580,0xb57bb580,0xb555b56d,0x34489b54,0x350e34c4
.long 0x356d3580,0x34c43535,0xb56db580,0xb4c4b535,0xb555b580,0x3448b4c4,0xb50e1a8d,0xb57bb56d
.long 0x35353580,0xb5351a8d,0x35353580,0xb5351a8d,0xb50eb580,0x357b34c4,0x35559b54,0x3448356d
.long 0x34c43580,0xb56db535,0xb4c4b580,0x356d3535,0xb448b580,0x350e356d,0xb57b1a8d,0x3555b4c4
.long 0x1a8d3580,0x9b54b580,0x1a8d3580,0x9b54b580,0x3448b580,0xb50e356d,0x357b9b54,0xb555b4c4
.long 0xb4c43580,0x356db535,0x34c4b580,0xb56d3535,0x350eb580,0xb57b34c4,0xb5551a8d,0xb448356d
.long 0xb5353580,0x35359b54,0xb5353580,0x35359b54,0x3555b580,0xb448b4c4,0x350e9b54,0x357bb56d
.long 0xb56d3580,0xb4c43535,0x356db580,0x34c4b535,0x357bb580,0x3555b56d,0xb4481a8d,0xb50e34c4
.long 0xb5803580,0xb5803580,0xb5803580,0xb5803580,0x357bb580,0x3555b56d,0xb4489b54,0xb50e34c4
.long 0xb56d3580,0xb4c43535,0x356db580,0x34c4b535,0x3555b580,0xb448b4c4,0x350e1a8d,0x357bb56d
.long 0xb5353580,0x35351a8d,0xb5353580,0x35351a8d,0x350eb580,0xb57b34c4,0xb5559b54,0xb448356d
.long 0xb4c43580,0x356db535,0x34c4b580,0xb56d3535,0x3448b580,0xb50e356d,0x357b1a8d,0xb555b4c4
.long 0x9b543580,0x1a8db580,0x9b543580,0x1a8db580,0xb448b580,0x350e356d,0xb57b9b54,0x3555b4c4
.long 0x34c43580,0xb56db535,0xb4c4b580,0x356d3535,0xb50eb580,0x357b34c4,0x35551a8d,0x3448356d
.long 0x35353580,0xb5359b54,0x35353580,0xb5359b54,0xb555b580,0x3448b4c4,0xb50e9b54,0xb57bb56d
.long 0x356d3580,0x34c43535,0xb56db580,0xb4c4b535,0xb57bb580,0xb555b56d,0x34481a8d,0x350e34c4
.long 0x35803580,0x35803580,0x35803580,0x35803580,0xb50eb535,0xb448b4c4,0x35553535,0x357b356d
.long 0xb4c41a8d,0xb56db535,0x34c49b54,0x356d3535,0x357b3535,0x350e356d,0xb448b535,0x355534c4
.long 0xb535b580,0x35359b54,0xb535b580,0x35359b54,0xb4483535,0xb555b56d,0xb57bb535,0x350eb4c4
.long 0x356d9b54,0xb4c43535,0xb56d1a8d,0x34c4b535,0xb555b535,0x357b34c4,0xb50e3535,0x3448b56d
.long 0x1a8d3580,0x9b54b580,0x1a8d3580,0x9b54b580,0x3555b535,0xb57b34c4,0x350e3535,0xb448b56d
.long 0xb56d1a8d,0x34c43535,0x356d9b54,0xb4c4b535,0x34483535,0x3555b56d,0x357bb535,0xb50eb4c4
.long 0x3535b580,0xb5351a8d,0x3535b580,0xb5351a8d,0xb57b3535,0xb50e356d,0x3448b535,0xb55534c4
.long 0x34c49b54,0x356db535,0xb4c41a8d,0xb56d3535,0x350eb535,0x3448b4c4,0xb5553535,0xb57b356d
.long 0xb5803580,0xb5803580,0xb5803580,0xb5803580,0x350eb535,0x3448b4c4,0xb5553535,0xb57b356d
.long 0x34c41a8d,0x356db535,0xb4c49b54,0xb56d3535,0xb57b3535,0xb50e356d,0x3448b535,0xb55534c4
.long 0x3535b580,0xb5359b54,0x3535b580,0xb5359b54,0x34483535,0x3555b56d,0x357bb535,0xb50eb4c4
.long 0xb56d9b54,0x34c43535,0x356d1a8d,0xb4c4b535,0x3555b535,0xb57b34c4,0x350e3535,0xb448b56d
.long 0x9b543580,0x1a8db580,0x9b543580,0x1a8db580,0xb555b535,0x357b34c4,0xb50e3535,0x3448b56d
.long 0x356d1a8d,0xb4c43535,0xb56d9b54,0x34c4b535,0xb4483535,0xb555b56d,0xb57bb535,0x350eb4c4
.long 0xb535b580,0x35351a8d,0xb535b580,0x35351a8d,0x357b3535,0x350e356d,0xb448b535,0x355534c4
.long 0xb4c49b54,0xb56db535,0x34c41a8d,0x356d3535,0xb50eb535,0xb448b4c4,0x35553535,0x357b356d
.long 0x80008000,0x80008000,0x80008000,0x80008000,0xb4488000,0xb50eb4c4,0xb57bb580,0xb555b56d
.long 0xb4c48000,0xb56db535,0x34c49b0d,0x356d3535,0xb50e8000,0xb57bb56d,0x35553580,0xb44834c4
.long 0xb5358000,0xb535b580,0xb5358000,0xb535b580,0xb5558000,0xb448b56d,0xb50eb580,0x357b34c4
.long 0xb56d8000,0x34c4b535,0x356d9b0d,0xb4c43535,0xb57b8000,0x3555b4c4,0x34483580,0xb50eb56d
.long 0xb5808000,0x35809b0d,0xb5808000,0x35809b0d,0xb57b8000,0x355534c4,0x3448b580,0xb50e356d
.long 0xb56d8000,0x34c43535,0x356d9b0d,0xb4c4b535,0xb5558000,0xb448356d,0xb50e3580,0x357bb4c4
.long 0xb5358000,0xb5353580,0xb5358000,0xb5353580,0xb50e8000,0xb57b356d,0x3555b580,0xb448b4c4
.long 0xb4c48000,0xb56d3535,0x34c49b0d,0x356db535,0xb4488000,0xb50e34c4,0xb57b3580,0xb555356d
.long 0x9b0d8000,0x9b0d8000,0x9b0d8000,0x9b0d8000,0x34488000,0x350eb4c4,0x357bb580,0x3555b56d
.long 0x34c48000,0x356db535,0xb4c49b0d,0xb56d3535,0x350e8000,0x357bb56d,0xb5553580,0x344834c4
.long 0x35358000,0x3535b580,0x35358000,0x3535b580,0x35558000,0x3448b56d,0x350eb580,0xb57b34c4
.long 0x356d8000,0xb4c4b535,0xb56d9b0d,0x34c43535,0x357b8000,0xb555b4c4,0xb4483580,0x350eb56d
.long 0x35808000,0xb5809b0d,0x35808000,0xb5809b0d,0x357b8000,0xb55534c4,0xb448b580,0x350e356d
.long 0x356d8000,0xb4c43535,0xb56d9b0d,0x34c4b535,0x35558000,0x3448356d,0x350e3580,0xb57bb4c4
.long 0x35358000,0x35353580,0x35358000,0x35353580,0x350e8000,0x357b356d,0xb555b580,0x3448b4c4
.long 0x34c48000,0x356d3535,0xb4c49b0d,0xb56db535,0x34488000,0x350e34c4,0x357b3580,0x3555356d
.long 0x80008000,0x80008000,0x80008000,0x80008000,0xb555b535,0xb57bb56d,0xb50eb535,0xb448b4c4
.long 0xb56db580,0xb4c4b535,0x356d3580,0x34c43535,0xb448b535,0x355534c4,0xb57bb535,0xb50eb56d
.long 0x35359b0d,0x35353580,0x35359b0d,0x35353580,0x357b3535,0xb50e34c4,0xb4483535,0xb555b56d
.long 0x34c43580,0xb56db535,0xb4c4b580,0x356d3535,0xb50e3535,0x3448b56d,0x35553535,0xb57bb4c4
.long 0xb5808000,0x35809b0d,0xb5808000,0x35809b0d,0xb50eb535,0x3448356d,0x3555b535,0xb57b34c4
.long 0x34c4b580,0xb56d3535,0xb4c43580,0x356db535,0x357bb535,0xb50eb4c4,0xb448b535,0xb555356d
.long 0x35359b0d,0x3535b580,0x35359b0d,0x3535b580,0xb4483535,0x3555b4c4,0xb57b3535,0xb50e356d
.long 0xb56d3580,0xb4c43535,0x356db580,0x34c4b535,0xb5553535,0xb57b356d,0xb50e3535,0xb44834c4
.long 0x9b0d8000,0x9b0d8000,0x9b0d8000,0x9b0d8000,0x3555b535,0x357bb56d,0x350eb535,0x3448b4c4
.long 0x356db580,0x34c4b535,0xb56d3580,0xb4c43535,0x3448b535,0xb55534c4,0x357bb535,0x350eb56d
.long 0xb5359b0d,0xb5353580,0xb5359b0d,0xb5353580,0xb57b3535,0x350e34c4,0x34483535,0x3555b56d
.long 0xb4c43580,0x356db535,0x34c4b580,0xb56d3535,0x350e3535,0xb448b56d,0xb5553535,0x357bb4c4
.long 0x35808000,0xb5809b0d,0x35808000,0xb5809b0d,0x350eb535,0xb448356d,0xb555b535,0x357b34c4
.long 0xb4c4b580,0x356d3535,0x34c43580,0xb56db535,0xb57bb535,0x350eb4c4,0x3448b535,0x3555356d
.long 0xb5359b0d,0xb535b580,0xb5359b0d,0xb535b580,0x34483535,0xb555b4c4,0x357b3535,0x350e356d
.long 0x356d3580,0x34c43535,0xb56db580,0xb4c4b535,0x35553535,0x357b356d,0x350e3535,0x344834c4
.long 0x80008000,0x80008000,0x80008000,0x80008000,0x34489b0d,0x350e34c4,0x357b3580,0x3555356d
.long 0xb4c48000,0xb56db535,0x34c49b0d,0x356d3535,0x350e9b0d,0x357b356d,0xb555b580,0x3448b4c4
.long 0xb5358000,0xb535b580,0xb5358000,0xb535b580,0x35559b0d,0x3448356d,0x350e3580,0xb57bb4c4
.long 0xb56d8000,0x34c4b535,0x356d9b0d,0xb4c43535,0x357b9b0d,0xb55534c4,0xb448b580,0x350e356d
.long 0xb5808000,0x35809b0d,0xb5808000,0x35809b0d,0x357b9b0d,0xb555b4c4,0xb4483580,0x350eb56d
.long 0xb56d8000,0x34c43535,0x356d9b0d,0xb4c4b535,0x35559b0d,0x3448b56d,0x350eb580,0xb57b34c4
.long 0xb5358000,0xb5353580,0xb5358000,0xb5353580,0x350e9b0d,0x357bb56d,0xb5553580,0x344834c4
.long 0xb4c48000,0xb56d3535,0x34c49b0d,0x356db535,0x34489b0d,0x350eb4c4,0x357bb580,0x3555b56d
.long 0x9b0d8000,0x9b0d8000,0x9b0d8000,0x9b0d8000,0xb4489b0d,0xb50e34c4,0xb57b3580,0xb555356d
.long 0x34c48000,0x356db535,0xb4c49b0d,0xb56d3535,0xb50e9b0d,0xb57b356d,0x3555b580,0xb448b4c4
.long 0x35358000,0x3535b580,0x35358000,0x3535b580,0xb5559b0d,0xb448356d,0xb50e3580,0x357bb4c4
.long 0x356d8000,0xb4c4b535,0xb56d9b0d,0x34c43535,0xb57b9b0d,0x355534c4,0x3448b580,0xb50e356d
.long 0x35808000,0xb5809b0d,0x35808000,0xb5809b0d,0xb57b9b0d,0x3555b4c4,0x34483580,0xb50eb56d
.long 0x356d8000,0xb4c43535,0xb56d9b0d,0x34c4b535,0xb5559b0d,0xb448b56d,0xb50eb580,0x357b34c4
.long 0x35358000,0x35353580,0x35358000,0x35353580,0xb50e9b0d,0xb57bb56d,0x35553580,0xb44834c4
.long 0x34c48000,0x356d3535,0xb4c49b0d,0xb56db535,0xb4489b0d,0xb50eb4c4,0xb57bb580,0xb555b56d
.long 0x80008000,0x80008000,0x80008000,0x80008000,0x35553535,0x357b356d,0x350e3535,0x344834c4
.long 0xb56db580,0xb4c4b535,0x356d3580,0x34c43535,0x34483535,0xb555b4c4,0x357b3535,0x350e356d
.long 0x35359b0d,0x35353580,0x35359b0d,0x35353580,0xb57bb535,0x350eb4c4,0x3448b535,0x3555356d
.long 0x34c43580,0xb56db535,0xb4c4b580,0x356d3535,0x350eb535,0xb448356d,0xb555b535,0x357b34c4
.long 0xb5808000,0x35809b0d,0xb5808000,0x35809b0d,0x350e3535,0xb448b56d,0xb5553535,0x357bb4c4
.long 0x34c4b580,0xb56d3535,0xb4c43580,0x356db535,0xb57b3535,0x350e34c4,0x34483535,0x3555b56d
.long 0x35359b0d,0x3535b580,0x35359b0d,0x3535b580,0x3448b535,0xb55534c4,0x357bb535,0x350eb56d
.long 0xb56d3580,0xb4c43535,0x356db580,0x34c4b535,0x3555b535,0x357bb56d,0x350eb535,0x3448b4c4
.long 0x9b0d8000,0x9b0d8000,0x9b0d8000,0x9b0d8000,0xb5553535,0xb57b356d,0xb50e3535,0xb44834c4
.long 0x356db580,0x34c4b535,0xb56d3580,0xb4c43535,0xb4483535,0x3555b4c4,0xb57b3535,0xb50e356d
.long 0xb5359b0d,0xb5353580,0xb5359b0d,0xb5353580,0x357bb535,0xb50eb4c4,0xb448b535,0xb555356d
.long 0xb4c43580,0x356db535,0x34c4b580,0xb56d3535,0xb50eb535,0x3448356d,0x3555b535,0xb57b34c4
.long 0x35808000,0xb5809b0d,0x35808000,0xb5809b0d,0xb50e3535,0x3448b56d,0x35553535,0xb57bb4c4
.long 0xb4c4b580,0x356d3535,0x34c43580,0xb56db535,0x357b3535,0xb50e34c4,0xb4483535,0xb555b56d
.long 0xb5359b0d,0xb535b580,0xb5359b0d,0xb535b580,0xb448b535,0x355534c4,0xb57bb535,0xb50eb56d
.long 0x356d3580,0x34c43535,0xb56db580,0xb4c4b535,0xb555b535,0xb57bb56d,0xb50eb535,0xb448b4c4
.long 0x3f800000,0x3f800000,0x3f800000,0x3f800000,0x3f800000,0x3f7ffec4,0x3f7ffb11,0x3f7ff4e6
.long 0x3f800000,0x3f7ffb11,0x3f7fec43,0x3f7fd397,0x3f800000,0x3f7ff4e6,0x3f7fd397,0x3f7f9c18
.long 0x3f800000,0x3f7fec43,0x3f7fb10f,0x3f7f4e6d,0x3f800000,0x3f7fe129,0x3f7f84ab,0x3f7eea9d
.long 0x3f800000,0x3f7fd397,0x3f7f4e6d,0x3f7e70b0,0x3f800000,0x3f7fc38f,0x3f7f0e58,0x3f7de0b1
.long 0x3f800000,0x3f7fb10f,0x3f7ec46d,0x3f7d3aac,0x3f800000,0x3f7f9c18,0x3f7e70b0,0x3f7c7eb0
.long 0x3f800000,0x3f7f84ab,0x3f7e1324,0x3f7baccd,0x3f800000,0x3f7f6ac7,0x3f7dabcc,0x3f7ac516
.long 0x3f800000,0x3f7f4e6d,0x3f7d3aac,0x3f79c79d,0x3f800000,0x3f7f2f9d,0x3f7cbfc9,0x3f78b47b
.long 0x3f800000,0x3f7f0e58,0x3f7c3b28,0x3f778bc5,0x3f800000,0x3f7eea9d,0x3f7baccd,0x3f764d97
.long 0x3f800000,0x3f7ec46d,0x3f7b14be,0x3f74fa0b,0x3f800000,0x3f7e9bc9,0x3f7a7302,0x3f73913f
.long 0x3f800000,0x3f7e70b0,0x3f79c79d,0x3f721352,0x3f800000,0x3f7e4323,0x3f791298,0x3f708066
.long 0x3f800000,0x3f7e1324,0x3f7853f8,0x3f6ed89e,0x3f800000,0x3f7de0b1,0x3f778bc5,0x3f6d1c1d
.long 0x3f800000,0x3f7dabcc,0x3f76ba07,0x3f6b4b0c,0x3f800000,0x3f7d7474,0x3f75dec6,0x3f696591
.long 0x3f800000,0x3f7d3aac,0x3f74fa0b,0x3f676bd8,0x3f800000,0x3f7cfe73,0x3f740bdd,0x3f655e0b
.long 0x3f800000,0x3f7cbfc9,0x3f731447,0x3f633c5a,0x3f800000,0x3f7c7eb0,0x3f721352,0x3f6106f2
.long 0x3f800000,0x3f7c3b28,0x3f710908,0x3f5ebe05,0x3f800000,0x3f7bf531,0x3f6ff573,0x3f5c61c7
.long 0x3f800000,0x3f7baccd,0x3f6ed89e,0x3f59f26a,0x3f800000,0x3f7b61fc,0x3f6db293,0x3f577026
.long 0x3f800000,0x3f800000,0x3f800000,0x3f800000,0x3f7fec43,0x3f7fe129,0x3f7fd397,0x3f7fc38f
.long 0x3f7fb10f,0x3f7f84ab,0x3f7f4e6d,0x3f7f0e58,0x3f7f4e6d,0x3f7eea9d,0x3f7e70b0,0x3f7de0b1
.long 0x3f7ec46d,0x3f7e1324,0x3f7d3aac,0x3f7c3b28,0x3f7e1324,0x3f7cfe73,0x3f7baccd,0x3f7a1e84
.long 0x3f7d3aac,0x3f7baccd,0x3f79c79d,0x3f778bc5,0x3f7c3b28,0x3f7a1e84,0x3f778bc5,0x3f748422
.long 0x3f7b14be,0x3f7853f8,0x3f74fa0b,0x3f710908,0x3f79c79d,0x3f764d97,0x3f721352,0x3f6d1c1d
.long 0x3f7853f8,0x3f740bdd,0x3f6ed89e,0x3f68bf3c,0x3f76ba07,0x3f718f57,0x3f6b4b0c,0x3f63f473
.long 0x3f74fa0b,0x3f6ed89e,0x3f676bd8,0x3f5ebe05,0x3f731447,0x3f6be858,0x3f633c5a,0x3f591e6a
.long 0x3f710908,0x3f68bf3c,0x3f5ebe05,0x3f531849,0x3f6ed89e,0x3f655e0b,0x3f59f26a,0x3f4cae79
.long 0x3f6c835e,0x3f61c598,0x3f54db31,0x3f45e403,0x3f6a09a7,0x3f5df6be,0x3f4f7a1f,0x3f3ebc1b
.long 0x3f676bd8,0x3f59f26a,0x3f49d112,0x3f373a23,0x3f64aa59,0x3f55b993,0x3f43e200,0x3f2f61a5
.long 0x3f61c598,0x3f514d3d,0x3f3daef9,0x3f273656,0x3f5ebe05,0x3f4cae79,0x3f373a23,0x3f1ebc12
.long 0x3f5b941a,0x3f47de65,0x3f3085bb,0x3f15f6d9,0x3f584853,0x3f42de29,0x3f299415,0x3f0cead0
.long 0x3f54db31,0x3f3daef9,0x3f226799,0x3f039c3d,0x3f514d3d,0x3f385216,0x3f1b02c6,0x3ef41f07
.long 0x3f4d9f02,0x3f32c8c9,0x3f13682a,0x3ee0924f,0x3f49d112,0x3f2d1469,0x3f0b9a6b,0x3ecc9b8b
.long 0x3f45e403,0x3f273656,0x3f039c3d,0x3eb8442a,0x3f41d870,0x3f212ff9,0x3ef6e0cb,0x3ea395c5
.long 0x3f3daef9,0x3f1b02c6,0x3ee63375,0x3e8e9a22,0x3f396842,0x3f14b039,0x3ed53641,0x3e72b651
.long 0x3f800000,0x3f800000,0x3f800000,0x3f800000,0x3f7fb10f,0x3f7f9c18,0x3f7f84ab,0x3f7f6ac7
.long 0x3f7ec46d,0x3f7e70b0,0x3f7e1324,0x3f7dabcc,0x3f7d3aac,0x3f7c7eb0,0x3f7baccd,0x3f7ac516
.long 0x3f7b14be,0x3f79c79d,0x3f7853f8,0x3f76ba07,0x3f7853f8,0x3f764d97,0x3f740bdd,0x3f718f57
.long 0x3f74fa0b,0x3f721352,0x3f6ed89e,0x3f6b4b0c,0x3f710908,0x3f6d1c1d,0x3f68bf3c,0x3f63f473
.long 0x3f6c835e,0x3f676bd8,0x3f61c598,0x3f5b941a,0x3f676bd8,0x3f6106f2,0x3f59f26a,0x3f5233c6
.long 0x3f61c598,0x3f59f26a,0x3f514d3d,0x3f47de65,0x3f5b941a,0x3f5233c6,0x3f47de65,0x3f3ca003
.long 0x3f54db31,0x3f49d112,0x3f3daef9,0x3f3085bb,0x3f4d9f02,0x3f40d0da,0x3f32c8c9,0x3f239da9
.long 0x3f45e403,0x3f373a23,0x3f273656,0x3f15f6d9,0x3f3daef9,0x3f2d1469,0x3f1b02c6,0x3f07a136
.long 0x3f3504f3,0x3f226799,0x3f0e39da,0x3ef15aea,0x3f2beb4a,0x3f173c07,0x3f00e7e4,0x3ed25a09
.long 0x3f226799,0x3f0b9a6b,0x3ee63375,0x3eb263ef,0x3f187fc0,0x3eff17b2,0x3ec9b953,0x3e919ddd
.long 0x3f0e39da,0x3ee63375,0x3eac7cd4,0x3e605c13,0x3f039c3d,0x3ecc9b8b,0x3e8e9a22,0x3e1c76de
.long 0x3ef15aea,0x3eb263ef,0x3e605c13,0x3dafb680,0x3edae880,0x3e97a117,0x3e22abb6,0x3c96c9b6
.long 0x3ec3ef15,0x3e78cfcc,0x3dc8bd36,0xbd48fb30,0x3eac7cd4,0x3e419b37,0x3d16c32c,0xbdee3876
.long 0x3e94a031,0x3e09cf86,0xbcc90ab0,0xbe3b6ecf,0x3e78cfcc,0x3da3308c,0xbdafb680,0xbe7ee6e1
.long 0x3e47c5c2,0x3cc90ab0,0xbe164083,0xbea09ae5,0x3e164083,0xbcfb49ba,0xbe541501,0xbec1071e
.long 0x3dc8bd36,0xbdafb680,0xbe888e93,0xbee0924f,0x3d48fb30,0xbe1008b7,0xbea68f12,0xbeff17b2
.long 0x3f800000,0x3f800000,0x3f800000,0x3f800000,0x3f7f4e6d,0x3f7f2f9d,0x3f7f0e58,0x3f7eea9d
.long 0x3f7d3aac,0x3f7cbfc9,0x3f7c3b28,0x3f7baccd,0x3f79c79d,0x3f78b47b,0x3f778bc5,0x3f764d97
.long 0x3f74fa0b,0x3f731447,0x3f710908,0x3f6ed89e,0x3f6ed89e,0x3f6be858,0x3f68bf3c,0x3f655e0b
.long 0x3f676bd8,0x3f633c5a,0x3f5ebe05,0x3f59f26a,0x3f5ebe05,0x3f591e6a,0x3f531849,0x3f4cae79
.long 0x3f54db31,0x3f4d9f02,0x3f45e403,0x3f3daef9,0x3f49d112,0x3f40d0da,0x3f373a23,0x3f2d1469
.long 0x3f3daef9,0x3f32c8c9,0x3f273656,0x3f1b02c6,0x3f3085bb,0x3f239da9,0x3f15f6d9,0x3f07a136
.long 0x3f226799,0x3f13682a,0x3f039c3d,0x3ee63375,0x3f13682a,0x3f0242b1,0x3ee0924f,0x3ebb31a0
.long 0x3f039c3d,0x3ee0924f,0x3eb8442a,0x3e8e9a22,0x3ee63375,0x3ebb31a0,0x3e8e9a22,0x3e419b37
.long 0x3ec3ef15,0x3e94a031,0x3e47c5c2,0x3dc8bd36,0x3ea09ae5,0x3e5a3997,0x3de1bc2e,0x3bc90f88
.long 0x3e78cfcc,0x3e09cf86,0x3cc90ab0,0xbdafb680,0x3e2f10a2,0x3d621469,0xbd7b2b74,0xbe354098
.long 0x3dc8bd36,0xbcc90ab0,0xbe164083,0xbe888e93,0x3cc90ab0,0xbdd53db9,0xbe6c9a7f,0xbeb554ec
.long 0xbd48fb30,0xbe3b6ecf,0xbea09ae5,0xbee0924f,0xbdfab273,0xbe8586ce,0xbec9b953,0xbf04f484
.long 0xbe47c5c2,0xbeac7cd4,0xbef15aea,0xbf187fc0,0xbe888e93,0xbed25a09,0xbf0b9a6b,0xbf2ac082
.long 0xbeac7cd4,0xbef6e0cb,0xbf1d7fd1,0xbf3b8f3b,0xbecf7bca,0xbf0cead0,0xbf2e3bde,0xbf4ac77f
.long 0xbef15aea,0xbf1d7fd1,0xbf3daef9,0xbf584853,0xbf08f59b,0xbf2d1469,0xbf4bbbf8,0xbf63f473
.long 0xbf187fc0,0xbf3b8f3b,0xbf584853,0xbf6db293,0xbf273656,0xbf48d8b3,0xbf633c5a,0xbf756d97
.long 0x3f800000,0x3f800000,0x3f800000,0x3f800000,0x3f7ec46d,0x3f7e9bc9,0x3f7e70b0,0x3f7e4323
.long 0x3f7b14be,0x3f7a7302,0x3f79c79d,0x3f791298,0x3f74fa0b,0x3f73913f,0x3f721352,0x3f708066
.long 0x3f6c835e,0x3f6a09a7,0x3f676bd8,0x3f64aa59,0x3f61c598,0x3f5df6be,0x3f59f26a,0x3f55b993
.long 0x3f54db31,0x3f4f7a1f,0x3f49d112,0x3f43e200,0x3f45e403,0x3f3ebc1b,0x3f373a23,0x3f2f61a5
.long 0x3f3504f3,0x3f2beb4a,0x3f226799,0x3f187fc0,0x3f226799,0x3f173c07,0x3f0b9a6b,0x3eff17b2
.long 0x3f0e39da,0x3f00e7e4,0x3ee63375,0x3ec9b953,0x3ef15aea,0x3ed25a09,0x3eb263ef,0x3e919ddd
.long 0x3ec3ef15,0x3ea09ae5,0x3e78cfcc,0x3e2f10a2,0x3e94a031,0x3e5a3997,0x3e09cf86,0x3d621469
.long 0x3e47c5c2,0x3de1bc2e,0x3cc90ab0,0xbd7b2b74,0x3dc8bd36,0x3bc90f88,0xbdafb680,0xbe354098
.long 0x248d3132,0xbdc8bd36,0xbe47c5c2,0xbe94a031,0xbdc8bd36,0xbe4dee60,0xbe9aa086,0xbecc9b8b
.long 0xbe47c5c2,0xbe9aa086,0xbecf7bca,0xbf00e7e4,0xbe94a031,0xbecc9b8b,0xbf00e7e4,0xbf19c200
.long 0xbec3ef15,0xbefc5d27,0xbf187fc0,0xbf3085bb,0xbef15aea,0xbf14b039,0xbf2e3bde,0xbf44e3f5
.long 0xbf0e39da,0xbf299415,0xbf41d870,0xbf5695e5,0xbf226799,0xbf3ca003,0xbf531849,0xbf655e0b
.long 0xbf3504f3,0xbf4d9f02,0xbf61c598,0xbf710908,0xbf45e403,0xbf5c61c7,0xbf6db293,0xbf796e4e
.long 0xbf54db31,0xbf68bf3c,0xbf76ba07,0xbf7e70b0,0xbf61c598,0xbf7294f8,0xbf7cbfc9,0xbf7ffec4
.long 0xbf6c835e,0xbf79c79d,0xbf7fb10f,0xbf7e1324,0xbf74fa0b,0xbf7e4323,0xbf7f84ab,0xbf78b47b
.long 0xbf7b14be,0xbf7ffb11,0xbf7c3b28,0xbf6ff573,0xbf7ec46d,0xbf7eea9d,0xbf75dec6,0xbf63f473
.long 0x3f800000,0x3f800000,0x3f800000,0x3f800000,0x3f7e1324,0x3f7de0b1,0x3f7dabcc,0x3f7d7474
.long 0x3f7853f8,0x3f778bc5,0x3f76ba07,0x3f75dec6,0x3f6ed89e,0x3f6d1c1d,0x3f6b4b0c,0x3f696591
.long 0x3f61c598,0x3f5ebe05,0x3f5b941a,0x3f584853,0x3f514d3d,0x3f4cae79,0x3f47de65,0x3f42de29
.long 0x3f3daef9,0x3f373a23,0x3f3085bb,0x3f299415,0x3f273656,0x3f1ebc12,0x3f15f6d9,0x3f0cead0
.long 0x3f0e39da,0x3f039c3d,0x3ef15aea,0x3edae880,0x3ee63375,0x3ecc9b8b,0x3eb263ef,0x3e97a117
.long 0x3eac7cd4,0x3e8e9a22,0x3e605c13,0x3e22abb6,0x3e605c13,0x3e1c76de,0x3dafb680,0x3c96c9b6
.long 0x3dc8bd36,0x3cc90ab0,0xbd48fb30,0xbdfab273,0xbcc90ab0,0xbdd53db9,0xbe3b6ecf,0xbe8586ce
.long 0xbe164083,0xbe6c9a7f,0xbea09ae5,0xbec9b953,0xbe888e93,0xbeb554ec,0xbee0924f,0xbf04f484
.long 0xbec3ef15,0xbef15aea,0xbf0e39da,0xbf226799,0xbefc5d27,0xbf14b039,0xbf299415,0xbf3ca003
.long 0xbf187fc0,0xbf2e3bde,0xbf41d870,0xbf531849,0xbf3085bb,0xbf44e3f5,0xbf5695e5,0xbf655e0b
.long 0xbf45e403,0xbf584853,0xbf676bd8,0xbf731447,0xbf584853,0xbf6816a8,0xbf740bdd,0xbf7bf531
.long 0xbf676bd8,0xbf740bdd,0xbf7c3b28,0xbf7fd397,0xbf731447,0xbf7bf531,0xbf7fd397,0xbf7e9bc9
.long 0xbf7b14be,0xbf7fb10f,0xbf7ec46d,0xbf7853f8,0xbf7f4e6d,0xbf7f2f9d,0xbf791298,0xbf6d1c1d
.long 0xbf7fb10f,0xbf7a7302,0xbf6ed89e,0xbf5d2d53,0xbf7c3b28,0xbf718f57,0xbf604621,0xbf48d8b3
.long 0xbf74fa0b,0xbf64aa59,0xbf4d9f02,0xbf3085bb,0xbf6a09a7,0xbf53fac3,0xbf373a23,0xbf14b039
.long 0xbf5b941a,0xbf3fc767,0xbf1d7fd1,0xbeebcbbb,0xbf49d112,0xbf286605,0xbf00e7e4,0xbea986c4
.long 0x3f800000,0x3f800000,0x3f800000,0x3f800000,0x3f7d3aac,0x3f7cfe73,0x3f7cbfc9,0x3f7c7eb0
.long 0x3f74fa0b,0x3f740bdd,0x3f731447,0x3f721352,0x3f676bd8,0x3f655e0b,0x3f633c5a,0x3f6106f2
.long 0x3f54db31,0x3f514d3d,0x3f4d9f02,0x3f49d112,0x3f3daef9,0x3f385216,0x3f32c8c9,0x3f2d1469
.long 0x3f226799,0x3f1b02c6,0x3f13682a,0x3f0b9a6b,0x3f039c3d,0x3ef41f07,0x3ee0924f,0x3ecc9b8b
.long 0x3ec3ef15,0x3eac7cd4,0x3e94a031,0x3e78cfcc,0x3e78cfcc,0x3e419b37,0x3e09cf86,0x3da3308c
.long 0x3dc8bd36,0x3d16c32c,0xbcc90ab0,0xbdafb680,0xbd48fb30,0xbdee3876,0xbe3b6ecf,0xbe7ee6e1
.long 0xbe47c5c2,0xbe888e93,0xbeac7cd4,0xbecf7bca,0xbeac7cd4,0xbed25a09,0xbef6e0cb,0xbf0cead0
.long 0xbef15aea,0xbf0b9a6b,0xbf1d7fd1,0xbf2e3bde,0xbf187fc0,0xbf2ac082,0xbf3b8f3b,0xbf4ac77f
.long 0xbf3504f3,0xbf45e403,0xbf54db31,0xbf61c598,0xbf4d9f02,0xbf5c61c7,0xbf68bf3c,0xbf7294f8
.long 0xbf61c598,0xbf6db293,0xbf76ba07,0xbf7cbfc9,0xbf710908,0xbf796e4e,0xbf7e70b0,0xbf7ffec4
.long 0xbf7b14be,0xbf7f4e6d,0xbf7fb10f,0xbf7c3b28,0xbf7fb10f,0xbf7f2f9d,0xbf7a7302,0xbf718f57
.long 0xbf7ec46d,0xbf791298,0xbf6ed89e,0xbf604621,0xbf7853f8,0xbf6d1c1d,0xbf5d2d53,0xbf48d8b3
.long 0xbf6c835e,0xbf5b941a,0xbf45e403,0xbf2beb4a,0xbf5b941a,0xbf44e3f5,0xbf299415,0xbf0a48ad
.long 0xbf45e403,0xbf299415,0xbf08f59b,0xbec9b953,0xbf2beb4a,0xbf0a48ad,0xbec9b953,0xbe72b651
.long 0xbf0e39da,0xbecf7bca,0xbe78cfcc,0xbd96a905,0xbedae880,0xbe8586ce,0xbdafb680,0x3dbc3ac3
.long 0xbe94a031,0xbde1bc2e,0x3d96a905,0x3e827dc0,0xbe164083,0x3d2fe007,0x3e6c9a7f,0x3ed25a09
.long 0x3f800000,0x3f800000,0x3f800000,0x3f800000,0x3f7c3b28,0x3f7bf531,0x3f7baccd,0x3f7b61fc
.long 0x3f710908,0x3f6ff573,0x3f6ed89e,0x3f6db293,0x3f5ebe05,0x3f5c61c7,0x3f59f26a,0x3f577026
.long 0x3f45e403,0x3f41d870,0x3f3daef9,0x3f396842,0x3f273656,0x3f212ff9,0x3f1b02c6,0x3f14b039
.long 0x3f039c3d,0x3ef6e0cb,0x3ee63375,0x3ed53641,0x3eb8442a,0x3ea395c5,0x3e8e9a22,0x3e72b651
.long 0x3e47c5c2,0x3e164083,0x3dc8bd36,0x3d48fb30,0x3cc90ab0,0xbcfb49ba,0xbdafb680,0xbe1008b7
.long 0xbe164083,0xbe541501,0xbe888e93,0xbea68f12,0xbea09ae5,0xbec1071e,0xbee0924f,0xbeff17b2
.long 0xbef15aea,0xbf08f59b,0xbf187fc0,0xbf273656,0xbf1d7fd1,0xbf2d1469,0xbf3b8f3b,0xbf48d8b3
.long 0xbf3daef9,0xbf4bbbf8,0xbf584853,0xbf633c5a,0xbf584853,0xbf63f473,0xbf6db293,0xbf756d97
.long 0xbf6c835e,0xbf74fa0b,0xbf7b14be,0xbf7ec46d,0xbf79c79d,0xbf7e4323,0xbf7ffb11,0xbf7eea9d
.long 0xbf7fb10f,0xbf7f84ab,0xbf7c3b28,0xbf75dec6,0xbf7e1324,0xbf78b47b,0xbf6ff573,0xbf63f473
.long 0xbf74fa0b,0xbf6a09a7,0xbf5b941a,0xbf49d112,0xbf64aa59,0xbf53fac3,0xbf3fc767,0xbf286605
.long 0xbf4d9f02,0xbf373a23,0xbf1d7fd1,0xbf00e7e4,0xbf3085bb,0xbf14b039,0xbeebcbbb,0xbea986c4
.long 0xbf0e39da,0xbedae880,0xbe94a031,0xbe164083,0xbecf7bca,0xbe8586ce,0xbde1bc2e,0x3d2fe007
.long 0xbe78cfcc,0xbdafb680,0x3d96a905,0x3e6c9a7f,0xbd96a905,0x3dbc3ac3,0x3e827dc0,0x3ed25a09
.long 0x3dc8bd36,0x3e888e93,0x3edae880,0x3f13682a,0x3e888e93,0x3eddbe79,0x3f15f6d9,0x3f385216
.long 0x3edae880,0x3f15f6d9,0x3f396842,0x3f5695e5,0x3f13682a,0x3f385216,0x3f5695e5,0x3f6d1c1d
.long 0x80000000,0x80000000,0x80000000,0x80000000,0x80000000,0x3bc90f88,0x3c490e90,0x3c96c9b6
.long 0x80000000,0x3c490e90,0x3cc90ab0,0x3d16c32c,0x80000000,0x3c96c9b6,0x3d16c32c,0x3d621469
.long 0x80000000,0x3cc90ab0,0x3d48fb30,0x3d96a905,0x80000000,0x3cfb49ba,0x3d7b2b74,0x3dbc3ac3
.long 0x80000000,0x3d16c32c,0x3d96a905,0x3de1bc2e,0x80000000,0x3d2fe007,0x3dafb680,0x3e039502
.long 0x80000000,0x3d48fb30,0x3dc8bd36,0x3e164083,0x80000000,0x3d621469,0x3de1bc2e,0x3e28defc
.long 0x80000000,0x3d7b2b74,0x3dfab273,0x3e3b6ecf,0x80000000,0x3d8a200a,0x3e09cf86,0x3e4dee60
.long 0x80000000,0x3d96a905,0x3e164083,0x3e605c13,0x80000000,0x3da3308c,0x3e22abb6,0x3e72b651
.long 0x80000000,0x3dafb680,0x3e2f10a2,0x3e827dc0,0x80000000,0x3dbc3ac3,0x3e3b6ecf,0x3e8b9507
.long 0x80000000,0x3dc8bd36,0x3e47c5c2,0x3e94a031,0x80000000,0x3dd53db9,0x3e541501,0x3e9d9e78
.long 0x80000000,0x3de1bc2e,0x3e605c13,0x3ea68f12,0x80000000,0x3dee3876,0x3e6c9a7f,0x3eaf713a
.long 0x80000000,0x3dfab273,0x3e78cfcc,0x3eb8442a,0x80000000,0x3e039502,0x3e827dc0,0x3ec1071e
.long 0x80000000,0x3e09cf86,0x3e888e93,0x3ec9b953,0x80000000,0x3e1008b7,0x3e8e9a22,0x3ed25a09
.long 0x80000000,0x3e164083,0x3e94a031,0x3edae880,0x80000000,0x3e1c76de,0x3e9aa086,0x3ee363fa
.long 0x80000000,0x3e22abb6,0x3ea09ae5,0x3eebcbbb,0x80000000,0x3e28defc,0x3ea68f12,0x3ef41f07
.long 0x80000000,0x3e2f10a2,0x3eac7cd4,0x3efc5d27,0x80000000,0x3e354098,0x3eb263ef,0x3f0242b1
.long 0x80000000,0x3e3b6ecf,0x3eb8442a,0x3f064b82,0x80000000,0x3e419b37,0x3ebe1d4a,0x3f0a48ad
.long 0x80000000,0x80000000,0x80000000,0x80000000,0x3cc90ab0,0x3cfb49ba,0x3d16c32c,0x3d2fe007
.long 0x3d48fb30,0x3d7b2b74,0x3d96a905,0x3dafb680,0x3d96a905,0x3dbc3ac3,0x3de1bc2e,0x3e039502
.long 0x3dc8bd36,0x3dfab273,0x3e164083,0x3e2f10a2,0x3dfab273,0x3e1c76de,0x3e3b6ecf,0x3e5a3997
.long 0x3e164083,0x3e3b6ecf,0x3e605c13,0x3e827dc0,0x3e2f10a2,0x3e5a3997,0x3e827dc0,0x3e97a117
.long 0x3e47c5c2,0x3e78cfcc,0x3e94a031,0x3eac7cd4,0x3e605c13,0x3e8b9507,0x3ea68f12,0x3ec1071e
.long 0x3e78cfcc,0x3e9aa086,0x3eb8442a,0x3ed53641,0x3e888e93,0x3ea986c4,0x3ec9b953,0x3ee900b7
.long 0x3e94a031,0x3eb8442a,0x3edae880,0x3efc5d27,0x3ea09ae5,0x3ec6d529,0x3eebcbbb,0x3f07a136
.long 0x3eac7cd4,0x3ed53641,0x3efc5d27,0x3f10d3cd,0x3eb8442a,0x3ee363fa,0x3f064b82,0x3f19c200
.long 0x3ec3ef15,0x3ef15aea,0x3f0e39da,0x3f226799,0x3ecf7bca,0x3eff17b2,0x3f15f6d9,0x3f2ac082
.long 0x3edae880,0x3f064b82,0x3f1d7fd1,0x3f32c8c9,0x3ee63375,0x3f0cead0,0x3f24d225,0x3f3a7ca4
.long 0x3ef15aea,0x3f13682a,0x3f2beb4a,0x3f41d870,0x3efc5d27,0x3f19c200,0x3f32c8c9,0x3f48d8b3
.long 0x3f039c3d,0x3f1ff6cb,0x3f396842,0x3f4f7a1f,0x3f08f59b,0x3f26050a,0x3f3fc767,0x3f55b993
.long 0x3f0e39da,0x3f2beb4a,0x3f45e403,0x3f5b941a,0x3f13682a,0x3f31a81d,0x3f4bbbf8,0x3f6106f2
.long 0x3f187fc0,0x3f373a23,0x3f514d3d,0x3f660f88,0x3f1d7fd1,0x3f3ca003,0x3f5695e5,0x3f6aab7b
.long 0x3f226799,0x3f41d870,0x3f5b941a,0x3f6ed89e,0x3f273656,0x3f46e22a,0x3f604621,0x3f7294f8
.long 0x3f2beb4a,0x3f4bbbf8,0x3f64aa59,0x3f75dec6,0x3f3085bb,0x3f5064af,0x3f68bf3c,0x3f78b47b
.long 0x80000000,0x80000000,0x80000000,0x80000000,0x3d48fb30,0x3d621469,0x3d7b2b74,0x3d8a200a
.long 0x3dc8bd36,0x3de1bc2e,0x3dfab273,0x3e09cf86,0x3e164083,0x3e28defc,0x3e3b6ecf,0x3e4dee60
.long 0x3e47c5c2,0x3e605c13,0x3e78cfcc,0x3e888e93,0x3e78cfcc,0x3e8b9507,0x3e9aa086,0x3ea986c4
.long 0x3e94a031,0x3ea68f12,0x3eb8442a,0x3ec9b953,0x3eac7cd4,0x3ec1071e,0x3ed53641,0x3ee900b7
.long 0x3ec3ef15,0x3edae880,0x3ef15aea,0x3f039c3d,0x3edae880,0x3ef41f07,0x3f064b82,0x3f121eb0
.long 0x3ef15aea,0x3f064b82,0x3f13682a,0x3f1ff6cb,0x3f039c3d,0x3f121eb0,0x3f1ff6cb,0x3f2d1469
.long 0x3f0e39da,0x3f1d7fd1,0x3f2beb4a,0x3f396842,0x3f187fc0,0x3f286605,0x3f373a23,0x3f44e3f5
.long 0x3f226799,0x3f32c8c9,0x3f41d870,0x3f4f7a1f,0x3f2beb4a,0x3f3ca003,0x3f4bbbf8,0x3f591e6a
.long 0x3f3504f3,0x3f45e403,0x3f54db31,0x3f61c598,0x3f3daef9,0x3f4e8d90,0x3f5d2d53,0x3f696591
.long 0x3f45e403,0x3f5695e5,0x3f64aa59,0x3f6ff573,0x3f4d9f02,0x3f5df6be,0x3f6b4b0c,0x3f756d97
.long 0x3f54db31,0x3f64aa59,0x3f710908,0x3f79c79d,0x3f5b941a,0x3f6aab7b,0x3f75dec6,0x3f7cfe73
.long 0x3f61c598,0x3f6ff573,0x3f79c79d,0x3f7f0e58,0x3f676bd8,0x3f748422,0x3f7cbfc9,0x3f7ff4e6
.long 0x3f6c835e,0x3f7853f8,0x3f7ec46d,0x3f7fb10f,0x3f710908,0x3f7b61fc,0x3f7fd397,0x3f7e4323
.long 0x3f74fa0b,0x3f7dabcc,0x3f7fec43,0x3f7baccd,0x3f7853f8,0x3f7f2f9d,0x3f7f0e58,0x3f77f110
.long 0x3f7b14be,0x3f7fec43,0x3f7d3aac,0x3f731447,0x3f7d3aac,0x3f7fe129,0x3f7a7302,0x3f6d1c1d
.long 0x3f7ec46d,0x3f7f0e58,0x3f76ba07,0x3f660f88,0x3f7fb10f,0x3f7d7474,0x3f721352,0x3f5df6be
.long 0x80000000,0x80000000,0x80000000,0x80000000,0x3d96a905,0x3da3308c,0x3dafb680,0x3dbc3ac3
.long 0x3e164083,0x3e22abb6,0x3e2f10a2,0x3e3b6ecf,0x3e605c13,0x3e72b651,0x3e827dc0,0x3e8b9507
.long 0x3e94a031,0x3ea09ae5,0x3eac7cd4,0x3eb8442a,0x3eb8442a,0x3ec6d529,0x3ed53641,0x3ee363fa
.long 0x3edae880,0x3eebcbbb,0x3efc5d27,0x3f064b82,0x3efc5d27,0x3f07a136,0x3f10d3cd,0x3f19c200
.long 0x3f0e39da,0x3f187fc0,0x3f226799,0x3f2beb4a,0x3f1d7fd1,0x3f286605,0x3f32c8c9,0x3f3ca003
.long 0x3f2beb4a,0x3f373a23,0x3f41d870,0x3f4bbbf8,0x3f396842,0x3f44e3f5,0x3f4f7a1f,0x3f591e6a
.long 0x3f45e403,0x3f514d3d,0x3f5b941a,0x3f64aa59,0x3f514d3d,0x3f5c61c7,0x3f660f88,0x3f6e46be
.long 0x3f5b941a,0x3f660f88,0x3f6ed89e,0x3f75dec6,0x3f64aa59,0x3f6e46be,0x3f75dec6,0x3f7b61fc
.long 0x3f6c835e,0x3f74fa0b,0x3f7b14be,0x3f7ec46d,0x3f731447,0x3f7a1e84,0x3f7e70b0,0x3f7ffec4
.long 0x3f7853f8,0x3f7dabcc,0x3f7fec43,0x3f7f0e58,0x3f7c3b28,0x3f7f9c18,0x3f7f84ab,0x3f7bf531
.long 0x3f7ec46d,0x3f7fec43,0x3f7d3aac,0x3f76ba07,0x3f7fec43,0x3f7e9bc9,0x3f791298,0x3f6f6830
.long 0x3f7fb10f,0x3f7baccd,0x3f731447,0x3f660f88,0x3f7e1324,0x3f772417,0x3f6b4b0c,0x3f5ac450
.long 0x3f7b14be,0x3f710908,0x3f61c598,0x3f4d9f02,0x3f76ba07,0x3f696591,0x3f5695e5,0x3f3ebc1b
.long 0x3f710908,0x3f604621,0x3f49d112,0x3f2e3bde,0x3f6a09a7,0x3f55b993,0x3f3b8f3b,0x3f1c420c
.long 0x3f61c598,0x3f49d112,0x3f2beb4a,0x3f08f59b,0x3f584853,0x3f3ca003,0x3f1b02c6,0x3ee900b7
.long 0x3f4d9f02,0x3f2e3bde,0x3f08f59b,0x3ebe1d4a,0x3f41d870,0x3f1ebc12,0x3eebcbbb,0x3e919ddd
.long 0x80000000,0x80000000,0x80000000,0x80000000,0x3dc8bd36,0x3dd53db9,0x3de1bc2e,0x3dee3876
.long 0x3e47c5c2,0x3e541501,0x3e605c13,0x3e6c9a7f,0x3e94a031,0x3e9d9e78,0x3ea68f12,0x3eaf713a
.long 0x3ec3ef15,0x3ecf7bca,0x3edae880,0x3ee63375,0x3ef15aea,0x3eff17b2,0x3f064b82,0x3f0cead0
.long 0x3f0e39da,0x3f15f6d9,0x3f1d7fd1,0x3f24d225,0x3f226799,0x3f2ac082,0x3f32c8c9,0x3f3a7ca4
.long 0x3f3504f3,0x3f3daef9,0x3f45e403,0x3f4d9f02,0x3f45e403,0x3f4e8d90,0x3f5695e5,0x3f5df6be
.long 0x3f54db31,0x3f5d2d53,0x3f64aa59,0x3f6b4b0c,0x3f61c598,0x3f696591,0x3f6ff573,0x3f756d97
.long 0x3f6c835e,0x3f731447,0x3f7853f8,0x3f7c3b28,0x3f74fa0b,0x3f7a1e84,0x3f7dabcc,0x3f7f9c18
.long 0x3f7b14be,0x3f7e70b0,0x3f7fec43,0x3f7f84ab,0x3f7ec46d,0x3f7ffec4,0x3f7f0e58,0x3f7bf531
.long 0x3f800000,0x3f7ec46d,0x3f7b14be,0x3f74fa0b,0x3f7ec46d,0x3f7ac516,0x3f740bdd,0x3f6aab7b
.long 0x3f7b14be,0x3f740bdd,0x3f6a09a7,0x3f5d2d53,0x3f74fa0b,0x3f6aab7b,0x3f5d2d53,0x3f4cae79
.long 0x3f6c835e,0x3f5ebe05,0x3f4d9f02,0x3f396842,0x3f61c598,0x3f5064af,0x3f3b8f3b,0x3f239da9
.long 0x3f54db31,0x3f3fc767,0x3f273656,0x3f0b9a6b,0x3f45e403,0x3f2d1469,0x3f10d3cd,0x3ee363fa
.long 0x3f3504f3,0x3f187fc0,0x3ef15aea,0x3eac7cd4,0x3f226799,0x3f0242b1,0x3ebe1d4a,0x3e667c66
.long 0x3f0e39da,0x3ed53641,0x3e888e93,0x3de1bc2e,0x3ef15aea,0x3ea395c5,0x3e22abb6,0xbbc90f88
.long 0x3ec3ef15,0x3e605c13,0x3d48fb30,0xbdfab273,0x3e94a031,0x3dee3876,0xbd7b2b74,0xbe72b651
.long 0x3e47c5c2,0x3c490e90,0xbe2f10a2,0xbeb263ef,0x3dc8bd36,0xbdbc3ac3,0xbe8e9a22,0xbee900b7
.long 0x80000000,0x80000000,0x80000000,0x80000000,0x3dfab273,0x3e039502,0x3e09cf86,0x3e1008b7
.long 0x3e78cfcc,0x3e827dc0,0x3e888e93,0x3e8e9a22,0x3eb8442a,0x3ec1071e,0x3ec9b953,0x3ed25a09
.long 0x3ef15aea,0x3efc5d27,0x3f039c3d,0x3f08f59b,0x3f13682a,0x3f19c200,0x3f1ff6cb,0x3f26050a
.long 0x3f2beb4a,0x3f32c8c9,0x3f396842,0x3f3fc767,0x3f41d870,0x3f48d8b3,0x3f4f7a1f,0x3f55b993
.long 0x3f54db31,0x3f5b941a,0x3f61c598,0x3f676bd8,0x3f64aa59,0x3f6aab7b,0x3f6ff573,0x3f748422
.long 0x3f710908,0x3f75dec6,0x3f79c79d,0x3f7cbfc9,0x3f79c79d,0x3f7cfe73,0x3f7f0e58,0x3f7ff4e6
.long 0x3f7ec46d,0x3f7fec43,0x3f7fb10f,0x3f7e1324,0x3f7fec43,0x3f7e9bc9,0x3f7baccd,0x3f772417
.long 0x3f7d3aac,0x3f791298,0x3f731447,0x3f6b4b0c,0x3f76ba07,0x3f6f6830,0x3f660f88,0x3f5ac450
.long 0x3f6c835e,0x3f61c598,0x3f54db31,0x3f45e403,0x3f5ebe05,0x3f5064af,0x3f3fc767,0x3f2d1469
.long 0x3f4d9f02,0x3f3b8f3b,0x3f273656,0x3f10d3cd,0x3f396842,0x3f239da9,0x3f0b9a6b,0x3ee363fa
.long 0x3f226799,0x3f08f59b,0x3edae880,0x3ea09ae5,0x3f08f59b,0x3ed8106b,0x3e9aa086,0x3e354098
.long 0x3edae880,0x3e9aa086,0x3e2f10a2,0x3d16c32c,0x3ea09ae5,0x3e354098,0x3d16c32c,0xbdd53db9
.long 0x3e47c5c2,0x3d48fb30,0xbdc8bd36,0xbe78cfcc,0x3d96a905,0xbda3308c,0xbe6c9a7f,0xbec1071e
.long 0xbd48fb30,0xbe541501,0xbeb8442a,0xbf00e7e4,0xbe2f10a2,0xbea986c4,0xbef6e0cb,0xbf1ebc12
.long 0xbe94a031,0xbee63375,0xbf187fc0,0xbf396842,0xbecf7bca,0xbf0f8784,0xbf32c8c9,0xbf5064af
.long 0xbf039c3d,0xbf299415,0xbf49d112,0xbf633c5a,0xbf1d7fd1,0xbf40d0da,0xbf5d2d53,0xbf718f57
.long 0x80000000,0x80000000,0x80000000,0x80000000,0x3e164083,0x3e1c76de,0x3e22abb6,0x3e28defc
.long 0x3e94a031,0x3e9aa086,0x3ea09ae5,0x3ea68f12,0x3edae880,0x3ee363fa,0x3eebcbbb,0x3ef41f07
.long 0x3f0e39da,0x3f13682a,0x3f187fc0,0x3f1d7fd1,0x3f2beb4a,0x3f31a81d,0x3f373a23,0x3f3ca003
.long 0x3f45e403,0x3f4bbbf8,0x3f514d3d,0x3f5695e5,0x3f5b941a,0x3f6106f2,0x3f660f88,0x3f6aab7b
.long 0x3f6c835e,0x3f710908,0x3f74fa0b,0x3f7853f8,0x3f7853f8,0x3f7b61fc,0x3f7dabcc,0x3f7f2f9d
.long 0x3f7ec46d,0x3f7fd397,0x3f7fec43,0x3f7f0e58,0x3f7fb10f,0x3f7e4323,0x3f7baccd,0x3f77f110
.long 0x3f7b14be,0x3f76ba07,0x3f710908,0x3f6a09a7,0x3f710908,0x3f696591,0x3f604621,0x3f55b993
.long 0x3f61c598,0x3f5695e5,0x3f49d112,0x3f3b8f3b,0x3f4d9f02,0x3f3ebc1b,0x3f2e3bde,0x3f1c420c
.long 0x3f3504f3,0x3f226799,0x3f0e39da,0x3ef15aea,0x3f187fc0,0x3f0242b1,0x3ed53641,0x3ea395c5
.long 0x3ef15aea,0x3ebe1d4a,0x3e888e93,0x3e22abb6,0x3eac7cd4,0x3e667c66,0x3de1bc2e,0xbbc90f88
.long 0x3e47c5c2,0x3d96a905,0xbd48fb30,0xbe2f10a2,0x3d48fb30,0xbda3308c,0xbe541501,0xbea986c4
.long 0xbdc8bd36,0xbe6c9a7f,0xbeb8442a,0xbef6e0cb,0xbe78cfcc,0xbec1071e,0xbf00e7e4,0xbf1ebc12
.long 0xbec3ef15,0xbf039c3d,0xbf226799,0xbf3daef9,0xbf039c3d,0xbf239da9,0xbf3fc767,0xbf577026
.long 0xbf226799,0xbf3fc767,0xbf584853,0xbf6b4b0c,0xbf3daef9,0xbf577026,0xbf6b4b0c,0xbf78b47b
.long 0xbf54db31,0xbf6a09a7,0xbf7853f8,0xbf7f4e6d,0xbf676bd8,0xbf772417,0xbf7f0e58,0xbf7eea9d
.long 0xbf74fa0b,0xbf7e70b0,0xbf7f4e6d,0xbf778bc5,0xbf7d3aac,0xbf7fc38f,0xbf791298,0xbf696591
.long 0x80000000,0x80000000,0x80000000,0x80000000,0x3e2f10a2,0x3e354098,0x3e3b6ecf,0x3e419b37
.long 0x3eac7cd4,0x3eb263ef,0x3eb8442a,0x3ebe1d4a,0x3efc5d27,0x3f0242b1,0x3f064b82,0x3f0a48ad
.long 0x3f226799,0x3f273656,0x3f2beb4a,0x3f3085bb,0x3f41d870,0x3f46e22a,0x3f4bbbf8,0x3f5064af
.long 0x3f5b941a,0x3f604621,0x3f64aa59,0x3f68bf3c,0x3f6ed89e,0x3f7294f8,0x3f75dec6,0x3f78b47b
.long 0x3f7b14be,0x3f7d3aac,0x3f7ec46d,0x3f7fb10f,0x3f7fec43,0x3f7fe129,0x3f7f0e58,0x3f7d7474
.long 0x3f7d3aac,0x3f7a7302,0x3f76ba07,0x3f721352,0x3f731447,0x3f6d1c1d,0x3f660f88,0x3f5df6be
.long 0x3f61c598,0x3f584853,0x3f4d9f02,0x3f41d870,0x3f49d112,0x3f3ca003,0x3f2e3bde,0x3f1ebc12
.long 0x3f2beb4a,0x3f1b02c6,0x3f08f59b,0x3eebcbbb,0x3f08f59b,0x3ee900b7,0x3ebe1d4a,0x3e919ddd
.long 0x3ec3ef15,0x3e94a031,0x3e47c5c2,0x3dc8bd36,0x3e605c13,0x3dee3876,0x3c490e90,0xbdbc3ac3
.long 0x3d48fb30,0xbd7b2b74,0xbe2f10a2,0xbe8e9a22,0xbdfab273,0xbe72b651,0xbeb263ef,0xbee900b7
.long 0xbe94a031,0xbecf7bca,0xbf039c3d,0xbf1d7fd1,0xbee63375,0xbf0f8784,0xbf299415,0xbf40d0da
.long 0xbf187fc0,0xbf32c8c9,0xbf49d112,0xbf5d2d53,0xbf396842,0xbf5064af,0xbf633c5a,0xbf718f57
.long 0xbf54db31,0xbf676bd8,0xbf74fa0b,0xbf7d3aac,0xbf6a09a7,0xbf772417,0xbf7e70b0,0xbf7fc38f
.long 0xbf7853f8,0xbf7f0e58,0xbf7f4e6d,0xbf791298,0xbf7f4e6d,0xbf7eea9d,0xbf778bc5,0xbf696591
.long 0xbf7ec46d,0xbf76ba07,0xbf676bd8,0xbf514d3d,0xbf76ba07,0xbf66becc,0xbf4f7a1f,0xbf31a81d
.long 0xbf676bd8,0xbf4f7a1f,0xbf3085bb,0xbf0b9a6b,0xbf514d3d,0xbf31a81d,0xbf0b9a6b,0xbec1071e
.size tab_f3, 16384
```
